```python
import torch

def _softmax(x, axis=-1):
    return torch.softmax(x, dim=axis)
def _gelu(x):
    return torch.nn.functional.gelu(x, approximate="tanh")
def _silu(x):
    return torch.nn.functional.silu(x)
def _sigmoid(x):
    return torch.sigmoid(x)
def _layernorm(x, axis=-1, eps=1e-5):
    m = x.mean(dim=axis, keepdim=True)
    v = x.var(dim=axis, keepdim=True, unbiased=False)
    return (x - m) / torch.sqrt(v + eps)
def _scatter_add(tgt, idx, src, axis=0):
    return tgt.clone().index_add_(axis, idx, src)
def _segment_sum(src, seg, n):
    out = torch.zeros((n,) + src.shape[1:], dtype=src.dtype)
    return out.index_add_(0, seg, src)
def _pad(x, pw):
    flat = tuple(v for pair in reversed(pw) for v in pair)
    return torch.nn.functional.pad(x, flat)

kernel_name = 'recurrent_scan__sliding_block_cached__glu_gated_geglu__prompt'

def setup_inputs():

    _w = (lambda a: (lambda t: t.to(torch.bfloat16) if t.is_floating_point() else t)(torch.as_tensor(a)))
    def _A_setup():
        B, Sq, D = 1, 2048, 448
        Hq, Hkv, Sk, Dh = 16, 8, 2048, 256
        assert Hq % Hkv == 0, (Hq, Hkv)
        return {
            "x": _w((lambda *s: torch.randn(*s, dtype=torch.bfloat16) * 0.2)(B, Sq, D)),
            "k_cache": _w((lambda *s: torch.randn(*s, dtype=torch.bfloat16) * 0.8)(B, Hkv, Sk, Dh)),
            "v_cache": _w((lambda *s: torch.randn(*s, dtype=torch.bfloat16) * 1.6)(B, Hkv, Sk, Dh)),
            "wq": _w((lambda *s: torch.randn(*s, dtype=torch.bfloat16) * 0.8)(D, Hq * Dh) * (D ** -0.5)),
            "wo": _w((lambda *s: torch.randn(*s, dtype=torch.bfloat16) * 1.6)(Hq * Dh, D) * ((Hq * Dh) ** -0.5)),
        }
    _A_in = _A_setup()

    def _B_setup():
        B, S, Dm, Df = 1, 2048, 448, 1792
        return {
            "x": _w((lambda *s: torch.randn(*s, dtype=torch.bfloat16) * 0.2)(B, S, Dm)),
            "w_gate": _w((lambda *s: torch.randn(*s, dtype=torch.bfloat16) * 0.8)(Dm, Df) * (Dm ** -0.5)),
            "w_up": _w((lambda *s: torch.randn(*s, dtype=torch.bfloat16) * 0.8)(Dm, Df) * (Dm ** -0.5)),
            "w_down": _w((lambda *s: torch.randn(*s, dtype=torch.bfloat16) * 0.8)(Df, Dm) * (Df ** -0.5)),
        }
    _B_in = _B_setup()

    return {
        "A_x": _A_in["x"],
        "A_k_cache": _A_in["k_cache"],
        "A_v_cache": _A_in["v_cache"],
        "A_wq": _A_in["wq"],
        "A_wo": _A_in["wo"],
        "B_x": _B_in["x"],
        "B_w_gate": _B_in["w_gate"],
        "B_w_up": _B_in["w_up"],
        "B_w_down": _B_in["w_down"],
    }

def reference(A_x, A_k_cache, A_v_cache, A_wq, A_wo, B_x, B_w_gate, B_w_up, B_w_down):
    def _A_ref(x, k_cache, v_cache, wq, wo):
        B, Sq, D = x.shape
        Hq, Dh = 16, 256
        Hkv, Sk = k_cache.shape[1], k_cache.shape[2]
        W = min(4096, max(256, Sk // 4))
        rep = Hq // Hkv
        q = (lambda x, *d: x.permute(*d))((x @ wq).reshape(B, Sq, Hq, Dh), 0, 2, 1, 3)
        k = (lambda x, n, axis: torch.repeat_interleave(x, n, dim=axis))(k_cache[:, :, Sk - W:, :], rep, axis=1)
        v = (lambda x, n, axis: torch.repeat_interleave(x, n, dim=axis))(v_cache[:, :, Sk - W:, :], rep, axis=1)
        scores = torch.einsum("bhqd,bhkd->bhqk", q, k) * (Dh ** -0.5)
        p = _softmax(scores, axis=-1)
        o = torch.einsum("bhqk,bhkd->bhqd", p, v)
        return (lambda x, *d: x.permute(*d))(o, 0, 2, 1, 3).reshape(B, Sq, Hq * Dh) @ wo

    def _B_ref(x, w_gate, w_up, w_down):
        g = torch.einsum("bsd,df->bsf", x, w_gate)
        u = torch.einsum("bsd,df->bsf", x, w_up)
        h = _gelu(g) * u
        return torch.einsum("bsf,fd->bsd", h, w_down)

    x = A_x
    xn = _layernorm(x, axis=-1)
    s = _A_ref(xn, A_k_cache, A_v_cache, A_wq, A_wo)
    g = _silu(_B_ref(xn, B_w_gate, B_w_up, B_w_down))
    return x + s * g
```

```asm
; @launch grid=(256,1,1) block=(256,1,1) lds=163840
.amdgcn_target "amdgcn-amd-amdhsa--gfx950"
.text
.globl recurrent_scan__sliding_block_cached__glu_gated_geglu__prompt_kernel
.p2align 8
.type recurrent_scan__sliding_block_cached__glu_gated_geglu__prompt_kernel,@function
recurrent_scan__sliding_block_cached__glu_gated_geglu__prompt_kernel:
    s_cmp_ge_u32 s2, 256
    s_cbranch_scc1 L_main_end
    s_load_dwordx16 s[64:79], s[0:1], 0
    s_load_dwordx8 s[80:87], s[0:1], 64
    s_getpc_b64 s[92:93]
L_pc_here:
    s_and_b32 s93, s93, 0xffff
    s_mov_b32 s94, L_all_code_end-L_pc_here
    s_mov_b32 s95, 0x00020000
    s_lshr_b32 s96, s2, 3
    s_and_b32 s96, s96, 3
    s_lshl_b32 s96, s96, 15
    v_lshlrev_b32 v255, 7, v0
    buffer_load_dword v198, v255, s[92:95], s96 offen offset:0
    v_and_b32 v249, 63, v0
    v_lshrrev_b32 v252, 6, v0
    v_and_b32 v250, 15, v249
    v_readfirstlane_b32 s38, v252
    v_lshrrev_b32 v251, 4, v249
    v_lshrrev_b32 v243, 3, v249
    v_lshlrev_b32 v240, 4, v249
    s_and_b32 s36, s2, 7
    s_lshr_b32 s37, s2, 3
    s_and_b32 s41, s36, 1
    s_and_b32 s40, s38, 1
    s_lshr_b32 s39, s38, 1
    s_lshl_b32 s42, s38, 12
    v_and_b32 v253, 7, v249
    v_lshlrev_b32 v254, 4, v253
    s_mov_b32 s98, 896
    v_mad_u32_u24 v252, v243, s98, v254
    s_waitcnt lgkmcnt(0)
    s_mov_b32 s4, s64
    s_mov_b32 s5, s65
    s_mov_b32 s6, 1835008
    s_mov_b32 s7, 0x00020000
    s_mul_i32 s98, s37, 57344
    s_mul_i32 s99, s38, 14336
    s_add_u32 s98, s98, s99
    s_add_u32 s99, s98, 7168
    s_cmp_eq_u32 s40, 0
    s_cselect_b32 s8, s76, s78
    s_cselect_b32 s9, s77, s79
    s_mov_b32 s10, 1605632
    s_mov_b32 s11, 0x00020000
    buffer_load_dwordx4 v[0:3], v252, s[4:7], s98 offen offset:0
    buffer_load_dwordx4 v[4:7], v252, s[4:7], s98 offen offset:128
    buffer_load_dwordx4 v[8:11], v252, s[4:7], s98 offen offset:256
    buffer_load_dwordx4 v[12:15], v252, s[4:7], s98 offen offset:384
    buffer_load_dwordx4 v[16:19], v252, s[4:7], s98 offen offset:512
    buffer_load_dwordx4 v[20:23], v252, s[4:7], s98 offen offset:640
    buffer_load_dwordx4 v[24:27], v252, s[4:7], s98 offen offset:768
    buffer_load_dwordx4 v[28:31], v252, s[4:7], s99 offen offset:0
    buffer_load_dwordx4 v[32:35], v252, s[4:7], s99 offen offset:128
    buffer_load_dwordx4 v[36:39], v252, s[4:7], s99 offen offset:256
    buffer_load_dwordx4 v[40:43], v252, s[4:7], s99 offen offset:384
    buffer_load_dwordx4 v[44:47], v252, s[4:7], s99 offen offset:512
    buffer_load_dwordx4 v[48:51], v252, s[4:7], s99 offen offset:640
    buffer_load_dwordx4 v[52:55], v252, s[4:7], s99 offen offset:768
    v_mov_b32 v90, 0x7ffffff0
    s_lshl_b32 s64, s37, 1
    s_add_u32 s64, s64, s39
    s_mul_i32 s43, s36, 7
    s_lshr_b32 s43, s43, 1
    s_lshl_b32 s43, s43, 7
    s_mul_i32 s65, s64, 28
    v_add_u32 v88, s65, v249
    v_lshrrev_b32 v89, 2, v88
    v_and_b32 v88, 3, v88
    s_mov_b32 s65, 3584
    v_lshlrev_b32 v88, 7, v88
    v_mad_u32_u24 v91, v89, s65, v88
    v_cmp_gt_u32 vcc, 28, v249
    s_nop 0
    s_nop 0
    v_cndmask_b32 v91, v90, v91, vcc
    buffer_load_dword v198, v91, s[8:11], s43 offen offset:0
    s_mov_b32 s12, s70
    s_mov_b32 s13, s71
    s_mov_b32 s14, 3670016
    s_mov_b32 s15, 0x00020000
    s_mov_b32 s16, s80
    s_mov_b32 s17, s81
    s_mov_b32 s18, 1605632
    s_mov_b32 s19, 0x00020000
    s_mov_b32 s28, s72
    s_mov_b32 s29, s73
    s_mov_b32 s30, 3670016
    s_mov_b32 s31, 0x00020000
    s_mov_b32 s32, s86
    s_mov_b32 s33, s87
    s_mov_b32 s34, 29392896
    s_mov_b32 s35, 0x00020000
    s_lshl_b32 s100, s36, 20
    s_add_u32 s100, s100, 786432
    s_add_u32 s20, s66, s100
    s_addc_u32 s21, s67, 0
    s_mov_b32 s22, 262144
    s_mov_b32 s23, 0x00020000
    s_lshl_b32 s100, s36, 20
    s_add_u32 s100, s100, 786432
    s_add_u32 s24, s68, s100
    s_addc_u32 s25, s69, 0
    s_mov_b32 s26, 262144
    s_mov_b32 s27, 0x00020000
    v_lshrrev_b32 v254, 1, v243
    v_and_b32 v254, 3, v254
    v_lshlrev_b32 v254, 1, v254
    v_xor_b32 v254, v254, v253
    v_lshlrev_b32 v244, 4, v254
    s_and_b32 s100, s8, 0x0fffffff
    v_add_u32 v233, s100, v244
    s_mov_b32 s100, 3584
    v_mad_u32_u24 v232, v243, s100, v233
    v_add_u32 v233, 27648, v232
    v_add_u32 v234, 55296, v232
    v_add_u32 v235, 82944, v232
    s_mul_i32 s98, s36, 7
    s_lshr_b32 s98, s98, 1
    s_lshl_b32 s98, s98, 7
    s_mul_i32 s99, s39, 114688
    s_add_u32 s98, s98, s99
    s_mul_i32 s99, s41, 0x180
    s_add_u32 s99, s99, 0
    s_add_u32 s44, s98, s99
    s_mul_i32 s99, s41, 0x80
    s_add_u32 s99, s99, 128
    s_add_u32 s45, s98, s99
    s_mul_i32 s99, s41, 0xffffff80
    s_add_u32 s99, s99, 256
    s_add_u32 s46, s98, s99
    s_mul_i32 s99, s41, 0xfffffe80
    s_add_u32 s99, s99, 384
    s_add_u32 s47, s98, s99
    v_mov_b32 v90, 0x7ffffff0
    s_lshl_b32 s64, s37, 2
    s_add_u32 s64, s64, s38
    s_lshl_b32 s4, s36, 10
    s_mul_i32 s65, s64, 28
    v_add_u32 v88, s65, v249
    v_lshrrev_b32 v89, 3, v88
    v_and_b32 v88, 7, v88
    s_mov_b32 s65, 8192
    v_lshlrev_b32 v88, 7, v88
    v_mad_u32_u24 v132, v89, s65, v88
    v_cmp_gt_u32 vcc, 28, v249
    s_nop 0
    s_nop 0
    v_cndmask_b32 v132, v90, v132, vcc
    s_mul_i32 s5, s36, 200704
    s_mul_i32 s65, s64, 1664
    s_add_u32 s5, s5, s65
    v_lshlrev_b32 v133, 7, v249
    v_cmp_gt_u32 vcc, 13, v249
    s_nop 0
    s_nop 0
    v_cndmask_b32 v133, v90, v133, vcc
    s_mov_b32 s6, 0
    s_mul_i32 s65, s64, 2048
    s_add_u32 s6, s6, s65
    v_lshlrev_b32 v134, 7, v249
    v_cmp_gt_u32 vcc, 16, v249
    s_nop 0
    s_nop 0
    v_cndmask_b32 v134, v90, v134, vcc
    s_mov_b32 s7, 0
    s_mul_i32 s65, s64, 2048
    s_add_u32 s7, s7, s65
    v_lshlrev_b32 v135, 7, v249
    v_cmp_gt_u32 vcc, 16, v249
    s_nop 0
    s_nop 0
    v_cndmask_b32 v135, v90, v135, vcc
    s_mul_i32 s43, s36, 458752
    s_mul_i32 s65, s64, 3584
    s_add_u32 s43, s43, s65
    v_lshlrev_b32 v199, 7, v249
    v_cmp_gt_u32 vcc, 28, v249
    s_nop 0
    s_nop 0
    v_cndmask_b32 v199, v90, v199, vcc
    v_mov_b32 v94, 0x7ffffff0
    s_lshl_b32 s100, s38, 6
    v_add_u32 v253, s100, v249
    v_cmp_eq_u32 vcc, 0, v253
    s_nop 1
    v_cndmask_b32 v94, v94, 0, vcc
    s_lshl_b32 s98, s2, 7
    s_add_u32 s98, s98, 29360128
    v_mov_b32 v253, 0
    buffer_store_dword v253, v94, s[32:35], s98 offen offset:0 sc1
    s_lshl_b32 s98, s36, 1
    s_add_u32 s98, s98, s39
    s_lshl_b32 s98, s98, 9
    s_lshl_b32 s99, s40, 18
    s_add_u32 s48, s98, s99
    s_mul_i32 s98, s36, 200704
    s_mul_i32 s99, s40, 28672
    s_mul_i32 s100, s39, 0x300
    s_add_u32 s100, s100, 0
    s_add_u32 s49, s98, s100
    s_add_u32 s49, s49, s99
    s_mul_i32 s100, s39, 0x200
    s_add_u32 s100, s100, 128
    s_add_u32 s50, s98, s100
    s_add_u32 s50, s50, s99
    s_mul_i32 s100, s39, 0x100
    s_add_u32 s100, s100, 256
    s_add_u32 s51, s98, s100
    s_add_u32 s51, s51, s99
    s_mul_i32 s100, s39, 0x300
    s_add_u32 s100, s100, 0
    s_mul_i32 s52, s39, 0x200
    s_add_u32 s52, s52, 128
    s_cmp_eq_u32 s40, 0
    s_cselect_b32 s100, s100, s52
    s_add_u32 s52, s98, s100
    s_mul_i32 s100, s39, 0x100
    s_add_u32 s100, s100, 172288
    s_mul_i32 s53, s39, 0x7000
    s_add_u32 s53, s53, 384
    s_cmp_eq_u32 s40, 0
    s_cselect_b32 s100, s100, s53
    s_add_u32 s53, s98, s100
    s_mul_i32 s100, s38, 28672
    s_add_u32 s54, s98, s100
    s_add_u32 s54, s54, 384
    s_add_u32 s55, s98, 172416
    s_lshl_b32 s56, s38, 12
    s_lshl_b32 s57, s38, 7
    s_lshl_b32 s98, s36, 9
    s_lshl_b32 s99, s40, 5
    s_add_u32 s98, s98, s99
    s_lshl_b32 s99, s39, 8
    s_add_u32 s99, s98, s99
    s_mul_i32 s99, s99, 896
    s_xor_b32 s100, s39, 1
    s_lshl_b32 s100, s100, 8
    s_add_u32 s98, s98, s100
    s_mul_i32 s98, s98, 896
    s_mul_i32 s100, s39, 0x300
    s_add_u32 s100, s100, 0
    s_add_u32 s58, s99, s100
    s_add_u32 s61, s98, s100
    s_mul_i32 s100, s39, 0x200
    s_add_u32 s100, s100, 128
    s_add_u32 s59, s99, s100
    s_add_u32 s62, s98, s100
    s_mul_i32 s100, s39, 0x100
    s_add_u32 s100, s100, 256
    s_add_u32 s60, s99, s100
    s_add_u32 s63, s98, s100
    s_add_u32 s88, s99, 384
    s_mul_i32 s98, s2, 57344
    s_mul_i32 s99, s40, 28672
    s_add_u32 s89, s98, s99
    s_add_u32 s66, s89, 14680064
    s_mul_i32 s90, s39, 0x6000
    s_add_u32 s90, s90, 0
    s_mul_i32 s91, s39, 0x4000
    s_add_u32 s91, s91, 4096
    s_mul_i32 s92, s39, 0x2000
    s_add_u32 s92, s92, 8192
    s_mul_i32 s93, s39, 0x800
    s_add_u32 s93, s93, 12288
    s_mul_i32 s98, s41, 0x5
    s_add_u32 s98, s98, 0
    s_add_u32 s98, s98, s39
    s_lshl_b32 s94, s98, 12
    s_mul_i32 s98, s41, 0x1
    s_add_u32 s98, s98, 2
    s_add_u32 s98, s98, s39
    s_lshl_b32 s95, s98, 12
    s_mul_i32 s98, s41, 0xfffffffd
    s_add_u32 s98, s98, 4
    s_add_u32 s98, s98, s39
    s_lshl_b32 s96, s98, 12
    s_mul_i32 s98, s41, 0xffffa000
    s_add_u32 s98, s98, 24576
    s_lshl_b32 s99, s39, 3
    s_add_u32 s97, s98, s99
    s_mov_b32 s101, 0x47800000
    s_mov_b32 s3, 0x3f803f80
    v_bfe_u32 v252, v249, 2, 2
    v_lshl_add_u32 v253, v251, 2, v252
    v_lshrrev_b32 v254, 1, v253
    v_and_b32 v254, 3, v254
    v_and_b32 v255, 3, v249
    v_lshlrev_b32 v255, 3, v255
    v_lshl_add_u32 v255, v253, 7, v255
    v_xor_b32 v252, 0, v254
    v_lshl_add_u32 v224, v252, 5, v255
    v_add_u32 v228, 65536, v224
    v_xor_b32 v252, 1, v254
    v_lshl_add_u32 v225, v252, 5, v255
    v_add_u32 v229, 65536, v225
    v_xor_b32 v252, 2, v254
    v_lshl_add_u32 v226, v252, 5, v255
    v_add_u32 v230, 65536, v226
    v_xor_b32 v252, 3, v254
    v_lshl_add_u32 v227, v252, 5, v255
    v_add_u32 v231, 65536, v227
    s_lshl_b32 s98, s39, 13
    v_add_u32 v200, s98, v224
    v_add_u32 v201, s98, v225
    v_add_u32 v202, s98, v226
    v_add_u32 v203, s98, v227
    v_add_u32 v204, s98, v228
    v_add_u32 v205, s98, v229
    v_add_u32 v206, s98, v230
    v_add_u32 v207, s98, v231
    s_lshl_b32 s98, s39, 1
    s_add_u32 s99, s98, 0
    v_xor_b32 v252, s99, v254
    v_lshl_add_u32 v208, v252, 5, v255
    v_add_u32 v210, 65536, v208
    s_add_u32 s99, s98, 1
    v_xor_b32 v252, s99, v254
    v_lshl_add_u32 v209, v252, 5, v255
    v_add_u32 v211, 65536, v209
    s_lshl_b32 s98, s41, 1
    s_add_u32 s99, s98, s39
    v_xor_b32 v252, s99, v254
    v_lshl_add_u32 v212, v252, 5, v255
    v_add_u32 v213, 65536, v212
    v_add_u32 v252, 0, v251
    v_xor_b32 v252, v252, v250
    v_lshlrev_b32 v252, 4, v252
    v_lshl_add_u32 v216, v250, 9, v252
    v_add_u32 v220, 65536, v216
    v_add_u32 v252, 4, v251
    v_xor_b32 v252, v252, v250
    v_lshlrev_b32 v252, 4, v252
    v_lshl_add_u32 v217, v250, 9, v252
    v_add_u32 v221, 65536, v217
    v_add_u32 v252, 8, v251
    v_xor_b32 v252, v252, v250
    v_lshlrev_b32 v252, 4, v252
    v_lshl_add_u32 v218, v250, 9, v252
    v_add_u32 v222, 65536, v218
    v_add_u32 v252, 12, v251
    v_xor_b32 v252, v252, v250
    v_lshlrev_b32 v252, 4, v252
    v_lshl_add_u32 v219, v250, 9, v252
    v_add_u32 v223, 65536, v219
    s_lshl_b32 s98, s40, 11
    s_add_u32 s98, s98, 131072
    v_add_u32 v242, s98, v240
    s_lshl_b32 s98, s38, 13
    s_add_u32 s98, s98, 131072
    v_add_u32 v245, s98, v240
    s_xor_b32 s98, s38, 2
    s_lshl_b32 s98, s98, 13
    s_add_u32 s98, s98, 131072
    v_add_u32 v246, s98, v240
    v_mov_b32 v197, 0xc30c6bf3
    s_lshl_b32 s98, s38, 10
    s_add_u32 s98, s98, 159744
    v_lshlrev_b32 v252, 6, v250
    v_add_u32 v252, s98, v252
    v_bfe_u32 v253, v250, 1, 2
    v_lshrrev_b32 v254, 1, v251
    v_xor_b32 v254, v254, v253
    v_lshl_add_u32 v254, v254, 4, v252
    v_and_b32 v255, 1, v251
    v_lshl_add_u32 v92, v255, 3, v254
    v_xor_b32 v95, 32, v92
    v_xor_b32 v254, v251, v253
    v_lshl_add_u32 v93, v254, 4, v252
    v_mov_b32 v64, 0
    v_mov_b32 v65, 0
    v_mov_b32 v66, 0
    v_mov_b32 v67, 0
    s_waitcnt vmcnt(15)
    v_dot2_f32_bf16 v64, v0, s3, v64
    v_dot2_f32_bf16 v66, v0, v0, v66
    v_dot2_f32_bf16 v65, v1, s3, v65
    v_dot2_f32_bf16 v67, v1, v1, v67
    v_dot2_f32_bf16 v64, v2, s3, v64
    v_dot2_f32_bf16 v66, v2, v2, v66
    v_dot2_f32_bf16 v65, v3, s3, v65
    v_dot2_f32_bf16 v67, v3, v3, v67
    s_mov_b32 s71, s9
    s_and_b32 s68, s8, 0xf0000000
    s_add_u32 s68, s68, s44
    s_add_u32 m0, s42, 0
    s_add_u32 s70, s68, 0
    global_load_lds_dwordx4 v232, s[70:71] offset:0
    s_waitcnt vmcnt(15)
    v_dot2_f32_bf16 v64, v4, s3, v64
    v_dot2_f32_bf16 v66, v4, v4, v66
    v_dot2_f32_bf16 v65, v5, s3, v65
    v_dot2_f32_bf16 v67, v5, v5, v67
    v_dot2_f32_bf16 v64, v6, s3, v64
    v_dot2_f32_bf16 v66, v6, v6, v66
    v_dot2_f32_bf16 v65, v7, s3, v65
    v_dot2_f32_bf16 v67, v7, v7, v67
    s_waitcnt vmcnt(14)
    v_dot2_f32_bf16 v64, v8, s3, v64
    v_dot2_f32_bf16 v66, v8, v8, v66
    v_dot2_f32_bf16 v65, v9, s3, v65
    v_dot2_f32_bf16 v67, v9, v9, v67
    v_dot2_f32_bf16 v64, v10, s3, v64
    v_dot2_f32_bf16 v66, v10, v10, v66
    global_load_lds_dwordx4 v233, s[70:71] offset:1024
    v_dot2_f32_bf16 v65, v11, s3, v65
    v_dot2_f32_bf16 v67, v11, v11, v67
    s_waitcnt vmcnt(14)
    v_dot2_f32_bf16 v64, v12, s3, v64
    v_dot2_f32_bf16 v66, v12, v12, v66
    v_dot2_f32_bf16 v65, v13, s3, v65
    v_dot2_f32_bf16 v67, v13, v13, v67
    v_dot2_f32_bf16 v64, v14, s3, v64
    v_dot2_f32_bf16 v66, v14, v14, v66
    v_dot2_f32_bf16 v65, v15, s3, v65
    v_dot2_f32_bf16 v67, v15, v15, v67
    s_waitcnt vmcnt(13)
    v_dot2_f32_bf16 v64, v16, s3, v64
    v_dot2_f32_bf16 v66, v16, v16, v66
    v_dot2_f32_bf16 v65, v17, s3, v65
    v_dot2_f32_bf16 v67, v17, v17, v67
    global_load_lds_dwordx4 v234, s[70:71] offset:2048
    v_dot2_f32_bf16 v64, v18, s3, v64
    v_dot2_f32_bf16 v66, v18, v18, v66
    v_dot2_f32_bf16 v65, v19, s3, v65
    v_dot2_f32_bf16 v67, v19, v19, v67
    s_waitcnt vmcnt(13)
    v_dot2_f32_bf16 v64, v20, s3, v64
    v_dot2_f32_bf16 v66, v20, v20, v66
    v_dot2_f32_bf16 v65, v21, s3, v65
    v_dot2_f32_bf16 v67, v21, v21, v67
    v_dot2_f32_bf16 v64, v22, s3, v64
    v_dot2_f32_bf16 v66, v22, v22, v66
    v_dot2_f32_bf16 v65, v23, s3, v65
    v_dot2_f32_bf16 v67, v23, v23, v67
    s_waitcnt vmcnt(12)
    v_dot2_f32_bf16 v64, v24, s3, v64
    v_dot2_f32_bf16 v66, v24, v24, v66
    global_load_lds_dwordx4 v235, s[70:71] offset:3072
    v_dot2_f32_bf16 v65, v25, s3, v65
    v_dot2_f32_bf16 v67, v25, v25, v67
    v_dot2_f32_bf16 v64, v26, s3, v64
    v_dot2_f32_bf16 v66, v26, v26, v66
    v_dot2_f32_bf16 v65, v27, s3, v65
    v_dot2_f32_bf16 v67, v27, v27, v67
    s_nop 1
    v_add_f32 v64, v64, v65
    v_add_f32 v66, v66, v67
    v_mov_b32 v68, 0
    v_mov_b32 v69, 0
    v_mov_b32 v70, 0
    v_mov_b32 v71, 0
    s_waitcnt vmcnt(12)
    v_dot2_f32_bf16 v68, v28, s3, v68
    v_dot2_f32_bf16 v70, v28, v28, v70
    v_dot2_f32_bf16 v69, v29, s3, v69
    v_dot2_f32_bf16 v71, v29, v29, v71
    v_dot2_f32_bf16 v68, v30, s3, v68
    v_dot2_f32_bf16 v70, v30, v30, v70
    v_dot2_f32_bf16 v69, v31, s3, v69
    v_dot2_f32_bf16 v71, v31, v31, v71
    s_add_u32 m0, s42, 16384
    s_add_u32 s70, s68, 229376
    global_load_lds_dwordx4 v232, s[70:71] offset:0
    s_waitcnt vmcnt(12)
    v_dot2_f32_bf16 v68, v32, s3, v68
    v_dot2_f32_bf16 v70, v32, v32, v70
    v_dot2_f32_bf16 v69, v33, s3, v69
    v_dot2_f32_bf16 v71, v33, v33, v71
    v_dot2_f32_bf16 v68, v34, s3, v68
    v_dot2_f32_bf16 v70, v34, v34, v70
    v_dot2_f32_bf16 v69, v35, s3, v69
    v_dot2_f32_bf16 v71, v35, v35, v71
    s_waitcnt vmcnt(11)
    v_dot2_f32_bf16 v68, v36, s3, v68
    v_dot2_f32_bf16 v70, v36, v36, v70
    v_dot2_f32_bf16 v69, v37, s3, v69
    v_dot2_f32_bf16 v71, v37, v37, v71
    v_dot2_f32_bf16 v68, v38, s3, v68
    v_dot2_f32_bf16 v70, v38, v38, v70
    global_load_lds_dwordx4 v233, s[70:71] offset:1024
    v_dot2_f32_bf16 v69, v39, s3, v69
    v_dot2_f32_bf16 v71, v39, v39, v71
    s_waitcnt vmcnt(11)
    v_dot2_f32_bf16 v68, v40, s3, v68
    v_dot2_f32_bf16 v70, v40, v40, v70
    v_dot2_f32_bf16 v69, v41, s3, v69
    v_dot2_f32_bf16 v71, v41, v41, v71
    v_dot2_f32_bf16 v68, v42, s3, v68
    v_dot2_f32_bf16 v70, v42, v42, v70
    v_dot2_f32_bf16 v69, v43, s3, v69
    v_dot2_f32_bf16 v71, v43, v43, v71
    s_waitcnt vmcnt(10)
    v_dot2_f32_bf16 v68, v44, s3, v68
    v_dot2_f32_bf16 v70, v44, v44, v70
    v_dot2_f32_bf16 v69, v45, s3, v69
    v_dot2_f32_bf16 v71, v45, v45, v71
    global_load_lds_dwordx4 v234, s[70:71] offset:2048
    v_dot2_f32_bf16 v68, v46, s3, v68
    v_dot2_f32_bf16 v70, v46, v46, v70
    v_dot2_f32_bf16 v69, v47, s3, v69
    v_dot2_f32_bf16 v71, v47, v47, v71
    s_waitcnt vmcnt(10)
    v_dot2_f32_bf16 v68, v48, s3, v68
    v_dot2_f32_bf16 v70, v48, v48, v70
    v_dot2_f32_bf16 v69, v49, s3, v69
    v_dot2_f32_bf16 v71, v49, v49, v71
    v_dot2_f32_bf16 v68, v50, s3, v68
    v_dot2_f32_bf16 v70, v50, v50, v70
    v_dot2_f32_bf16 v69, v51, s3, v69
    v_dot2_f32_bf16 v71, v51, v51, v71
    s_waitcnt vmcnt(9)
    v_dot2_f32_bf16 v68, v52, s3, v68
    v_dot2_f32_bf16 v70, v52, v52, v70
    global_load_lds_dwordx4 v235, s[70:71] offset:3072
    v_dot2_f32_bf16 v69, v53, s3, v69
    v_dot2_f32_bf16 v71, v53, v53, v71
    v_dot2_f32_bf16 v68, v54, s3, v68
    v_dot2_f32_bf16 v70, v54, v54, v70
    v_dot2_f32_bf16 v69, v55, s3, v69
    v_dot2_f32_bf16 v71, v55, v55, v71
    s_nop 1
    v_add_f32 v68, v68, v69
    v_add_f32 v70, v70, v71
    v_add_f32_dpp v64, v64, v64 quad_perm:[1,0,3,2] row_mask:0xf bank_mask:0xf
    v_add_f32_dpp v66, v66, v66 quad_perm:[1,0,3,2] row_mask:0xf bank_mask:0xf
    v_add_f32_dpp v68, v68, v68 quad_perm:[1,0,3,2] row_mask:0xf bank_mask:0xf
    v_add_f32_dpp v70, v70, v70 quad_perm:[1,0,3,2] row_mask:0xf bank_mask:0xf
    v_add_f32_dpp v64, v64, v64 quad_perm:[2,3,0,1] row_mask:0xf bank_mask:0xf
    v_add_f32_dpp v66, v66, v66 quad_perm:[2,3,0,1] row_mask:0xf bank_mask:0xf
    v_add_f32_dpp v68, v68, v68 quad_perm:[2,3,0,1] row_mask:0xf bank_mask:0xf
    v_add_f32_dpp v70, v70, v70 quad_perm:[2,3,0,1] row_mask:0xf bank_mask:0xf
    v_add_f32_dpp v64, v64, v64 row_half_mirror row_mask:0xf bank_mask:0xf
    v_add_f32_dpp v66, v66, v66 row_half_mirror row_mask:0xf bank_mask:0xf
    v_add_f32_dpp v68, v68, v68 row_half_mirror row_mask:0xf bank_mask:0xf
    v_add_f32_dpp v70, v70, v70 row_half_mirror row_mask:0xf bank_mask:0xf
    v_mul_f32 v64, 0x3b124925, v64
    v_mul_f32 v66, 0x3b124925, v66
    v_fma_f32 v66, -v64, v64, v66
    v_max_f32 v66, 0, v66
    v_add_f32 v66, 0x3727c5ac, v66
    v_rsq_f32 v66, v66
    s_nop 0
    v_mul_f32 v66, 0x3db8aa3b, v66
    v_mul_f32 v64, v64, v66
    v_sub_f32 v65, 0, v64
    v_mul_f32 v68, 0x3b124925, v68
    v_mul_f32 v70, 0x3b124925, v70
    v_fma_f32 v70, -v68, v68, v70
    v_max_f32 v70, 0, v70
    v_add_f32 v70, 0x3727c5ac, v70
    v_rsq_f32 v70, v70
    s_nop 0
    v_mul_f32 v70, 0x3db8aa3b, v70
    v_mul_f32 v68, v68, v70
    v_sub_f32 v69, 0, v68
    v_and_b32 v252, 7, v249
    v_and_b32 v253, 3, v252
    v_lshrrev_b32 v252, 2, v252
    v_lshlrev_b32 v252, 6, v252
    v_and_b32 v254, 1, v253
    v_lshl_add_u32 v252, v254, 5, v252
    v_lshrrev_b32 v253, 1, v253
    v_lshl_add_u32 v252, v253, 3, v252
    s_mov_b32 s98, 912
    v_mad_u32_u24 v252, v243, s98, v252
    s_mul_i32 s99, s38, 14592
    s_add_u32 s99, s99, 98304
    v_add_u32 v252, s99, v252
    v_add_u32 v253, 7296, v252
    s_mov_b32 s100, 0xffff0000
    v_lshlrev_b32 v72, 16, v0
    v_and_b32 v73, s100, v0
    v_lshlrev_b32 v74, 16, v1
    v_and_b32 v75, s100, v1
    v_lshlrev_b32 v76, 16, v2
    v_and_b32 v77, s100, v2
    v_lshlrev_b32 v78, 16, v3
    v_and_b32 v79, s100, v3
    v_pk_fma_f32 v[72:73], v[72:73], v[66:67], v[64:65] op_sel:[0,0,1] op_sel_hi:[1,0,1]
    v_pk_fma_f32 v[74:75], v[74:75], v[66:67], v[64:65] op_sel:[0,0,1] op_sel_hi:[1,0,1]
    v_pk_fma_f32 v[76:77], v[76:77], v[66:67], v[64:65] op_sel:[0,0,1] op_sel_hi:[1,0,1]
    v_pk_fma_f32 v[78:79], v[78:79], v[66:67], v[64:65] op_sel:[0,0,1] op_sel_hi:[1,0,1]
    v_cvt_pk_bf16_f32 v0, v72, v73
    v_cvt_pk_bf16_f32 v1, v74, v75
    v_cvt_pk_bf16_f32 v2, v76, v77
    v_cvt_pk_bf16_f32 v3, v78, v79
    ds_write2_b64 v252, v[0:1], v[2:3] offset0:0 offset1:2
    s_add_u32 m0, s42, 32768
    s_add_u32 s70, s68, 458752
    global_load_lds_dwordx4 v232, s[70:71] offset:0
    v_lshlrev_b32 v72, 16, v4
    v_and_b32 v73, s100, v4
    v_lshlrev_b32 v74, 16, v5
    v_and_b32 v75, s100, v5
    v_lshlrev_b32 v76, 16, v6
    v_and_b32 v77, s100, v6
    v_lshlrev_b32 v78, 16, v7
    v_and_b32 v79, s100, v7
    v_pk_fma_f32 v[72:73], v[72:73], v[66:67], v[64:65] op_sel:[0,0,1] op_sel_hi:[1,0,1]
    v_pk_fma_f32 v[74:75], v[74:75], v[66:67], v[64:65] op_sel:[0,0,1] op_sel_hi:[1,0,1]
    v_pk_fma_f32 v[76:77], v[76:77], v[66:67], v[64:65] op_sel:[0,0,1] op_sel_hi:[1,0,1]
    v_pk_fma_f32 v[78:79], v[78:79], v[66:67], v[64:65] op_sel:[0,0,1] op_sel_hi:[1,0,1]
    v_cvt_pk_bf16_f32 v4, v72, v73
    v_cvt_pk_bf16_f32 v5, v74, v75
    v_cvt_pk_bf16_f32 v6, v76, v77
    v_cvt_pk_bf16_f32 v7, v78, v79
    ds_write2_b64 v252, v[4:5], v[6:7] offset0:16 offset1:18
    global_load_lds_dwordx4 v233, s[70:71] offset:1024
    v_lshlrev_b32 v72, 16, v8
    v_and_b32 v73, s100, v8
    v_lshlrev_b32 v74, 16, v9
    v_and_b32 v75, s100, v9
    v_lshlrev_b32 v76, 16, v10
    v_and_b32 v77, s100, v10
    v_lshlrev_b32 v78, 16, v11
    v_and_b32 v79, s100, v11
    v_pk_fma_f32 v[72:73], v[72:73], v[66:67], v[64:65] op_sel:[0,0,1] op_sel_hi:[1,0,1]
    v_pk_fma_f32 v[74:75], v[74:75], v[66:67], v[64:65] op_sel:[0,0,1] op_sel_hi:[1,0,1]
    v_pk_fma_f32 v[76:77], v[76:77], v[66:67], v[64:65] op_sel:[0,0,1] op_sel_hi:[1,0,1]
    v_pk_fma_f32 v[78:79], v[78:79], v[66:67], v[64:65] op_sel:[0,0,1] op_sel_hi:[1,0,1]
    v_cvt_pk_bf16_f32 v8, v72, v73
    v_cvt_pk_bf16_f32 v9, v74, v75
    v_cvt_pk_bf16_f32 v10, v76, v77
    v_cvt_pk_bf16_f32 v11, v78, v79
    ds_write2_b64 v252, v[8:9], v[10:11] offset0:32 offset1:34
    global_load_lds_dwordx4 v234, s[70:71] offset:2048
    v_lshlrev_b32 v72, 16, v12
    v_and_b32 v73, s100, v12
    v_lshlrev_b32 v74, 16, v13
    v_and_b32 v75, s100, v13
    v_lshlrev_b32 v76, 16, v14
    v_and_b32 v77, s100, v14
    v_lshlrev_b32 v78, 16, v15
    v_and_b32 v79, s100, v15
    v_pk_fma_f32 v[72:73], v[72:73], v[66:67], v[64:65] op_sel:[0,0,1] op_sel_hi:[1,0,1]
    v_pk_fma_f32 v[74:75], v[74:75], v[66:67], v[64:65] op_sel:[0,0,1] op_sel_hi:[1,0,1]
    v_pk_fma_f32 v[76:77], v[76:77], v[66:67], v[64:65] op_sel:[0,0,1] op_sel_hi:[1,0,1]
    v_pk_fma_f32 v[78:79], v[78:79], v[66:67], v[64:65] op_sel:[0,0,1] op_sel_hi:[1,0,1]
    v_cvt_pk_bf16_f32 v12, v72, v73
    v_cvt_pk_bf16_f32 v13, v74, v75
    v_cvt_pk_bf16_f32 v14, v76, v77
    v_cvt_pk_bf16_f32 v15, v78, v79
    ds_write2_b64 v252, v[12:13], v[14:15] offset0:48 offset1:50
    global_load_lds_dwordx4 v235, s[70:71] offset:3072
    v_lshlrev_b32 v72, 16, v16
    v_and_b32 v73, s100, v16
    v_lshlrev_b32 v74, 16, v17
    v_and_b32 v75, s100, v17
    v_lshlrev_b32 v76, 16, v18
    v_and_b32 v77, s100, v18
    v_lshlrev_b32 v78, 16, v19
    v_and_b32 v79, s100, v19
    v_pk_fma_f32 v[72:73], v[72:73], v[66:67], v[64:65] op_sel:[0,0,1] op_sel_hi:[1,0,1]
    v_pk_fma_f32 v[74:75], v[74:75], v[66:67], v[64:65] op_sel:[0,0,1] op_sel_hi:[1,0,1]
    v_pk_fma_f32 v[76:77], v[76:77], v[66:67], v[64:65] op_sel:[0,0,1] op_sel_hi:[1,0,1]
    v_pk_fma_f32 v[78:79], v[78:79], v[66:67], v[64:65] op_sel:[0,0,1] op_sel_hi:[1,0,1]
    v_cvt_pk_bf16_f32 v16, v72, v73
    v_cvt_pk_bf16_f32 v17, v74, v75
    v_cvt_pk_bf16_f32 v18, v76, v77
    v_cvt_pk_bf16_f32 v19, v78, v79
    ds_write2_b64 v252, v[16:17], v[18:19] offset0:64 offset1:66
    s_add_u32 m0, s42, 49152
    s_add_u32 s70, s68, 688128
    global_load_lds_dwordx4 v232, s[70:71] offset:0
    v_lshlrev_b32 v72, 16, v20
    v_and_b32 v73, s100, v20
    v_lshlrev_b32 v74, 16, v21
    v_and_b32 v75, s100, v21
    v_lshlrev_b32 v76, 16, v22
    v_and_b32 v77, s100, v22
    v_lshlrev_b32 v78, 16, v23
    v_and_b32 v79, s100, v23
    v_pk_fma_f32 v[72:73], v[72:73], v[66:67], v[64:65] op_sel:[0,0,1] op_sel_hi:[1,0,1]
    v_pk_fma_f32 v[74:75], v[74:75], v[66:67], v[64:65] op_sel:[0,0,1] op_sel_hi:[1,0,1]
    v_pk_fma_f32 v[76:77], v[76:77], v[66:67], v[64:65] op_sel:[0,0,1] op_sel_hi:[1,0,1]
    v_pk_fma_f32 v[78:79], v[78:79], v[66:67], v[64:65] op_sel:[0,0,1] op_sel_hi:[1,0,1]
    v_cvt_pk_bf16_f32 v20, v72, v73
    v_cvt_pk_bf16_f32 v21, v74, v75
    v_cvt_pk_bf16_f32 v22, v76, v77
    v_cvt_pk_bf16_f32 v23, v78, v79
    ds_write2_b64 v252, v[20:21], v[22:23] offset0:80 offset1:82
    global_load_lds_dwordx4 v233, s[70:71] offset:1024
    v_lshlrev_b32 v72, 16, v24
    v_and_b32 v73, s100, v24
    v_lshlrev_b32 v74, 16, v25
    v_and_b32 v75, s100, v25
    v_lshlrev_b32 v76, 16, v26
    v_and_b32 v77, s100, v26
    v_lshlrev_b32 v78, 16, v27
    v_and_b32 v79, s100, v27
    v_pk_fma_f32 v[72:73], v[72:73], v[66:67], v[64:65] op_sel:[0,0,1] op_sel_hi:[1,0,1]
    v_pk_fma_f32 v[74:75], v[74:75], v[66:67], v[64:65] op_sel:[0,0,1] op_sel_hi:[1,0,1]
    v_pk_fma_f32 v[76:77], v[76:77], v[66:67], v[64:65] op_sel:[0,0,1] op_sel_hi:[1,0,1]
    v_pk_fma_f32 v[78:79], v[78:79], v[66:67], v[64:65] op_sel:[0,0,1] op_sel_hi:[1,0,1]
    v_cvt_pk_bf16_f32 v24, v72, v73
    v_cvt_pk_bf16_f32 v25, v74, v75
    v_cvt_pk_bf16_f32 v26, v76, v77
    v_cvt_pk_bf16_f32 v27, v78, v79
    ds_write2_b64 v252, v[24:25], v[26:27] offset0:96 offset1:98
    global_load_lds_dwordx4 v234, s[70:71] offset:2048
    v_lshlrev_b32 v72, 16, v28
    v_and_b32 v73, s100, v28
    v_lshlrev_b32 v74, 16, v29
    v_and_b32 v75, s100, v29
    v_lshlrev_b32 v76, 16, v30
    v_and_b32 v77, s100, v30
    v_lshlrev_b32 v78, 16, v31
    v_and_b32 v79, s100, v31
    v_pk_fma_f32 v[72:73], v[72:73], v[70:71], v[68:69] op_sel:[0,0,1] op_sel_hi:[1,0,1]
    v_pk_fma_f32 v[74:75], v[74:75], v[70:71], v[68:69] op_sel:[0,0,1] op_sel_hi:[1,0,1]
    v_pk_fma_f32 v[76:77], v[76:77], v[70:71], v[68:69] op_sel:[0,0,1] op_sel_hi:[1,0,1]
    v_pk_fma_f32 v[78:79], v[78:79], v[70:71], v[68:69] op_sel:[0,0,1] op_sel_hi:[1,0,1]
    v_cvt_pk_bf16_f32 v28, v72, v73
    v_cvt_pk_bf16_f32 v29, v74, v75
    v_cvt_pk_bf16_f32 v30, v76, v77
    v_cvt_pk_bf16_f32 v31, v78, v79
    ds_write2_b64 v253, v[28:29], v[30:31] offset0:0 offset1:2
    global_load_lds_dwordx4 v235, s[70:71] offset:3072
    v_lshlrev_b32 v72, 16, v32
    v_and_b32 v73, s100, v32
    v_lshlrev_b32 v74, 16, v33
    v_and_b32 v75, s100, v33
    v_lshlrev_b32 v76, 16, v34
    v_and_b32 v77, s100, v34
    v_lshlrev_b32 v78, 16, v35
    v_and_b32 v79, s100, v35
    v_pk_fma_f32 v[72:73], v[72:73], v[70:71], v[68:69] op_sel:[0,0,1] op_sel_hi:[1,0,1]
    v_pk_fma_f32 v[74:75], v[74:75], v[70:71], v[68:69] op_sel:[0,0,1] op_sel_hi:[1,0,1]
    v_pk_fma_f32 v[76:77], v[76:77], v[70:71], v[68:69] op_sel:[0,0,1] op_sel_hi:[1,0,1]
    v_pk_fma_f32 v[78:79], v[78:79], v[70:71], v[68:69] op_sel:[0,0,1] op_sel_hi:[1,0,1]
    v_cvt_pk_bf16_f32 v32, v72, v73
    v_cvt_pk_bf16_f32 v33, v74, v75
    v_cvt_pk_bf16_f32 v34, v76, v77
    v_cvt_pk_bf16_f32 v35, v78, v79
    ds_write2_b64 v253, v[32:33], v[34:35] offset0:16 offset1:18
    v_lshlrev_b32 v72, 16, v36
    v_and_b32 v73, s100, v36
    v_lshlrev_b32 v74, 16, v37
    v_and_b32 v75, s100, v37
    v_lshlrev_b32 v76, 16, v38
    v_and_b32 v77, s100, v38
    v_lshlrev_b32 v78, 16, v39
    v_and_b32 v79, s100, v39
    v_pk_fma_f32 v[72:73], v[72:73], v[70:71], v[68:69] op_sel:[0,0,1] op_sel_hi:[1,0,1]
    v_pk_fma_f32 v[74:75], v[74:75], v[70:71], v[68:69] op_sel:[0,0,1] op_sel_hi:[1,0,1]
    v_pk_fma_f32 v[76:77], v[76:77], v[70:71], v[68:69] op_sel:[0,0,1] op_sel_hi:[1,0,1]
    v_pk_fma_f32 v[78:79], v[78:79], v[70:71], v[68:69] op_sel:[0,0,1] op_sel_hi:[1,0,1]
    v_cvt_pk_bf16_f32 v36, v72, v73
    v_cvt_pk_bf16_f32 v37, v74, v75
    v_cvt_pk_bf16_f32 v38, v76, v77
    v_cvt_pk_bf16_f32 v39, v78, v79
    ds_write2_b64 v253, v[36:37], v[38:39] offset0:32 offset1:34
    v_lshlrev_b32 v72, 16, v40
    v_and_b32 v73, s100, v40
    v_lshlrev_b32 v74, 16, v41
    v_and_b32 v75, s100, v41
    v_lshlrev_b32 v76, 16, v42
    v_and_b32 v77, s100, v42
    v_lshlrev_b32 v78, 16, v43
    v_and_b32 v79, s100, v43
    v_pk_fma_f32 v[72:73], v[72:73], v[70:71], v[68:69] op_sel:[0,0,1] op_sel_hi:[1,0,1]
    v_pk_fma_f32 v[74:75], v[74:75], v[70:71], v[68:69] op_sel:[0,0,1] op_sel_hi:[1,0,1]
    v_pk_fma_f32 v[76:77], v[76:77], v[70:71], v[68:69] op_sel:[0,0,1] op_sel_hi:[1,0,1]
    v_pk_fma_f32 v[78:79], v[78:79], v[70:71], v[68:69] op_sel:[0,0,1] op_sel_hi:[1,0,1]
    v_cvt_pk_bf16_f32 v40, v72, v73
    v_cvt_pk_bf16_f32 v41, v74, v75
    v_cvt_pk_bf16_f32 v42, v76, v77
    v_cvt_pk_bf16_f32 v43, v78, v79
    ds_write2_b64 v253, v[40:41], v[42:43] offset0:48 offset1:50
    v_lshlrev_b32 v72, 16, v44
    v_and_b32 v73, s100, v44
    v_lshlrev_b32 v74, 16, v45
    v_and_b32 v75, s100, v45
    v_lshlrev_b32 v76, 16, v46
    v_and_b32 v77, s100, v46
    v_lshlrev_b32 v78, 16, v47
    v_and_b32 v79, s100, v47
    v_pk_fma_f32 v[72:73], v[72:73], v[70:71], v[68:69] op_sel:[0,0,1] op_sel_hi:[1,0,1]
    v_pk_fma_f32 v[74:75], v[74:75], v[70:71], v[68:69] op_sel:[0,0,1] op_sel_hi:[1,0,1]
    v_pk_fma_f32 v[76:77], v[76:77], v[70:71], v[68:69] op_sel:[0,0,1] op_sel_hi:[1,0,1]
    v_pk_fma_f32 v[78:79], v[78:79], v[70:71], v[68:69] op_sel:[0,0,1] op_sel_hi:[1,0,1]
    v_cvt_pk_bf16_f32 v44, v72, v73
    v_cvt_pk_bf16_f32 v45, v74, v75
    v_cvt_pk_bf16_f32 v46, v76, v77
    v_cvt_pk_bf16_f32 v47, v78, v79
    ds_write2_b64 v253, v[44:45], v[46:47] offset0:64 offset1:66
    v_lshlrev_b32 v72, 16, v48
    v_and_b32 v73, s100, v48
    v_lshlrev_b32 v74, 16, v49
    v_and_b32 v75, s100, v49
    v_lshlrev_b32 v76, 16, v50
    v_and_b32 v77, s100, v50
    v_lshlrev_b32 v78, 16, v51
    v_and_b32 v79, s100, v51
    v_pk_fma_f32 v[72:73], v[72:73], v[70:71], v[68:69] op_sel:[0,0,1] op_sel_hi:[1,0,1]
    v_pk_fma_f32 v[74:75], v[74:75], v[70:71], v[68:69] op_sel:[0,0,1] op_sel_hi:[1,0,1]
    v_pk_fma_f32 v[76:77], v[76:77], v[70:71], v[68:69] op_sel:[0,0,1] op_sel_hi:[1,0,1]
    v_pk_fma_f32 v[78:79], v[78:79], v[70:71], v[68:69] op_sel:[0,0,1] op_sel_hi:[1,0,1]
    v_cvt_pk_bf16_f32 v48, v72, v73
    v_cvt_pk_bf16_f32 v49, v74, v75
    v_cvt_pk_bf16_f32 v50, v76, v77
    v_cvt_pk_bf16_f32 v51, v78, v79
    ds_write2_b64 v253, v[48:49], v[50:51] offset0:80 offset1:82
    v_lshlrev_b32 v72, 16, v52
    v_and_b32 v73, s100, v52
    v_lshlrev_b32 v74, 16, v53
    v_and_b32 v75, s100, v53
    v_lshlrev_b32 v76, 16, v54
    v_and_b32 v77, s100, v54
    v_lshlrev_b32 v78, 16, v55
    v_and_b32 v79, s100, v55
    v_pk_fma_f32 v[72:73], v[72:73], v[70:71], v[68:69] op_sel:[0,0,1] op_sel_hi:[1,0,1]
    v_pk_fma_f32 v[74:75], v[74:75], v[70:71], v[68:69] op_sel:[0,0,1] op_sel_hi:[1,0,1]
    v_pk_fma_f32 v[76:77], v[76:77], v[70:71], v[68:69] op_sel:[0,0,1] op_sel_hi:[1,0,1]
    v_pk_fma_f32 v[78:79], v[78:79], v[70:71], v[68:69] op_sel:[0,0,1] op_sel_hi:[1,0,1]
    v_cvt_pk_bf16_f32 v52, v72, v73
    v_cvt_pk_bf16_f32 v53, v74, v75
    v_cvt_pk_bf16_f32 v54, v76, v77
    v_cvt_pk_bf16_f32 v55, v78, v79
    ds_write2_b64 v253, v[52:53], v[54:55] offset0:96 offset1:98
    s_waitcnt lgkmcnt(0)
    s_barrier
    s_lshl_b32 s98, s40, 5
    v_add_u32 v252, s98, v250
    s_mov_b32 s98, 912
    v_lshlrev_b32 v254, 4, v251
    v_mad_u32_u24 v252, v252, s98, v254
    v_add_u32 v252, 98304, v252
    ds_read_b128 a[0:3], v252 offset:0
    ds_read_b128 a[4:7], v252 offset:14592
    ds_read_b128 a[8:11], v252 offset:64
    ds_read_b128 a[12:15], v252 offset:14656
    ds_read_b128 a[16:19], v252 offset:128
    ds_read_b128 a[20:23], v252 offset:14720
    ds_read_b128 a[24:27], v252 offset:192
    ds_read_b128 a[28:31], v252 offset:14784
    ds_read_b128 a[32:35], v252 offset:256
    ds_read_b128 a[36:39], v252 offset:14848
    ds_read_b128 a[40:43], v252 offset:320
    ds_read_b128 a[44:47], v252 offset:14912
    ds_read_b128 a[48:51], v252 offset:384
    ds_read_b128 a[52:55], v252 offset:14976
    ds_read_b128 a[56:59], v252 offset:448
    ds_read_b128 a[60:63], v252 offset:15040
    ds_read_b128 a[64:67], v252 offset:512
    ds_read_b128 a[68:71], v252 offset:15104
    ds_read_b128 a[72:75], v252 offset:576
    ds_read_b128 a[76:79], v252 offset:15168
    ds_read_b128 a[80:83], v252 offset:640
    ds_read_b128 a[84:87], v252 offset:15232
    ds_read_b128 a[88:91], v252 offset:704
    ds_read_b128 a[92:95], v252 offset:15296
    ds_read_b128 a[96:99], v252 offset:768
    ds_read_b128 a[100:103], v252 offset:15360
    ds_read_b128 a[104:107], v252 offset:832
    ds_read_b128 a[108:111], v252 offset:15424
    s_waitcnt vmcnt(8)
    s_barrier
    ds_read_b64_tr_b16 a[112:113], v208 offset:0
    ds_read_b64_tr_b16 a[114:115], v208 offset:2048
    ds_read_b64_tr_b16 a[116:117], v208 offset:8192
    ds_read_b64_tr_b16 a[118:119], v208 offset:10240
    ds_read_b64_tr_b16 a[120:121], v208 offset:4096
    ds_read_b64_tr_b16 a[122:123], v208 offset:6144
    ds_read_b64_tr_b16 a[124:125], v208 offset:12288
    ds_read_b64_tr_b16 a[126:127], v208 offset:14336
    ds_read_b64_tr_b16 a[128:129], v209 offset:0
    ds_read_b64_tr_b16 a[130:131], v209 offset:2048
    ds_read_b64_tr_b16 a[132:133], v209 offset:8192
    ds_read_b64_tr_b16 a[134:135], v209 offset:10240
    ds_read_b64_tr_b16 a[136:137], v209 offset:4096
    ds_read_b64_tr_b16 a[138:139], v209 offset:6144
    ds_read_b64_tr_b16 a[140:141], v209 offset:12288
    ds_read_b64_tr_b16 a[142:143], v209 offset:14336
    ds_read_b64_tr_b16 a[144:145], v208 offset:16384
    ds_read_b64_tr_b16 a[146:147], v208 offset:18432
    ds_read_b64_tr_b16 a[148:149], v208 offset:24576
    ds_read_b64_tr_b16 a[150:151], v208 offset:26624
    ds_read_b64_tr_b16 a[152:153], v208 offset:20480
    ds_read_b64_tr_b16 a[154:155], v208 offset:22528
    ds_read_b64_tr_b16 a[156:157], v208 offset:28672
    ds_read_b64_tr_b16 a[158:159], v208 offset:30720
    s_waitcnt lgkmcnt(15)
    v_mfma_f32_16x16x32_bf16 v[0:3], a[112:115], a[0:3], 0
    s_add_u32 m0, s42, 65536
    s_add_u32 s70, s68, 917504
    v_mfma_f32_16x16x32_bf16 v[0:3], a[116:119], a[8:11], v[0:3]
    global_load_lds_dwordx4 v232, s[70:71] offset:0
    v_mfma_f32_16x16x32_bf16 v[4:7], a[112:115], a[4:7], 0
    v_mfma_f32_16x16x32_bf16 v[4:7], a[116:119], a[12:15], v[4:7]
    ds_read_b64_tr_b16 a[112:113], v209 offset:16384
    v_mfma_f32_16x16x32_bf16 v[16:19], a[120:123], a[0:3], 0
    ds_read_b64_tr_b16 a[114:115], v209 offset:18432
    v_mfma_f32_16x16x32_bf16 v[16:19], a[124:127], a[8:11], v[16:19]
    ds_read_b64_tr_b16 a[116:117], v209 offset:24576
    global_load_lds_dwordx4 v233, s[70:71] offset:1024
    v_mfma_f32_16x16x32_bf16 v[20:23], a[120:123], a[4:7], 0
    ds_read_b64_tr_b16 a[118:119], v209 offset:26624
    v_mfma_f32_16x16x32_bf16 v[20:23], a[124:127], a[12:15], v[20:23]
    ds_read_b64_tr_b16 a[120:121], v209 offset:20480
    s_waitcnt lgkmcnt(13)
    v_mfma_f32_16x16x32_bf16 v[8:11], a[128:131], a[0:3], 0
    ds_read_b64_tr_b16 a[122:123], v209 offset:22528
    v_mfma_f32_16x16x32_bf16 v[8:11], a[132:135], a[8:11], v[8:11]
    ds_read_b64_tr_b16 a[124:125], v209 offset:28672
    global_load_lds_dwordx4 v234, s[70:71] offset:2048
    v_mfma_f32_16x16x32_bf16 v[12:15], a[128:131], a[4:7], 0
    ds_read_b64_tr_b16 a[126:127], v209 offset:30720
    v_mfma_f32_16x16x32_bf16 v[12:15], a[132:135], a[12:15], v[12:15]
    global_load_lds_dwordx4 v235, s[70:71] offset:3072
    s_add_u32 m0, s42, 81920
    s_add_u32 s70, s68, 1146880
    global_load_lds_dwordx4 v232, s[70:71] offset:0
    global_load_lds_dwordx4 v233, s[70:71] offset:1024
    global_load_lds_dwordx4 v234, s[70:71] offset:2048
    global_load_lds_dwordx4 v235, s[70:71] offset:3072
    s_waitcnt vmcnt(8)
    s_barrier
    ds_read_b64_tr_b16 a[128:129], v208 offset:32768
    s_add_u32 m0, s42, 98304
    s_add_u32 s70, s68, 1376256
    v_mfma_f32_16x16x32_bf16 v[24:27], a[136:139], a[0:3], 0
    ds_read_b64_tr_b16 a[130:131], v208 offset:34816
    global_load_lds_dwordx4 v232, s[70:71] offset:0
    v_mfma_f32_16x16x32_bf16 v[24:27], a[140:143], a[8:11], v[24:27]
    ds_read_b64_tr_b16 a[132:133], v208 offset:40960
    v_mfma_f32_16x16x32_bf16 v[28:31], a[136:139], a[4:7], 0
    ds_read_b64_tr_b16 a[134:135], v208 offset:43008
    v_mfma_f32_16x16x32_bf16 v[28:31], a[140:143], a[12:15], v[28:31]
    ds_read_b64_tr_b16 a[136:137], v208 offset:36864
    s_waitcnt lgkmcnt(13)
    v_mfma_f32_16x16x32_bf16 v[0:3], a[144:147], a[16:19], v[0:3]
    ds_read_b64_tr_b16 a[138:139], v208 offset:38912
    global_load_lds_dwordx4 v233, s[70:71] offset:1024
    v_mfma_f32_16x16x32_bf16 v[0:3], a[148:151], a[24:27], v[0:3]
    ds_read_b64_tr_b16 a[140:141], v208 offset:45056
    v_mfma_f32_16x16x32_bf16 v[4:7], a[144:147], a[20:23], v[4:7]
    ds_read_b64_tr_b16 a[142:143], v208 offset:47104
    v_mfma_f32_16x16x32_bf16 v[4:7], a[148:151], a[28:31], v[4:7]
    ds_read_b64_tr_b16 a[144:145], v209 offset:32768
    v_mfma_f32_16x16x32_bf16 v[16:19], a[152:155], a[16:19], v[16:19]
    ds_read_b64_tr_b16 a[146:147], v209 offset:34816
    global_load_lds_dwordx4 v234, s[70:71] offset:2048
    v_mfma_f32_16x16x32_bf16 v[16:19], a[156:159], a[24:27], v[16:19]
    ds_read_b64_tr_b16 a[148:149], v209 offset:40960
    v_mfma_f32_16x16x32_bf16 v[20:23], a[152:155], a[20:23], v[20:23]
    ds_read_b64_tr_b16 a[150:151], v209 offset:43008
    v_mfma_f32_16x16x32_bf16 v[20:23], a[156:159], a[28:31], v[20:23]
    ds_read_b64_tr_b16 a[152:153], v209 offset:36864
    s_waitcnt lgkmcnt(13)
    v_mfma_f32_16x16x32_bf16 v[8:11], a[112:115], a[16:19], v[8:11]
    ds_read_b64_tr_b16 a[154:155], v209 offset:38912
    global_load_lds_dwordx4 v235, s[70:71] offset:3072
    v_mfma_f32_16x16x32_bf16 v[8:11], a[116:119], a[24:27], v[8:11]
    ds_read_b64_tr_b16 a[156:157], v209 offset:45056
    s_and_b32 s68, s8, 0xf0000000
    s_add_u32 s68, s68, s45
    v_mfma_f32_16x16x32_bf16 v[12:15], a[112:115], a[20:23], v[12:15]
    ds_read_b64_tr_b16 a[158:159], v209 offset:47104
    s_add_u32 m0, s42, 114688
    v_mfma_f32_16x16x32_bf16 v[12:15], a[116:119], a[28:31], v[12:15]
    ds_read_b64_tr_b16 a[112:113], v208 offset:49152
    s_add_u32 s70, s68, 0
    global_load_lds_dwordx4 v232, s[70:71] offset:0
    v_mfma_f32_16x16x32_bf16 v[24:27], a[120:123], a[16:19], v[24:27]
    ds_read_b64_tr_b16 a[114:115], v208 offset:51200
    v_mfma_f32_16x16x32_bf16 v[24:27], a[124:127], a[24:27], v[24:27]
    ds_read_b64_tr_b16 a[116:117], v208 offset:57344
    v_mfma_f32_16x16x32_bf16 v[28:31], a[120:123], a[20:23], v[28:31]
    ds_read_b64_tr_b16 a[118:119], v208 offset:59392
    v_mfma_f32_16x16x32_bf16 v[28:31], a[124:127], a[28:31], v[28:31]
    ds_read_b64_tr_b16 a[120:121], v208 offset:53248
    global_load_lds_dwordx4 v233, s[70:71] offset:1024
    s_waitcnt lgkmcnt(13)
    v_mfma_f32_16x16x32_bf16 v[0:3], a[128:131], a[32:35], v[0:3]
    ds_read_b64_tr_b16 a[122:123], v208 offset:55296
    v_mfma_f32_16x16x32_bf16 v[0:3], a[132:135], a[40:43], v[0:3]
    ds_read_b64_tr_b16 a[124:125], v208 offset:61440
    v_mfma_f32_16x16x32_bf16 v[4:7], a[128:131], a[36:39], v[4:7]
    ds_read_b64_tr_b16 a[126:127], v208 offset:63488
    v_mfma_f32_16x16x32_bf16 v[4:7], a[132:135], a[44:47], v[4:7]
    ds_read_b64_tr_b16 a[128:129], v209 offset:49152
    global_load_lds_dwordx4 v234, s[70:71] offset:2048
    v_mfma_f32_16x16x32_bf16 v[16:19], a[136:139], a[32:35], v[16:19]
    ds_read_b64_tr_b16 a[130:131], v209 offset:51200
    v_mfma_f32_16x16x32_bf16 v[16:19], a[140:143], a[40:43], v[16:19]
    ds_read_b64_tr_b16 a[132:133], v209 offset:57344
    v_mfma_f32_16x16x32_bf16 v[20:23], a[136:139], a[36:39], v[20:23]
    ds_read_b64_tr_b16 a[134:135], v209 offset:59392
    v_mfma_f32_16x16x32_bf16 v[20:23], a[140:143], a[44:47], v[20:23]
    ds_read_b64_tr_b16 a[136:137], v209 offset:53248
    global_load_lds_dwordx4 v235, s[70:71] offset:3072
    s_waitcnt lgkmcnt(13)
    v_mfma_f32_16x16x32_bf16 v[8:11], a[144:147], a[32:35], v[8:11]
    ds_read_b64_tr_b16 a[138:139], v209 offset:55296
    v_mfma_f32_16x16x32_bf16 v[8:11], a[148:151], a[40:43], v[8:11]
    ds_read_b64_tr_b16 a[140:141], v209 offset:61440
    v_mfma_f32_16x16x32_bf16 v[12:15], a[144:147], a[36:39], v[12:15]
    ds_read_b64_tr_b16 a[142:143], v209 offset:63488
    v_mfma_f32_16x16x32_bf16 v[12:15], a[148:151], a[44:47], v[12:15]
    s_waitcnt vmcnt(8)
    s_barrier
    ds_read_b64_tr_b16 a[144:145], v210 offset:0
    s_add_u32 m0, s42, 0
    s_add_u32 s70, s68, 229376
    v_mfma_f32_16x16x32_bf16 v[24:27], a[152:155], a[32:35], v[24:27]
    ds_read_b64_tr_b16 a[146:147], v210 offset:2048
    global_load_lds_dwordx4 v232, s[70:71] offset:0
    v_mfma_f32_16x16x32_bf16 v[24:27], a[156:159], a[40:43], v[24:27]
    ds_read_b64_tr_b16 a[148:149], v210 offset:8192
    v_mfma_f32_16x16x32_bf16 v[28:31], a[152:155], a[36:39], v[28:31]
    ds_read_b64_tr_b16 a[150:151], v210 offset:10240
    v_mfma_f32_16x16x32_bf16 v[28:31], a[156:159], a[44:47], v[28:31]
    ds_read_b64_tr_b16 a[152:153], v210 offset:4096
    s_waitcnt lgkmcnt(13)
    v_mfma_f32_16x16x32_bf16 v[0:3], a[112:115], a[48:51], v[0:3]
    ds_read_b64_tr_b16 a[154:155], v210 offset:6144
    global_load_lds_dwordx4 v233, s[70:71] offset:1024
    v_mfma_f32_16x16x32_bf16 v[0:3], a[116:119], a[56:59], v[0:3]
    ds_read_b64_tr_b16 a[156:157], v210 offset:12288
    v_mfma_f32_16x16x32_bf16 v[4:7], a[112:115], a[52:55], v[4:7]
    ds_read_b64_tr_b16 a[158:159], v210 offset:14336
    v_mfma_f32_16x16x32_bf16 v[4:7], a[116:119], a[60:63], v[4:7]
    ds_read_b64_tr_b16 a[112:113], v211 offset:0
    v_mfma_f32_16x16x32_bf16 v[16:19], a[120:123], a[48:51], v[16:19]
    ds_read_b64_tr_b16 a[114:115], v211 offset:2048
    global_load_lds_dwordx4 v234, s[70:71] offset:2048
    v_mfma_f32_16x16x32_bf16 v[16:19], a[124:127], a[56:59], v[16:19]
    ds_read_b64_tr_b16 a[116:117], v211 offset:8192
    v_mfma_f32_16x16x32_bf16 v[20:23], a[120:123], a[52:55], v[20:23]
    ds_read_b64_tr_b16 a[118:119], v211 offset:10240
    v_mfma_f32_16x16x32_bf16 v[20:23], a[124:127], a[60:63], v[20:23]
    ds_read_b64_tr_b16 a[120:121], v211 offset:4096
    s_waitcnt lgkmcnt(13)
    v_mfma_f32_16x16x32_bf16 v[8:11], a[128:131], a[48:51], v[8:11]
    ds_read_b64_tr_b16 a[122:123], v211 offset:6144
    global_load_lds_dwordx4 v235, s[70:71] offset:3072
    v_mfma_f32_16x16x32_bf16 v[8:11], a[132:135], a[56:59], v[8:11]
    ds_read_b64_tr_b16 a[124:125], v211 offset:12288
    s_add_u32 m0, s42, 16384
    v_mfma_f32_16x16x32_bf16 v[12:15], a[128:131], a[52:55], v[12:15]
    ds_read_b64_tr_b16 a[126:127], v211 offset:14336
    s_add_u32 s70, s68, 458752
    v_mfma_f32_16x16x32_bf16 v[12:15], a[132:135], a[60:63], v[12:15]
    ds_read_b64_tr_b16 a[128:129], v210 offset:16384
    global_load_lds_dwordx4 v232, s[70:71] offset:0
    v_mfma_f32_16x16x32_bf16 v[24:27], a[136:139], a[48:51], v[24:27]
    ds_read_b64_tr_b16 a[130:131], v210 offset:18432
    v_mfma_f32_16x16x32_bf16 v[24:27], a[140:143], a[56:59], v[24:27]
    ds_read_b64_tr_b16 a[132:133], v210 offset:24576
    v_mfma_f32_16x16x32_bf16 v[28:31], a[136:139], a[52:55], v[28:31]
    ds_read_b64_tr_b16 a[134:135], v210 offset:26624
    v_mfma_f32_16x16x32_bf16 v[28:31], a[140:143], a[60:63], v[28:31]
    ds_read_b64_tr_b16 a[136:137], v210 offset:20480
    global_load_lds_dwordx4 v233, s[70:71] offset:1024
    s_waitcnt lgkmcnt(13)
    v_mfma_f32_16x16x32_bf16 v[0:3], a[144:147], a[64:67], v[0:3]
    ds_read_b64_tr_b16 a[138:139], v210 offset:22528
    v_mfma_f32_16x16x32_bf16 v[0:3], a[148:151], a[72:75], v[0:3]
    ds_read_b64_tr_b16 a[140:141], v210 offset:28672
    v_mfma_f32_16x16x32_bf16 v[4:7], a[144:147], a[68:71], v[4:7]
    ds_read_b64_tr_b16 a[142:143], v210 offset:30720
    v_mfma_f32_16x16x32_bf16 v[4:7], a[148:151], a[76:79], v[4:7]
    ds_read_b64_tr_b16 a[144:145], v211 offset:16384
    global_load_lds_dwordx4 v234, s[70:71] offset:2048
    v_mfma_f32_16x16x32_bf16 v[16:19], a[152:155], a[64:67], v[16:19]
    ds_read_b64_tr_b16 a[146:147], v211 offset:18432
    v_mfma_f32_16x16x32_bf16 v[16:19], a[156:159], a[72:75], v[16:19]
    ds_read_b64_tr_b16 a[148:149], v211 offset:24576
    v_mfma_f32_16x16x32_bf16 v[20:23], a[152:155], a[68:71], v[20:23]
    ds_read_b64_tr_b16 a[150:151], v211 offset:26624
    v_mfma_f32_16x16x32_bf16 v[20:23], a[156:159], a[76:79], v[20:23]
    ds_read_b64_tr_b16 a[152:153], v211 offset:20480
    global_load_lds_dwordx4 v235, s[70:71] offset:3072
    s_waitcnt lgkmcnt(13)
    v_mfma_f32_16x16x32_bf16 v[8:11], a[112:115], a[64:67], v[8:11]
    ds_read_b64_tr_b16 a[154:155], v211 offset:22528
    v_mfma_f32_16x16x32_bf16 v[8:11], a[116:119], a[72:75], v[8:11]
    ds_read_b64_tr_b16 a[156:157], v211 offset:28672
    v_mfma_f32_16x16x32_bf16 v[12:15], a[112:115], a[68:71], v[12:15]
    ds_read_b64_tr_b16 a[158:159], v211 offset:30720
    v_mfma_f32_16x16x32_bf16 v[12:15], a[116:119], a[76:79], v[12:15]
    s_waitcnt vmcnt(8)
    s_barrier
    ds_read_b64_tr_b16 a[112:113], v210 offset:32768
    s_add_u32 m0, s42, 32768
    s_add_u32 s70, s68, 688128
    v_mfma_f32_16x16x32_bf16 v[24:27], a[120:123], a[64:67], v[24:27]
    ds_read_b64_tr_b16 a[114:115], v210 offset:34816
    global_load_lds_dwordx4 v232, s[70:71] offset:0
    v_mfma_f32_16x16x32_bf16 v[24:27], a[124:127], a[72:75], v[24:27]
    ds_read_b64_tr_b16 a[116:117], v210 offset:40960
    v_mfma_f32_16x16x32_bf16 v[28:31], a[120:123], a[68:71], v[28:31]
    ds_read_b64_tr_b16 a[118:119], v210 offset:43008
    v_mfma_f32_16x16x32_bf16 v[28:31], a[124:127], a[76:79], v[28:31]
    ds_read_b64_tr_b16 a[120:121], v210 offset:36864
    s_waitcnt lgkmcnt(13)
    v_mfma_f32_16x16x32_bf16 v[0:3], a[128:131], a[80:83], v[0:3]
    ds_read_b64_tr_b16 a[122:123], v210 offset:38912
    global_load_lds_dwordx4 v233, s[70:71] offset:1024
    v_mfma_f32_16x16x32_bf16 v[0:3], a[132:135], a[88:91], v[0:3]
    ds_read_b64_tr_b16 a[124:125], v210 offset:45056
    v_mfma_f32_16x16x32_bf16 v[4:7], a[128:131], a[84:87], v[4:7]
    ds_read_b64_tr_b16 a[126:127], v210 offset:47104
    v_mfma_f32_16x16x32_bf16 v[4:7], a[132:135], a[92:95], v[4:7]
    ds_read_b64_tr_b16 a[128:129], v211 offset:32768
    v_mfma_f32_16x16x32_bf16 v[16:19], a[136:139], a[80:83], v[16:19]
    ds_read_b64_tr_b16 a[130:131], v211 offset:34816
    global_load_lds_dwordx4 v234, s[70:71] offset:2048
    v_mfma_f32_16x16x32_bf16 v[16:19], a[140:143], a[88:91], v[16:19]
    ds_read_b64_tr_b16 a[132:133], v211 offset:40960
    v_mfma_f32_16x16x32_bf16 v[20:23], a[136:139], a[84:87], v[20:23]
    ds_read_b64_tr_b16 a[134:135], v211 offset:43008
    v_mfma_f32_16x16x32_bf16 v[20:23], a[140:143], a[92:95], v[20:23]
    ds_read_b64_tr_b16 a[136:137], v211 offset:36864
    s_waitcnt lgkmcnt(13)
    v_mfma_f32_16x16x32_bf16 v[8:11], a[144:147], a[80:83], v[8:11]
    ds_read_b64_tr_b16 a[138:139], v211 offset:38912
    global_load_lds_dwordx4 v235, s[70:71] offset:3072
    v_mfma_f32_16x16x32_bf16 v[8:11], a[148:151], a[88:91], v[8:11]
    ds_read_b64_tr_b16 a[140:141], v211 offset:45056
    s_add_u32 m0, s42, 49152
    v_mfma_f32_16x16x32_bf16 v[12:15], a[144:147], a[84:87], v[12:15]
    ds_read_b64_tr_b16 a[142:143], v211 offset:47104
    s_add_u32 s70, s68, 917504
    v_mfma_f32_16x16x32_bf16 v[12:15], a[148:151], a[92:95], v[12:15]
    ds_read_b64_tr_b16 a[144:145], v210 offset:49152
    global_load_lds_dwordx4 v232, s[70:71] offset:0
    v_mfma_f32_16x16x32_bf16 v[24:27], a[152:155], a[80:83], v[24:27]
    ds_read_b64_tr_b16 a[146:147], v210 offset:51200
    v_mfma_f32_16x16x32_bf16 v[24:27], a[156:159], a[88:91], v[24:27]
    ds_read_b64_tr_b16 a[148:149], v210 offset:57344
    v_mfma_f32_16x16x32_bf16 v[28:31], a[152:155], a[84:87], v[28:31]
    ds_read_b64_tr_b16 a[150:151], v210 offset:59392
    v_mfma_f32_16x16x32_bf16 v[28:31], a[156:159], a[92:95], v[28:31]
    ds_read_b64_tr_b16 a[152:153], v210 offset:53248
    global_load_lds_dwordx4 v233, s[70:71] offset:1024
    s_waitcnt lgkmcnt(13)
    v_mfma_f32_16x16x32_bf16 v[0:3], a[112:115], a[96:99], v[0:3]
    ds_read_b64_tr_b16 a[154:155], v210 offset:55296
    v_mfma_f32_16x16x32_bf16 v[0:3], a[116:119], a[104:107], v[0:3]
    ds_read_b64_tr_b16 a[156:157], v210 offset:61440
    v_mfma_f32_16x16x32_bf16 v[4:7], a[112:115], a[100:103], v[4:7]
    ds_read_b64_tr_b16 a[158:159], v210 offset:63488
    v_mfma_f32_16x16x32_bf16 v[4:7], a[116:119], a[108:111], v[4:7]
    ds_read_b64_tr_b16 a[112:113], v211 offset:49152
    global_load_lds_dwordx4 v234, s[70:71] offset:2048
    v_mfma_f32_16x16x32_bf16 v[16:19], a[120:123], a[96:99], v[16:19]
    ds_read_b64_tr_b16 a[114:115], v211 offset:51200
    v_mfma_f32_16x16x32_bf16 v[16:19], a[124:127], a[104:107], v[16:19]
    ds_read_b64_tr_b16 a[116:117], v211 offset:57344
    v_mfma_f32_16x16x32_bf16 v[20:23], a[120:123], a[100:103], v[20:23]
    ds_read_b64_tr_b16 a[118:119], v211 offset:59392
    v_mfma_f32_16x16x32_bf16 v[20:23], a[124:127], a[108:111], v[20:23]
    ds_read_b64_tr_b16 a[120:121], v211 offset:53248
    global_load_lds_dwordx4 v235, s[70:71] offset:3072
    s_waitcnt lgkmcnt(13)
    v_mfma_f32_16x16x32_bf16 v[8:11], a[128:131], a[96:99], v[8:11]
    ds_read_b64_tr_b16 a[122:123], v211 offset:55296
    v_mfma_f32_16x16x32_bf16 v[8:11], a[132:135], a[104:107], v[8:11]
    ds_read_b64_tr_b16 a[124:125], v211 offset:61440
    v_mfma_f32_16x16x32_bf16 v[12:15], a[128:131], a[100:103], v[12:15]
    ds_read_b64_tr_b16 a[126:127], v211 offset:63488
    v_mfma_f32_16x16x32_bf16 v[12:15], a[132:135], a[108:111], v[12:15]
    s_waitcnt vmcnt(8)
    s_barrier
    ds_read_b64_tr_b16 a[128:129], v208 offset:0
    s_add_u32 m0, s42, 65536
    s_add_u32 s70, s68, 1146880
    v_mfma_f32_16x16x32_bf16 v[24:27], a[136:139], a[96:99], v[24:27]
    ds_read_b64_tr_b16 a[130:131], v208 offset:2048
    global_load_lds_dwordx4 v232, s[70:71] offset:0
    v_mfma_f32_16x16x32_bf16 v[24:27], a[140:143], a[104:107], v[24:27]
    ds_read_b64_tr_b16 a[132:133], v208 offset:8192
    v_mfma_f32_16x16x32_bf16 v[28:31], a[136:139], a[100:103], v[28:31]
    ds_read_b64_tr_b16 a[134:135], v208 offset:10240
    v_mfma_f32_16x16x32_bf16 v[28:31], a[140:143], a[108:111], v[28:31]
    ds_read_b64_tr_b16 a[136:137], v208 offset:4096
    s_waitcnt lgkmcnt(13)
    v_mfma_f32_16x16x32_bf16 v[32:35], a[144:147], a[0:3], 0
    ds_read_b64_tr_b16 a[138:139], v208 offset:6144
    global_load_lds_dwordx4 v233, s[70:71] offset:1024
    v_mfma_f32_16x16x32_bf16 v[32:35], a[148:151], a[8:11], v[32:35]
    ds_read_b64_tr_b16 a[140:141], v208 offset:12288
    v_mfma_f32_16x16x32_bf16 v[36:39], a[144:147], a[4:7], 0
    ds_read_b64_tr_b16 a[142:143], v208 offset:14336
    v_mfma_f32_16x16x32_bf16 v[36:39], a[148:151], a[12:15], v[36:39]
    ds_read_b64_tr_b16 a[144:145], v209 offset:0
    v_mfma_f32_16x16x32_bf16 v[48:51], a[152:155], a[0:3], 0
    ds_read_b64_tr_b16 a[146:147], v209 offset:2048
    global_load_lds_dwordx4 v234, s[70:71] offset:2048
    v_mfma_f32_16x16x32_bf16 v[48:51], a[156:159], a[8:11], v[48:51]
    ds_read_b64_tr_b16 a[148:149], v209 offset:8192
    v_mfma_f32_16x16x32_bf16 v[52:55], a[152:155], a[4:7], 0
    ds_read_b64_tr_b16 a[150:151], v209 offset:10240
    v_add_u32 v241, s94, v242
    v_mfma_f32_16x16x32_bf16 v[52:55], a[156:159], a[12:15], v[52:55]
    ds_read_b64_tr_b16 a[152:153], v209 offset:4096
    v_mul_f32 v64, v0, v0
    s_waitcnt lgkmcnt(13)
    v_mfma_f32_16x16x32_bf16 v[40:43], a[112:115], a[0:3], 0
    ds_read_b64_tr_b16 a[154:155], v209 offset:6144
    global_load_lds_dwordx4 v235, s[70:71] offset:3072
    v_mul_f32 v65, v1, v1
    v_mfma_f32_16x16x32_bf16 v[40:43], a[116:119], a[8:11], v[40:43]
    ds_read_b64_tr_b16 a[156:157], v209 offset:12288
    s_add_u32 m0, s42, 81920
    v_mul_f32 v66, v2, v2
    v_mfma_f32_16x16x32_bf16 v[44:47], a[112:115], a[4:7], 0
    ds_read_b64_tr_b16 a[158:159], v209 offset:14336
    s_add_u32 s70, s68, 1376256
    v_mul_f32 v67, v3, v3
    v_mfma_f32_16x16x32_bf16 v[44:47], a[116:119], a[12:15], v[44:47]
    ds_read_b64_tr_b16 a[112:113], v208 offset:16384
    global_load_lds_dwordx4 v232, s[70:71] offset:0
    v_fmaak_f32 v64, v64, v197, 0xc1cc422a
    v_mfma_f32_16x16x32_bf16 v[56:59], a[120:123], a[0:3], 0
    ds_read_b64_tr_b16 a[114:115], v208 offset:18432
    v_fmaak_f32 v65, v65, v197, 0xc1cc422a
    v_mfma_f32_16x16x32_bf16 v[56:59], a[124:127], a[8:11], v[56:59]
    ds_read_b64_tr_b16 a[116:117], v208 offset:24576
    v_fmaak_f32 v66, v66, v197, 0xc1cc422a
    v_mfma_f32_16x16x32_bf16 v[60:63], a[120:123], a[4:7], 0
    ds_read_b64_tr_b16 a[118:119], v208 offset:26624
    v_fmaak_f32 v67, v67, v197, 0xc1cc422a
    v_mfma_f32_16x16x32_bf16 v[60:63], a[124:127], a[12:15], v[60:63]
    ds_read_b64_tr_b16 a[120:121], v208 offset:20480
    global_load_lds_dwordx4 v233, s[70:71] offset:1024
    v_mul_f32 v64, v0, v64
    s_waitcnt lgkmcnt(13)
    v_mfma_f32_16x16x32_bf16 v[32:35], a[128:131], a[16:19], v[32:35]
    ds_read_b64_tr_b16 a[122:123], v208 offset:22528
    v_mul_f32 v65, v1, v65
    v_mul_f32 v66, v2, v66
    v_mfma_f32_16x16x32_bf16 v[32:35], a[132:135], a[24:27], v[32:35]
    ds_read_b64_tr_b16 a[124:125], v208 offset:28672
    v_mul_f32 v67, v3, v67
    v_mfma_f32_16x16x32_bf16 v[36:39], a[128:131], a[20:23], v[36:39]
    ds_read_b64_tr_b16 a[126:127], v208 offset:30720
    v_exp_f32 v68, v64
    v_mfma_f32_16x16x32_bf16 v[36:39], a[132:135], a[28:31], v[36:39]
    ds_read_b64_tr_b16 a[128:129], v209 offset:16384
    global_load_lds_dwordx4 v234, s[70:71] offset:2048
    v_exp_f32 v69, v65
    v_mfma_f32_16x16x32_bf16 v[48:51], a[136:139], a[16:19], v[48:51]
    ds_read_b64_tr_b16 a[130:131], v209 offset:18432
    v_exp_f32 v70, v66
    v_mfma_f32_16x16x32_bf16 v[48:51], a[140:143], a[24:27], v[48:51]
    ds_read_b64_tr_b16 a[132:133], v209 offset:24576
    v_exp_f32 v71, v67
    v_mfma_f32_16x16x32_bf16 v[52:55], a[136:139], a[20:23], v[52:55]
    ds_read_b64_tr_b16 a[134:135], v209 offset:26624
    v_mul_f32 v64, v0, v16
    v_mfma_f32_16x16x32_bf16 v[52:55], a[140:143], a[28:31], v[52:55]
    ds_read_b64_tr_b16 a[136:137], v209 offset:20480
    global_load_lds_dwordx4 v235, s[70:71] offset:3072
    v_mul_f32 v65, v1, v17
    s_waitcnt lgkmcnt(13)
    v_mfma_f32_16x16x32_bf16 v[40:43], a[144:147], a[16:19], v[40:43]
    ds_read_b64_tr_b16 a[138:139], v209 offset:22528
    v_mul_f32 v66, v2, v18
    v_mfma_f32_16x16x32_bf16 v[40:43], a[148:151], a[24:27], v[40:43]
    ds_read_b64_tr_b16 a[140:141], v209 offset:28672
    v_mul_f32 v67, v3, v19
    v_mfma_f32_16x16x32_bf16 v[44:47], a[144:147], a[20:23], v[44:47]
    ds_read_b64_tr_b16 a[142:143], v209 offset:30720
    v_add_f32 v68, 1.0, v68
    v_add_f32 v69, 1.0, v69
    v_mfma_f32_16x16x32_bf16 v[44:47], a[148:151], a[28:31], v[44:47]
    s_waitcnt vmcnt(8)
    s_barrier
    ds_read_b64_tr_b16 a[144:145], v208 offset:32768
    s_and_b32 s68, s8, 0xf0000000
    s_add_u32 s68, s68, s46
    s_add_u32 m0, s42, 98304
    s_add_u32 s70, s68, 0
    v_add_f32 v70, 1.0, v70
    v_mfma_f32_16x16x32_bf16 v[56:59], a[152:155], a[16:19], v[56:59]
    ds_read_b64_tr_b16 a[146:147], v208 offset:34816
    global_load_lds_dwordx4 v232, s[70:71] offset:0
    v_add_f32 v71, 1.0, v71
    v_mfma_f32_16x16x32_bf16 v[56:59], a[156:159], a[24:27], v[56:59]
    ds_read_b64_tr_b16 a[148:149], v208 offset:40960
    v_rcp_f32 v68, v68
    v_mfma_f32_16x16x32_bf16 v[60:63], a[152:155], a[20:23], v[60:63]
    ds_read_b64_tr_b16 a[150:151], v208 offset:43008
    v_rcp_f32 v69, v69
    v_mfma_f32_16x16x32_bf16 v[60:63], a[156:159], a[28:31], v[60:63]
    ds_read_b64_tr_b16 a[152:153], v208 offset:36864
    v_rcp_f32 v70, v70
    s_waitcnt lgkmcnt(13)
    v_mfma_f32_16x16x32_bf16 v[32:35], a[112:115], a[32:35], v[32:35]
    ds_read_b64_tr_b16 a[154:155], v208 offset:38912
    global_load_lds_dwordx4 v233, s[70:71] offset:1024
    v_rcp_f32 v71, v71
    v_mfma_f32_16x16x32_bf16 v[32:35], a[116:119], a[40:43], v[32:35]
    ds_read_b64_tr_b16 a[156:157], v208 offset:45056
    v_mul_f32 v64, v64, v68
    v_mfma_f32_16x16x32_bf16 v[36:39], a[112:115], a[36:39], v[36:39]
    ds_read_b64_tr_b16 a[158:159], v208 offset:47104
    v_mul_f32 v65, v65, v69
    v_mfma_f32_16x16x32_bf16 v[36:39], a[116:119], a[44:47], v[36:39]
    ds_read_b64_tr_b16 a[112:113], v209 offset:32768
    v_mul_f32 v66, v66, v70
    v_mfma_f32_16x16x32_bf16 v[48:51], a[120:123], a[32:35], v[48:51]
    ds_read_b64_tr_b16 a[114:115], v209 offset:34816
    global_load_lds_dwordx4 v234, s[70:71] offset:2048
    v_mul_f32 v67, v67, v71
    v_cvt_pk_bf16_f32 v80, v64, v65
    v_mfma_f32_16x16x32_bf16 v[48:51], a[124:127], a[40:43], v[48:51]
    ds_read_b64_tr_b16 a[116:117], v209 offset:40960
    v_cvt_pk_bf16_f32 v81, v66, v67
    v_mfma_f32_16x16x32_bf16 v[52:55], a[120:123], a[36:39], v[52:55]
    ds_read_b64_tr_b16 a[118:119], v209 offset:43008
    v_mul_f32 v64, v8, v8
    v_mfma_f32_16x16x32_bf16 v[52:55], a[124:127], a[44:47], v[52:55]
    ds_read_b64_tr_b16 a[120:121], v209 offset:36864
    v_mul_f32 v65, v9, v9
    s_waitcnt lgkmcnt(13)
    v_mfma_f32_16x16x32_bf16 v[40:43], a[128:131], a[32:35], v[40:43]
    ds_read_b64_tr_b16 a[122:123], v209 offset:38912
    global_load_lds_dwordx4 v235, s[70:71] offset:3072
    v_mul_f32 v66, v10, v10
    v_mfma_f32_16x16x32_bf16 v[40:43], a[132:135], a[40:43], v[40:43]
    ds_read_b64_tr_b16 a[124:125], v209 offset:45056
    s_add_u32 m0, s42, 114688
    v_mul_f32 v67, v11, v11
    v_mfma_f32_16x16x32_bf16 v[44:47], a[128:131], a[36:39], v[44:47]
    ds_read_b64_tr_b16 a[126:127], v209 offset:47104
    s_add_u32 s70, s68, 229376
    v_fmaak_f32 v64, v64, v197, 0xc1cc422a
    v_mfma_f32_16x16x32_bf16 v[44:47], a[132:135], a[44:47], v[44:47]
    ds_read_b64_tr_b16 a[128:129], v208 offset:49152
    global_load_lds_dwordx4 v232, s[70:71] offset:0
    v_fmaak_f32 v65, v65, v197, 0xc1cc422a
    v_mfma_f32_16x16x32_bf16 v[56:59], a[136:139], a[32:35], v[56:59]
    ds_read_b64_tr_b16 a[130:131], v208 offset:51200
    v_fmaak_f32 v66, v66, v197, 0xc1cc422a
    v_mfma_f32_16x16x32_bf16 v[56:59], a[140:143], a[40:43], v[56:59]
    ds_read_b64_tr_b16 a[132:133], v208 offset:57344
    v_fmaak_f32 v67, v67, v197, 0xc1cc422a
    v_mul_f32 v64, v8, v64
    v_mfma_f32_16x16x32_bf16 v[60:63], a[136:139], a[36:39], v[60:63]
    ds_read_b64_tr_b16 a[134:135], v208 offset:59392
    v_mul_f32 v65, v9, v65
    v_mfma_f32_16x16x32_bf16 v[60:63], a[140:143], a[44:47], v[60:63]
    ds_read_b64_tr_b16 a[136:137], v208 offset:53248
    global_load_lds_dwordx4 v233, s[70:71] offset:1024
    v_mul_f32 v66, v10, v66
    s_waitcnt lgkmcnt(13)
    v_mfma_f32_16x16x32_bf16 v[32:35], a[144:147], a[48:51], v[32:35]
    ds_read_b64_tr_b16 a[138:139], v208 offset:55296
    v_mul_f32 v67, v11, v67
    v_mfma_f32_16x16x32_bf16 v[32:35], a[148:151], a[56:59], v[32:35]
    ds_read_b64_tr_b16 a[140:141], v208 offset:61440
    v_exp_f32 v68, v64
    v_mfma_f32_16x16x32_bf16 v[36:39], a[144:147], a[52:55], v[36:39]
    ds_read_b64_tr_b16 a[142:143], v208 offset:63488
    v_exp_f32 v69, v65
    v_mfma_f32_16x16x32_bf16 v[36:39], a[148:151], a[60:63], v[36:39]
    ds_read_b64_tr_b16 a[144:145], v209 offset:49152
    global_load_lds_dwordx4 v234, s[70:71] offset:2048
    v_exp_f32 v70, v66
    v_mfma_f32_16x16x32_bf16 v[48:51], a[152:155], a[48:51], v[48:51]
    ds_read_b64_tr_b16 a[146:147], v209 offset:51200
    v_exp_f32 v71, v67
    v_mfma_f32_16x16x32_bf16 v[48:51], a[156:159], a[56:59], v[48:51]
    ds_read_b64_tr_b16 a[148:149], v209 offset:57344
    v_mul_f32 v64, v8, v24
    v_mfma_f32_16x16x32_bf16 v[52:55], a[152:155], a[52:55], v[52:55]
    ds_read_b64_tr_b16 a[150:151], v209 offset:59392
    v_mul_f32 v65, v9, v25
    v_mfma_f32_16x16x32_bf16 v[52:55], a[156:159], a[60:63], v[52:55]
    ds_read_b64_tr_b16 a[152:153], v209 offset:53248
    global_load_lds_dwordx4 v235, s[70:71] offset:3072
    v_mul_f32 v66, v10, v26
    v_mul_f32 v67, v11, v27
    s_waitcnt lgkmcnt(13)
    v_mfma_f32_16x16x32_bf16 v[40:43], a[112:115], a[48:51], v[40:43]
    ds_read_b64_tr_b16 a[154:155], v209 offset:55296
    v_add_f32 v68, 1.0, v68
    v_mfma_f32_16x16x32_bf16 v[40:43], a[116:119], a[56:59], v[40:43]
    ds_read_b64_tr_b16 a[156:157], v209 offset:61440
    v_add_f32 v69, 1.0, v69
    v_mfma_f32_16x16x32_bf16 v[44:47], a[112:115], a[52:55], v[44:47]
    ds_read_b64_tr_b16 a[158:159], v209 offset:63488
    v_add_f32 v70, 1.0, v70
    v_mfma_f32_16x16x32_bf16 v[44:47], a[116:119], a[60:63], v[44:47]
    s_waitcnt vmcnt(8)
    s_barrier
    ds_read_b64_tr_b16 a[112:113], v210 offset:0
    s_add_u32 m0, s42, 0
    s_add_u32 s70, s68, 458752
    v_add_f32 v71, 1.0, v71
    v_mfma_f32_16x16x32_bf16 v[56:59], a[120:123], a[48:51], v[56:59]
    ds_read_b64_tr_b16 a[114:115], v210 offset:2048
    global_load_lds_dwordx4 v232, s[70:71] offset:0
    v_rcp_f32 v68, v68
    v_mfma_f32_16x16x32_bf16 v[56:59], a[124:127], a[56:59], v[56:59]
    ds_read_b64_tr_b16 a[116:117], v210 offset:8192
    v_rcp_f32 v69, v69
    v_mfma_f32_16x16x32_bf16 v[60:63], a[120:123], a[52:55], v[60:63]
    ds_read_b64_tr_b16 a[118:119], v210 offset:10240
    v_rcp_f32 v70, v70
    v_mfma_f32_16x16x32_bf16 v[60:63], a[124:127], a[60:63], v[60:63]
    ds_read_b64_tr_b16 a[120:121], v210 offset:4096
    v_rcp_f32 v71, v71
    s_waitcnt lgkmcnt(13)
    v_mfma_f32_16x16x32_bf16 v[32:35], a[128:131], a[64:67], v[32:35]
    ds_read_b64_tr_b16 a[122:123], v210 offset:6144
    global_load_lds_dwordx4 v233, s[70:71] offset:1024
    v_mul_f32 v64, v64, v68
    v_mfma_f32_16x16x32_bf16 v[32:35], a[132:135], a[72:75], v[32:35]
    ds_read_b64_tr_b16 a[124:125], v210 offset:12288
    v_mul_f32 v65, v65, v69
    v_mul_f32 v66, v66, v70
    v_mfma_f32_16x16x32_bf16 v[36:39], a[128:131], a[68:71], v[36:39]
    ds_read_b64_tr_b16 a[126:127], v210 offset:14336
    v_mul_f32 v67, v67, v71
    v_mfma_f32_16x16x32_bf16 v[36:39], a[132:135], a[76:79], v[36:39]
    ds_read_b64_tr_b16 a[128:129], v211 offset:0
    v_cvt_pk_bf16_f32 v82, v64, v65
    v_mfma_f32_16x16x32_bf16 v[48:51], a[136:139], a[64:67], v[48:51]
    ds_read_b64_tr_b16 a[130:131], v211 offset:2048
    global_load_lds_dwordx4 v234, s[70:71] offset:2048
    v_cvt_pk_bf16_f32 v83, v66, v67
    v_mfma_f32_16x16x32_bf16 v[48:51], a[140:143], a[72:75], v[48:51]
    ds_read_b64_tr_b16 a[132:133], v211 offset:8192
    ds_write_b128 v241, v[80:83] offset:0
    v_mfma_f32_16x16x32_bf16 v[52:55], a[136:139], a[68:71], v[52:55]
    ds_read_b64_tr_b16 a[134:135], v211 offset:10240
    v_mul_f32 v64, v4, v4
    v_mfma_f32_16x16x32_bf16 v[52:55], a[140:143], a[76:79], v[52:55]
    ds_read_b64_tr_b16 a[136:137], v211 offset:4096
    v_mul_f32 v65, v5, v5
    s_waitcnt lgkmcnt(14)
    v_mfma_f32_16x16x32_bf16 v[40:43], a[144:147], a[64:67], v[40:43]
    ds_read_b64_tr_b16 a[138:139], v211 offset:6144
    global_load_lds_dwordx4 v235, s[70:71] offset:3072
    v_mul_f32 v66, v6, v6
    v_mfma_f32_16x16x32_bf16 v[40:43], a[148:151], a[72:75], v[40:43]
    ds_read_b64_tr_b16 a[140:141], v211 offset:12288
    s_add_u32 m0, s42, 16384
    v_mul_f32 v67, v7, v7
    v_mfma_f32_16x16x32_bf16 v[44:47], a[144:147], a[68:71], v[44:47]
    ds_read_b64_tr_b16 a[142:143], v211 offset:14336
    s_add_u32 s70, s68, 688128
    v_fmaak_f32 v64, v64, v197, 0xc1cc422a
    v_fmaak_f32 v65, v65, v197, 0xc1cc422a
    v_mfma_f32_16x16x32_bf16 v[44:47], a[148:151], a[76:79], v[44:47]
    ds_read_b64_tr_b16 a[144:145], v210 offset:16384
    global_load_lds_dwordx4 v232, s[70:71] offset:0
    v_fmaak_f32 v66, v66, v197, 0xc1cc422a
    v_mfma_f32_16x16x32_bf16 v[56:59], a[152:155], a[64:67], v[56:59]
    ds_read_b64_tr_b16 a[146:147], v210 offset:18432
    v_fmaak_f32 v67, v67, v197, 0xc1cc422a
    v_mfma_f32_16x16x32_bf16 v[56:59], a[156:159], a[72:75], v[56:59]
    ds_read_b64_tr_b16 a[148:149], v210 offset:24576
    v_mul_f32 v64, v4, v64
    v_mfma_f32_16x16x32_bf16 v[60:63], a[152:155], a[68:71], v[60:63]
    ds_read_b64_tr_b16 a[150:151], v210 offset:26624
    v_mul_f32 v65, v5, v65
    v_mfma_f32_16x16x32_bf16 v[60:63], a[156:159], a[76:79], v[60:63]
    ds_read_b64_tr_b16 a[152:153], v210 offset:20480
    global_load_lds_dwordx4 v233, s[70:71] offset:1024
    v_mul_f32 v66, v6, v66
    s_waitcnt lgkmcnt(14)
    v_mfma_f32_16x16x32_bf16 v[32:35], a[112:115], a[80:83], v[32:35]
    ds_read_b64_tr_b16 a[154:155], v210 offset:22528
    v_mul_f32 v67, v7, v67
    v_mfma_f32_16x16x32_bf16 v[32:35], a[116:119], a[88:91], v[32:35]
    ds_read_b64_tr_b16 a[156:157], v210 offset:28672
    v_exp_f32 v68, v64
    v_mfma_f32_16x16x32_bf16 v[36:39], a[112:115], a[84:87], v[36:39]
    ds_read_b64_tr_b16 a[158:159], v210 offset:30720
    v_exp_f32 v69, v65
    v_mfma_f32_16x16x32_bf16 v[36:39], a[116:119], a[92:95], v[36:39]
    ds_read_b64_tr_b16 a[112:113], v211 offset:16384
    global_load_lds_dwordx4 v234, s[70:71] offset:2048
    v_exp_f32 v70, v66
    v_mfma_f32_16x16x32_bf16 v[48:51], a[120:123], a[80:83], v[48:51]
    ds_read_b64_tr_b16 a[114:115], v211 offset:18432
    v_exp_f32 v71, v67
    v_mul_f32 v64, v4, v20
    v_mfma_f32_16x16x32_bf16 v[48:51], a[124:127], a[88:91], v[48:51]
    ds_read_b64_tr_b16 a[116:117], v211 offset:24576
    v_mul_f32 v65, v5, v21
    v_mfma_f32_16x16x32_bf16 v[52:55], a[120:123], a[84:87], v[52:55]
    ds_read_b64_tr_b16 a[118:119], v211 offset:26624
    v_mul_f32 v66, v6, v22
    v_mfma_f32_16x16x32_bf16 v[52:55], a[124:127], a[92:95], v[52:55]
    ds_read_b64_tr_b16 a[120:121], v211 offset:20480
    global_load_lds_dwordx4 v235, s[70:71] offset:3072
    v_mul_f32 v67, v7, v23
    s_waitcnt lgkmcnt(13)
    v_mfma_f32_16x16x32_bf16 v[40:43], a[128:131], a[80:83], v[40:43]
    ds_read_b64_tr_b16 a[122:123], v211 offset:22528
    v_add_f32 v68, 1.0, v68
    v_mfma_f32_16x16x32_bf16 v[40:43], a[132:135], a[88:91], v[40:43]
    ds_read_b64_tr_b16 a[124:125], v211 offset:28672
    v_add_f32 v69, 1.0, v69
    v_mfma_f32_16x16x32_bf16 v[44:47], a[128:131], a[84:87], v[44:47]
    ds_read_b64_tr_b16 a[126:127], v211 offset:30720
    v_add_f32 v70, 1.0, v70
    v_mfma_f32_16x16x32_bf16 v[44:47], a[132:135], a[92:95], v[44:47]
    s_waitcnt vmcnt(8)
    s_barrier
    ds_read_b64_tr_b16 a[128:129], v210 offset:32768
    s_add_u32 m0, s42, 32768
    s_add_u32 s70, s68, 917504
    v_add_f32 v71, 1.0, v71
    v_mfma_f32_16x16x32_bf16 v[56:59], a[136:139], a[80:83], v[56:59]
    ds_read_b64_tr_b16 a[130:131], v210 offset:34816
    global_load_lds_dwordx4 v232, s[70:71] offset:0
    v_rcp_f32 v68, v68
    v_mfma_f32_16x16x32_bf16 v[56:59], a[140:143], a[88:91], v[56:59]
    ds_read_b64_tr_b16 a[132:133], v210 offset:40960
    v_rcp_f32 v69, v69
    v_mfma_f32_16x16x32_bf16 v[60:63], a[136:139], a[84:87], v[60:63]
    ds_read_b64_tr_b16 a[134:135], v210 offset:43008
    v_rcp_f32 v70, v70
    v_rcp_f32 v71, v71
    v_mfma_f32_16x16x32_bf16 v[60:63], a[140:143], a[92:95], v[60:63]
    ds_read_b64_tr_b16 a[136:137], v210 offset:36864
    v_mul_f32 v64, v64, v68
    s_waitcnt lgkmcnt(13)
    v_mfma_f32_16x16x32_bf16 v[32:35], a[144:147], a[96:99], v[32:35]
    ds_read_b64_tr_b16 a[138:139], v210 offset:38912
    global_load_lds_dwordx4 v233, s[70:71] offset:1024
    v_mul_f32 v65, v65, v69
    v_mfma_f32_16x16x32_bf16 v[32:35], a[148:151], a[104:107], v[32:35]
    ds_read_b64_tr_b16 a[140:141], v210 offset:45056
    v_mul_f32 v66, v66, v70
    v_mfma_f32_16x16x32_bf16 v[36:39], a[144:147], a[100:103], v[36:39]
    ds_read_b64_tr_b16 a[142:143], v210 offset:47104
    v_mul_f32 v67, v67, v71
    v_mfma_f32_16x16x32_bf16 v[36:39], a[148:151], a[108:111], v[36:39]
    ds_read_b64_tr_b16 a[144:145], v211 offset:32768
    v_cvt_pk_bf16_f32 v84, v64, v65
    v_mfma_f32_16x16x32_bf16 v[48:51], a[152:155], a[96:99], v[48:51]
    ds_read_b64_tr_b16 a[146:147], v211 offset:34816
    global_load_lds_dwordx4 v234, s[70:71] offset:2048
    v_cvt_pk_bf16_f32 v85, v66, v67
    v_mfma_f32_16x16x32_bf16 v[48:51], a[156:159], a[104:107], v[48:51]
    ds_read_b64_tr_b16 a[148:149], v211 offset:40960
    v_mul_f32 v64, v12, v12
    v_mfma_f32_16x16x32_bf16 v[52:55], a[152:155], a[100:103], v[52:55]
    ds_read_b64_tr_b16 a[150:151], v211 offset:43008
    v_mul_f32 v65, v13, v13
    v_mfma_f32_16x16x32_bf16 v[52:55], a[156:159], a[108:111], v[52:55]
    ds_read_b64_tr_b16 a[152:153], v211 offset:36864
    v_mul_f32 v66, v14, v14
    v_mul_f32 v67, v15, v15
    s_waitcnt lgkmcnt(13)
    v_mfma_f32_16x16x32_bf16 v[40:43], a[112:115], a[96:99], v[40:43]
    ds_read_b64_tr_b16 a[154:155], v211 offset:38912
    global_load_lds_dwordx4 v235, s[70:71] offset:3072
    v_fmaak_f32 v64, v64, v197, 0xc1cc422a
    v_mfma_f32_16x16x32_bf16 v[40:43], a[116:119], a[104:107], v[40:43]
    ds_read_b64_tr_b16 a[156:157], v211 offset:45056
    s_add_u32 m0, s42, 49152
    v_fmaak_f32 v65, v65, v197, 0xc1cc422a
    v_mfma_f32_16x16x32_bf16 v[44:47], a[112:115], a[100:103], v[44:47]
    ds_read_b64_tr_b16 a[158:159], v211 offset:47104
    s_add_u32 s70, s68, 1146880
    v_fmaak_f32 v66, v66, v197, 0xc1cc422a
    v_mfma_f32_16x16x32_bf16 v[44:47], a[116:119], a[108:111], v[44:47]
    ds_read_b64_tr_b16 a[112:113], v210 offset:49152
    global_load_lds_dwordx4 v232, s[70:71] offset:0
    v_fmaak_f32 v67, v67, v197, 0xc1cc422a
    v_mfma_f32_16x16x32_bf16 v[56:59], a[120:123], a[96:99], v[56:59]
    ds_read_b64_tr_b16 a[114:115], v210 offset:51200
    v_mul_f32 v64, v12, v64
    v_mfma_f32_16x16x32_bf16 v[56:59], a[124:127], a[104:107], v[56:59]
    ds_read_b64_tr_b16 a[116:117], v210 offset:57344
    v_mul_f32 v65, v13, v65
    v_mfma_f32_16x16x32_bf16 v[60:63], a[120:123], a[100:103], v[60:63]
    ds_read_b64_tr_b16 a[118:119], v210 offset:59392
    v_mul_f32 v66, v14, v66
    v_mfma_f32_16x16x32_bf16 v[60:63], a[124:127], a[108:111], v[60:63]
    ds_read_b64_tr_b16 a[120:121], v210 offset:53248
    global_load_lds_dwordx4 v233, s[70:71] offset:1024
    v_mul_f32 v67, v15, v67
    s_waitcnt lgkmcnt(13)
    v_mfma_f32_16x16x32_bf16 v[96:99], a[128:131], a[0:3], 0
    ds_read_b64_tr_b16 a[122:123], v210 offset:55296
    v_exp_f32 v68, v64
    v_mfma_f32_16x16x32_bf16 v[96:99], a[132:135], a[8:11], v[96:99]
    ds_read_b64_tr_b16 a[124:125], v210 offset:61440
    v_exp_f32 v69, v65
    v_exp_f32 v70, v66
    v_mfma_f32_16x16x32_bf16 v[100:103], a[128:131], a[4:7], 0
    ds_read_b64_tr_b16 a[126:127], v210 offset:63488
    v_exp_f32 v71, v67
    buffer_load_dword v198, v132, s[12:15], s4 offen offset:0
    v_mfma_f32_16x16x32_bf16 v[100:103], a[132:135], a[12:15], v[100:103]
    ds_read_b64_tr_b16 a[128:129], v211 offset:49152
    global_load_lds_dwordx4 v234, s[70:71] offset:2048
    v_mul_f32 v64, v12, v28
    v_mfma_f32_16x16x32_bf16 v[112:115], a[136:139], a[0:3], 0
    ds_read_b64_tr_b16 a[130:131], v211 offset:51200
    v_mul_f32 v65, v13, v29
    v_mfma_f32_16x16x32_bf16 v[112:115], a[140:143], a[8:11], v[112:115]
    ds_read_b64_tr_b16 a[132:133], v211 offset:57344
    v_mul_f32 v66, v14, v30
    v_mfma_f32_16x16x32_bf16 v[116:119], a[136:139], a[4:7], 0
    ds_read_b64_tr_b16 a[134:135], v211 offset:59392
    v_mul_f32 v67, v15, v31
    v_mfma_f32_16x16x32_bf16 v[116:119], a[140:143], a[12:15], v[116:119]
    ds_read_b64_tr_b16 a[136:137], v211 offset:53248
    global_load_lds_dwordx4 v235, s[70:71] offset:3072
    v_add_f32 v68, 1.0, v68
    s_waitcnt lgkmcnt(13)
    v_mfma_f32_16x16x32_bf16 v[104:107], a[144:147], a[0:3], 0
    ds_read_b64_tr_b16 a[138:139], v211 offset:55296
    v_add_f32 v69, 1.0, v69
    v_mfma_f32_16x16x32_bf16 v[104:107], a[148:151], a[8:11], v[104:107]
    ds_read_b64_tr_b16 a[140:141], v211 offset:61440
    v_add_f32 v70, 1.0, v70
    v_mfma_f32_16x16x32_bf16 v[108:111], a[144:147], a[4:7], 0
    ds_read_b64_tr_b16 a[142:143], v211 offset:63488
    v_add_f32 v71, 1.0, v71
    v_mfma_f32_16x16x32_bf16 v[108:111], a[148:151], a[12:15], v[108:111]
    s_waitcnt vmcnt(9)
    s_barrier
    ds_read_b64_tr_b16 a[144:145], v208 offset:0
    s_add_u32 m0, s42, 65536
    s_add_u32 s70, s68, 1376256
    v_rcp_f32 v68, v68
    v_rcp_f32 v69, v69
    v_mfma_f32_16x16x32_bf16 v[120:123], a[152:155], a[0:3], 0
    ds_read_b64_tr_b16 a[146:147], v208 offset:2048
    global_load_lds_dwordx4 v232, s[70:71] offset:0
    v_rcp_f32 v70, v70
    v_mfma_f32_16x16x32_bf16 v[120:123], a[156:159], a[8:11], v[120:123]
    ds_read_b64_tr_b16 a[148:149], v208 offset:8192
    v_rcp_f32 v71, v71
    v_mfma_f32_16x16x32_bf16 v[124:127], a[152:155], a[4:7], 0
    ds_read_b64_tr_b16 a[150:151], v208 offset:10240
    v_mul_f32 v64, v64, v68
    v_mfma_f32_16x16x32_bf16 v[124:127], a[156:159], a[12:15], v[124:127]
    ds_read_b64_tr_b16 a[152:153], v208 offset:4096
    v_mul_f32 v65, v65, v69
    s_waitcnt lgkmcnt(13)
    v_mfma_f32_16x16x32_bf16 v[96:99], a[112:115], a[16:19], v[96:99]
    ds_read_b64_tr_b16 a[154:155], v208 offset:6144
    global_load_lds_dwordx4 v233, s[70:71] offset:1024
    v_mul_f32 v66, v66, v70
    v_mfma_f32_16x16x32_bf16 v[96:99], a[116:119], a[24:27], v[96:99]
    ds_read_b64_tr_b16 a[156:157], v208 offset:12288
    v_mul_f32 v67, v67, v71
    v_mfma_f32_16x16x32_bf16 v[100:103], a[112:115], a[20:23], v[100:103]
    ds_read_b64_tr_b16 a[158:159], v208 offset:14336
    v_cvt_pk_bf16_f32 v86, v64, v65
    v_mfma_f32_16x16x32_bf16 v[100:103], a[116:119], a[28:31], v[100:103]
    ds_read_b64_tr_b16 a[112:113], v209 offset:0
    v_cvt_pk_bf16_f32 v87, v66, v67
    v_mfma_f32_16x16x32_bf16 v[112:115], a[120:123], a[16:19], v[112:115]
    ds_read_b64_tr_b16 a[114:115], v209 offset:2048
    global_load_lds_dwordx4 v234, s[70:71] offset:2048
    ds_write_b128 v241, v[84:87] offset:1024
    v_mfma_f32_16x16x32_bf16 v[112:115], a[124:127], a[24:27], v[112:115]
    ds_read_b64_tr_b16 a[116:117], v209 offset:8192
    v_mfma_f32_16x16x32_bf16 v[116:119], a[120:123], a[20:23], v[116:119]
    ds_read_b64_tr_b16 a[118:119], v209 offset:10240
    v_mfma_f32_16x16x32_bf16 v[116:119], a[124:127], a[28:31], v[116:119]
    ds_read_b64_tr_b16 a[120:121], v209 offset:4096
    s_waitcnt lgkmcnt(14)
    v_mfma_f32_16x16x32_bf16 v[104:107], a[128:131], a[16:19], v[104:107]
    ds_read_b64_tr_b16 a[122:123], v209 offset:6144
    global_load_lds_dwordx4 v235, s[70:71] offset:3072
    v_add_u32 v241, s95, v242
    v_mfma_f32_16x16x32_bf16 v[104:107], a[132:135], a[24:27], v[104:107]
    ds_read_b64_tr_b16 a[124:125], v209 offset:12288
    s_and_b32 s68, s8, 0xf0000000
    s_add_u32 s68, s68, s47
    v_mul_f32 v64, v32, v32
    v_mfma_f32_16x16x32_bf16 v[108:111], a[128:131], a[20:23], v[108:111]
    ds_read_b64_tr_b16 a[126:127], v209 offset:14336
    s_add_u32 m0, s42, 81920
    v_mul_f32 v65, v33, v33
    v_mfma_f32_16x16x32_bf16 v[108:111], a[132:135], a[28:31], v[108:111]
    ds_read_b64_tr_b16 a[128:129], v208 offset:16384
    s_add_u32 s70, s68, 0
    global_load_lds_dwordx4 v232, s[70:71] offset:0
    v_mul_f32 v66, v34, v34
    v_mul_f32 v67, v35, v35
    v_mfma_f32_16x16x32_bf16 v[120:123], a[136:139], a[16:19], v[120:123]
    ds_read_b64_tr_b16 a[130:131], v208 offset:18432
    v_fmaak_f32 v64, v64, v197, 0xc1cc422a
    v_mfma_f32_16x16x32_bf16 v[120:123], a[140:143], a[24:27], v[120:123]
    ds_read_b64_tr_b16 a[132:133], v208 offset:24576
    v_fmaak_f32 v65, v65, v197, 0xc1cc422a
    v_fmaak_f32 v66, v66, v197, 0xc1cc422a
    v_mfma_f32_16x16x32_bf16 v[124:127], a[136:139], a[20:23], v[124:127]
    ds_read_b64_tr_b16 a[134:135], v208 offset:26624
    v_fmaak_f32 v67, v67, v197, 0xc1cc422a
    v_mfma_f32_16x16x32_bf16 v[124:127], a[140:143], a[28:31], v[124:127]
    ds_read_b64_tr_b16 a[136:137], v208 offset:20480
    global_load_lds_dwordx4 v233, s[70:71] offset:1024
    v_mul_f32 v64, v32, v64
    s_waitcnt lgkmcnt(14)
    v_mfma_f32_16x16x32_bf16 v[96:99], a[144:147], a[32:35], v[96:99]
    ds_read_b64_tr_b16 a[138:139], v208 offset:22528
    v_mul_f32 v65, v33, v65
    v_mul_f32 v66, v34, v66
    v_mfma_f32_16x16x32_bf16 v[96:99], a[148:151], a[40:43], v[96:99]
    ds_read_b64_tr_b16 a[140:141], v208 offset:28672
    v_mul_f32 v67, v35, v67
    v_mfma_f32_16x16x32_bf16 v[100:103], a[144:147], a[36:39], v[100:103]
    ds_read_b64_tr_b16 a[142:143], v208 offset:30720
    v_exp_f32 v68, v64
    v_exp_f32 v69, v65
    v_mfma_f32_16x16x32_bf16 v[100:103], a[148:151], a[44:47], v[100:103]
    ds_read_b64_tr_b16 a[144:145], v209 offset:16384
    global_load_lds_dwordx4 v234, s[70:71] offset:2048
    v_exp_f32 v70, v66
    v_mfma_f32_16x16x32_bf16 v[112:115], a[152:155], a[32:35], v[112:115]
    ds_read_b64_tr_b16 a[146:147], v209 offset:18432
    v_exp_f32 v71, v67
    v_mul_f32 v64, v32, v48
    v_mfma_f32_16x16x32_bf16 v[112:115], a[156:159], a[40:43], v[112:115]
    ds_read_b64_tr_b16 a[148:149], v209 offset:24576
    v_mul_f32 v65, v33, v49
    v_mfma_f32_16x16x32_bf16 v[116:119], a[152:155], a[36:39], v[116:119]
    ds_read_b64_tr_b16 a[150:151], v209 offset:26624
    v_mul_f32 v66, v34, v50
    v_mfma_f32_16x16x32_bf16 v[116:119], a[156:159], a[44:47], v[116:119]
    ds_read_b64_tr_b16 a[152:153], v209 offset:20480
    global_load_lds_dwordx4 v235, s[70:71] offset:3072
    v_mul_f32 v67, v35, v51
    v_add_f32 v68, 1.0, v68
    s_waitcnt lgkmcnt(13)
    v_mfma_f32_16x16x32_bf16 v[104:107], a[112:115], a[32:35], v[104:107]
    ds_read_b64_tr_b16 a[154:155], v209 offset:22528
    v_add_f32 v69, 1.0, v69
    v_mfma_f32_16x16x32_bf16 v[104:107], a[116:119], a[40:43], v[104:107]
    ds_read_b64_tr_b16 a[156:157], v209 offset:28672
    v_add_f32 v70, 1.0, v70
    v_add_f32 v71, 1.0, v71
    v_mfma_f32_16x16x32_bf16 v[108:111], a[112:115], a[36:39], v[108:111]
    ds_read_b64_tr_b16 a[158:159], v209 offset:30720
    v_rcp_f32 v68, v68
    v_mfma_f32_16x16x32_bf16 v[108:111], a[116:119], a[44:47], v[108:111]
    s_waitcnt vmcnt(8)
    s_barrier
    ds_read_b64_tr_b16 a[112:113], v208 offset:32768
    s_add_u32 m0, s42, 98304
    s_add_u32 s70, s68, 229376
    v_rcp_f32 v69, v69
    v_mfma_f32_16x16x32_bf16 v[120:123], a[120:123], a[32:35], v[120:123]
    ds_read_b64_tr_b16 a[114:115], v208 offset:34816
    global_load_lds_dwordx4 v232, s[70:71] offset:0
    v_rcp_f32 v70, v70
    v_rcp_f32 v71, v71
    v_mfma_f32_16x16x32_bf16 v[120:123], a[124:127], a[40:43], v[120:123]
    ds_read_b64_tr_b16 a[116:117], v208 offset:40960
    v_mul_f32 v64, v64, v68
    v_mfma_f32_16x16x32_bf16 v[124:127], a[120:123], a[36:39], v[124:127]
    ds_read_b64_tr_b16 a[118:119], v208 offset:43008
    v_mul_f32 v65, v65, v69
    v_mul_f32 v66, v66, v70
    v_mfma_f32_16x16x32_bf16 v[124:127], a[124:127], a[44:47], v[124:127]
    ds_read_b64_tr_b16 a[120:121], v208 offset:36864
    v_mul_f32 v67, v67, v71
    s_waitcnt lgkmcnt(13)
    v_mfma_f32_16x16x32_bf16 v[96:99], a[128:131], a[48:51], v[96:99]
    ds_read_b64_tr_b16 a[122:123], v208 offset:38912
    global_load_lds_dwordx4 v233, s[70:71] offset:1024
    v_cvt_pk_bf16_f32 v80, v64, v65
    v_cvt_pk_bf16_f32 v81, v66, v67
    v_mfma_f32_16x16x32_bf16 v[96:99], a[132:135], a[56:59], v[96:99]
    ds_read_b64_tr_b16 a[124:125], v208 offset:45056
    v_mul_f32 v64, v40, v40
    v_mfma_f32_16x16x32_bf16 v[100:103], a[128:131], a[52:55], v[100:103]
    ds_read_b64_tr_b16 a[126:127], v208 offset:47104
    v_mul_f32 v65, v41, v41
    v_mfma_f32_16x16x32_bf16 v[100:103], a[132:135], a[60:63], v[100:103]
    ds_read_b64_tr_b16 a[128:129], v209 offset:32768
    v_mul_f32 v66, v42, v42
    v_mul_f32 v67, v43, v43
    v_mfma_f32_16x16x32_bf16 v[112:115], a[136:139], a[48:51], v[112:115]
    ds_read_b64_tr_b16 a[130:131], v209 offset:34816
    global_load_lds_dwordx4 v234, s[70:71] offset:2048
    v_fmaak_f32 v64, v64, v197, 0xc1cc422a
    v_mfma_f32_16x16x32_bf16 v[112:115], a[140:143], a[56:59], v[112:115]
    ds_read_b64_tr_b16 a[132:133], v209 offset:40960
    v_fmaak_f32 v65, v65, v197, 0xc1cc422a
    v_fmaak_f32 v66, v66, v197, 0xc1cc422a
    v_mfma_f32_16x16x32_bf16 v[116:119], a[136:139], a[52:55], v[116:119]
    ds_read_b64_tr_b16 a[134:135], v209 offset:43008
    v_fmaak_f32 v67, v67, v197, 0xc1cc422a
    v_mfma_f32_16x16x32_bf16 v[116:119], a[140:143], a[60:63], v[116:119]
    ds_read_b64_tr_b16 a[136:137], v209 offset:36864
    v_mul_f32 v64, v40, v64
    s_waitcnt lgkmcnt(13)
    v_mfma_f32_16x16x32_bf16 v[104:107], a[144:147], a[48:51], v[104:107]
    ds_read_b64_tr_b16 a[138:139], v209 offset:38912
    global_load_lds_dwordx4 v235, s[70:71] offset:3072
    v_mul_f32 v65, v41, v65
    v_mul_f32 v66, v42, v66
    v_mfma_f32_16x16x32_bf16 v[104:107], a[148:151], a[56:59], v[104:107]
    ds_read_b64_tr_b16 a[140:141], v209 offset:45056
    s_add_u32 m0, s42, 114688
    v_mul_f32 v67, v43, v67
    v_mfma_f32_16x16x32_bf16 v[108:111], a[144:147], a[52:55], v[108:111]
    ds_read_b64_tr_b16 a[142:143], v209 offset:47104
    s_add_u32 s70, s68, 458752
    v_exp_f32 v68, v64
    v_exp_f32 v69, v65
    v_mfma_f32_16x16x32_bf16 v[108:111], a[148:151], a[60:63], v[108:111]
    ds_read_b64_tr_b16 a[144:145], v208 offset:49152
    global_load_lds_dwordx4 v232, s[70:71] offset:0
    v_exp_f32 v70, v66
    v_mfma_f32_16x16x32_bf16 v[120:123], a[152:155], a[48:51], v[120:123]
    ds_read_b64_tr_b16 a[146:147], v208 offset:51200
    v_exp_f32 v71, v67
    v_mul_f32 v64, v40, v56
    v_mfma_f32_16x16x32_bf16 v[120:123], a[156:159], a[56:59], v[120:123]
    ds_read_b64_tr_b16 a[148:149], v208 offset:57344
    v_mul_f32 v65, v41, v57
    v_mfma_f32_16x16x32_bf16 v[124:127], a[152:155], a[52:55], v[124:127]
    ds_read_b64_tr_b16 a[150:151], v208 offset:59392
    v_mul_f32 v66, v42, v58
    v_mfma_f32_16x16x32_bf16 v[124:127], a[156:159], a[60:63], v[124:127]
    ds_read_b64_tr_b16 a[152:153], v208 offset:53248
    global_load_lds_dwordx4 v233, s[70:71] offset:1024
    v_mul_f32 v67, v43, v59
    v_add_f32 v68, 1.0, v68
    s_waitcnt lgkmcnt(13)
    v_mfma_f32_16x16x32_bf16 v[96:99], a[112:115], a[64:67], v[96:99]
    ds_read_b64_tr_b16 a[154:155], v208 offset:55296
    v_add_f32 v69, 1.0, v69
    v_mfma_f32_16x16x32_bf16 v[96:99], a[116:119], a[72:75], v[96:99]
    ds_read_b64_tr_b16 a[156:157], v208 offset:61440
    v_add_f32 v70, 1.0, v70
    v_add_f32 v71, 1.0, v71
    v_mfma_f32_16x16x32_bf16 v[100:103], a[112:115], a[68:71], v[100:103]
    ds_read_b64_tr_b16 a[158:159], v208 offset:63488
    v_rcp_f32 v68, v68
    v_mfma_f32_16x16x32_bf16 v[100:103], a[116:119], a[76:79], v[100:103]
    ds_read_b64_tr_b16 a[112:113], v209 offset:49152
    global_load_lds_dwordx4 v234, s[70:71] offset:2048
    v_rcp_f32 v69, v69
    v_mfma_f32_16x16x32_bf16 v[112:115], a[120:123], a[64:67], v[112:115]
    ds_read_b64_tr_b16 a[114:115], v209 offset:51200
    v_rcp_f32 v70, v70
    v_rcp_f32 v71, v71
    v_mfma_f32_16x16x32_bf16 v[112:115], a[124:127], a[72:75], v[112:115]
    ds_read_b64_tr_b16 a[116:117], v209 offset:57344
    v_mul_f32 v64, v64, v68
    v_mfma_f32_16x16x32_bf16 v[116:119], a[120:123], a[68:71], v[116:119]
    ds_read_b64_tr_b16 a[118:119], v209 offset:59392
    v_mul_f32 v65, v65, v69
    v_mul_f32 v66, v66, v70
    v_mfma_f32_16x16x32_bf16 v[116:119], a[124:127], a[76:79], v[116:119]
    ds_read_b64_tr_b16 a[120:121], v209 offset:53248
    global_load_lds_dwordx4 v235, s[70:71] offset:3072
    v_mul_f32 v67, v67, v71
    s_waitcnt lgkmcnt(13)
    v_mfma_f32_16x16x32_bf16 v[104:107], a[128:131], a[64:67], v[104:107]
    ds_read_b64_tr_b16 a[122:123], v209 offset:55296
    v_cvt_pk_bf16_f32 v82, v64, v65
    v_cvt_pk_bf16_f32 v83, v66, v67
    v_mfma_f32_16x16x32_bf16 v[104:107], a[132:135], a[72:75], v[104:107]
    ds_read_b64_tr_b16 a[124:125], v209 offset:61440
    ds_write_b128 v241, v[80:83] offset:0
    v_mfma_f32_16x16x32_bf16 v[108:111], a[128:131], a[68:71], v[108:111]
    ds_read_b64_tr_b16 a[126:127], v209 offset:63488
    v_mul_f32 v64, v36, v36
    v_mfma_f32_16x16x32_bf16 v[108:111], a[132:135], a[76:79], v[108:111]
    s_waitcnt vmcnt(8)
    s_barrier
    ds_read_b64_tr_b16 a[128:129], v210 offset:0
    s_add_u32 m0, s42, 0
    s_add_u32 s70, s68, 688128
    v_mul_f32 v65, v37, v37
    v_mul_f32 v66, v38, v38
    v_mfma_f32_16x16x32_bf16 v[120:123], a[136:139], a[64:67], v[120:123]
    ds_read_b64_tr_b16 a[130:131], v210 offset:2048
    global_load_lds_dwordx4 v232, s[70:71] offset:0
    v_mul_f32 v67, v39, v39
    v_mfma_f32_16x16x32_bf16 v[120:123], a[140:143], a[72:75], v[120:123]
    ds_read_b64_tr_b16 a[132:133], v210 offset:8192
    v_fmaak_f32 v64, v64, v197, 0xc1cc422a
    v_fmaak_f32 v65, v65, v197, 0xc1cc422a
    v_mfma_f32_16x16x32_bf16 v[124:127], a[136:139], a[68:71], v[124:127]
    ds_read_b64_tr_b16 a[134:135], v210 offset:10240
    v_fmaak_f32 v66, v66, v197, 0xc1cc422a
    v_mfma_f32_16x16x32_bf16 v[124:127], a[140:143], a[76:79], v[124:127]
    ds_read_b64_tr_b16 a[136:137], v210 offset:4096
    global_load_lds_dwordx4 v233, s[70:71] offset:1024
    v_fmaak_f32 v67, v67, v197, 0xc1cc422a
    v_mul_f32 v64, v36, v64
    s_waitcnt lgkmcnt(14)
    v_mfma_f32_16x16x32_bf16 v[96:99], a[144:147], a[80:83], v[96:99]
    ds_read_b64_tr_b16 a[138:139], v210 offset:6144
    v_mul_f32 v65, v37, v65
    v_mfma_f32_16x16x32_bf16 v[96:99], a[148:151], a[88:91], v[96:99]
    ds_read_b64_tr_b16 a[140:141], v210 offset:12288
    v_mul_f32 v66, v38, v66
    v_mfma_f32_16x16x32_bf16 v[100:103], a[144:147], a[84:87], v[100:103]
    ds_read_b64_tr_b16 a[142:143], v210 offset:14336
    global_load_lds_dwordx4 v234, s[70:71] offset:2048
    v_mul_f32 v67, v39, v67
    v_exp_f32 v68, v64
    v_mfma_f32_16x16x32_bf16 v[100:103], a[148:151], a[92:95], v[100:103]
    ds_read_b64_tr_b16 a[144:145], v211 offset:0
    v_exp_f32 v69, v65
    v_mfma_f32_16x16x32_bf16 v[112:115], a[152:155], a[80:83], v[112:115]
    ds_read_b64_tr_b16 a[146:147], v211 offset:2048
    v_exp_f32 v70, v66
    v_exp_f32 v71, v67
    v_mfma_f32_16x16x32_bf16 v[112:115], a[156:159], a[88:91], v[112:115]
    ds_read_b64_tr_b16 a[148:149], v211 offset:8192
    global_load_lds_dwordx4 v235, s[70:71] offset:3072
    v_mul_f32 v64, v36, v52
    v_mfma_f32_16x16x32_bf16 v[116:119], a[152:155], a[84:87], v[116:119]
    ds_read_b64_tr_b16 a[150:151], v211 offset:10240
    s_add_u32 m0, s42, 16384
    v_mul_f32 v65, v37, v53
    v_mfma_f32_16x16x32_bf16 v[116:119], a[156:159], a[92:95], v[116:119]
    ds_read_b64_tr_b16 a[152:153], v211 offset:4096
    s_add_u32 s70, s68, 917504
    global_load_lds_dwordx4 v232, s[70:71] offset:0
    v_mul_f32 v66, v38, v54
    v_mul_f32 v67, v39, v55
    s_waitcnt lgkmcnt(13)
    v_mfma_f32_16x16x32_bf16 v[104:107], a[112:115], a[80:83], v[104:107]
    ds_read_b64_tr_b16 a[154:155], v211 offset:6144
    v_add_f32 v68, 1.0, v68
    v_mfma_f32_16x16x32_bf16 v[104:107], a[116:119], a[88:91], v[104:107]
    ds_read_b64_tr_b16 a[156:157], v211 offset:12288
    v_add_f32 v69, 1.0, v69
    v_add_f32 v70, 1.0, v70
    v_mfma_f32_16x16x32_bf16 v[108:111], a[112:115], a[84:87], v[108:111]
    ds_read_b64_tr_b16 a[158:159], v211 offset:14336
    global_load_lds_dwordx4 v233, s[70:71] offset:1024
    v_add_f32 v71, 1.0, v71
    v_mfma_f32_16x16x32_bf16 v[108:111], a[116:119], a[92:95], v[108:111]
    ds_read_b64_tr_b16 a[112:113], v213 offset:16384
    v_rcp_f32 v68, v68
    v_rcp_f32 v69, v69
    v_mfma_f32_16x16x32_bf16 v[120:123], a[120:123], a[80:83], v[120:123]
    ds_read_b64_tr_b16 a[114:115], v213 offset:18432
    v_rcp_f32 v70, v70
    v_mfma_f32_16x16x32_bf16 v[120:123], a[124:127], a[88:91], v[120:123]
    ds_read_b64_tr_b16 a[116:117], v213 offset:24576
    global_load_lds_dwordx4 v234, s[70:71] offset:2048
    v_rcp_f32 v71, v71
    v_mfma_f32_16x16x32_bf16 v[124:127], a[120:123], a[84:87], v[124:127]
    ds_read_b64_tr_b16 a[118:119], v213 offset:26624
    v_mul_f32 v64, v64, v68
    v_mul_f32 v65, v65, v69
    v_mfma_f32_16x16x32_bf16 v[124:127], a[124:127], a[92:95], v[124:127]
    ds_read_b64_tr_b16 a[120:121], v213 offset:20480
    v_mul_f32 v66, v66, v70
    s_waitcnt lgkmcnt(13)
    v_mfma_f32_16x16x32_bf16 v[96:99], a[128:131], a[96:99], v[96:99]
    ds_read_b64_tr_b16 a[122:123], v213 offset:22528
    global_load_lds_dwordx4 v235, s[70:71] offset:3072
    v_mul_f32 v67, v67, v71
    v_cvt_pk_bf16_f32 v84, v64, v65
    v_mfma_f32_16x16x32_bf16 v[96:99], a[132:135], a[104:107], v[96:99]
    ds_read_b64_tr_b16 a[124:125], v213 offset:28672
    v_cvt_pk_bf16_f32 v85, v66, v67
    v_mfma_f32_16x16x32_bf16 v[100:103], a[128:131], a[100:103], v[100:103]
    ds_read_b64_tr_b16 a[126:127], v213 offset:30720
    v_mul_f32 v64, v44, v44
    v_mfma_f32_16x16x32_bf16 v[100:103], a[132:135], a[108:111], v[100:103]
    s_waitcnt vmcnt(8)
    s_barrier
    ds_read_b64_tr_b16 a[128:129], v213 offset:32768
    s_add_u32 m0, s42, 32768
    s_add_u32 s70, s68, 1146880
    v_mul_f32 v65, v45, v45
    v_mul_f32 v66, v46, v46
    v_mfma_f32_16x16x32_bf16 v[112:115], a[136:139], a[96:99], v[112:115]
    ds_read_b64_tr_b16 a[130:131], v213 offset:34816
    global_load_lds_dwordx4 v232, s[70:71] offset:0
    v_mul_f32 v67, v47, v47
    v_mfma_f32_16x16x32_bf16 v[112:115], a[140:143], a[104:107], v[112:115]
    ds_read_b64_tr_b16 a[132:133], v213 offset:40960
    v_fmaak_f32 v64, v64, v197, 0xc1cc422a
    v_fmaak_f32 v65, v65, v197, 0xc1cc422a
    v_mfma_f32_16x16x32_bf16 v[116:119], a[136:139], a[100:103], v[116:119]
    ds_read_b64_tr_b16 a[134:135], v213 offset:43008
    global_load_lds_dwordx4 v233, s[70:71] offset:1024
    v_fmaak_f32 v66, v66, v197, 0xc1cc422a
    v_mfma_f32_16x16x32_bf16 v[116:119], a[140:143], a[108:111], v[116:119]
    ds_read_b64_tr_b16 a[136:137], v213 offset:36864
    v_fmaak_f32 v67, v67, v197, 0xc1cc422a
    v_mul_f32 v64, v44, v64
    s_waitcnt lgkmcnt(13)
    v_mfma_f32_16x16x32_bf16 v[104:107], a[144:147], a[96:99], v[104:107]
    ds_read_b64_tr_b16 a[138:139], v213 offset:38912
    global_load_lds_dwordx4 v234, s[70:71] offset:2048
    v_mul_f32 v65, v45, v65
    v_mfma_f32_16x16x32_bf16 v[104:107], a[148:151], a[104:107], v[104:107]
    ds_read_b64_tr_b16 a[140:141], v213 offset:45056
    v_mul_f32 v66, v46, v66
    v_mfma_f32_16x16x32_bf16 v[108:111], a[144:147], a[100:103], v[108:111]
    ds_read_b64_tr_b16 a[142:143], v213 offset:47104
    global_load_lds_dwordx4 v235, s[70:71] offset:3072
    s_add_u32 m0, s42, 49152
    v_mul_f32 v67, v47, v67
    v_exp_f32 v68, v64
    v_mfma_f32_16x16x32_bf16 v[108:111], a[148:151], a[108:111], v[108:111]
    ds_read_b64_tr_b16 a[144:145], v213 offset:49152
    s_add_u32 s70, s68, 1376256
    global_load_lds_dwordx4 v232, s[70:71] offset:0
    v_exp_f32 v69, v65
    v_mfma_f32_16x16x32_bf16 v[120:123], a[152:155], a[96:99], v[120:123]
    ds_read_b64_tr_b16 a[146:147], v213 offset:51200
    v_exp_f32 v70, v66
    v_exp_f32 v71, v67
    v_mfma_f32_16x16x32_bf16 v[120:123], a[156:159], a[104:107], v[120:123]
    ds_read_b64_tr_b16 a[148:149], v213 offset:57344
    global_load_lds_dwordx4 v233, s[70:71] offset:1024
    v_mul_f32 v64, v44, v60
    v_mfma_f32_16x16x32_bf16 v[124:127], a[152:155], a[100:103], v[124:127]
    ds_read_b64_tr_b16 a[150:151], v213 offset:59392
    v_mul_f32 v65, v45, v61
    v_mfma_f32_16x16x32_bf16 v[124:127], a[156:159], a[108:111], v[124:127]
    ds_read_b64_tr_b16 a[152:153], v213 offset:53248
    global_load_lds_dwordx4 v234, s[70:71] offset:2048
    v_mul_f32 v66, v46, v62
    v_mul_f32 v67, v47, v63
    s_waitcnt lgkmcnt(13)
    v_mfma_f32_16x16x32_bf16 v[0:3], a[112:115], a[0:3], 0
    ds_read_b64_tr_b16 a[154:155], v213 offset:55296
    v_add_f32 v68, 1.0, v68
    v_mfma_f32_16x16x32_bf16 v[0:3], a[116:119], a[8:11], v[0:3]
    ds_read_b64_tr_b16 a[156:157], v213 offset:61440
    global_load_lds_dwordx4 v235, s[70:71] offset:3072
    v_add_f32 v69, 1.0, v69
    v_add_f32 v70, 1.0, v70
    v_mfma_f32_16x16x32_bf16 v[4:7], a[112:115], a[4:7], 0
    ds_read_b64_tr_b16 a[158:159], v213 offset:63488
    v_add_f32 v71, 1.0, v71
    v_mfma_f32_16x16x32_bf16 v[4:7], a[116:119], a[12:15], v[4:7]
    s_waitcnt vmcnt(8)
    s_barrier
    ds_read_b64_tr_b16 a[112:113], v212 offset:0
    s_and_b32 s100, s12, 0x0fffffff
    v_add_u32 v237, s100, v244
    s_mov_b32 s100, 8192
    v_mad_u32_u24 v236, v243, s100, v237
    v_add_u32 v237, 64512, v236
    v_add_u32 v238, 129024, v236
    v_add_u32 v239, 193536, v236
    s_mov_b32 s73, s13
    s_and_b32 s69, s12, 0xf0000000
    s_add_u32 s69, s69, s48
    s_add_u32 m0, s42, 65536
    s_add_u32 s72, s69, 0
    v_rcp_f32 v68, v68
    v_rcp_f32 v69, v69
    v_mfma_f32_16x16x32_bf16 v[16:19], a[120:123], a[0:3], 0
    ds_read_b64_tr_b16 a[114:115], v212 offset:2048
    global_load_lds_dwordx4 v236, s[72:73] offset:0
    v_rcp_f32 v70, v70
    v_mfma_f32_16x16x32_bf16 v[16:19], a[124:127], a[8:11], v[16:19]
    ds_read_b64_tr_b16 a[116:117], v212 offset:8192
    v_rcp_f32 v71, v71
    v_mfma_f32_16x16x32_bf16 v[20:23], a[120:123], a[4:7], 0
    ds_read_b64_tr_b16 a[118:119], v212 offset:10240
    global_load_lds_dwordx4 v237, s[72:73] offset:1024
    v_mul_f32 v64, v64, v68
    v_mul_f32 v65, v65, v69
    v_mfma_f32_16x16x32_bf16 v[20:23], a[124:127], a[12:15], v[20:23]
    ds_read_b64_tr_b16 a[120:121], v212 offset:4096
    v_mul_f32 v66, v66, v70
    s_waitcnt lgkmcnt(13)
    v_mfma_f32_16x16x32_bf16 v[0:3], a[128:131], a[16:19], v[0:3]
    ds_read_b64_tr_b16 a[122:123], v212 offset:6144
    global_load_lds_dwordx4 v238, s[72:73] offset:2048
    v_mul_f32 v67, v67, v71
    v_cvt_pk_bf16_f32 v86, v64, v65
    v_mfma_f32_16x16x32_bf16 v[0:3], a[132:135], a[24:27], v[0:3]
    ds_read_b64_tr_b16 a[124:125], v212 offset:12288
    v_cvt_pk_bf16_f32 v87, v66, v67
    v_mfma_f32_16x16x32_bf16 v[4:7], a[128:131], a[20:23], v[4:7]
    ds_read_b64_tr_b16 a[126:127], v212 offset:14336
    global_load_lds_dwordx4 v239, s[72:73] offset:3072
    s_add_u32 m0, s42, 81920
    ds_write_b128 v241, v[84:87] offset:1024
    v_mfma_f32_16x16x32_bf16 v[4:7], a[132:135], a[28:31], v[4:7]
    ds_read_b64_tr_b16 a[128:129], v212 offset:16384
    s_add_u32 s72, s69, 524288
    global_load_lds_dwordx4 v236, s[72:73] offset:0
    v_mfma_f32_16x16x32_bf16 v[16:19], a[136:139], a[16:19], v[16:19]
    ds_read_b64_tr_b16 a[130:131], v212 offset:18432
    v_mfma_f32_16x16x32_bf16 v[16:19], a[140:143], a[24:27], v[16:19]
    ds_read_b64_tr_b16 a[132:133], v212 offset:24576
    global_load_lds_dwordx4 v237, s[72:73] offset:1024
    v_mfma_f32_16x16x32_bf16 v[20:23], a[136:139], a[20:23], v[20:23]
    ds_read_b64_tr_b16 a[134:135], v212 offset:26624
    v_add_u32 v241, s96, v242
    v_mfma_f32_16x16x32_bf16 v[20:23], a[140:143], a[28:31], v[20:23]
    ds_read_b64_tr_b16 a[136:137], v212 offset:20480
    global_load_lds_dwordx4 v238, s[72:73] offset:2048
    v_mul_f32 v64, v96, v96
    s_waitcnt lgkmcnt(14)
    v_mfma_f32_16x16x32_bf16 v[0:3], a[144:147], a[32:35], v[0:3]
    ds_read_b64_tr_b16 a[138:139], v212 offset:22528
    v_mul_f32 v65, v97, v97
    v_mul_f32 v66, v98, v98
    v_mfma_f32_16x16x32_bf16 v[0:3], a[148:151], a[40:43], v[0:3]
    ds_read_b64_tr_b16 a[140:141], v212 offset:28672
    global_load_lds_dwordx4 v239, s[72:73] offset:3072
    v_mul_f32 v67, v99, v99
    v_mfma_f32_16x16x32_bf16 v[4:7], a[144:147], a[36:39], v[4:7]
    ds_read_b64_tr_b16 a[142:143], v212 offset:30720
    v_fmaak_f32 v64, v64, v197, 0xc1cc422a
    v_fmaak_f32 v65, v65, v197, 0xc1cc422a
    v_mfma_f32_16x16x32_bf16 v[4:7], a[148:151], a[44:47], v[4:7]
    s_waitcnt vmcnt(8)
    s_barrier
    ds_read_b64_tr_b16 a[144:145], v212 offset:32768
    s_add_u32 m0, s42, 98304
    s_add_u32 s72, s69, 1048576
    v_fmaak_f32 v66, v66, v197, 0xc1cc422a
    v_mfma_f32_16x16x32_bf16 v[16:19], a[152:155], a[32:35], v[16:19]
    ds_read_b64_tr_b16 a[146:147], v212 offset:34816
    global_load_lds_dwordx4 v236, s[72:73] offset:0
    v_fmaak_f32 v67, v67, v197, 0xc1cc422a
    v_mul_f32 v64, v96, v64
    v_mfma_f32_16x16x32_bf16 v[16:19], a[156:159], a[40:43], v[16:19]
    ds_read_b64_tr_b16 a[148:149], v212 offset:40960
    v_mul_f32 v65, v97, v65
    v_mfma_f32_16x16x32_bf16 v[20:23], a[152:155], a[36:39], v[20:23]
    ds_read_b64_tr_b16 a[150:151], v212 offset:43008
    global_load_lds_dwordx4 v237, s[72:73] offset:1024
    v_mul_f32 v66, v98, v66
    v_mul_f32 v67, v99, v67
    v_mfma_f32_16x16x32_bf16 v[20:23], a[156:159], a[44:47], v[20:23]
    ds_read_b64_tr_b16 a[152:153], v212 offset:36864
    v_exp_f32 v68, v64
    s_waitcnt lgkmcnt(14)
    v_mfma_f32_16x16x32_bf16 v[0:3], a[112:115], a[48:51], v[0:3]
    ds_read_b64_tr_b16 a[154:155], v212 offset:38912
    global_load_lds_dwordx4 v238, s[72:73] offset:2048
    v_exp_f32 v69, v65
    v_exp_f32 v70, v66
    v_mfma_f32_16x16x32_bf16 v[0:3], a[116:119], a[56:59], v[0:3]
    ds_read_b64_tr_b16 a[156:157], v212 offset:45056
    v_exp_f32 v71, v67
    v_mfma_f32_16x16x32_bf16 v[4:7], a[112:115], a[52:55], v[4:7]
    ds_read_b64_tr_b16 a[158:159], v212 offset:47104
    global_load_lds_dwordx4 v239, s[72:73] offset:3072
    s_add_u32 m0, s42, 114688
    v_mul_f32 v64, v96, v112
    v_mul_f32 v65, v97, v113
    v_mfma_f32_16x16x32_bf16 v[4:7], a[116:119], a[60:63], v[4:7]
    ds_read_b64_tr_b16 a[112:113], v212 offset:49152
    s_add_u32 s72, s69, 1572864
    global_load_lds_dwordx4 v236, s[72:73] offset:0
    v_mul_f32 v66, v98, v114
    v_mfma_f32_16x16x32_bf16 v[16:19], a[120:123], a[48:51], v[16:19]
    ds_read_b64_tr_b16 a[114:115], v212 offset:51200
    v_mul_f32 v67, v99, v115
    v_add_f32 v68, 1.0, v68
    v_mfma_f32_16x16x32_bf16 v[16:19], a[124:127], a[56:59], v[16:19]
    ds_read_b64_tr_b16 a[116:117], v212 offset:57344
    global_load_lds_dwordx4 v237, s[72:73] offset:1024
    v_add_f32 v69, 1.0, v69
    v_mfma_f32_16x16x32_bf16 v[20:23], a[120:123], a[52:55], v[20:23]
    ds_read_b64_tr_b16 a[118:119], v212 offset:59392
    v_add_f32 v70, 1.0, v70
    v_add_f32 v71, 1.0, v71
    v_mfma_f32_16x16x32_bf16 v[20:23], a[124:127], a[60:63], v[20:23]
    ds_read_b64_tr_b16 a[120:121], v212 offset:53248
    global_load_lds_dwordx4 v238, s[72:73] offset:2048
    v_rcp_f32 v68, v68
    s_waitcnt lgkmcnt(13)
    v_mfma_f32_16x16x32_bf16 v[0:3], a[128:131], a[64:67], v[0:3]
    ds_read_b64_tr_b16 a[122:123], v212 offset:55296
    v_rcp_f32 v69, v69
    v_rcp_f32 v70, v70
    v_mfma_f32_16x16x32_bf16 v[0:3], a[132:135], a[72:75], v[0:3]
    ds_read_b64_tr_b16 a[124:125], v212 offset:61440
    global_load_lds_dwordx4 v239, s[72:73] offset:3072
    v_rcp_f32 v71, v71
    v_mfma_f32_16x16x32_bf16 v[4:7], a[128:131], a[68:71], v[4:7]
    ds_read_b64_tr_b16 a[126:127], v212 offset:63488
    v_mul_f32 v64, v64, v68
    v_mul_f32 v65, v65, v69
    v_mfma_f32_16x16x32_bf16 v[4:7], a[132:135], a[76:79], v[4:7]
    s_waitcnt vmcnt(8)
    s_barrier
    ds_read_b64_tr_b16 a[128:129], v204 offset:0
    s_add_u32 m0, s42, 0
    s_add_u32 s72, s69, 2097152
    v_mul_f32 v66, v66, v70
    v_mfma_f32_16x16x32_bf16 v[16:19], a[136:139], a[64:67], v[16:19]
    ds_read_b64_tr_b16 a[130:131], v204 offset:2048
    global_load_lds_dwordx4 v236, s[72:73] offset:0
    v_mul_f32 v67, v67, v71
    v_cvt_pk_bf16_f32 v80, v64, v65
    v_mfma_f32_16x16x32_bf16 v[16:19], a[140:143], a[72:75], v[16:19]
    ds_read_b64_tr_b16 a[132:133], v204 offset:4096
    v_cvt_pk_bf16_f32 v81, v66, v67
    v_mfma_f32_16x16x32_bf16 v[20:23], a[136:139], a[68:71], v[20:23]
    ds_read_b64_tr_b16 a[134:135], v204 offset:6144
    v_mul_f32 v64, v104, v104
    v_mul_f32 v65, v105, v105
    v_mfma_f32_16x16x32_bf16 v[20:23], a[140:143], a[76:79], v[20:23]
    ds_read_b64_tr_b16 a[136:137], v205 offset:0
    v_mul_f32 v66, v106, v106
    s_waitcnt lgkmcnt(13)
    v_mfma_f32_16x16x32_bf16 v[0:3], a[144:147], a[80:83], v[0:3]
    ds_read_b64_tr_b16 a[138:139], v205 offset:2048
    global_load_lds_dwordx4 v237, s[72:73] offset:1024
    v_mul_f32 v67, v107, v107
    v_fmaak_f32 v64, v64, v197, 0xc1cc422a
    v_mfma_f32_16x16x32_bf16 v[0:3], a[148:151], a[88:91], v[0:3]
    ds_read_b64_tr_b16 a[140:141], v205 offset:4096
    v_fmaak_f32 v65, v65, v197, 0xc1cc422a
    v_mfma_f32_16x16x32_bf16 v[4:7], a[144:147], a[84:87], v[4:7]
    ds_read_b64_tr_b16 a[142:143], v205 offset:6144
    v_fmaak_f32 v66, v66, v197, 0xc1cc422a
    v_fmaak_f32 v67, v67, v197, 0xc1cc422a
    v_mfma_f32_16x16x32_bf16 v[4:7], a[148:151], a[92:95], v[4:7]
    ds_read_b64_tr_b16 a[144:145], v206 offset:0
    v_mul_f32 v64, v104, v64
    v_mfma_f32_16x16x32_bf16 v[16:19], a[152:155], a[80:83], v[16:19]
    ds_read_b64_tr_b16 a[146:147], v206 offset:2048
    global_load_lds_dwordx4 v238, s[72:73] offset:2048
    v_mul_f32 v65, v105, v65
    v_mul_f32 v66, v106, v66
    v_mfma_f32_16x16x32_bf16 v[16:19], a[156:159], a[88:91], v[16:19]
    ds_read_b64_tr_b16 a[148:149], v206 offset:4096
    v_mul_f32 v67, v107, v67
    v_mfma_f32_16x16x32_bf16 v[20:23], a[152:155], a[84:87], v[20:23]
    ds_read_b64_tr_b16 a[150:151], v206 offset:6144
    v_exp_f32 v68, v64
    v_exp_f32 v69, v65
    v_mfma_f32_16x16x32_bf16 v[20:23], a[156:159], a[92:95], v[20:23]
    ds_read_b64_tr_b16 a[152:153], v207 offset:0
    v_exp_f32 v70, v66
    s_waitcnt lgkmcnt(13)
    v_mfma_f32_16x16x32_bf16 v[0:3], a[112:115], a[96:99], v[0:3]
    ds_read_b64_tr_b16 a[154:155], v207 offset:2048
    global_load_lds_dwordx4 v239, s[72:73] offset:3072
    v_exp_f32 v71, v67
    v_mul_f32 v64, v104, v120
    v_mfma_f32_16x16x32_bf16 v[0:3], a[116:119], a[104:107], v[0:3]
    ds_read_b64_tr_b16 a[156:157], v207 offset:4096
    s_add_u32 m0, s42, 16384
    v_mul_f32 v65, v105, v121
    v_mfma_f32_16x16x32_bf16 v[4:7], a[112:115], a[100:103], v[4:7]
    ds_read_b64_tr_b16 a[158:159], v207 offset:6144
    s_add_u32 s72, s69, 2621440
    v_mul_f32 v66, v106, v122
    v_mul_f32 v67, v107, v123
    v_mfma_f32_16x16x32_bf16 v[4:7], a[116:119], a[108:111], v[4:7]
    ds_read_b64_tr_b16 a[112:113], v204 offset:16384
    global_load_lds_dwordx4 v236, s[72:73] offset:0
    v_add_f32 v68, 1.0, v68
    v_mfma_f32_16x16x32_bf16 v[16:19], a[120:123], a[96:99], v[16:19]
    ds_read_b64_tr_b16 a[114:115], v204 offset:18432
    v_add_f32 v69, 1.0, v69
    v_add_f32 v70, 1.0, v70
    v_mfma_f32_16x16x32_bf16 v[16:19], a[124:127], a[104:107], v[16:19]
    ds_read_b64_tr_b16 a[116:117], v204 offset:20480
    v_add_f32 v71, 1.0, v71
    v_mfma_f32_16x16x32_bf16 v[20:23], a[120:123], a[100:103], v[20:23]
    ds_read_b64_tr_b16 a[118:119], v204 offset:22528
    v_rcp_f32 v68, v68
    v_rcp_f32 v69, v69
    v_mfma_f32_16x16x32_bf16 v[20:23], a[124:127], a[108:111], v[20:23]
    ds_read_b64_tr_b16 a[120:121], v205 offset:16384
    global_load_lds_dwordx4 v237, s[72:73] offset:1024
    v_rcp_f32 v70, v70
    s_waitcnt lgkmcnt(13)
    v_mfma_f32_16x16x32_bf16 v[32:35], a[128:131], a[0:3], 0
    ds_read_b64_tr_b16 a[122:123], v205 offset:18432
    v_rcp_f32 v71, v71
    v_mul_f32 v64, v64, v68
    v_mfma_f32_16x16x32_bf16 v[32:35], a[132:135], a[8:11], v[32:35]
    ds_read_b64_tr_b16 a[124:125], v205 offset:20480
    v_mul_f32 v65, v65, v69
    v_mfma_f32_16x16x32_bf16 v[36:39], a[128:131], a[4:7], 0
    ds_read_b64_tr_b16 a[126:127], v205 offset:22528
    v_mul_f32 v66, v66, v70
    v_mul_f32 v67, v67, v71
    v_mfma_f32_16x16x32_bf16 v[36:39], a[132:135], a[12:15], v[36:39]
    ds_read_b64_tr_b16 a[128:129], v206 offset:16384
    global_load_lds_dwordx4 v238, s[72:73] offset:2048
    v_cvt_pk_bf16_f32 v82, v64, v65
    v_mfma_f32_16x16x32_bf16 v[40:43], a[136:139], a[0:3], 0
    ds_read_b64_tr_b16 a[130:131], v206 offset:18432
    v_cvt_pk_bf16_f32 v83, v66, v67
    ds_write_b128 v241, v[80:83] offset:0
    v_mfma_f32_16x16x32_bf16 v[40:43], a[140:143], a[8:11], v[40:43]
    ds_read_b64_tr_b16 a[132:133], v206 offset:20480
    v_mul_f32 v64, v100, v100
    v_mul_f32 v65, v101, v101
    v_mfma_f32_16x16x32_bf16 v[44:47], a[136:139], a[4:7], 0
    ds_read_b64_tr_b16 a[134:135], v206 offset:22528
    v_mul_f32 v66, v102, v102
    v_mfma_f32_16x16x32_bf16 v[44:47], a[140:143], a[12:15], v[44:47]
    ds_read_b64_tr_b16 a[136:137], v207 offset:16384
    global_load_lds_dwordx4 v239, s[72:73] offset:3072
    v_mul_f32 v67, v103, v103
    v_fmaak_f32 v64, v64, v197, 0xc1cc422a
    s_waitcnt lgkmcnt(14)
    v_mfma_f32_16x16x32_bf16 v[48:51], a[144:147], a[0:3], 0
    ds_read_b64_tr_b16 a[138:139], v207 offset:18432
    v_fmaak_f32 v65, v65, v197, 0xc1cc422a
    v_mfma_f32_16x16x32_bf16 v[48:51], a[148:151], a[8:11], v[48:51]
    ds_read_b64_tr_b16 a[140:141], v207 offset:20480
    v_fmaak_f32 v66, v66, v197, 0xc1cc422a
    v_fmaak_f32 v67, v67, v197, 0xc1cc422a
    v_mfma_f32_16x16x32_bf16 v[52:55], a[144:147], a[4:7], 0
    ds_read_b64_tr_b16 a[142:143], v207 offset:22528
    v_mul_f32 v64, v100, v64
    v_mfma_f32_16x16x32_bf16 v[52:55], a[148:151], a[12:15], v[52:55]
    s_waitcnt vmcnt(8)
    s_barrier
    ds_read_b64_tr_b16 a[144:145], v204 offset:32768
    s_add_u32 m0, s42, 32768
    s_add_u32 s72, s69, 3145728
    v_mul_f32 v65, v101, v65
    v_mul_f32 v66, v102, v66
    v_mfma_f32_16x16x32_bf16 v[56:59], a[152:155], a[0:3], 0
    ds_read_b64_tr_b16 a[146:147], v204 offset:34816
    global_load_lds_dwordx4 v236, s[72:73] offset:0
    v_mul_f32 v67, v103, v67
    v_mfma_f32_16x16x32_bf16 v[56:59], a[156:159], a[8:11], v[56:59]
    ds_read_b64_tr_b16 a[148:149], v204 offset:36864
    v_exp_f32 v68, v64
    v_exp_f32 v69, v65
    v_mfma_f32_16x16x32_bf16 v[60:63], a[152:155], a[4:7], 0
    ds_read_b64_tr_b16 a[150:151], v204 offset:38912
    v_exp_f32 v70, v66
    v_mfma_f32_16x16x32_bf16 v[60:63], a[156:159], a[12:15], v[60:63]
    ds_read_b64_tr_b16 a[152:153], v205 offset:32768
    v_exp_f32 v71, v67
    v_mul_f32 v64, v100, v116
    s_waitcnt lgkmcnt(14)
    v_mfma_f32_16x16x32_bf16 v[32:35], a[112:115], a[16:19], v[32:35]
    ds_read_b64_tr_b16 a[154:155], v205 offset:34816
    global_load_lds_dwordx4 v237, s[72:73] offset:1024
    v_mul_f32 v65, v101, v117
    v_mfma_f32_16x16x32_bf16 v[32:35], a[116:119], a[24:27], v[32:35]
    ds_read_b64_tr_b16 a[156:157], v205 offset:36864
    v_mul_f32 v66, v102, v118
    v_mul_f32 v67, v103, v119
    v_mfma_f32_16x16x32_bf16 v[36:39], a[112:115], a[20:23], v[36:39]
    ds_read_b64_tr_b16 a[158:159], v205 offset:38912
    v_add_f32 v68, 1.0, v68
    v_mfma_f32_16x16x32_bf16 v[36:39], a[116:119], a[28:31], v[36:39]
    ds_read_b64_tr_b16 a[112:113], v206 offset:32768
    v_add_f32 v69, 1.0, v69
    v_add_f32 v70, 1.0, v70
    v_mfma_f32_16x16x32_bf16 v[40:43], a[120:123], a[16:19], v[40:43]
    ds_read_b64_tr_b16 a[114:115], v206 offset:34816
    global_load_lds_dwordx4 v238, s[72:73] offset:2048
    v_add_f32 v71, 1.0, v71
    v_mfma_f32_16x16x32_bf16 v[40:43], a[124:127], a[24:27], v[40:43]
    ds_read_b64_tr_b16 a[116:117], v206 offset:36864
    v_rcp_f32 v68, v68
    v_rcp_f32 v69, v69
    v_mfma_f32_16x16x32_bf16 v[44:47], a[120:123], a[20:23], v[44:47]
    ds_read_b64_tr_b16 a[118:119], v206 offset:38912
    v_rcp_f32 v70, v70
    v_mfma_f32_16x16x32_bf16 v[44:47], a[124:127], a[28:31], v[44:47]
    ds_read_b64_tr_b16 a[120:121], v207 offset:32768
    v_rcp_f32 v71, v71
    v_mul_f32 v64, v64, v68
    s_waitcnt lgkmcnt(13)
    v_mfma_f32_16x16x32_bf16 v[48:51], a[128:131], a[16:19], v[48:51]
    ds_read_b64_tr_b16 a[122:123], v207 offset:34816
    global_load_lds_dwordx4 v239, s[72:73] offset:3072
    v_mul_f32 v65, v65, v69
    v_mfma_f32_16x16x32_bf16 v[48:51], a[132:135], a[24:27], v[48:51]
    ds_read_b64_tr_b16 a[124:125], v207 offset:36864
    s_add_u32 m0, s42, 49152
    v_mul_f32 v66, v66, v70
    v_mul_f32 v67, v67, v71
    v_mfma_f32_16x16x32_bf16 v[52:55], a[128:131], a[20:23], v[52:55]
    ds_read_b64_tr_b16 a[126:127], v207 offset:38912
    s_add_u32 s72, s69, 128
    v_cvt_pk_bf16_f32 v84, v64, v65
    v_mfma_f32_16x16x32_bf16 v[52:55], a[132:135], a[28:31], v[52:55]
    ds_read_b64_tr_b16 a[128:129], v204 offset:49152
    global_load_lds_dwordx4 v236, s[72:73] offset:0
    v_cvt_pk_bf16_f32 v85, v66, v67
    v_mul_f32 v64, v108, v108
    v_mfma_f32_16x16x32_bf16 v[56:59], a[136:139], a[16:19], v[56:59]
    ds_read_b64_tr_b16 a[130:131], v204 offset:51200
    v_mul_f32 v65, v109, v109
    v_mfma_f32_16x16x32_bf16 v[56:59], a[140:143], a[24:27], v[56:59]
    ds_read_b64_tr_b16 a[132:133], v204 offset:53248
    v_mul_f32 v66, v110, v110
    v_mul_f32 v67, v111, v111
    v_mfma_f32_16x16x32_bf16 v[60:63], a[136:139], a[20:23], v[60:63]
    ds_read_b64_tr_b16 a[134:135], v204 offset:55296
    v_fmaak_f32 v64, v64, v197, 0xc1cc422a
    v_mfma_f32_16x16x32_bf16 v[60:63], a[140:143], a[28:31], v[60:63]
    ds_read_b64_tr_b16 a[136:137], v205 offset:49152
    global_load_lds_dwordx4 v237, s[72:73] offset:1024
    v_fmaak_f32 v65, v65, v197, 0xc1cc422a
    v_fmaak_f32 v66, v66, v197, 0xc1cc422a
    s_waitcnt lgkmcnt(13)
    v_mfma_f32_16x16x32_bf16 v[32:35], a[144:147], a[32:35], v[32:35]
    ds_read_b64_tr_b16 a[138:139], v205 offset:51200
    v_fmaak_f32 v67, v67, v197, 0xc1cc422a
    v_mfma_f32_16x16x32_bf16 v[32:35], a[148:151], a[40:43], v[32:35]
    ds_read_b64_tr_b16 a[140:141], v205 offset:53248
    v_mul_f32 v64, v108, v64
    v_mul_f32 v65, v109, v65
    v_mfma_f32_16x16x32_bf16 v[36:39], a[144:147], a[36:39], v[36:39]
    ds_read_b64_tr_b16 a[142:143], v205 offset:55296
    v_mul_f32 v66, v110, v66
    v_mfma_f32_16x16x32_bf16 v[36:39], a[148:151], a[44:47], v[36:39]
    ds_read_b64_tr_b16 a[144:145], v206 offset:49152
    global_load_lds_dwordx4 v238, s[72:73] offset:2048
    v_mul_f32 v67, v111, v67
    v_exp_f32 v68, v64
    v_mfma_f32_16x16x32_bf16 v[40:43], a[152:155], a[32:35], v[40:43]
    ds_read_b64_tr_b16 a[146:147], v206 offset:51200
    v_exp_f32 v69, v65
    v_mfma_f32_16x16x32_bf16 v[40:43], a[156:159], a[40:43], v[40:43]
    ds_read_b64_tr_b16 a[148:149], v206 offset:53248
    v_exp_f32 v70, v66
    v_exp_f32 v71, v67
    v_mfma_f32_16x16x32_bf16 v[44:47], a[152:155], a[36:39], v[44:47]
    ds_read_b64_tr_b16 a[150:151], v206 offset:55296
    v_mul_f32 v64, v108, v124
    v_mfma_f32_16x16x32_bf16 v[44:47], a[156:159], a[44:47], v[44:47]
    ds_read_b64_tr_b16 a[152:153], v207 offset:49152
    global_load_lds_dwordx4 v239, s[72:73] offset:3072
    v_mul_f32 v65, v109, v125
    v_mul_f32 v66, v110, v126
    s_waitcnt lgkmcnt(13)
    v_mfma_f32_16x16x32_bf16 v[48:51], a[112:115], a[32:35], v[48:51]
    ds_read_b64_tr_b16 a[154:155], v207 offset:51200
    v_mul_f32 v67, v111, v127
    v_mfma_f32_16x16x32_bf16 v[48:51], a[116:119], a[40:43], v[48:51]
    ds_read_b64_tr_b16 a[156:157], v207 offset:53248
    v_add_f32 v68, 1.0, v68
    v_add_f32 v69, 1.0, v69
    v_mfma_f32_16x16x32_bf16 v[52:55], a[112:115], a[36:39], v[52:55]
    ds_read_b64_tr_b16 a[158:159], v207 offset:55296
    v_add_f32 v70, 1.0, v70
    v_mfma_f32_16x16x32_bf16 v[52:55], a[116:119], a[44:47], v[52:55]
    s_waitcnt vmcnt(8)
    s_barrier
    ds_read_b64_tr_b16 a[112:113], v200 offset:0
    s_add_u32 m0, s42, 65536
    s_add_u32 s72, s69, 524416
    v_add_f32 v71, 1.0, v71
    v_rcp_f32 v68, v68
    v_mfma_f32_16x16x32_bf16 v[56:59], a[120:123], a[32:35], v[56:59]
    ds_read_b64_tr_b16 a[114:115], v200 offset:2048
    global_load_lds_dwordx4 v236, s[72:73] offset:0
    v_rcp_f32 v69, v69
    v_mfma_f32_16x16x32_bf16 v[56:59], a[124:127], a[40:43], v[56:59]
    ds_read_b64_tr_b16 a[116:117], v200 offset:4096
    v_rcp_f32 v70, v70
    v_rcp_f32 v71, v71
    v_mfma_f32_16x16x32_bf16 v[60:63], a[120:123], a[36:39], v[60:63]
    ds_read_b64_tr_b16 a[118:119], v200 offset:6144
    v_mul_f32 v64, v64, v68
    v_mfma_f32_16x16x32_bf16 v[60:63], a[124:127], a[44:47], v[60:63]
    ds_read_b64_tr_b16 a[120:121], v201 offset:0
    v_mul_f32 v65, v65, v69
    v_mul_f32 v66, v66, v70
    s_waitcnt lgkmcnt(13)
    v_mfma_f32_16x16x32_bf16 v[32:35], a[128:131], a[48:51], v[32:35]
    ds_read_b64_tr_b16 a[122:123], v201 offset:2048
    global_load_lds_dwordx4 v237, s[72:73] offset:1024
    v_mul_f32 v67, v67, v71
    v_mfma_f32_16x16x32_bf16 v[32:35], a[132:135], a[56:59], v[32:35]
    ds_read_b64_tr_b16 a[124:125], v201 offset:4096
    v_cvt_pk_bf16_f32 v86, v64, v65
    v_cvt_pk_bf16_f32 v87, v66, v67
    v_mfma_f32_16x16x32_bf16 v[36:39], a[128:131], a[52:55], v[36:39]
    ds_read_b64_tr_b16 a[126:127], v201 offset:6144
    ds_write_b128 v241, v[84:87] offset:1024
    v_mfma_f32_16x16x32_bf16 v[36:39], a[132:135], a[60:63], v[36:39]
    ds_read_b64_tr_b16 a[128:129], v202 offset:0
    v_mfma_f32_16x16x32_bf16 v[40:43], a[136:139], a[48:51], v[40:43]
    ds_read_b64_tr_b16 a[130:131], v202 offset:2048
    global_load_lds_dwordx4 v238, s[72:73] offset:2048
    v_mfma_f32_16x16x32_bf16 v[40:43], a[140:143], a[56:59], v[40:43]
    ds_read_b64_tr_b16 a[132:133], v202 offset:4096
    v_mfma_f32_16x16x32_bf16 v[44:47], a[136:139], a[52:55], v[44:47]
    ds_read_b64_tr_b16 a[134:135], v202 offset:6144
    v_add_u32 v241, s97, v242
    v_mfma_f32_16x16x32_bf16 v[44:47], a[140:143], a[60:63], v[44:47]
    ds_read_b64_tr_b16 a[136:137], v203 offset:0
    v_mul_f32 v64, v0, v0
    s_waitcnt lgkmcnt(14)
    v_mfma_f32_16x16x32_bf16 v[48:51], a[144:147], a[48:51], v[48:51]
    ds_read_b64_tr_b16 a[138:139], v203 offset:2048
    global_load_lds_dwordx4 v239, s[72:73] offset:3072
    v_mul_f32 v65, v1, v1
    v_mfma_f32_16x16x32_bf16 v[48:51], a[148:151], a[56:59], v[48:51]
    ds_read_b64_tr_b16 a[140:141], v203 offset:4096
    s_add_u32 m0, s42, 81920
    v_mul_f32 v66, v2, v2
    v_mul_f32 v67, v3, v3
    v_mfma_f32_16x16x32_bf16 v[52:55], a[144:147], a[52:55], v[52:55]
    ds_read_b64_tr_b16 a[142:143], v203 offset:6144
    s_add_u32 s72, s69, 1048704
    v_fmaak_f32 v64, v64, v197, 0xc1cc422a
    v_mfma_f32_16x16x32_bf16 v[52:55], a[148:151], a[60:63], v[52:55]
    ds_read_b64_tr_b16 a[144:145], v200 offset:16384
    global_load_lds_dwordx4 v236, s[72:73] offset:0
    v_fmaak_f32 v65, v65, v197, 0xc1cc422a
    v_fmaak_f32 v66, v66, v197, 0xc1cc422a
    v_mfma_f32_16x16x32_bf16 v[56:59], a[152:155], a[48:51], v[56:59]
    ds_read_b64_tr_b16 a[146:147], v200 offset:18432
    v_fmaak_f32 v67, v67, v197, 0xc1cc422a
    v_mfma_f32_16x16x32_bf16 v[56:59], a[156:159], a[56:59], v[56:59]
    ds_read_b64_tr_b16 a[148:149], v200 offset:20480
    v_mul_f32 v64, v0, v64
    v_mfma_f32_16x16x32_bf16 v[60:63], a[152:155], a[52:55], v[60:63]
    ds_read_b64_tr_b16 a[150:151], v200 offset:22528
    v_mul_f32 v65, v1, v65
    v_mul_f32 v66, v2, v66
    v_mfma_f32_16x16x32_bf16 v[60:63], a[156:159], a[60:63], v[60:63]
    ds_read_b64_tr_b16 a[152:153], v201 offset:16384
    global_load_lds_dwordx4 v237, s[72:73] offset:1024
    v_mul_f32 v67, v3, v67
    s_waitcnt lgkmcnt(14)
    v_mfma_f32_16x16x32_bf16 v[32:35], a[112:115], a[64:67], v[32:35]
    ds_read_b64_tr_b16 a[154:155], v201 offset:18432
    v_exp_f32 v68, v64
    v_exp_f32 v69, v65
    v_mfma_f32_16x16x32_bf16 v[32:35], a[116:119], a[72:75], v[32:35]
    ds_read_b64_tr_b16 a[156:157], v201 offset:20480
    v_exp_f32 v70, v66
    v_mfma_f32_16x16x32_bf16 v[36:39], a[112:115], a[68:71], v[36:39]
    ds_read_b64_tr_b16 a[158:159], v201 offset:22528
    v_exp_f32 v71, v67
    v_mul_f32 v64, v0, v16
    v_mfma_f32_16x16x32_bf16 v[36:39], a[116:119], a[76:79], v[36:39]
    ds_read_b64_tr_b16 a[112:113], v202 offset:16384
    global_load_lds_dwordx4 v238, s[72:73] offset:2048
    v_mul_f32 v65, v1, v17
    v_mfma_f32_16x16x32_bf16 v[40:43], a[120:123], a[64:67], v[40:43]
    ds_read_b64_tr_b16 a[114:115], v202 offset:18432
    v_mul_f32 v66, v2, v18
    v_mfma_f32_16x16x32_bf16 v[40:43], a[124:127], a[72:75], v[40:43]
    ds_read_b64_tr_b16 a[116:117], v202 offset:20480
    v_mul_f32 v67, v3, v19
    v_add_f32 v68, 1.0, v68
    v_mfma_f32_16x16x32_bf16 v[44:47], a[120:123], a[68:71], v[44:47]
    ds_read_b64_tr_b16 a[118:119], v202 offset:22528
    v_add_f32 v69, 1.0, v69
    v_mfma_f32_16x16x32_bf16 v[44:47], a[124:127], a[76:79], v[44:47]
    ds_read_b64_tr_b16 a[120:121], v203 offset:16384
    global_load_lds_dwordx4 v239, s[72:73] offset:3072
    v_add_f32 v70, 1.0, v70
    v_add_f32 v71, 1.0, v71
    s_waitcnt lgkmcnt(13)
    v_mfma_f32_16x16x32_bf16 v[48:51], a[128:131], a[64:67], v[48:51]
    ds_read_b64_tr_b16 a[122:123], v203 offset:18432
    v_rcp_f32 v68, v68
    v_mfma_f32_16x16x32_bf16 v[48:51], a[132:135], a[72:75], v[48:51]
    ds_read_b64_tr_b16 a[124:125], v203 offset:20480
    v_rcp_f32 v69, v69
    v_mfma_f32_16x16x32_bf16 v[52:55], a[128:131], a[68:71], v[52:55]
    ds_read_b64_tr_b16 a[126:127], v203 offset:22528
    v_rcp_f32 v70, v70
    v_rcp_f32 v71, v71
    v_mfma_f32_16x16x32_bf16 v[52:55], a[132:135], a[76:79], v[52:55]
    s_waitcnt vmcnt(8)
    s_barrier
    ds_read_b64_tr_b16 a[128:129], v200 offset:32768
    s_add_u32 m0, s42, 98304
    s_add_u32 s72, s69, 1572992
    v_mul_f32 v64, v64, v68
    v_mfma_f32_16x16x32_bf16 v[56:59], a[136:139], a[64:67], v[56:59]
    ds_read_b64_tr_b16 a[130:131], v200 offset:34816
    global_load_lds_dwordx4 v236, s[72:73] offset:0
    v_mul_f32 v65, v65, v69
    v_mul_f32 v66, v66, v70
    v_mfma_f32_16x16x32_bf16 v[56:59], a[140:143], a[72:75], v[56:59]
    ds_read_b64_tr_b16 a[132:133], v200 offset:36864
    v_mul_f32 v67, v67, v71
    v_mfma_f32_16x16x32_bf16 v[60:63], a[136:139], a[68:71], v[60:63]
    ds_read_b64_tr_b16 a[134:135], v200 offset:38912
    v_cvt_pk_bf16_f32 v80, v64, v65
    v_cvt_pk_bf16_f32 v81, v66, v67
    v_mfma_f32_16x16x32_bf16 v[60:63], a[140:143], a[76:79], v[60:63]
    ds_read_b64_tr_b16 a[136:137], v201 offset:32768
    ds_write_b64 v241, v[80:81] offset:0
    s_waitcnt lgkmcnt(14)
    v_mfma_f32_16x16x32_bf16 v[32:35], a[144:147], a[80:83], v[32:35]
    ds_read_b64_tr_b16 a[138:139], v201 offset:34816
    global_load_lds_dwordx4 v237, s[72:73] offset:1024
    v_mul_f32 v64, v4, v4
    v_mfma_f32_16x16x32_bf16 v[32:35], a[148:151], a[88:91], v[32:35]
    ds_read_b64_tr_b16 a[140:141], v201 offset:36864
    v_mul_f32 v65, v5, v5
    v_mul_f32 v66, v6, v6
    v_mfma_f32_16x16x32_bf16 v[36:39], a[144:147], a[84:87], v[36:39]
    ds_read_b64_tr_b16 a[142:143], v201 offset:38912
    v_mul_f32 v67, v7, v7
    v_mfma_f32_16x16x32_bf16 v[36:39], a[148:151], a[92:95], v[36:39]
    ds_read_b64_tr_b16 a[144:145], v202 offset:32768
    v_fmaak_f32 v64, v64, v197, 0xc1cc422a
    v_fmaak_f32 v65, v65, v197, 0xc1cc422a
    v_mfma_f32_16x16x32_bf16 v[40:43], a[152:155], a[80:83], v[40:43]
    ds_read_b64_tr_b16 a[146:147], v202 offset:34816
    global_load_lds_dwordx4 v238, s[72:73] offset:2048
    v_fmaak_f32 v66, v66, v197, 0xc1cc422a
    v_mfma_f32_16x16x32_bf16 v[40:43], a[156:159], a[88:91], v[40:43]
    ds_read_b64_tr_b16 a[148:149], v202 offset:36864
    v_fmaak_f32 v67, v67, v197, 0xc1cc422a
    v_mul_f32 v64, v4, v64
    v_mfma_f32_16x16x32_bf16 v[44:47], a[152:155], a[84:87], v[44:47]
    ds_read_b64_tr_b16 a[150:151], v202 offset:38912
    v_mul_f32 v65, v5, v65
    v_mfma_f32_16x16x32_bf16 v[44:47], a[156:159], a[92:95], v[44:47]
    ds_read_b64_tr_b16 a[152:153], v203 offset:32768
    v_mul_f32 v66, v6, v66
    s_waitcnt lgkmcnt(14)
    v_mfma_f32_16x16x32_bf16 v[48:51], a[112:115], a[80:83], v[48:51]
    ds_read_b64_tr_b16 a[154:155], v203 offset:34816
    global_load_lds_dwordx4 v239, s[72:73] offset:3072
    v_mul_f32 v67, v7, v67
    v_exp_f32 v68, v64
    v_mfma_f32_16x16x32_bf16 v[48:51], a[116:119], a[88:91], v[48:51]
    ds_read_b64_tr_b16 a[156:157], v203 offset:36864
    s_add_u32 m0, s42, 114688
    v_exp_f32 v69, v65
    v_mfma_f32_16x16x32_bf16 v[52:55], a[112:115], a[84:87], v[52:55]
    ds_read_b64_tr_b16 a[158:159], v203 offset:38912
    s_add_u32 s72, s69, 2097280
    v_exp_f32 v70, v66
    v_exp_f32 v71, v67
    v_mfma_f32_16x16x32_bf16 v[52:55], a[116:119], a[92:95], v[52:55]
    ds_read_b64_tr_b16 a[112:113], v200 offset:49152
    global_load_lds_dwordx4 v236, s[72:73] offset:0
    v_mul_f32 v64, v4, v20
    v_mfma_f32_16x16x32_bf16 v[56:59], a[120:123], a[80:83], v[56:59]
    ds_read_b64_tr_b16 a[114:115], v200 offset:51200
    v_mul_f32 v65, v5, v21
    v_mfma_f32_16x16x32_bf16 v[56:59], a[124:127], a[88:91], v[56:59]
    ds_read_b64_tr_b16 a[116:117], v200 offset:53248
    v_mul_f32 v66, v6, v22
    v_mul_f32 v67, v7, v23
    v_mfma_f32_16x16x32_bf16 v[60:63], a[120:123], a[84:87], v[60:63]
    ds_read_b64_tr_b16 a[118:119], v200 offset:55296
    v_add_f32 v68, 1.0, v68
    v_mfma_f32_16x16x32_bf16 v[60:63], a[124:127], a[92:95], v[60:63]
    ds_read_b64_tr_b16 a[120:121], v201 offset:49152
    global_load_lds_dwordx4 v237, s[72:73] offset:1024
    v_add_f32 v69, 1.0, v69
    v_add_f32 v70, 1.0, v70
    s_waitcnt lgkmcnt(13)
    v_mfma_f32_16x16x32_bf16 v[32:35], a[128:131], a[96:99], v[32:35]
    ds_read_b64_tr_b16 a[122:123], v201 offset:51200
    v_add_f32 v71, 1.0, v71
    v_mfma_f32_16x16x32_bf16 v[32:35], a[132:135], a[104:107], v[32:35]
    ds_read_b64_tr_b16 a[124:125], v201 offset:53248
    v_rcp_f32 v68, v68
    v_rcp_f32 v69, v69
    v_mfma_f32_16x16x32_bf16 v[36:39], a[128:131], a[100:103], v[36:39]
    ds_read_b64_tr_b16 a[126:127], v201 offset:55296
    v_rcp_f32 v70, v70
    v_mfma_f32_16x16x32_bf16 v[36:39], a[132:135], a[108:111], v[36:39]
    ds_read_b64_tr_b16 a[128:129], v202 offset:49152
    global_load_lds_dwordx4 v238, s[72:73] offset:2048
    v_rcp_f32 v71, v71
    v_mfma_f32_16x16x32_bf16 v[40:43], a[136:139], a[96:99], v[40:43]
    ds_read_b64_tr_b16 a[130:131], v202 offset:51200
    v_mul_f32 v64, v64, v68
    v_mul_f32 v65, v65, v69
    v_mfma_f32_16x16x32_bf16 v[40:43], a[140:143], a[104:107], v[40:43]
    ds_read_b64_tr_b16 a[132:133], v202 offset:53248
    v_mul_f32 v66, v66, v70
    v_mfma_f32_16x16x32_bf16 v[44:47], a[136:139], a[100:103], v[44:47]
    ds_read_b64_tr_b16 a[134:135], v202 offset:55296
    v_mul_f32 v67, v67, v71
    v_cvt_pk_bf16_f32 v84, v64, v65
    v_mfma_f32_16x16x32_bf16 v[44:47], a[140:143], a[108:111], v[44:47]
    ds_read_b64_tr_b16 a[136:137], v203 offset:49152
    global_load_lds_dwordx4 v239, s[72:73] offset:3072
    v_cvt_pk_bf16_f32 v85, v66, v67
    s_waitcnt lgkmcnt(13)
    v_mfma_f32_16x16x32_bf16 v[48:51], a[144:147], a[96:99], v[48:51]
    ds_read_b64_tr_b16 a[138:139], v203 offset:51200
    ds_write_b64 v241, v[84:85] offset:1024
    v_mfma_f32_16x16x32_bf16 v[48:51], a[148:151], a[104:107], v[48:51]
    ds_read_b64_tr_b16 a[140:141], v203 offset:53248
    v_mfma_f32_16x16x32_bf16 v[52:55], a[144:147], a[100:103], v[52:55]
    ds_read_b64_tr_b16 a[142:143], v203 offset:55296
    v_mfma_f32_16x16x32_bf16 v[52:55], a[148:151], a[108:111], v[52:55]
    s_waitcnt vmcnt(8)
    s_barrier
    ds_read_b64_tr_b16 a[144:145], v204 offset:0
    s_add_u32 m0, s42, 0
    s_add_u32 s72, s69, 2621568
    v_mfma_f32_16x16x32_bf16 v[56:59], a[152:155], a[96:99], v[56:59]
    ds_read_b64_tr_b16 a[146:147], v204 offset:2048
    global_load_lds_dwordx4 v236, s[72:73] offset:0
    v_mfma_f32_16x16x32_bf16 v[56:59], a[156:159], a[104:107], v[56:59]
    ds_read_b64_tr_b16 a[148:149], v204 offset:4096
    v_mfma_f32_16x16x32_bf16 v[60:63], a[152:155], a[100:103], v[60:63]
    ds_read_b64_tr_b16 a[150:151], v204 offset:6144
    v_mfma_f32_16x16x32_bf16 v[60:63], a[156:159], a[108:111], v[60:63]
    ds_read_b64_tr_b16 a[152:153], v205 offset:0
    s_waitcnt lgkmcnt(14)
    v_mfma_f32_16x16x32_bf16 v[96:99], a[112:115], a[0:3], 0
    ds_read_b64_tr_b16 a[154:155], v205 offset:2048
    global_load_lds_dwordx4 v237, s[72:73] offset:1024
    v_mfma_f32_16x16x32_bf16 v[96:99], a[116:119], a[8:11], v[96:99]
    ds_read_b64_tr_b16 a[156:157], v205 offset:4096
    v_mfma_f32_16x16x32_bf16 v[100:103], a[112:115], a[4:7], 0
    ds_read_b64_tr_b16 a[158:159], v205 offset:6144
    v_mfma_f32_16x16x32_bf16 v[100:103], a[116:119], a[12:15], v[100:103]
    ds_read_b64_tr_b16 a[112:113], v206 offset:0
    v_mfma_f32_16x16x32_bf16 v[104:107], a[120:123], a[0:3], 0
    ds_read_b64_tr_b16 a[114:115], v206 offset:2048
    global_load_lds_dwordx4 v238, s[72:73] offset:2048
    v_mfma_f32_16x16x32_bf16 v[104:107], a[124:127], a[8:11], v[104:107]
    ds_read_b64_tr_b16 a[116:117], v206 offset:4096
    v_mfma_f32_16x16x32_bf16 v[108:111], a[120:123], a[4:7], 0
    ds_read_b64_tr_b16 a[118:119], v206 offset:6144
    v_cvt_pk_bf16_f32 v80, v32, v33
    v_mfma_f32_16x16x32_bf16 v[108:111], a[124:127], a[12:15], v[108:111]
    ds_read_b64_tr_b16 a[120:121], v207 offset:0
    s_waitcnt lgkmcnt(13)
    v_mfma_f32_16x16x32_bf16 v[112:115], a[128:131], a[0:3], 0
    ds_read_b64_tr_b16 a[122:123], v207 offset:2048
    global_load_lds_dwordx4 v239, s[72:73] offset:3072
    v_cvt_pk_bf16_f32 v81, v34, v35
    v_mfma_f32_16x16x32_bf16 v[112:115], a[132:135], a[8:11], v[112:115]
    ds_read_b64_tr_b16 a[124:125], v207 offset:4096
    s_add_u32 m0, s42, 16384
    v_mfma_f32_16x16x32_bf16 v[116:119], a[128:131], a[4:7], 0
    ds_read_b64_tr_b16 a[126:127], v207 offset:6144
    s_add_u32 s72, s69, 3145856
    v_cvt_pk_bf16_f32 v82, v40, v41
    v_mfma_f32_16x16x32_bf16 v[116:119], a[132:135], a[12:15], v[116:119]
    ds_read_b64_tr_b16 a[128:129], v204 offset:16384
    global_load_lds_dwordx4 v236, s[72:73] offset:0
    v_mfma_f32_16x16x32_bf16 v[120:123], a[136:139], a[0:3], 0
    ds_read_b64_tr_b16 a[130:131], v204 offset:18432
    v_cvt_pk_bf16_f32 v83, v42, v43
    v_mfma_f32_16x16x32_bf16 v[120:123], a[140:143], a[8:11], v[120:123]
    ds_read_b64_tr_b16 a[132:133], v204 offset:20480
    v_permlane32_swap_b32 v80, v82
    v_mfma_f32_16x16x32_bf16 v[124:127], a[136:139], a[4:7], 0
    ds_read_b64_tr_b16 a[134:135], v204 offset:22528
    v_permlane32_swap_b32 v81, v83
    v_mfma_f32_16x16x32_bf16 v[124:127], a[140:143], a[12:15], v[124:127]
    ds_read_b64_tr_b16 a[136:137], v205 offset:16384
    global_load_lds_dwordx4 v237, s[72:73] offset:1024
    s_waitcnt lgkmcnt(13)
    v_mfma_f32_16x16x32_bf16 v[96:99], a[144:147], a[16:19], v[96:99]
    ds_read_b64_tr_b16 a[138:139], v205 offset:18432
    s_nop 0
    v_mfma_f32_16x16x32_bf16 v[96:99], a[148:151], a[24:27], v[96:99]
    ds_read_b64_tr_b16 a[140:141], v205 offset:20480
    v_permlane16_swap_b32 v80, v82
    v_mfma_f32_16x16x32_bf16 v[100:103], a[144:147], a[20:23], v[100:103]
    ds_read_b64_tr_b16 a[142:143], v205 offset:22528
    v_permlane16_swap_b32 v81, v83
    v_mfma_f32_16x16x32_bf16 v[100:103], a[148:151], a[28:31], v[100:103]
    ds_read_b64_tr_b16 a[144:145], v206 offset:16384
    global_load_lds_dwordx4 v238, s[72:73] offset:2048
    v_mfma_f32_16x16x32_bf16 v[104:107], a[152:155], a[16:19], v[104:107]
    ds_read_b64_tr_b16 a[146:147], v206 offset:18432
    v_accvgpr_write_b32 a192, v80
    v_mfma_f32_16x16x32_bf16 v[104:107], a[156:159], a[24:27], v[104:107]
    ds_read_b64_tr_b16 a[148:149], v206 offset:20480
    v_accvgpr_write_b32 a193, v81
    v_mfma_f32_16x16x32_bf16 v[108:111], a[152:155], a[20:23], v[108:111]
    ds_read_b64_tr_b16 a[150:151], v206 offset:22528
    v_accvgpr_write_b32 a194, v82
    v_mfma_f32_16x16x32_bf16 v[108:111], a[156:159], a[28:31], v[108:111]
    ds_read_b64_tr_b16 a[152:153], v207 offset:16384
    global_load_lds_dwordx4 v239, s[72:73] offset:3072
    s_waitcnt lgkmcnt(13)
    v_mfma_f32_16x16x32_bf16 v[112:115], a[112:115], a[16:19], v[112:115]
    ds_read_b64_tr_b16 a[154:155], v207 offset:18432
    v_accvgpr_write_b32 a195, v83
    v_mfma_f32_16x16x32_bf16 v[112:115], a[116:119], a[24:27], v[112:115]
    ds_read_b64_tr_b16 a[156:157], v207 offset:20480
    v_cvt_pk_bf16_f32 v84, v36, v37
    v_mfma_f32_16x16x32_bf16 v[116:119], a[112:115], a[20:23], v[116:119]
    ds_read_b64_tr_b16 a[158:159], v207 offset:22528
    v_cvt_pk_bf16_f32 v85, v38, v39
    v_mfma_f32_16x16x32_bf16 v[116:119], a[116:119], a[28:31], v[116:119]
    s_waitcnt vmcnt(8)
    s_barrier
    ds_read_b64_tr_b16 a[112:113], v204 offset:32768
    s_add_u32 m0, s42, 32768
    s_add_u32 s72, s69, 256
    v_mfma_f32_16x16x32_bf16 v[120:123], a[120:123], a[16:19], v[120:123]
    ds_read_b64_tr_b16 a[114:115], v204 offset:34816
    global_load_lds_dwordx4 v236, s[72:73] offset:0
    v_mfma_f32_16x16x32_bf16 v[120:123], a[124:127], a[24:27], v[120:123]
    ds_read_b64_tr_b16 a[116:117], v204 offset:36864
    v_cvt_pk_bf16_f32 v86, v44, v45
    v_mfma_f32_16x16x32_bf16 v[124:127], a[120:123], a[20:23], v[124:127]
    ds_read_b64_tr_b16 a[118:119], v204 offset:38912
    v_cvt_pk_bf16_f32 v87, v46, v47
    v_mfma_f32_16x16x32_bf16 v[124:127], a[124:127], a[28:31], v[124:127]
    ds_read_b64_tr_b16 a[120:121], v205 offset:32768
    s_waitcnt lgkmcnt(13)
    v_mfma_f32_16x16x32_bf16 v[96:99], a[128:131], a[32:35], v[96:99]
    ds_read_b64_tr_b16 a[122:123], v205 offset:34816
    global_load_lds_dwordx4 v237, s[72:73] offset:1024
    v_mfma_f32_16x16x32_bf16 v[96:99], a[132:135], a[40:43], v[96:99]
    ds_read_b64_tr_b16 a[124:125], v205 offset:36864
    v_permlane32_swap_b32 v84, v86
    v_mfma_f32_16x16x32_bf16 v[100:103], a[128:131], a[36:39], v[100:103]
    ds_read_b64_tr_b16 a[126:127], v205 offset:38912
    v_permlane32_swap_b32 v85, v87
    v_mfma_f32_16x16x32_bf16 v[100:103], a[132:135], a[44:47], v[100:103]
    ds_read_b64_tr_b16 a[128:129], v206 offset:32768
    s_nop 0
    v_mfma_f32_16x16x32_bf16 v[104:107], a[136:139], a[32:35], v[104:107]
    ds_read_b64_tr_b16 a[130:131], v206 offset:34816
    global_load_lds_dwordx4 v238, s[72:73] offset:2048
    v_mfma_f32_16x16x32_bf16 v[104:107], a[140:143], a[40:43], v[104:107]
    ds_read_b64_tr_b16 a[132:133], v206 offset:36864
    v_permlane16_swap_b32 v84, v86
    v_mfma_f32_16x16x32_bf16 v[108:111], a[136:139], a[36:39], v[108:111]
    ds_read_b64_tr_b16 a[134:135], v206 offset:38912
    v_permlane16_swap_b32 v85, v87
    v_mfma_f32_16x16x32_bf16 v[108:111], a[140:143], a[44:47], v[108:111]
    ds_read_b64_tr_b16 a[136:137], v207 offset:32768
    s_waitcnt lgkmcnt(13)
    v_mfma_f32_16x16x32_bf16 v[112:115], a[144:147], a[32:35], v[112:115]
    ds_read_b64_tr_b16 a[138:139], v207 offset:34816
    global_load_lds_dwordx4 v239, s[72:73] offset:3072
    v_mfma_f32_16x16x32_bf16 v[112:115], a[148:151], a[40:43], v[112:115]
    ds_read_b64_tr_b16 a[140:141], v207 offset:36864
    s_add_u32 m0, s42, 49152
    v_mfma_f32_16x16x32_bf16 v[116:119], a[144:147], a[36:39], v[116:119]
    ds_read_b64_tr_b16 a[142:143], v207 offset:38912
    s_add_u32 s72, s69, 524544
    v_mfma_f32_16x16x32_bf16 v[116:119], a[148:151], a[44:47], v[116:119]
    ds_read_b64_tr_b16 a[144:145], v204 offset:49152
    global_load_lds_dwordx4 v236, s[72:73] offset:0
    v_mfma_f32_16x16x32_bf16 v[120:123], a[152:155], a[32:35], v[120:123]
    ds_read_b64_tr_b16 a[146:147], v204 offset:51200
    v_accvgpr_write_b32 a196, v84
    v_mfma_f32_16x16x32_bf16 v[120:123], a[156:159], a[40:43], v[120:123]
    ds_read_b64_tr_b16 a[148:149], v204 offset:53248
    v_accvgpr_write_b32 a197, v85
    v_mfma_f32_16x16x32_bf16 v[124:127], a[152:155], a[36:39], v[124:127]
    ds_read_b64_tr_b16 a[150:151], v204 offset:55296
    v_accvgpr_write_b32 a198, v86
    v_mfma_f32_16x16x32_bf16 v[124:127], a[156:159], a[44:47], v[124:127]
    ds_read_b64_tr_b16 a[152:153], v205 offset:49152
    global_load_lds_dwordx4 v237, s[72:73] offset:1024
    s_waitcnt lgkmcnt(13)
    v_mfma_f32_16x16x32_bf16 v[96:99], a[112:115], a[48:51], v[96:99]
    ds_read_b64_tr_b16 a[154:155], v205 offset:51200
    v_accvgpr_write_b32 a199, v87
    v_mfma_f32_16x16x32_bf16 v[96:99], a[116:119], a[56:59], v[96:99]
    ds_read_b64_tr_b16 a[156:157], v205 offset:53248
    v_cvt_pk_bf16_f32 v80, v48, v49
    v_mfma_f32_16x16x32_bf16 v[100:103], a[112:115], a[52:55], v[100:103]
    ds_read_b64_tr_b16 a[158:159], v205 offset:55296
    v_cvt_pk_bf16_f32 v81, v50, v51
    v_mfma_f32_16x16x32_bf16 v[100:103], a[116:119], a[60:63], v[100:103]
    ds_read_b64_tr_b16 a[112:113], v206 offset:49152
    global_load_lds_dwordx4 v238, s[72:73] offset:2048
    v_mfma_f32_16x16x32_bf16 v[104:107], a[120:123], a[48:51], v[104:107]
    ds_read_b64_tr_b16 a[114:115], v206 offset:51200
    v_cvt_pk_bf16_f32 v82, v56, v57
    v_mfma_f32_16x16x32_bf16 v[104:107], a[124:127], a[56:59], v[104:107]
    ds_read_b64_tr_b16 a[116:117], v206 offset:53248
    v_cvt_pk_bf16_f32 v83, v58, v59
    v_mfma_f32_16x16x32_bf16 v[108:111], a[120:123], a[52:55], v[108:111]
    ds_read_b64_tr_b16 a[118:119], v206 offset:55296
    v_permlane32_swap_b32 v80, v82
    v_mfma_f32_16x16x32_bf16 v[108:111], a[124:127], a[60:63], v[108:111]
    ds_read_b64_tr_b16 a[120:121], v207 offset:49152
    global_load_lds_dwordx4 v239, s[72:73] offset:3072
    s_waitcnt lgkmcnt(13)
    v_mfma_f32_16x16x32_bf16 v[112:115], a[128:131], a[48:51], v[112:115]
    ds_read_b64_tr_b16 a[122:123], v207 offset:51200
    v_permlane32_swap_b32 v81, v83
    v_mfma_f32_16x16x32_bf16 v[112:115], a[132:135], a[56:59], v[112:115]
    ds_read_b64_tr_b16 a[124:125], v207 offset:53248
    s_nop 0
    v_mfma_f32_16x16x32_bf16 v[116:119], a[128:131], a[52:55], v[116:119]
    ds_read_b64_tr_b16 a[126:127], v207 offset:55296
    v_permlane16_swap_b32 v80, v82
    v_mfma_f32_16x16x32_bf16 v[116:119], a[132:135], a[60:63], v[116:119]
    s_waitcnt vmcnt(8)
    s_barrier
    ds_read_b64_tr_b16 a[128:129], v200 offset:0
    s_add_u32 m0, s42, 65536
    s_add_u32 s72, s69, 1048832
    v_mfma_f32_16x16x32_bf16 v[120:123], a[136:139], a[48:51], v[120:123]
    ds_read_b64_tr_b16 a[130:131], v200 offset:2048
    global_load_lds_dwordx4 v236, s[72:73] offset:0
    v_mfma_f32_16x16x32_bf16 v[120:123], a[140:143], a[56:59], v[120:123]
    ds_read_b64_tr_b16 a[132:133], v200 offset:4096
    v_permlane16_swap_b32 v81, v83
    v_mfma_f32_16x16x32_bf16 v[124:127], a[136:139], a[52:55], v[124:127]
    ds_read_b64_tr_b16 a[134:135], v200 offset:6144
    v_accvgpr_write_b32 a200, v80
    v_mfma_f32_16x16x32_bf16 v[124:127], a[140:143], a[60:63], v[124:127]
    ds_read_b64_tr_b16 a[136:137], v201 offset:0
    s_waitcnt lgkmcnt(13)
    v_mfma_f32_16x16x32_bf16 v[96:99], a[144:147], a[64:67], v[96:99]
    ds_read_b64_tr_b16 a[138:139], v201 offset:2048
    global_load_lds_dwordx4 v237, s[72:73] offset:1024
    v_mfma_f32_16x16x32_bf16 v[96:99], a[148:151], a[72:75], v[96:99]
    ds_read_b64_tr_b16 a[140:141], v201 offset:4096
    v_accvgpr_write_b32 a201, v81
    v_mfma_f32_16x16x32_bf16 v[100:103], a[144:147], a[68:71], v[100:103]
    ds_read_b64_tr_b16 a[142:143], v201 offset:6144
    v_accvgpr_write_b32 a202, v82
    v_mfma_f32_16x16x32_bf16 v[100:103], a[148:151], a[76:79], v[100:103]
    ds_read_b64_tr_b16 a[144:145], v202 offset:0
    v_accvgpr_write_b32 a203, v83
    v_mfma_f32_16x16x32_bf16 v[104:107], a[152:155], a[64:67], v[104:107]
    ds_read_b64_tr_b16 a[146:147], v202 offset:2048
    global_load_lds_dwordx4 v238, s[72:73] offset:2048
    v_mfma_f32_16x16x32_bf16 v[104:107], a[156:159], a[72:75], v[104:107]
    ds_read_b64_tr_b16 a[148:149], v202 offset:4096
    v_cvt_pk_bf16_f32 v84, v52, v53
    v_mfma_f32_16x16x32_bf16 v[108:111], a[152:155], a[68:71], v[108:111]
    ds_read_b64_tr_b16 a[150:151], v202 offset:6144
    v_cvt_pk_bf16_f32 v85, v54, v55
    v_mfma_f32_16x16x32_bf16 v[108:111], a[156:159], a[76:79], v[108:111]
    ds_read_b64_tr_b16 a[152:153], v203 offset:0
    s_waitcnt lgkmcnt(13)
    v_mfma_f32_16x16x32_bf16 v[112:115], a[112:115], a[64:67], v[112:115]
    ds_read_b64_tr_b16 a[154:155], v203 offset:2048
    global_load_lds_dwordx4 v239, s[72:73] offset:3072
    v_mfma_f32_16x16x32_bf16 v[112:115], a[116:119], a[72:75], v[112:115]
    ds_read_b64_tr_b16 a[156:157], v203 offset:4096
    s_add_u32 m0, s42, 81920
    v_mfma_f32_16x16x32_bf16 v[116:119], a[112:115], a[68:71], v[116:119]
    ds_read_b64_tr_b16 a[158:159], v203 offset:6144
    s_add_u32 s72, s69, 1573120
    v_mfma_f32_16x16x32_bf16 v[116:119], a[116:119], a[76:79], v[116:119]
    ds_read_b64_tr_b16 a[112:113], v200 offset:16384
    global_load_lds_dwordx4 v236, s[72:73] offset:0
    v_mfma_f32_16x16x32_bf16 v[120:123], a[120:123], a[64:67], v[120:123]
    ds_read_b64_tr_b16 a[114:115], v200 offset:18432
    v_cvt_pk_bf16_f32 v86, v60, v61
    v_mfma_f32_16x16x32_bf16 v[120:123], a[124:127], a[72:75], v[120:123]
    ds_read_b64_tr_b16 a[116:117], v200 offset:20480
    v_cvt_pk_bf16_f32 v87, v62, v63
    v_mfma_f32_16x16x32_bf16 v[124:127], a[120:123], a[68:71], v[124:127]
    ds_read_b64_tr_b16 a[118:119], v200 offset:22528
    v_permlane32_swap_b32 v84, v86
    v_mfma_f32_16x16x32_bf16 v[124:127], a[124:127], a[76:79], v[124:127]
    ds_read_b64_tr_b16 a[120:121], v201 offset:16384
    global_load_lds_dwordx4 v237, s[72:73] offset:1024
    s_waitcnt lgkmcnt(13)
    v_mfma_f32_16x16x32_bf16 v[96:99], a[128:131], a[80:83], v[96:99]
    ds_read_b64_tr_b16 a[122:123], v201 offset:18432
    v_permlane32_swap_b32 v85, v87
    v_mfma_f32_16x16x32_bf16 v[96:99], a[132:135], a[88:91], v[96:99]
    ds_read_b64_tr_b16 a[124:125], v201 offset:20480
    s_nop 0
    v_mfma_f32_16x16x32_bf16 v[100:103], a[128:131], a[84:87], v[100:103]
    ds_read_b64_tr_b16 a[126:127], v201 offset:22528
    v_permlane16_swap_b32 v84, v86
    v_mfma_f32_16x16x32_bf16 v[100:103], a[132:135], a[92:95], v[100:103]
    ds_read_b64_tr_b16 a[128:129], v202 offset:16384
    global_load_lds_dwordx4 v238, s[72:73] offset:2048
    v_mfma_f32_16x16x32_bf16 v[104:107], a[136:139], a[80:83], v[104:107]
    ds_read_b64_tr_b16 a[130:131], v202 offset:18432
    v_permlane16_swap_b32 v85, v87
    v_mfma_f32_16x16x32_bf16 v[104:107], a[140:143], a[88:91], v[104:107]
    ds_read_b64_tr_b16 a[132:133], v202 offset:20480
    v_accvgpr_write_b32 a204, v84
    v_mfma_f32_16x16x32_bf16 v[108:111], a[136:139], a[84:87], v[108:111]
    ds_read_b64_tr_b16 a[134:135], v202 offset:22528
    v_accvgpr_write_b32 a205, v85
    v_mfma_f32_16x16x32_bf16 v[108:111], a[140:143], a[92:95], v[108:111]
    ds_read_b64_tr_b16 a[136:137], v203 offset:16384
    global_load_lds_dwordx4 v239, s[72:73] offset:3072
    s_waitcnt lgkmcnt(13)
    v_mfma_f32_16x16x32_bf16 v[112:115], a[144:147], a[80:83], v[112:115]
    ds_read_b64_tr_b16 a[138:139], v203 offset:18432
    v_accvgpr_write_b32 a206, v86
    v_mfma_f32_16x16x32_bf16 v[112:115], a[148:151], a[88:91], v[112:115]
    ds_read_b64_tr_b16 a[140:141], v203 offset:20480
    v_accvgpr_write_b32 a207, v87
    v_mfma_f32_16x16x32_bf16 v[116:119], a[144:147], a[84:87], v[116:119]
    ds_read_b64_tr_b16 a[142:143], v203 offset:22528
    v_mfma_f32_16x16x32_bf16 v[116:119], a[148:151], a[92:95], v[116:119]
    s_waitcnt vmcnt(8)
    s_barrier
    ds_read_b64_tr_b16 a[144:145], v200 offset:32768
    s_add_u32 m0, s42, 98304
    s_add_u32 s72, s69, 2097408
    v_mfma_f32_16x16x32_bf16 v[120:123], a[152:155], a[80:83], v[120:123]
    ds_read_b64_tr_b16 a[146:147], v200 offset:34816
    global_load_lds_dwordx4 v236, s[72:73] offset:0
    v_mfma_f32_16x16x32_bf16 v[120:123], a[156:159], a[88:91], v[120:123]
    ds_read_b64_tr_b16 a[148:149], v200 offset:36864
    v_mfma_f32_16x16x32_bf16 v[124:127], a[152:155], a[84:87], v[124:127]
    ds_read_b64_tr_b16 a[150:151], v200 offset:38912
    v_mfma_f32_16x16x32_bf16 v[124:127], a[156:159], a[92:95], v[124:127]
    ds_read_b64_tr_b16 a[152:153], v201 offset:32768
    s_waitcnt lgkmcnt(13)
    v_mfma_f32_16x16x32_bf16 v[96:99], a[112:115], a[96:99], v[96:99]
    ds_read_b64_tr_b16 a[154:155], v201 offset:34816
    global_load_lds_dwordx4 v237, s[72:73] offset:1024
    v_mfma_f32_16x16x32_bf16 v[96:99], a[116:119], a[104:107], v[96:99]
    ds_read_b64_tr_b16 a[156:157], v201 offset:36864
    v_mfma_f32_16x16x32_bf16 v[100:103], a[112:115], a[100:103], v[100:103]
    ds_read_b64_tr_b16 a[158:159], v201 offset:38912
    v_mfma_f32_16x16x32_bf16 v[100:103], a[116:119], a[108:111], v[100:103]
    ds_read_b64_tr_b16 a[112:113], v202 offset:32768
    v_mfma_f32_16x16x32_bf16 v[104:107], a[120:123], a[96:99], v[104:107]
    ds_read_b64_tr_b16 a[114:115], v202 offset:34816
    global_load_lds_dwordx4 v238, s[72:73] offset:2048
    v_mfma_f32_16x16x32_bf16 v[104:107], a[124:127], a[104:107], v[104:107]
    ds_read_b64_tr_b16 a[116:117], v202 offset:36864
    v_mfma_f32_16x16x32_bf16 v[108:111], a[120:123], a[100:103], v[108:111]
    ds_read_b64_tr_b16 a[118:119], v202 offset:38912
    v_mfma_f32_16x16x32_bf16 v[108:111], a[124:127], a[108:111], v[108:111]
    ds_read_b64_tr_b16 a[120:121], v203 offset:32768
    s_waitcnt lgkmcnt(13)
    v_mfma_f32_16x16x32_bf16 v[112:115], a[128:131], a[96:99], v[112:115]
    ds_read_b64_tr_b16 a[122:123], v203 offset:34816
    global_load_lds_dwordx4 v239, s[72:73] offset:3072
    v_mfma_f32_16x16x32_bf16 v[112:115], a[132:135], a[104:107], v[112:115]
    ds_read_b64_tr_b16 a[124:125], v203 offset:36864
    s_add_u32 m0, s42, 114688
    v_mfma_f32_16x16x32_bf16 v[116:119], a[128:131], a[100:103], v[116:119]
    ds_read_b64_tr_b16 a[126:127], v203 offset:38912
    s_add_u32 s72, s69, 2621696
    v_mfma_f32_16x16x32_bf16 v[116:119], a[132:135], a[108:111], v[116:119]
    ds_read_b64_tr_b16 a[128:129], v200 offset:49152
    global_load_lds_dwordx4 v236, s[72:73] offset:0
    v_mfma_f32_16x16x32_bf16 v[120:123], a[136:139], a[96:99], v[120:123]
    ds_read_b64_tr_b16 a[130:131], v200 offset:51200
    v_mfma_f32_16x16x32_bf16 v[120:123], a[140:143], a[104:107], v[120:123]
    ds_read_b64_tr_b16 a[132:133], v200 offset:53248
    v_mfma_f32_16x16x32_bf16 v[124:127], a[136:139], a[100:103], v[124:127]
    ds_read_b64_tr_b16 a[134:135], v200 offset:55296
    v_mfma_f32_16x16x32_bf16 v[124:127], a[140:143], a[108:111], v[124:127]
    ds_read_b64_tr_b16 a[136:137], v201 offset:49152
    global_load_lds_dwordx4 v237, s[72:73] offset:1024
    s_waitcnt lgkmcnt(13)
    v_mfma_f32_16x16x32_bf16 v[0:3], a[144:147], a[0:3], 0
    ds_read_b64_tr_b16 a[138:139], v201 offset:51200
    v_mfma_f32_16x16x32_bf16 v[0:3], a[148:151], a[8:11], v[0:3]
    ds_read_b64_tr_b16 a[140:141], v201 offset:53248
    v_mfma_f32_16x16x32_bf16 v[4:7], a[144:147], a[4:7], 0
    ds_read_b64_tr_b16 a[142:143], v201 offset:55296
    buffer_load_dword v198, v133, s[16:19], s5 offen offset:0
    v_mfma_f32_16x16x32_bf16 v[4:7], a[148:151], a[12:15], v[4:7]
    ds_read_b64_tr_b16 a[144:145], v202 offset:49152
    global_load_lds_dwordx4 v238, s[72:73] offset:2048
    v_mfma_f32_16x16x32_bf16 v[8:11], a[152:155], a[0:3], 0
    ds_read_b64_tr_b16 a[146:147], v202 offset:51200
    v_mfma_f32_16x16x32_bf16 v[8:11], a[156:159], a[8:11], v[8:11]
    ds_read_b64_tr_b16 a[148:149], v202 offset:53248
    v_mfma_f32_16x16x32_bf16 v[12:15], a[152:155], a[4:7], 0
    ds_read_b64_tr_b16 a[150:151], v202 offset:55296
    v_cvt_pk_bf16_f32 v80, v96, v97
    v_mfma_f32_16x16x32_bf16 v[12:15], a[156:159], a[12:15], v[12:15]
    ds_read_b64_tr_b16 a[152:153], v203 offset:49152
    global_load_lds_dwordx4 v239, s[72:73] offset:3072
    s_waitcnt lgkmcnt(13)
    v_mfma_f32_16x16x32_bf16 v[16:19], a[112:115], a[0:3], 0
    ds_read_b64_tr_b16 a[154:155], v203 offset:51200
    v_cvt_pk_bf16_f32 v81, v98, v99
    v_mfma_f32_16x16x32_bf16 v[16:19], a[116:119], a[8:11], v[16:19]
    ds_read_b64_tr_b16 a[156:157], v203 offset:53248
    v_cvt_pk_bf16_f32 v82, v104, v105
    v_mfma_f32_16x16x32_bf16 v[20:23], a[112:115], a[4:7], 0
    ds_read_b64_tr_b16 a[158:159], v203 offset:55296
    v_cvt_pk_bf16_f32 v83, v106, v107
    v_mfma_f32_16x16x32_bf16 v[20:23], a[116:119], a[12:15], v[20:23]
    s_waitcnt vmcnt(9)
    s_barrier
    ds_read_b64_tr_b16 a[112:113], v204 offset:0
    s_add_u32 m0, s42, 0
    s_add_u32 s72, s69, 3145984
    v_mfma_f32_16x16x32_bf16 v[24:27], a[120:123], a[0:3], 0
    ds_read_b64_tr_b16 a[114:115], v204 offset:2048
    global_load_lds_dwordx4 v236, s[72:73] offset:0
    v_mfma_f32_16x16x32_bf16 v[24:27], a[124:127], a[8:11], v[24:27]
    ds_read_b64_tr_b16 a[116:117], v204 offset:4096
    v_permlane32_swap_b32 v80, v82
    v_mfma_f32_16x16x32_bf16 v[28:31], a[120:123], a[4:7], 0
    ds_read_b64_tr_b16 a[118:119], v204 offset:6144
    v_permlane32_swap_b32 v81, v83
    v_mfma_f32_16x16x32_bf16 v[28:31], a[124:127], a[12:15], v[28:31]
    ds_read_b64_tr_b16 a[120:121], v205 offset:0
    s_waitcnt lgkmcnt(13)
    v_mfma_f32_16x16x32_bf16 v[0:3], a[128:131], a[16:19], v[0:3]
    ds_read_b64_tr_b16 a[122:123], v205 offset:2048
    global_load_lds_dwordx4 v237, s[72:73] offset:1024
    v_mfma_f32_16x16x32_bf16 v[0:3], a[132:135], a[24:27], v[0:3]
    ds_read_b64_tr_b16 a[124:125], v205 offset:4096
    s_nop 0
    v_mfma_f32_16x16x32_bf16 v[4:7], a[128:131], a[20:23], v[4:7]
    ds_read_b64_tr_b16 a[126:127], v205 offset:6144
    v_permlane16_swap_b32 v80, v82
    v_mfma_f32_16x16x32_bf16 v[4:7], a[132:135], a[28:31], v[4:7]
    ds_read_b64_tr_b16 a[128:129], v206 offset:0
    v_permlane16_swap_b32 v81, v83
    v_mfma_f32_16x16x32_bf16 v[8:11], a[136:139], a[16:19], v[8:11]
    ds_read_b64_tr_b16 a[130:131], v206 offset:2048
    global_load_lds_dwordx4 v238, s[72:73] offset:2048
    v_mfma_f32_16x16x32_bf16 v[8:11], a[140:143], a[24:27], v[8:11]
    ds_read_b64_tr_b16 a[132:133], v206 offset:4096
    v_accvgpr_write_b32 a208, v80
    v_mfma_f32_16x16x32_bf16 v[12:15], a[136:139], a[20:23], v[12:15]
    ds_read_b64_tr_b16 a[134:135], v206 offset:6144
    v_accvgpr_write_b32 a209, v81
    v_mfma_f32_16x16x32_bf16 v[12:15], a[140:143], a[28:31], v[12:15]
    ds_read_b64_tr_b16 a[136:137], v207 offset:0
    s_waitcnt lgkmcnt(13)
    v_mfma_f32_16x16x32_bf16 v[16:19], a[144:147], a[16:19], v[16:19]
    ds_read_b64_tr_b16 a[138:139], v207 offset:2048
    global_load_lds_dwordx4 v239, s[72:73] offset:3072
    v_mfma_f32_16x16x32_bf16 v[16:19], a[148:151], a[24:27], v[16:19]
    ds_read_b64_tr_b16 a[140:141], v207 offset:4096
    s_add_u32 m0, s42, 16384
    v_mfma_f32_16x16x32_bf16 v[20:23], a[144:147], a[20:23], v[20:23]
    ds_read_b64_tr_b16 a[142:143], v207 offset:6144
    s_add_u32 s72, s69, 384
    v_mfma_f32_16x16x32_bf16 v[20:23], a[148:151], a[28:31], v[20:23]
    ds_read_b64_tr_b16 a[144:145], v204 offset:16384
    global_load_lds_dwordx4 v236, s[72:73] offset:0
    v_accvgpr_write_b32 a210, v82
    v_mfma_f32_16x16x32_bf16 v[24:27], a[152:155], a[16:19], v[24:27]
    ds_read_b64_tr_b16 a[146:147], v204 offset:18432
    v_accvgpr_write_b32 a211, v83
    v_mfma_f32_16x16x32_bf16 v[24:27], a[156:159], a[24:27], v[24:27]
    ds_read_b64_tr_b16 a[148:149], v204 offset:20480
    v_cvt_pk_bf16_f32 v84, v100, v101
    v_mfma_f32_16x16x32_bf16 v[28:31], a[152:155], a[20:23], v[28:31]
    ds_read_b64_tr_b16 a[150:151], v204 offset:22528
    v_cvt_pk_bf16_f32 v85, v102, v103
    v_mfma_f32_16x16x32_bf16 v[28:31], a[156:159], a[28:31], v[28:31]
    ds_read_b64_tr_b16 a[152:153], v205 offset:16384
    global_load_lds_dwordx4 v237, s[72:73] offset:1024
    s_waitcnt lgkmcnt(13)
    v_mfma_f32_16x16x32_bf16 v[0:3], a[112:115], a[32:35], v[0:3]
    ds_read_b64_tr_b16 a[154:155], v205 offset:18432
    v_cvt_pk_bf16_f32 v86, v108, v109
    v_mfma_f32_16x16x32_bf16 v[0:3], a[116:119], a[40:43], v[0:3]
    ds_read_b64_tr_b16 a[156:157], v205 offset:20480
    v_cvt_pk_bf16_f32 v87, v110, v111
    v_mfma_f32_16x16x32_bf16 v[4:7], a[112:115], a[36:39], v[4:7]
    ds_read_b64_tr_b16 a[158:159], v205 offset:22528
    v_permlane32_swap_b32 v84, v86
    v_mfma_f32_16x16x32_bf16 v[4:7], a[116:119], a[44:47], v[4:7]
    ds_read_b64_tr_b16 a[112:113], v206 offset:16384
    global_load_lds_dwordx4 v238, s[72:73] offset:2048
    v_mfma_f32_16x16x32_bf16 v[8:11], a[120:123], a[32:35], v[8:11]
    ds_read_b64_tr_b16 a[114:115], v206 offset:18432
    v_permlane32_swap_b32 v85, v87
    v_mfma_f32_16x16x32_bf16 v[8:11], a[124:127], a[40:43], v[8:11]
    ds_read_b64_tr_b16 a[116:117], v206 offset:20480
    s_nop 0
    v_mfma_f32_16x16x32_bf16 v[12:15], a[120:123], a[36:39], v[12:15]
    ds_read_b64_tr_b16 a[118:119], v206 offset:22528
    v_permlane16_swap_b32 v84, v86
    v_mfma_f32_16x16x32_bf16 v[12:15], a[124:127], a[44:47], v[12:15]
    ds_read_b64_tr_b16 a[120:121], v207 offset:16384
    global_load_lds_dwordx4 v239, s[72:73] offset:3072
    s_waitcnt lgkmcnt(13)
    v_mfma_f32_16x16x32_bf16 v[16:19], a[128:131], a[32:35], v[16:19]
    ds_read_b64_tr_b16 a[122:123], v207 offset:18432
    v_permlane16_swap_b32 v85, v87
    v_mfma_f32_16x16x32_bf16 v[16:19], a[132:135], a[40:43], v[16:19]
    ds_read_b64_tr_b16 a[124:125], v207 offset:20480
    v_accvgpr_write_b32 a212, v84
    v_mfma_f32_16x16x32_bf16 v[20:23], a[128:131], a[36:39], v[20:23]
    ds_read_b64_tr_b16 a[126:127], v207 offset:22528
    v_accvgpr_write_b32 a213, v85
    v_mfma_f32_16x16x32_bf16 v[20:23], a[132:135], a[44:47], v[20:23]
    s_waitcnt vmcnt(8)
    s_barrier
    ds_read_b64_tr_b16 a[128:129], v204 offset:32768
    s_add_u32 m0, s42, 32768
    s_add_u32 s72, s69, 524672
    v_mfma_f32_16x16x32_bf16 v[24:27], a[136:139], a[32:35], v[24:27]
    ds_read_b64_tr_b16 a[130:131], v204 offset:34816
    global_load_lds_dwordx4 v236, s[72:73] offset:0
    v_mfma_f32_16x16x32_bf16 v[24:27], a[140:143], a[40:43], v[24:27]
    ds_read_b64_tr_b16 a[132:133], v204 offset:36864
    v_accvgpr_write_b32 a214, v86
    v_mfma_f32_16x16x32_bf16 v[28:31], a[136:139], a[36:39], v[28:31]
    ds_read_b64_tr_b16 a[134:135], v204 offset:38912
    v_accvgpr_write_b32 a215, v87
    v_mfma_f32_16x16x32_bf16 v[28:31], a[140:143], a[44:47], v[28:31]
    ds_read_b64_tr_b16 a[136:137], v205 offset:32768
    s_waitcnt lgkmcnt(13)
    v_mfma_f32_16x16x32_bf16 v[0:3], a[144:147], a[48:51], v[0:3]
    ds_read_b64_tr_b16 a[138:139], v205 offset:34816
    global_load_lds_dwordx4 v237, s[72:73] offset:1024
    v_mfma_f32_16x16x32_bf16 v[0:3], a[148:151], a[56:59], v[0:3]
    ds_read_b64_tr_b16 a[140:141], v205 offset:36864
    v_cvt_pk_bf16_f32 v80, v112, v113
    v_mfma_f32_16x16x32_bf16 v[4:7], a[144:147], a[52:55], v[4:7]
    ds_read_b64_tr_b16 a[142:143], v205 offset:38912
    v_cvt_pk_bf16_f32 v81, v114, v115
    v_mfma_f32_16x16x32_bf16 v[4:7], a[148:151], a[60:63], v[4:7]
    ds_read_b64_tr_b16 a[144:145], v206 offset:32768
    v_cvt_pk_bf16_f32 v82, v120, v121
    v_mfma_f32_16x16x32_bf16 v[8:11], a[152:155], a[48:51], v[8:11]
    ds_read_b64_tr_b16 a[146:147], v206 offset:34816
    global_load_lds_dwordx4 v238, s[72:73] offset:2048
    v_mfma_f32_16x16x32_bf16 v[8:11], a[156:159], a[56:59], v[8:11]
    ds_read_b64_tr_b16 a[148:149], v206 offset:36864
    v_cvt_pk_bf16_f32 v83, v122, v123
    v_mfma_f32_16x16x32_bf16 v[12:15], a[152:155], a[52:55], v[12:15]
    ds_read_b64_tr_b16 a[150:151], v206 offset:38912
    v_permlane32_swap_b32 v80, v82
    v_mfma_f32_16x16x32_bf16 v[12:15], a[156:159], a[60:63], v[12:15]
    ds_read_b64_tr_b16 a[152:153], v207 offset:32768
    s_waitcnt lgkmcnt(13)
    v_mfma_f32_16x16x32_bf16 v[16:19], a[112:115], a[48:51], v[16:19]
    ds_read_b64_tr_b16 a[154:155], v207 offset:34816
    global_load_lds_dwordx4 v239, s[72:73] offset:3072
    v_mfma_f32_16x16x32_bf16 v[16:19], a[116:119], a[56:59], v[16:19]
    ds_read_b64_tr_b16 a[156:157], v207 offset:36864
    s_add_u32 m0, s42, 49152
    v_mfma_f32_16x16x32_bf16 v[20:23], a[112:115], a[52:55], v[20:23]
    ds_read_b64_tr_b16 a[158:159], v207 offset:38912
    s_add_u32 s72, s69, 1048960
    v_mfma_f32_16x16x32_bf16 v[20:23], a[116:119], a[60:63], v[20:23]
    ds_read_b64_tr_b16 a[112:113], v204 offset:49152
    global_load_lds_dwordx4 v236, s[72:73] offset:0
    v_mfma_f32_16x16x32_bf16 v[24:27], a[120:123], a[48:51], v[24:27]
    ds_read_b64_tr_b16 a[114:115], v204 offset:51200
    v_permlane32_swap_b32 v81, v83
    v_mfma_f32_16x16x32_bf16 v[24:27], a[124:127], a[56:59], v[24:27]
    ds_read_b64_tr_b16 a[116:117], v204 offset:53248
    s_nop 0
    v_mfma_f32_16x16x32_bf16 v[28:31], a[120:123], a[52:55], v[28:31]
    ds_read_b64_tr_b16 a[118:119], v204 offset:55296
    v_permlane16_swap_b32 v80, v82
    v_mfma_f32_16x16x32_bf16 v[28:31], a[124:127], a[60:63], v[28:31]
    ds_read_b64_tr_b16 a[120:121], v205 offset:49152
    global_load_lds_dwordx4 v237, s[72:73] offset:1024
    s_waitcnt lgkmcnt(13)
    v_mfma_f32_16x16x32_bf16 v[0:3], a[128:131], a[64:67], v[0:3]
    ds_read_b64_tr_b16 a[122:123], v205 offset:51200
    v_permlane16_swap_b32 v81, v83
    v_mfma_f32_16x16x32_bf16 v[0:3], a[132:135], a[72:75], v[0:3]
    ds_read_b64_tr_b16 a[124:125], v205 offset:53248
    v_accvgpr_write_b32 a216, v80
    v_mfma_f32_16x16x32_bf16 v[4:7], a[128:131], a[68:71], v[4:7]
    ds_read_b64_tr_b16 a[126:127], v205 offset:55296
    v_accvgpr_write_b32 a217, v81
    v_mfma_f32_16x16x32_bf16 v[4:7], a[132:135], a[76:79], v[4:7]
    ds_read_b64_tr_b16 a[128:129], v206 offset:49152
    global_load_lds_dwordx4 v238, s[72:73] offset:2048
    v_mfma_f32_16x16x32_bf16 v[8:11], a[136:139], a[64:67], v[8:11]
    ds_read_b64_tr_b16 a[130:131], v206 offset:51200
    v_accvgpr_write_b32 a218, v82
    v_mfma_f32_16x16x32_bf16 v[8:11], a[140:143], a[72:75], v[8:11]
    ds_read_b64_tr_b16 a[132:133], v206 offset:53248
    v_accvgpr_write_b32 a219, v83
    v_mfma_f32_16x16x32_bf16 v[12:15], a[136:139], a[68:71], v[12:15]
    ds_read_b64_tr_b16 a[134:135], v206 offset:55296
    v_cvt_pk_bf16_f32 v84, v116, v117
    v_mfma_f32_16x16x32_bf16 v[12:15], a[140:143], a[76:79], v[12:15]
    ds_read_b64_tr_b16 a[136:137], v207 offset:49152
    global_load_lds_dwordx4 v239, s[72:73] offset:3072
    s_waitcnt lgkmcnt(13)
    v_mfma_f32_16x16x32_bf16 v[16:19], a[144:147], a[64:67], v[16:19]
    ds_read_b64_tr_b16 a[138:139], v207 offset:51200
    v_cvt_pk_bf16_f32 v85, v118, v119
    v_mfma_f32_16x16x32_bf16 v[16:19], a[148:151], a[72:75], v[16:19]
    ds_read_b64_tr_b16 a[140:141], v207 offset:53248
    v_cvt_pk_bf16_f32 v86, v124, v125
    v_mfma_f32_16x16x32_bf16 v[20:23], a[144:147], a[68:71], v[20:23]
    ds_read_b64_tr_b16 a[142:143], v207 offset:55296
    v_cvt_pk_bf16_f32 v87, v126, v127
    v_mfma_f32_16x16x32_bf16 v[20:23], a[148:151], a[76:79], v[20:23]
    s_waitcnt vmcnt(8)
    s_barrier
    ds_read_b64_tr_b16 a[144:145], v200 offset:0
    s_add_u32 m0, s42, 65536
    s_add_u32 s72, s69, 1573248
    v_mfma_f32_16x16x32_bf16 v[24:27], a[152:155], a[64:67], v[24:27]
    ds_read_b64_tr_b16 a[146:147], v200 offset:2048
    global_load_lds_dwordx4 v236, s[72:73] offset:0
    v_mfma_f32_16x16x32_bf16 v[24:27], a[156:159], a[72:75], v[24:27]
    ds_read_b64_tr_b16 a[148:149], v200 offset:4096
    v_permlane32_swap_b32 v84, v86
    v_mfma_f32_16x16x32_bf16 v[28:31], a[152:155], a[68:71], v[28:31]
    ds_read_b64_tr_b16 a[150:151], v200 offset:6144
    v_permlane32_swap_b32 v85, v87
    v_mfma_f32_16x16x32_bf16 v[28:31], a[156:159], a[76:79], v[28:31]
    ds_read_b64_tr_b16 a[152:153], v201 offset:0
    s_waitcnt lgkmcnt(13)
    v_mfma_f32_16x16x32_bf16 v[0:3], a[112:115], a[80:83], v[0:3]
    ds_read_b64_tr_b16 a[154:155], v201 offset:2048
    global_load_lds_dwordx4 v237, s[72:73] offset:1024
    v_mfma_f32_16x16x32_bf16 v[0:3], a[116:119], a[88:91], v[0:3]
    ds_read_b64_tr_b16 a[156:157], v201 offset:4096
    s_nop 0
    v_mfma_f32_16x16x32_bf16 v[4:7], a[112:115], a[84:87], v[4:7]
    ds_read_b64_tr_b16 a[158:159], v201 offset:6144
    v_permlane16_swap_b32 v84, v86
    v_mfma_f32_16x16x32_bf16 v[4:7], a[116:119], a[92:95], v[4:7]
    ds_read_b64_tr_b16 a[112:113], v202 offset:0
    v_permlane16_swap_b32 v85, v87
    v_mfma_f32_16x16x32_bf16 v[8:11], a[120:123], a[80:83], v[8:11]
    ds_read_b64_tr_b16 a[114:115], v202 offset:2048
    global_load_lds_dwordx4 v238, s[72:73] offset:2048
    v_mfma_f32_16x16x32_bf16 v[8:11], a[124:127], a[88:91], v[8:11]
    ds_read_b64_tr_b16 a[116:117], v202 offset:4096
    v_accvgpr_write_b32 a220, v84
    v_mfma_f32_16x16x32_bf16 v[12:15], a[120:123], a[84:87], v[12:15]
    ds_read_b64_tr_b16 a[118:119], v202 offset:6144
    v_accvgpr_write_b32 a221, v85
    v_mfma_f32_16x16x32_bf16 v[12:15], a[124:127], a[92:95], v[12:15]
    ds_read_b64_tr_b16 a[120:121], v203 offset:0
    s_waitcnt lgkmcnt(13)
    v_mfma_f32_16x16x32_bf16 v[16:19], a[128:131], a[80:83], v[16:19]
    ds_read_b64_tr_b16 a[122:123], v203 offset:2048
    global_load_lds_dwordx4 v239, s[72:73] offset:3072
    v_mfma_f32_16x16x32_bf16 v[16:19], a[132:135], a[88:91], v[16:19]
    ds_read_b64_tr_b16 a[124:125], v203 offset:4096
    s_add_u32 m0, s42, 81920
    v_mfma_f32_16x16x32_bf16 v[20:23], a[128:131], a[84:87], v[20:23]
    ds_read_b64_tr_b16 a[126:127], v203 offset:6144
    s_add_u32 s72, s69, 2097536
    v_mfma_f32_16x16x32_bf16 v[20:23], a[132:135], a[92:95], v[20:23]
    ds_read_b64_tr_b16 a[128:129], v200 offset:16384
    global_load_lds_dwordx4 v236, s[72:73] offset:0
    v_mfma_f32_16x16x32_bf16 v[24:27], a[136:139], a[80:83], v[24:27]
    ds_read_b64_tr_b16 a[130:131], v200 offset:18432
    v_accvgpr_write_b32 a222, v86
    v_mfma_f32_16x16x32_bf16 v[24:27], a[140:143], a[88:91], v[24:27]
    ds_read_b64_tr_b16 a[132:133], v200 offset:20480
    v_accvgpr_write_b32 a223, v87
    v_mfma_f32_16x16x32_bf16 v[28:31], a[136:139], a[84:87], v[28:31]
    ds_read_b64_tr_b16 a[134:135], v200 offset:22528
    v_mfma_f32_16x16x32_bf16 v[28:31], a[140:143], a[92:95], v[28:31]
    ds_read_b64_tr_b16 a[136:137], v201 offset:16384
    global_load_lds_dwordx4 v237, s[72:73] offset:1024
    s_waitcnt lgkmcnt(13)
    v_mfma_f32_16x16x32_bf16 v[0:3], a[144:147], a[96:99], v[0:3]
    ds_read_b64_tr_b16 a[138:139], v201 offset:18432
    v_mfma_f32_16x16x32_bf16 v[0:3], a[148:151], a[104:107], v[0:3]
    ds_read_b64_tr_b16 a[140:141], v201 offset:20480
    v_mfma_f32_16x16x32_bf16 v[4:7], a[144:147], a[100:103], v[4:7]
    ds_read_b64_tr_b16 a[142:143], v201 offset:22528
    v_mfma_f32_16x16x32_bf16 v[4:7], a[148:151], a[108:111], v[4:7]
    ds_read_b64_tr_b16 a[144:145], v202 offset:16384
    global_load_lds_dwordx4 v238, s[72:73] offset:2048
    v_mfma_f32_16x16x32_bf16 v[8:11], a[152:155], a[96:99], v[8:11]
    ds_read_b64_tr_b16 a[146:147], v202 offset:18432
    v_mfma_f32_16x16x32_bf16 v[8:11], a[156:159], a[104:107], v[8:11]
    ds_read_b64_tr_b16 a[148:149], v202 offset:20480
    v_mfma_f32_16x16x32_bf16 v[12:15], a[152:155], a[100:103], v[12:15]
    ds_read_b64_tr_b16 a[150:151], v202 offset:22528
    v_mfma_f32_16x16x32_bf16 v[12:15], a[156:159], a[108:111], v[12:15]
    ds_read_b64_tr_b16 a[152:153], v203 offset:16384
    global_load_lds_dwordx4 v239, s[72:73] offset:3072
    s_waitcnt lgkmcnt(13)
    v_mfma_f32_16x16x32_bf16 v[16:19], a[112:115], a[96:99], v[16:19]
    ds_read_b64_tr_b16 a[154:155], v203 offset:18432
    v_mfma_f32_16x16x32_bf16 v[16:19], a[116:119], a[104:107], v[16:19]
    ds_read_b64_tr_b16 a[156:157], v203 offset:20480
    v_mfma_f32_16x16x32_bf16 v[20:23], a[112:115], a[100:103], v[20:23]
    ds_read_b64_tr_b16 a[158:159], v203 offset:22528
    v_mfma_f32_16x16x32_bf16 v[20:23], a[116:119], a[108:111], v[20:23]
    s_waitcnt vmcnt(8)
    s_barrier
    ds_read_b64_tr_b16 a[112:113], v200 offset:32768
    s_add_u32 m0, s42, 98304
    s_add_u32 s72, s69, 2621824
    v_mfma_f32_16x16x32_bf16 v[24:27], a[120:123], a[96:99], v[24:27]
    ds_read_b64_tr_b16 a[114:115], v200 offset:34816
    global_load_lds_dwordx4 v236, s[72:73] offset:0
    v_mfma_f32_16x16x32_bf16 v[24:27], a[124:127], a[104:107], v[24:27]
    ds_read_b64_tr_b16 a[116:117], v200 offset:36864
    v_mfma_f32_16x16x32_bf16 v[28:31], a[120:123], a[100:103], v[28:31]
    ds_read_b64_tr_b16 a[118:119], v200 offset:38912
    v_mfma_f32_16x16x32_bf16 v[28:31], a[124:127], a[108:111], v[28:31]
    ds_read_b64_tr_b16 a[120:121], v201 offset:32768
    s_waitcnt lgkmcnt(13)
    v_mfma_f32_16x16x32_bf16 v[32:35], a[128:131], a[0:3], 0
    ds_read_b64_tr_b16 a[122:123], v201 offset:34816
    global_load_lds_dwordx4 v237, s[72:73] offset:1024
    v_mfma_f32_16x16x32_bf16 v[32:35], a[132:135], a[8:11], v[32:35]
    ds_read_b64_tr_b16 a[124:125], v201 offset:36864
    v_mfma_f32_16x16x32_bf16 v[36:39], a[128:131], a[4:7], 0
    ds_read_b64_tr_b16 a[126:127], v201 offset:38912
    v_mfma_f32_16x16x32_bf16 v[36:39], a[132:135], a[12:15], v[36:39]
    ds_read_b64_tr_b16 a[128:129], v202 offset:32768
    v_mfma_f32_16x16x32_bf16 v[40:43], a[136:139], a[0:3], 0
    ds_read_b64_tr_b16 a[130:131], v202 offset:34816
    global_load_lds_dwordx4 v238, s[72:73] offset:2048
    v_mfma_f32_16x16x32_bf16 v[40:43], a[140:143], a[8:11], v[40:43]
    ds_read_b64_tr_b16 a[132:133], v202 offset:36864
    v_mfma_f32_16x16x32_bf16 v[44:47], a[136:139], a[4:7], 0
    ds_read_b64_tr_b16 a[134:135], v202 offset:38912
    v_cvt_pk_bf16_f32 v80, v0, v1
    v_mfma_f32_16x16x32_bf16 v[44:47], a[140:143], a[12:15], v[44:47]
    ds_read_b64_tr_b16 a[136:137], v203 offset:32768
    s_waitcnt lgkmcnt(13)
    v_mfma_f32_16x16x32_bf16 v[48:51], a[144:147], a[0:3], 0
    ds_read_b64_tr_b16 a[138:139], v203 offset:34816
    global_load_lds_dwordx4 v239, s[72:73] offset:3072
    v_cvt_pk_bf16_f32 v81, v2, v3
    v_mfma_f32_16x16x32_bf16 v[48:51], a[148:151], a[8:11], v[48:51]
    ds_read_b64_tr_b16 a[140:141], v203 offset:36864
    s_add_u32 m0, s42, 114688
    v_mfma_f32_16x16x32_bf16 v[52:55], a[144:147], a[4:7], 0
    ds_read_b64_tr_b16 a[142:143], v203 offset:38912
    s_add_u32 s72, s69, 3146112
    v_cvt_pk_bf16_f32 v82, v8, v9
    v_mfma_f32_16x16x32_bf16 v[52:55], a[148:151], a[12:15], v[52:55]
    ds_read_b64_tr_b16 a[144:145], v200 offset:49152
    global_load_lds_dwordx4 v236, s[72:73] offset:0
    v_mfma_f32_16x16x32_bf16 v[56:59], a[152:155], a[0:3], 0
    ds_read_b64_tr_b16 a[146:147], v200 offset:51200
    v_cvt_pk_bf16_f32 v83, v10, v11
    v_mfma_f32_16x16x32_bf16 v[56:59], a[156:159], a[8:11], v[56:59]
    ds_read_b64_tr_b16 a[148:149], v200 offset:53248
    v_permlane32_swap_b32 v80, v82
    v_mfma_f32_16x16x32_bf16 v[60:63], a[152:155], a[4:7], 0
    ds_read_b64_tr_b16 a[150:151], v200 offset:55296
    v_permlane32_swap_b32 v81, v83
    v_mfma_f32_16x16x32_bf16 v[60:63], a[156:159], a[12:15], v[60:63]
    ds_read_b64_tr_b16 a[152:153], v201 offset:49152
    global_load_lds_dwordx4 v237, s[72:73] offset:1024
    s_waitcnt lgkmcnt(13)
    v_mfma_f32_16x16x32_bf16 v[32:35], a[112:115], a[16:19], v[32:35]
    ds_read_b64_tr_b16 a[154:155], v201 offset:51200
    v_mfma_f32_16x16x32_bf16 v[32:35], a[116:119], a[24:27], v[32:35]
    ds_read_b64_tr_b16 a[156:157], v201 offset:53248
    ds_read_b128 a[0:3], v242 offset:0
    ds_read_b128 a[4:7], v242 offset:1024
    v_mfma_f32_16x16x32_bf16 v[36:39], a[112:115], a[20:23], v[36:39]
    ds_read_b64_tr_b16 a[158:159], v201 offset:55296
    s_nop 0
    v_mfma_f32_16x16x32_bf16 v[36:39], a[116:119], a[28:31], v[36:39]
    ds_read_b64_tr_b16 a[112:113], v202 offset:49152
    global_load_lds_dwordx4 v238, s[72:73] offset:2048
    ds_read_b128 a[8:11], v242 offset:4096
    ds_read_b128 a[12:15], v242 offset:5120
    v_mfma_f32_16x16x32_bf16 v[40:43], a[120:123], a[16:19], v[40:43]
    ds_read_b64_tr_b16 a[114:115], v202 offset:51200
    v_permlane16_swap_b32 v80, v82
    v_mfma_f32_16x16x32_bf16 v[40:43], a[124:127], a[24:27], v[40:43]
    ds_read_b64_tr_b16 a[116:117], v202 offset:53248
    v_permlane16_swap_b32 v81, v83
    v_mfma_f32_16x16x32_bf16 v[44:47], a[120:123], a[20:23], v[44:47]
    ds_read_b64_tr_b16 a[118:119], v202 offset:55296
    v_accvgpr_write_b32 a224, v80
    v_mfma_f32_16x16x32_bf16 v[44:47], a[124:127], a[28:31], v[44:47]
    ds_read_b64_tr_b16 a[120:121], v203 offset:49152
    global_load_lds_dwordx4 v239, s[72:73] offset:3072
    s_waitcnt lgkmcnt(15)
    v_mfma_f32_16x16x32_bf16 v[48:51], a[128:131], a[16:19], v[48:51]
    ds_read_b64_tr_b16 a[122:123], v203 offset:51200
    v_accvgpr_write_b32 a225, v81
    v_mfma_f32_16x16x32_bf16 v[48:51], a[132:135], a[24:27], v[48:51]
    ds_read_b64_tr_b16 a[124:125], v203 offset:53248
    v_accvgpr_write_b32 a226, v82
    v_mfma_f32_16x16x32_bf16 v[52:55], a[128:131], a[20:23], v[52:55]
    ds_read_b64_tr_b16 a[126:127], v203 offset:55296
    v_accvgpr_write_b32 a227, v83
    v_mfma_f32_16x16x32_bf16 v[52:55], a[132:135], a[28:31], v[52:55]
    s_waitcnt vmcnt(8)
    s_barrier
    ds_read_b64_tr_b16 a[128:129], v204 offset:0
    s_and_b32 s100, s16, 0x0fffffff
    v_add_u32 v233, s100, v244
    s_mov_b32 s100, 896
    v_mad_u32_u24 v232, v243, s100, v233
    v_add_u32 v233, 6144, v232
    v_add_u32 v234, 12288, v232
    v_add_u32 v235, 18432, v232
    s_mov_b32 s71, s17
    s_and_b32 s68, s16, 0xf0000000
    s_add_u32 s68, s68, s49
    s_add_u32 m0, s42, 0
    s_add_u32 s70, s68, 0
    v_mfma_f32_16x16x32_bf16 v[56:59], a[136:139], a[16:19], v[56:59]
    ds_read_b64_tr_b16 a[130:131], v204 offset:2048
    global_load_lds_dwordx4 v232, s[70:71] offset:0
    v_mfma_f32_16x16x32_bf16 v[56:59], a[140:143], a[24:27], v[56:59]
    ds_read_b64_tr_b16 a[132:133], v204 offset:4096
    v_cvt_pk_bf16_f32 v84, v4, v5
    v_mfma_f32_16x16x32_bf16 v[60:63], a[136:139], a[20:23], v[60:63]
    ds_read_b64_tr_b16 a[134:135], v204 offset:6144
    v_cvt_pk_bf16_f32 v85, v6, v7
    v_mfma_f32_16x16x32_bf16 v[60:63], a[140:143], a[28:31], v[60:63]
    ds_read_b64_tr_b16 a[136:137], v205 offset:0
    s_waitcnt lgkmcnt(15)
    v_mfma_f32_16x16x32_bf16 v[32:35], a[144:147], a[32:35], v[32:35]
    ds_read_b64_tr_b16 a[138:139], v205 offset:2048
    global_load_lds_dwordx4 v233, s[70:71] offset:1024
    v_mfma_f32_16x16x32_bf16 v[32:35], a[148:151], a[40:43], v[32:35]
    ds_read_b64_tr_b16 a[140:141], v205 offset:4096
    ds_read_b128 a[16:19], v242 offset:8192
    ds_read_b128 a[20:23], v242 offset:9216
    v_mfma_f32_16x16x32_bf16 v[36:39], a[144:147], a[36:39], v[36:39]
    ds_read_b64_tr_b16 a[142:143], v205 offset:6144
    v_cvt_pk_bf16_f32 v86, v12, v13
    v_mfma_f32_16x16x32_bf16 v[36:39], a[148:151], a[44:47], v[36:39]
    ds_read_b64_tr_b16 a[144:145], v206 offset:0
    ds_read_b128 a[24:27], v242 offset:12288
    ds_read_b128 a[28:31], v242 offset:13312
    v_mfma_f32_16x16x32_bf16 v[40:43], a[152:155], a[32:35], v[40:43]
    ds_read_b64_tr_b16 a[146:147], v206 offset:2048
    global_load_lds_dwordx4 v234, s[70:71] offset:2048
    v_mfma_f32_16x16x32_bf16 v[40:43], a[156:159], a[40:43], v[40:43]
    ds_read_b64_tr_b16 a[148:149], v206 offset:4096
    v_cvt_pk_bf16_f32 v87, v14, v15
    v_mfma_f32_16x16x32_bf16 v[44:47], a[152:155], a[36:39], v[44:47]
    ds_read_b64_tr_b16 a[150:151], v206 offset:6144
    v_permlane32_swap_b32 v84, v86
    v_mfma_f32_16x16x32_bf16 v[44:47], a[156:159], a[44:47], v[44:47]
    ds_read_b64_tr_b16 a[152:153], v207 offset:0
    s_waitcnt lgkmcnt(15)
    v_mfma_f32_16x16x32_bf16 v[48:51], a[112:115], a[32:35], v[48:51]
    ds_read_b64_tr_b16 a[154:155], v207 offset:2048
    global_load_lds_dwordx4 v235, s[70:71] offset:3072
    v_permlane32_swap_b32 v85, v87
    v_mfma_f32_16x16x32_bf16 v[48:51], a[116:119], a[40:43], v[48:51]
    ds_read_b64_tr_b16 a[156:157], v207 offset:4096
    s_add_u32 m0, s42, 16384
    v_mfma_f32_16x16x32_bf16 v[52:55], a[112:115], a[36:39], v[52:55]
    ds_read_b64_tr_b16 a[158:159], v207 offset:6144
    s_add_u32 s70, s68, 57344
    s_nop 0
    v_mfma_f32_16x16x32_bf16 v[52:55], a[116:119], a[44:47], v[52:55]
    ds_read_b64_tr_b16 a[112:113], v204 offset:16384
    global_load_lds_dwordx4 v232, s[70:71] offset:0
    v_mfma_f32_16x16x32_bf16 v[56:59], a[120:123], a[32:35], v[56:59]
    ds_read_b64_tr_b16 a[114:115], v204 offset:18432
    v_permlane16_swap_b32 v84, v86
    v_mfma_f32_16x16x32_bf16 v[56:59], a[124:127], a[40:43], v[56:59]
    ds_read_b64_tr_b16 a[116:117], v204 offset:20480
    v_permlane16_swap_b32 v85, v87
    v_mfma_f32_16x16x32_bf16 v[60:63], a[120:123], a[36:39], v[60:63]
    ds_read_b64_tr_b16 a[118:119], v204 offset:22528
    v_accvgpr_write_b32 a228, v84
    v_mfma_f32_16x16x32_bf16 v[60:63], a[124:127], a[44:47], v[60:63]
    ds_read_b64_tr_b16 a[120:121], v205 offset:16384
    global_load_lds_dwordx4 v233, s[70:71] offset:1024
    s_waitcnt lgkmcnt(15)
    v_mfma_f32_16x16x32_bf16 v[32:35], a[128:131], a[48:51], v[32:35]
    ds_read_b64_tr_b16 a[122:123], v205 offset:18432
    v_mfma_f32_16x16x32_bf16 v[32:35], a[132:135], a[56:59], v[32:35]
    ds_read_b64_tr_b16 a[124:125], v205 offset:20480
    ds_read_b128 a[32:35], v242 offset:16384
    ds_read_b128 a[36:39], v242 offset:17408
    v_mfma_f32_16x16x32_bf16 v[36:39], a[128:131], a[52:55], v[36:39]
    ds_read_b64_tr_b16 a[126:127], v205 offset:22528
    v_accvgpr_write_b32 a229, v85
    v_mfma_f32_16x16x32_bf16 v[36:39], a[132:135], a[60:63], v[36:39]
    ds_read_b64_tr_b16 a[128:129], v206 offset:16384
    global_load_lds_dwordx4 v234, s[70:71] offset:2048
    ds_read_b128 a[40:43], v242 offset:20480
    ds_read_b128 a[44:47], v242 offset:21504
    v_mfma_f32_16x16x32_bf16 v[40:43], a[136:139], a[48:51], v[40:43]
    ds_read_b64_tr_b16 a[130:131], v206 offset:18432
    v_accvgpr_write_b32 a230, v86
    v_mfma_f32_16x16x32_bf16 v[40:43], a[140:143], a[56:59], v[40:43]
    ds_read_b64_tr_b16 a[132:133], v206 offset:20480
    v_accvgpr_write_b32 a231, v87
    v_mfma_f32_16x16x32_bf16 v[44:47], a[136:139], a[52:55], v[44:47]
    ds_read_b64_tr_b16 a[134:135], v206 offset:22528
    v_cvt_pk_bf16_f32 v80, v16, v17
    v_mfma_f32_16x16x32_bf16 v[44:47], a[140:143], a[60:63], v[44:47]
    ds_read_b64_tr_b16 a[136:137], v207 offset:16384
    global_load_lds_dwordx4 v235, s[70:71] offset:3072
    s_waitcnt lgkmcnt(15)
    v_mfma_f32_16x16x32_bf16 v[48:51], a[144:147], a[48:51], v[48:51]
    ds_read_b64_tr_b16 a[138:139], v207 offset:18432
    v_cvt_pk_bf16_f32 v81, v18, v19
    v_mfma_f32_16x16x32_bf16 v[48:51], a[148:151], a[56:59], v[48:51]
    ds_read_b64_tr_b16 a[140:141], v207 offset:20480
    v_cvt_pk_bf16_f32 v82, v24, v25
    v_mfma_f32_16x16x32_bf16 v[52:55], a[144:147], a[52:55], v[52:55]
    ds_read_b64_tr_b16 a[142:143], v207 offset:22528
    v_cvt_pk_bf16_f32 v83, v26, v27
    v_mfma_f32_16x16x32_bf16 v[52:55], a[148:151], a[60:63], v[52:55]
    s_waitcnt vmcnt(8)
    s_barrier
    ds_read_b64_tr_b16 a[144:145], v204 offset:32768
    s_add_u32 m0, s42, 32768
    s_add_u32 s70, s68, 114688
    v_mfma_f32_16x16x32_bf16 v[56:59], a[152:155], a[48:51], v[56:59]
    ds_read_b64_tr_b16 a[146:147], v204 offset:34816
    global_load_lds_dwordx4 v232, s[70:71] offset:0
    v_mfma_f32_16x16x32_bf16 v[56:59], a[156:159], a[56:59], v[56:59]
    ds_read_b64_tr_b16 a[148:149], v204 offset:36864
    v_permlane32_swap_b32 v80, v82
    v_mfma_f32_16x16x32_bf16 v[60:63], a[152:155], a[52:55], v[60:63]
    ds_read_b64_tr_b16 a[150:151], v204 offset:38912
    v_permlane32_swap_b32 v81, v83
    v_mfma_f32_16x16x32_bf16 v[60:63], a[156:159], a[60:63], v[60:63]
    ds_read_b64_tr_b16 a[152:153], v205 offset:32768
    s_waitcnt lgkmcnt(15)
    v_mfma_f32_16x16x32_bf16 v[32:35], a[112:115], a[64:67], v[32:35]
    ds_read_b64_tr_b16 a[154:155], v205 offset:34816
    global_load_lds_dwordx4 v233, s[70:71] offset:1024
    v_mfma_f32_16x16x32_bf16 v[32:35], a[116:119], a[72:75], v[32:35]
    ds_read_b64_tr_b16 a[156:157], v205 offset:36864
    ds_read_b128 a[48:51], v242 offset:24576
    ds_read_b128 a[52:55], v242 offset:25600
    v_mfma_f32_16x16x32_bf16 v[36:39], a[112:115], a[68:71], v[36:39]
    ds_read_b64_tr_b16 a[158:159], v205 offset:38912
    s_nop 0
    v_mfma_f32_16x16x32_bf16 v[36:39], a[116:119], a[76:79], v[36:39]
    ds_read_b64_tr_b16 a[112:113], v206 offset:32768
    v_permlane16_swap_b32 v80, v82
    v_mfma_f32_16x16x32_bf16 v[40:43], a[120:123], a[64:67], v[40:43]
    ds_read_b64_tr_b16 a[114:115], v206 offset:34816
    global_load_lds_dwordx4 v234, s[70:71] offset:2048
    v_mfma_f32_16x16x32_bf16 v[40:43], a[124:127], a[72:75], v[40:43]
    ds_read_b64_tr_b16 a[116:117], v206 offset:36864
    v_permlane16_swap_b32 v81, v83
    v_mfma_f32_16x16x32_bf16 v[44:47], a[120:123], a[68:71], v[44:47]
    ds_read_b64_tr_b16 a[118:119], v206 offset:38912
    v_accvgpr_write_b32 a232, v80
    v_mfma_f32_16x16x32_bf16 v[44:47], a[124:127], a[76:79], v[44:47]
    ds_read_b64_tr_b16 a[120:121], v207 offset:32768
    s_waitcnt lgkmcnt(15)
    v_mfma_f32_16x16x32_bf16 v[48:51], a[128:131], a[64:67], v[48:51]
    ds_read_b64_tr_b16 a[122:123], v207 offset:34816
    global_load_lds_dwordx4 v235, s[70:71] offset:3072
    v_mfma_f32_16x16x32_bf16 v[48:51], a[132:135], a[72:75], v[48:51]
    ds_read_b64_tr_b16 a[124:125], v207 offset:36864
    s_and_b32 s68, s16, 0xf0000000
    s_add_u32 s68, s68, s52
    v_mfma_f32_16x16x32_bf16 v[52:55], a[128:131], a[68:71], v[52:55]
    ds_read_b64_tr_b16 a[126:127], v207 offset:38912
    s_add_u32 m0, s42, 49152
    v_accvgpr_write_b32 a233, v81
    v_mfma_f32_16x16x32_bf16 v[52:55], a[132:135], a[76:79], v[52:55]
    ds_read_b64_tr_b16 a[128:129], v204 offset:49152
    s_add_u32 s70, s68, 172032
    global_load_lds_dwordx4 v232, s[70:71] offset:0
    v_mfma_f32_16x16x32_bf16 v[56:59], a[136:139], a[64:67], v[56:59]
    ds_read_b64_tr_b16 a[130:131], v204 offset:51200
    v_accvgpr_write_b32 a234, v82
    v_mfma_f32_16x16x32_bf16 v[56:59], a[140:143], a[72:75], v[56:59]
    ds_read_b64_tr_b16 a[132:133], v204 offset:53248
    v_accvgpr_write_b32 a235, v83
    v_mfma_f32_16x16x32_bf16 v[60:63], a[136:139], a[68:71], v[60:63]
    ds_read_b64_tr_b16 a[134:135], v204 offset:55296
    v_cvt_pk_bf16_f32 v84, v20, v21
    v_mfma_f32_16x16x32_bf16 v[60:63], a[140:143], a[76:79], v[60:63]
    ds_read_b64_tr_b16 a[136:137], v205 offset:49152
    global_load_lds_dwordx4 v233, s[70:71] offset:1024
    s_waitcnt lgkmcnt(13)
    v_mfma_f32_16x16x32_bf16 v[32:35], a[144:147], a[80:83], v[32:35]
    ds_read_b64_tr_b16 a[138:139], v205 offset:51200
    v_cvt_pk_bf16_f32 v85, v22, v23
    v_mfma_f32_16x16x32_bf16 v[32:35], a[148:151], a[88:91], v[32:35]
    ds_read_b64_tr_b16 a[140:141], v205 offset:53248
    v_cvt_pk_bf16_f32 v86, v28, v29
    v_mfma_f32_16x16x32_bf16 v[36:39], a[144:147], a[84:87], v[36:39]
    ds_read_b64_tr_b16 a[142:143], v205 offset:55296
    v_cvt_pk_bf16_f32 v87, v30, v31
    v_mfma_f32_16x16x32_bf16 v[36:39], a[148:151], a[92:95], v[36:39]
    ds_read_b64_tr_b16 a[144:145], v206 offset:49152
    global_load_lds_dwordx4 v234, s[70:71] offset:2048
    v_mfma_f32_16x16x32_bf16 v[40:43], a[152:155], a[80:83], v[40:43]
    ds_read_b64_tr_b16 a[146:147], v206 offset:51200
    v_permlane32_swap_b32 v84, v86
    v_mfma_f32_16x16x32_bf16 v[40:43], a[156:159], a[88:91], v[40:43]
    ds_read_b64_tr_b16 a[148:149], v206 offset:53248
    v_permlane32_swap_b32 v85, v87
    v_mfma_f32_16x16x32_bf16 v[44:47], a[152:155], a[84:87], v[44:47]
    ds_read_b64_tr_b16 a[150:151], v206 offset:55296
    s_nop 0
    v_mfma_f32_16x16x32_bf16 v[44:47], a[156:159], a[92:95], v[44:47]
    ds_read_b64_tr_b16 a[152:153], v207 offset:49152
    global_load_lds_dwordx4 v235, s[70:71] offset:3072
    s_waitcnt lgkmcnt(13)
    v_mfma_f32_16x16x32_bf16 v[48:51], a[112:115], a[80:83], v[48:51]
    ds_read_b64_tr_b16 a[154:155], v207 offset:51200
    v_permlane16_swap_b32 v84, v86
    v_mfma_f32_16x16x32_bf16 v[48:51], a[116:119], a[88:91], v[48:51]
    ds_read_b64_tr_b16 a[156:157], v207 offset:53248
    v_permlane16_swap_b32 v85, v87
    v_mfma_f32_16x16x32_bf16 v[52:55], a[112:115], a[84:87], v[52:55]
    ds_read_b64_tr_b16 a[158:159], v207 offset:55296
    v_accvgpr_write_b32 a236, v84
    v_mfma_f32_16x16x32_bf16 v[52:55], a[116:119], a[92:95], v[52:55]
    s_waitcnt vmcnt(8)
    s_barrier
    ds_read_b64_tr_b16 a[112:113], v200 offset:0
    s_and_b32 s68, s16, 0xf0000000
    s_add_u32 s68, s68, s50
    s_add_u32 m0, s42, 65536
    s_add_u32 s70, s68, 0
    v_mfma_f32_16x16x32_bf16 v[56:59], a[120:123], a[80:83], v[56:59]
    ds_read_b64_tr_b16 a[114:115], v200 offset:2048
    global_load_lds_dwordx4 v232, s[70:71] offset:0
    v_mfma_f32_16x16x32_bf16 v[56:59], a[124:127], a[88:91], v[56:59]
    ds_read_b64_tr_b16 a[116:117], v200 offset:4096
    v_accvgpr_write_b32 a237, v85
    v_mfma_f32_16x16x32_bf16 v[60:63], a[120:123], a[84:87], v[60:63]
    ds_read_b64_tr_b16 a[118:119], v200 offset:6144
    v_accvgpr_write_b32 a238, v86
    v_mfma_f32_16x16x32_bf16 v[60:63], a[124:127], a[92:95], v[60:63]
    ds_read_b64_tr_b16 a[120:121], v201 offset:0
    s_waitcnt lgkmcnt(13)
    v_mfma_f32_16x16x32_bf16 v[32:35], a[128:131], a[96:99], v[32:35]
    ds_read_b64_tr_b16 a[122:123], v201 offset:2048
    global_load_lds_dwordx4 v233, s[70:71] offset:1024
    v_mfma_f32_16x16x32_bf16 v[32:35], a[132:135], a[104:107], v[32:35]
    ds_read_b64_tr_b16 a[124:125], v201 offset:4096
    v_accvgpr_write_b32 a239, v87
    v_mfma_f32_16x16x32_bf16 v[36:39], a[128:131], a[100:103], v[36:39]
    ds_read_b64_tr_b16 a[126:127], v201 offset:6144
    v_mfma_f32_16x16x32_bf16 v[36:39], a[132:135], a[108:111], v[36:39]
    ds_read_b64_tr_b16 a[128:129], v202 offset:0
    v_mfma_f32_16x16x32_bf16 v[40:43], a[136:139], a[96:99], v[40:43]
    ds_read_b64_tr_b16 a[130:131], v202 offset:2048
    global_load_lds_dwordx4 v234, s[70:71] offset:2048
    v_mfma_f32_16x16x32_bf16 v[40:43], a[140:143], a[104:107], v[40:43]
    ds_read_b64_tr_b16 a[132:133], v202 offset:4096
    v_mfma_f32_16x16x32_bf16 v[44:47], a[136:139], a[100:103], v[44:47]
    ds_read_b64_tr_b16 a[134:135], v202 offset:6144
    v_mfma_f32_16x16x32_bf16 v[44:47], a[140:143], a[108:111], v[44:47]
    ds_read_b64_tr_b16 a[136:137], v203 offset:0
    s_waitcnt lgkmcnt(13)
    v_mfma_f32_16x16x32_bf16 v[48:51], a[144:147], a[96:99], v[48:51]
    ds_read_b64_tr_b16 a[138:139], v203 offset:2048
    global_load_lds_dwordx4 v235, s[70:71] offset:3072
    v_mfma_f32_16x16x32_bf16 v[48:51], a[148:151], a[104:107], v[48:51]
    ds_read_b64_tr_b16 a[140:141], v203 offset:4096
    s_add_u32 m0, s42, 81920
    v_mfma_f32_16x16x32_bf16 v[52:55], a[144:147], a[100:103], v[52:55]
    ds_read_b64_tr_b16 a[142:143], v203 offset:6144
    s_add_u32 s70, s68, 57344
    v_mfma_f32_16x16x32_bf16 v[52:55], a[148:151], a[108:111], v[52:55]
    ds_read_b64_tr_b16 a[144:145], v200 offset:16384
    global_load_lds_dwordx4 v232, s[70:71] offset:0
    v_mfma_f32_16x16x32_bf16 v[56:59], a[152:155], a[96:99], v[56:59]
    ds_read_b64_tr_b16 a[146:147], v200 offset:18432
    v_mfma_f32_16x16x32_bf16 v[56:59], a[156:159], a[104:107], v[56:59]
    ds_read_b64_tr_b16 a[148:149], v200 offset:20480
    v_mfma_f32_16x16x32_bf16 v[60:63], a[152:155], a[100:103], v[60:63]
    ds_read_b64_tr_b16 a[150:151], v200 offset:22528
    v_mfma_f32_16x16x32_bf16 v[60:63], a[156:159], a[108:111], v[60:63]
    ds_read_b64_tr_b16 a[152:153], v201 offset:16384
    global_load_lds_dwordx4 v233, s[70:71] offset:1024
    s_waitcnt lgkmcnt(13)
    v_mfma_f32_16x16x32_bf16 v[96:99], a[112:115], a[0:3], 0
    ds_read_b64_tr_b16 a[154:155], v201 offset:18432
    v_mfma_f32_16x16x32_bf16 v[96:99], a[116:119], a[8:11], v[96:99]
    ds_read_b64_tr_b16 a[156:157], v201 offset:20480
    v_mfma_f32_16x16x32_bf16 v[100:103], a[112:115], a[4:7], 0
    ds_read_b64_tr_b16 a[158:159], v201 offset:22528
    buffer_load_dword v198, v134, s[20:23], s6 offen offset:0
    v_mfma_f32_16x16x32_bf16 v[100:103], a[116:119], a[12:15], v[100:103]
    ds_read_b64_tr_b16 a[112:113], v202 offset:16384
    global_load_lds_dwordx4 v234, s[70:71] offset:2048
    v_mfma_f32_16x16x32_bf16 v[104:107], a[120:123], a[0:3], 0
    ds_read_b64_tr_b16 a[114:115], v202 offset:18432
    v_mfma_f32_16x16x32_bf16 v[104:107], a[124:127], a[8:11], v[104:107]
    ds_read_b64_tr_b16 a[116:117], v202 offset:20480
    v_mfma_f32_16x16x32_bf16 v[108:111], a[120:123], a[4:7], 0
    ds_read_b64_tr_b16 a[118:119], v202 offset:22528
    v_cvt_pk_bf16_f32 v80, v32, v33
    v_mfma_f32_16x16x32_bf16 v[108:111], a[124:127], a[12:15], v[108:111]
    ds_read_b64_tr_b16 a[120:121], v203 offset:16384
    global_load_lds_dwordx4 v235, s[70:71] offset:3072
    v_cvt_pk_bf16_f32 v81, v34, v35
    s_waitcnt lgkmcnt(13)
    v_mfma_f32_16x16x32_bf16 v[112:115], a[128:131], a[0:3], 0
    ds_read_b64_tr_b16 a[122:123], v203 offset:18432
    v_cvt_pk_bf16_f32 v82, v40, v41
    v_mfma_f32_16x16x32_bf16 v[112:115], a[132:135], a[8:11], v[112:115]
    ds_read_b64_tr_b16 a[124:125], v203 offset:20480
    v_cvt_pk_bf16_f32 v83, v42, v43
    buffer_load_dword v198, v135, s[24:27], s7 offen offset:0
    v_mfma_f32_16x16x32_bf16 v[116:119], a[128:131], a[4:7], 0
    ds_read_b64_tr_b16 a[126:127], v203 offset:22528
    v_permlane32_swap_b32 v80, v82
    v_mfma_f32_16x16x32_bf16 v[116:119], a[132:135], a[12:15], v[116:119]
    s_waitcnt vmcnt(10)
    s_barrier
    ds_read_b64_tr_b16 a[128:129], v200 offset:32768
    s_add_u32 m0, s42, 98304
    s_add_u32 s70, s68, 114688
    v_permlane32_swap_b32 v81, v83
    s_nop 0
    v_mfma_f32_16x16x32_bf16 v[120:123], a[136:139], a[0:3], 0
    ds_read_b64_tr_b16 a[130:131], v200 offset:34816
    global_load_lds_dwordx4 v232, s[70:71] offset:0
    v_permlane16_swap_b32 v80, v82
    v_mfma_f32_16x16x32_bf16 v[120:123], a[140:143], a[8:11], v[120:123]
    ds_read_b64_tr_b16 a[132:133], v200 offset:36864
    v_permlane16_swap_b32 v81, v83
    v_mfma_f32_16x16x32_bf16 v[124:127], a[136:139], a[4:7], 0
    ds_read_b64_tr_b16 a[134:135], v200 offset:38912
    v_accvgpr_write_b32 a240, v80
    v_mfma_f32_16x16x32_bf16 v[124:127], a[140:143], a[12:15], v[124:127]
    ds_read_b64_tr_b16 a[136:137], v201 offset:32768
    v_accvgpr_write_b32 a241, v81
    v_accvgpr_write_b32 a242, v82
    s_waitcnt lgkmcnt(13)
    v_mfma_f32_16x16x32_bf16 v[96:99], a[144:147], a[16:19], v[96:99]
    ds_read_b64_tr_b16 a[138:139], v201 offset:34816
    global_load_lds_dwordx4 v233, s[70:71] offset:1024
    v_accvgpr_write_b32 a243, v83
    v_mfma_f32_16x16x32_bf16 v[96:99], a[148:151], a[24:27], v[96:99]
    ds_read_b64_tr_b16 a[140:141], v201 offset:36864
    v_cvt_pk_bf16_f32 v84, v36, v37
    v_mfma_f32_16x16x32_bf16 v[100:103], a[144:147], a[20:23], v[100:103]
    ds_read_b64_tr_b16 a[142:143], v201 offset:38912
    v_cvt_pk_bf16_f32 v85, v38, v39
    v_mfma_f32_16x16x32_bf16 v[100:103], a[148:151], a[28:31], v[100:103]
    ds_read_b64_tr_b16 a[144:145], v202 offset:32768
    v_cvt_pk_bf16_f32 v86, v44, v45
    v_cvt_pk_bf16_f32 v87, v46, v47
    v_mfma_f32_16x16x32_bf16 v[104:107], a[152:155], a[16:19], v[104:107]
    ds_read_b64_tr_b16 a[146:147], v202 offset:34816
    global_load_lds_dwordx4 v234, s[70:71] offset:2048
    v_permlane32_swap_b32 v84, v86
    v_mfma_f32_16x16x32_bf16 v[104:107], a[156:159], a[24:27], v[104:107]
    ds_read_b64_tr_b16 a[148:149], v202 offset:36864
    v_permlane32_swap_b32 v85, v87
    v_mfma_f32_16x16x32_bf16 v[108:111], a[152:155], a[20:23], v[108:111]
    ds_read_b64_tr_b16 a[150:151], v202 offset:38912
    s_nop 0
    v_mfma_f32_16x16x32_bf16 v[108:111], a[156:159], a[28:31], v[108:111]
    ds_read_b64_tr_b16 a[152:153], v203 offset:32768
    v_permlane16_swap_b32 v84, v86
    v_permlane16_swap_b32 v85, v87
    s_waitcnt lgkmcnt(13)
    v_mfma_f32_16x16x32_bf16 v[112:115], a[112:115], a[16:19], v[112:115]
    ds_read_b64_tr_b16 a[154:155], v203 offset:34816
    global_load_lds_dwordx4 v235, s[70:71] offset:3072
    v_accvgpr_write_b32 a244, v84
    v_mfma_f32_16x16x32_bf16 v[112:115], a[116:119], a[24:27], v[112:115]
    ds_read_b64_tr_b16 a[156:157], v203 offset:36864
    s_and_b32 s68, s16, 0xf0000000
    s_add_u32 s68, s68, s51
    v_accvgpr_write_b32 a245, v85
    v_mfma_f32_16x16x32_bf16 v[116:119], a[112:115], a[20:23], v[116:119]
    ds_read_b64_tr_b16 a[158:159], v203 offset:38912
    s_add_u32 m0, s42, 114688
    v_accvgpr_write_b32 a246, v86
    v_mfma_f32_16x16x32_bf16 v[116:119], a[116:119], a[28:31], v[116:119]
    ds_read_b64_tr_b16 a[112:113], v200 offset:49152
    s_add_u32 s70, s68, 0
    global_load_lds_dwordx4 v232, s[70:71] offset:0
    v_accvgpr_write_b32 a247, v87
    v_cvt_pk_bf16_f32 v80, v48, v49
    v_mfma_f32_16x16x32_bf16 v[120:123], a[120:123], a[16:19], v[120:123]
    ds_read_b64_tr_b16 a[114:115], v200 offset:51200
    v_cvt_pk_bf16_f32 v81, v50, v51
    v_mfma_f32_16x16x32_bf16 v[120:123], a[124:127], a[24:27], v[120:123]
    ds_read_b64_tr_b16 a[116:117], v201 offset:49152
    v_cvt_pk_bf16_f32 v82, v56, v57
    v_mfma_f32_16x16x32_bf16 v[124:127], a[120:123], a[20:23], v[124:127]
    ds_read_b64_tr_b16 a[118:119], v201 offset:51200
    v_cvt_pk_bf16_f32 v83, v58, v59
    v_mfma_f32_16x16x32_bf16 v[124:127], a[124:127], a[28:31], v[124:127]
    ds_read_b64_tr_b16 a[120:121], v202 offset:49152
    global_load_lds_dwordx4 v233, s[70:71] offset:1024
    v_permlane32_swap_b32 v80, v82
    s_waitcnt lgkmcnt(13)
    v_mfma_f32_16x16x32_bf16 v[96:99], a[128:131], a[32:35], v[96:99]
    ds_read_b64_tr_b16 a[122:123], v202 offset:51200
    v_permlane32_swap_b32 v81, v83
    s_nop 0
    v_mfma_f32_16x16x32_bf16 v[96:99], a[132:135], a[40:43], v[96:99]
    ds_read_b64_tr_b16 a[124:125], v203 offset:49152
    v_permlane16_swap_b32 v80, v82
    v_mfma_f32_16x16x32_bf16 v[100:103], a[128:131], a[36:39], v[100:103]
    ds_read_b64_tr_b16 a[126:127], v203 offset:51200
    v_permlane16_swap_b32 v81, v83
    v_mfma_f32_16x16x32_bf16 v[100:103], a[132:135], a[44:47], v[100:103]
    ds_read_b64_tr_b16 a[128:129], v200 offset:53248
    global_load_lds_dwordx4 v234, s[70:71] offset:2048
    v_accvgpr_write_b32 a248, v80
    v_mfma_f32_16x16x32_bf16 v[104:107], a[136:139], a[32:35], v[104:107]
    ds_read_b64_tr_b16 a[130:131], v200 offset:55296
    v_accvgpr_write_b32 a249, v81
    v_accvgpr_write_b32 a250, v82
    v_mfma_f32_16x16x32_bf16 v[104:107], a[140:143], a[40:43], v[104:107]
    ds_read_b64_tr_b16 a[132:133], v201 offset:53248
    v_accvgpr_write_b32 a251, v83
    v_mfma_f32_16x16x32_bf16 v[108:111], a[136:139], a[36:39], v[108:111]
    ds_read_b64_tr_b16 a[134:135], v201 offset:55296
    v_cvt_pk_bf16_f32 v84, v52, v53
    v_mfma_f32_16x16x32_bf16 v[108:111], a[140:143], a[44:47], v[108:111]
    ds_read_b64_tr_b16 a[136:137], v202 offset:53248
    global_load_lds_dwordx4 v235, s[70:71] offset:3072
    v_cvt_pk_bf16_f32 v85, v54, v55
    s_waitcnt lgkmcnt(13)
    v_mfma_f32_16x16x32_bf16 v[112:115], a[144:147], a[32:35], v[112:115]
    ds_read_b64_tr_b16 a[138:139], v202 offset:55296
    v_cvt_pk_bf16_f32 v86, v60, v61
    v_cvt_pk_bf16_f32 v87, v62, v63
    v_mfma_f32_16x16x32_bf16 v[112:115], a[148:151], a[40:43], v[112:115]
    ds_read_b64_tr_b16 a[140:141], v203 offset:53248
    v_permlane32_swap_b32 v84, v86
    v_mfma_f32_16x16x32_bf16 v[116:119], a[144:147], a[36:39], v[116:119]
    ds_read_b64_tr_b16 a[142:143], v203 offset:55296
    v_permlane32_swap_b32 v85, v87
    v_mfma_f32_16x16x32_bf16 v[116:119], a[148:151], a[44:47], v[116:119]
    s_waitcnt vmcnt(9)
    s_barrier
    ds_read_b64_tr_b16 a[144:145], v204 offset:0
    s_add_u32 m0, s42, 0
    s_add_u32 s70, s68, 57344
    s_nop 0
    v_mfma_f32_16x16x32_bf16 v[120:123], a[152:155], a[32:35], v[120:123]
    ds_read_b64_tr_b16 a[146:147], v204 offset:2048
    global_load_lds_dwordx4 v232, s[70:71] offset:0
    v_permlane16_swap_b32 v84, v86
    v_permlane16_swap_b32 v85, v87
    v_mfma_f32_16x16x32_bf16 v[120:123], a[156:159], a[40:43], v[120:123]
    ds_read_b64_tr_b16 a[148:149], v204 offset:4096
    v_accvgpr_write_b32 a252, v84
    v_mfma_f32_16x16x32_bf16 v[124:127], a[152:155], a[36:39], v[124:127]
    ds_read_b64_tr_b16 a[150:151], v204 offset:6144
    v_accvgpr_write_b32 a253, v85
    v_mfma_f32_16x16x32_bf16 v[124:127], a[156:159], a[44:47], v[124:127]
    ds_read_b64_tr_b16 a[152:153], v205 offset:0
    v_accvgpr_write_b32 a254, v86
    s_waitcnt lgkmcnt(15)
    v_mfma_f32_16x16x32_bf16 v[96:99], a[112:115], a[48:51], v[96:99]
    ds_read_b64_tr_b16 a[154:155], v205 offset:2048
    ds_read_b64_tr_b16 a[156:157], v205 offset:4096
    global_load_lds_dwordx4 v233, s[70:71] offset:1024
    v_accvgpr_write_b32 a255, v87
    v_mfma_f32_16x16x32_bf16 v[100:103], a[112:115], a[52:55], v[100:103]
    ds_read_b64_tr_b16 a[158:159], v205 offset:6144
    v_mfma_f32_16x16x32_bf16 v[104:107], a[116:119], a[48:51], v[104:107]
    v_mfma_f32_16x16x32_bf16 v[108:111], a[116:119], a[52:55], v[108:111]
    ds_read_b64_tr_b16 a[112:113], v206 offset:0
    ds_read_b64_tr_b16 a[114:115], v206 offset:2048
    s_waitcnt lgkmcnt(15)
    v_mfma_f32_16x16x32_bf16 v[112:115], a[120:123], a[48:51], v[112:115]
    ds_read_b64_tr_b16 a[116:117], v206 offset:4096
    ds_read_b64_tr_b16 a[118:119], v206 offset:6144
    global_load_lds_dwordx4 v234, s[70:71] offset:2048
    v_mfma_f32_16x16x32_bf16 v[116:119], a[120:123], a[52:55], v[116:119]
    v_mfma_f32_16x16x32_bf16 v[120:123], a[124:127], a[48:51], v[120:123]
    v_mfma_f32_16x16x32_bf16 v[124:127], a[124:127], a[52:55], v[124:127]
    ds_read_b64_tr_b16 a[120:121], v207 offset:0
    ds_read_b64_tr_b16 a[122:123], v207 offset:2048
    s_waitcnt lgkmcnt(15)
    v_mfma_f32_16x16x32_bf16 v[0:3], a[128:131], a[48:51], 0
    ds_read_b64_tr_b16 a[124:125], v207 offset:4096
    ds_read_b64_tr_b16 a[126:127], v207 offset:6144
    global_load_lds_dwordx4 v235, s[70:71] offset:3072
    v_mfma_f32_16x16x32_bf16 v[4:7], a[128:131], a[52:55], 0
    s_add_u32 m0, s42, 16384
    v_mfma_f32_16x16x32_bf16 v[8:11], a[132:135], a[48:51], 0
    s_add_u32 s70, s68, 114688
    v_mfma_f32_16x16x32_bf16 v[12:15], a[132:135], a[52:55], 0
    ds_read_b64_tr_b16 a[128:129], v204 offset:16384
    ds_read_b64_tr_b16 a[130:131], v204 offset:18432
    global_load_lds_dwordx4 v232, s[70:71] offset:0
    s_waitcnt lgkmcnt(15)
    v_mfma_f32_16x16x32_bf16 v[16:19], a[136:139], a[48:51], 0
    ds_read_b64_tr_b16 a[132:133], v204 offset:20480
    ds_read_b64_tr_b16 a[134:135], v204 offset:22528
    v_mfma_f32_16x16x32_bf16 v[20:23], a[136:139], a[52:55], 0
    v_mfma_f32_16x16x32_bf16 v[24:27], a[140:143], a[48:51], 0
    v_cvt_pk_bf16_f32 v80, v96, v97
    v_cvt_pk_bf16_f32 v81, v98, v99
    v_mfma_f32_16x16x32_bf16 v[28:31], a[140:143], a[52:55], 0
    ds_read_b64_tr_b16 a[136:137], v205 offset:16384
    ds_read_b64_tr_b16 a[138:139], v205 offset:18432
    global_load_lds_dwordx4 v233, s[70:71] offset:1024
    s_waitcnt lgkmcnt(14)
    v_mfma_f32_16x16x32_bf16 v[0:3], a[144:147], a[0:3], v[0:3]
    ds_read_b64_tr_b16 a[140:141], v205 offset:20480
    v_cvt_pk_bf16_f32 v82, v104, v105
    v_mfma_f32_16x16x32_bf16 v[0:3], a[148:151], a[8:11], v[0:3]
    ds_read_b64_tr_b16 a[142:143], v205 offset:22528
    v_cvt_pk_bf16_f32 v83, v106, v107
    v_mfma_f32_16x16x32_bf16 v[4:7], a[144:147], a[4:7], v[4:7]
    v_accvgpr_write_b32 a56, v80
    v_accvgpr_write_b32 a57, v81
    v_mfma_f32_16x16x32_bf16 v[4:7], a[148:151], a[12:15], v[4:7]
    ds_read_b64_tr_b16 a[144:145], v206 offset:16384
    global_load_lds_dwordx4 v234, s[70:71] offset:2048
    v_mfma_f32_16x16x32_bf16 v[8:11], a[152:155], a[0:3], v[8:11]
    ds_read_b64_tr_b16 a[146:147], v206 offset:18432
    v_accvgpr_write_b32 a58, v82
    v_mfma_f32_16x16x32_bf16 v[8:11], a[156:159], a[8:11], v[8:11]
    ds_read_b64_tr_b16 a[148:149], v206 offset:20480
    v_accvgpr_write_b32 a59, v83
    v_mfma_f32_16x16x32_bf16 v[12:15], a[152:155], a[4:7], v[12:15]
    ds_read_b64_tr_b16 a[150:151], v206 offset:22528
    v_cvt_pk_bf16_f32 v84, v100, v101
    v_mfma_f32_16x16x32_bf16 v[12:15], a[156:159], a[12:15], v[12:15]
    ds_read_b64_tr_b16 a[152:153], v207 offset:16384
    global_load_lds_dwordx4 v235, s[70:71] offset:3072
    s_waitcnt lgkmcnt(13)
    v_mfma_f32_16x16x32_bf16 v[16:19], a[112:115], a[0:3], v[16:19]
    ds_read_b64_tr_b16 a[154:155], v207 offset:18432
    v_cvt_pk_bf16_f32 v85, v102, v103
    v_mfma_f32_16x16x32_bf16 v[16:19], a[116:119], a[8:11], v[16:19]
    ds_read_b64_tr_b16 a[156:157], v207 offset:20480
    v_cvt_pk_bf16_f32 v86, v108, v109
    v_mfma_f32_16x16x32_bf16 v[20:23], a[112:115], a[4:7], v[20:23]
    ds_read_b64_tr_b16 a[158:159], v207 offset:22528
    v_cvt_pk_bf16_f32 v87, v110, v111
    v_mfma_f32_16x16x32_bf16 v[20:23], a[116:119], a[12:15], v[20:23]
    s_waitcnt vmcnt(8)
    s_barrier
    ds_read_b64_tr_b16 a[112:113], v204 offset:32768
    s_and_b32 s68, s16, 0xf0000000
    s_add_u32 s68, s68, s53
    s_add_u32 m0, s42, 32768
    s_add_u32 s70, s68, 0
    v_mfma_f32_16x16x32_bf16 v[24:27], a[120:123], a[0:3], v[24:27]
    ds_read_b64_tr_b16 a[114:115], v204 offset:34816
    global_load_lds_dwordx4 v232, s[70:71] offset:0
    v_mfma_f32_16x16x32_bf16 v[24:27], a[124:127], a[8:11], v[24:27]
    ds_read_b64_tr_b16 a[116:117], v204 offset:36864
    v_accvgpr_write_b32 a60, v84
    v_mfma_f32_16x16x32_bf16 v[28:31], a[120:123], a[4:7], v[28:31]
    ds_read_b64_tr_b16 a[118:119], v204 offset:38912
    v_accvgpr_write_b32 a61, v85
    v_mfma_f32_16x16x32_bf16 v[28:31], a[124:127], a[12:15], v[28:31]
    ds_read_b64_tr_b16 a[120:121], v205 offset:32768
    s_waitcnt lgkmcnt(13)
    v_mfma_f32_16x16x32_bf16 v[0:3], a[128:131], a[16:19], v[0:3]
    ds_read_b64_tr_b16 a[122:123], v205 offset:34816
    global_load_lds_dwordx4 v233, s[70:71] offset:1024
    v_mfma_f32_16x16x32_bf16 v[0:3], a[132:135], a[24:27], v[0:3]
    ds_read_b64_tr_b16 a[124:125], v205 offset:36864
    v_accvgpr_write_b32 a62, v86
    v_mfma_f32_16x16x32_bf16 v[4:7], a[128:131], a[20:23], v[4:7]
    ds_read_b64_tr_b16 a[126:127], v205 offset:38912
    v_accvgpr_write_b32 a63, v87
    v_mfma_f32_16x16x32_bf16 v[4:7], a[132:135], a[28:31], v[4:7]
    ds_read_b64_tr_b16 a[128:129], v206 offset:32768
    v_cvt_pk_bf16_f32 v80, v112, v113
    v_mfma_f32_16x16x32_bf16 v[8:11], a[136:139], a[16:19], v[8:11]
    ds_read_b64_tr_b16 a[130:131], v206 offset:34816
    global_load_lds_dwordx4 v234, s[70:71] offset:2048
    v_mfma_f32_16x16x32_bf16 v[8:11], a[140:143], a[24:27], v[8:11]
    ds_read_b64_tr_b16 a[132:133], v206 offset:36864
    v_cvt_pk_bf16_f32 v81, v114, v115
    v_mfma_f32_16x16x32_bf16 v[12:15], a[136:139], a[20:23], v[12:15]
    ds_read_b64_tr_b16 a[134:135], v206 offset:38912
    v_cvt_pk_bf16_f32 v82, v120, v121
    v_mfma_f32_16x16x32_bf16 v[12:15], a[140:143], a[28:31], v[12:15]
    ds_read_b64_tr_b16 a[136:137], v207 offset:32768
    v_cvt_pk_bf16_f32 v83, v122, v123
    s_waitcnt lgkmcnt(13)
    v_mfma_f32_16x16x32_bf16 v[16:19], a[144:147], a[16:19], v[16:19]
    ds_read_b64_tr_b16 a[138:139], v207 offset:34816
    global_load_lds_dwordx4 v235, s[70:71] offset:3072
    v_mfma_f32_16x16x32_bf16 v[16:19], a[148:151], a[24:27], v[16:19]
    ds_read_b64_tr_b16 a[140:141], v207 offset:36864
    s_and_b32 s68, s16, 0xf0000000
    s_add_u32 s68, s68, s54
    v_accvgpr_write_b32 a64, v80
    v_mfma_f32_16x16x32_bf16 v[20:23], a[144:147], a[20:23], v[20:23]
    ds_read_b64_tr_b16 a[142:143], v207 offset:38912
    s_add_u32 m0, s42, 49152
    v_accvgpr_write_b32 a65, v81
    v_mfma_f32_16x16x32_bf16 v[20:23], a[148:151], a[28:31], v[20:23]
    ds_read_b64_tr_b16 a[144:145], v204 offset:49152
    s_add_u32 s70, s68, 57344
    global_load_lds_dwordx4 v232, s[70:71] offset:0
    v_accvgpr_write_b32 a66, v82
    v_mfma_f32_16x16x32_bf16 v[24:27], a[152:155], a[16:19], v[24:27]
    ds_read_b64_tr_b16 a[146:147], v204 offset:51200
    v_accvgpr_write_b32 a67, v83
    v_mfma_f32_16x16x32_bf16 v[24:27], a[156:159], a[24:27], v[24:27]
    ds_read_b64_tr_b16 a[148:149], v204 offset:53248
    v_cvt_pk_bf16_f32 v84, v116, v117
    v_mfma_f32_16x16x32_bf16 v[28:31], a[152:155], a[20:23], v[28:31]
    ds_read_b64_tr_b16 a[150:151], v204 offset:55296
    v_cvt_pk_bf16_f32 v85, v118, v119
    v_mfma_f32_16x16x32_bf16 v[28:31], a[156:159], a[28:31], v[28:31]
    ds_read_b64_tr_b16 a[152:153], v205 offset:49152
    global_load_lds_dwordx4 v233, s[70:71] offset:1024
    s_waitcnt lgkmcnt(13)
    v_mfma_f32_16x16x32_bf16 v[0:3], a[112:115], a[32:35], v[0:3]
    ds_read_b64_tr_b16 a[154:155], v205 offset:51200
    v_cvt_pk_bf16_f32 v86, v124, v125
    v_mfma_f32_16x16x32_bf16 v[0:3], a[116:119], a[40:43], v[0:3]
    ds_read_b64_tr_b16 a[156:157], v205 offset:53248
    v_cvt_pk_bf16_f32 v87, v126, v127
    v_mfma_f32_16x16x32_bf16 v[4:7], a[112:115], a[36:39], v[4:7]
    ds_read_b64_tr_b16 a[158:159], v205 offset:55296
    v_accvgpr_write_b32 a68, v84
    v_mfma_f32_16x16x32_bf16 v[4:7], a[116:119], a[44:47], v[4:7]
    ds_read_b64_tr_b16 a[112:113], v206 offset:49152
    global_load_lds_dwordx4 v234, s[70:71] offset:2048
    v_mfma_f32_16x16x32_bf16 v[8:11], a[120:123], a[32:35], v[8:11]
    ds_read_b64_tr_b16 a[114:115], v206 offset:51200
    v_accvgpr_write_b32 a69, v85
    v_mfma_f32_16x16x32_bf16 v[8:11], a[124:127], a[40:43], v[8:11]
    ds_read_b64_tr_b16 a[116:117], v206 offset:53248
    v_accvgpr_write_b32 a70, v86
    v_mfma_f32_16x16x32_bf16 v[12:15], a[120:123], a[36:39], v[12:15]
    ds_read_b64_tr_b16 a[118:119], v206 offset:55296
    v_accvgpr_write_b32 a71, v87
    v_mfma_f32_16x16x32_bf16 v[12:15], a[124:127], a[44:47], v[12:15]
    ds_read_b64_tr_b16 a[120:121], v207 offset:49152
    global_load_lds_dwordx4 v235, s[70:71] offset:3072
    s_waitcnt lgkmcnt(13)
    v_mfma_f32_16x16x32_bf16 v[16:19], a[128:131], a[32:35], v[16:19]
    ds_read_b64_tr_b16 a[122:123], v207 offset:51200
    v_mfma_f32_16x16x32_bf16 v[16:19], a[132:135], a[40:43], v[16:19]
    ds_read_b64_tr_b16 a[124:125], v207 offset:53248
    v_mfma_f32_16x16x32_bf16 v[20:23], a[128:131], a[36:39], v[20:23]
    ds_read_b64_tr_b16 a[126:127], v207 offset:55296
    v_mfma_f32_16x16x32_bf16 v[20:23], a[132:135], a[44:47], v[20:23]
    s_waitcnt vmcnt(8)
    s_barrier
    ds_read_b64_tr_b16 a[128:129], v200 offset:0
    s_and_b32 s68, s16, 0xf0000000
    s_add_u32 s68, s68, s55
    s_add_u32 m0, s42, 65536
    s_add_u32 s70, s68, 0
    v_mfma_f32_16x16x32_bf16 v[24:27], a[136:139], a[32:35], v[24:27]
    ds_read_b64_tr_b16 a[130:131], v200 offset:2048
    global_load_lds_dwordx4 v232, s[70:71] offset:0
    v_mfma_f32_16x16x32_bf16 v[24:27], a[140:143], a[40:43], v[24:27]
    ds_read_b64_tr_b16 a[132:133], v200 offset:4096
    v_mfma_f32_16x16x32_bf16 v[28:31], a[136:139], a[36:39], v[28:31]
    ds_read_b64_tr_b16 a[134:135], v200 offset:6144
    v_mfma_f32_16x16x32_bf16 v[28:31], a[140:143], a[44:47], v[28:31]
    ds_read_b64_tr_b16 a[136:137], v201 offset:0
    s_waitcnt lgkmcnt(13)
    v_mfma_f32_16x16x32_bf16 v[32:35], a[144:147], a[0:3], 0
    ds_read_b64_tr_b16 a[138:139], v201 offset:2048
    global_load_lds_dwordx4 v233, s[70:71] offset:1024
    v_mfma_f32_16x16x32_bf16 v[32:35], a[148:151], a[8:11], v[32:35]
    ds_read_b64_tr_b16 a[140:141], v201 offset:4096
    v_mfma_f32_16x16x32_bf16 v[36:39], a[144:147], a[4:7], 0
    ds_read_b64_tr_b16 a[142:143], v201 offset:6144
    v_mfma_f32_16x16x32_bf16 v[36:39], a[148:151], a[12:15], v[36:39]
    ds_read_b64_tr_b16 a[144:145], v202 offset:0
    v_mfma_f32_16x16x32_bf16 v[40:43], a[152:155], a[0:3], 0
    ds_read_b64_tr_b16 a[146:147], v202 offset:2048
    global_load_lds_dwordx4 v234, s[70:71] offset:2048
    v_mfma_f32_16x16x32_bf16 v[40:43], a[156:159], a[8:11], v[40:43]
    ds_read_b64_tr_b16 a[148:149], v202 offset:4096
    v_mfma_f32_16x16x32_bf16 v[44:47], a[152:155], a[4:7], 0
    ds_read_b64_tr_b16 a[150:151], v202 offset:6144
    v_cvt_pk_bf16_f32 v80, v0, v1
    v_mfma_f32_16x16x32_bf16 v[44:47], a[156:159], a[12:15], v[44:47]
    ds_read_b64_tr_b16 a[152:153], v203 offset:0
    s_waitcnt lgkmcnt(13)
    v_mfma_f32_16x16x32_bf16 v[48:51], a[112:115], a[0:3], 0
    ds_read_b64_tr_b16 a[154:155], v203 offset:2048
    global_load_lds_dwordx4 v235, s[70:71] offset:3072
    v_lshrrev_b32 v252, 5, v249
    v_and_b32 v253, 31, v249
    s_lshl_b32 s100, s40, 3
    v_xor_b32 v253, v253, v252
    v_xor_b32 v253, s100, v253
    v_lshlrev_b32 v252, 9, v252
    s_and_b32 s100, s20, 0x0fffffff
    v_add_u32 v252, s100, v252
    v_xor_b32 v254, 0, v253
    v_lshl_add_u32 v236, v254, 4, v252
    v_xor_b32 v254, 2, v253
    v_lshl_add_u32 v237, v254, 4, v252
    v_xor_b32 v254, 4, v253
    v_lshl_add_u32 v238, v254, 4, v252
    v_xor_b32 v254, 6, v253
    v_lshl_add_u32 v239, v254, 4, v252
    v_cvt_pk_bf16_f32 v81, v2, v3
    v_mfma_f32_16x16x32_bf16 v[48:51], a[116:119], a[8:11], v[48:51]
    ds_read_b64_tr_b16 a[156:157], v203 offset:4096
    s_mov_b32 s73, s21
    v_cvt_pk_bf16_f32 v82, v8, v9
    v_mfma_f32_16x16x32_bf16 v[52:55], a[112:115], a[4:7], 0
    ds_read_b64_tr_b16 a[158:159], v203 offset:6144
    s_and_b32 s69, s20, 0xf0000000
    s_add_u32 s69, s69, s56
    s_add_u32 m0, s42, 81920
    v_cvt_pk_bf16_f32 v83, v10, v11
    v_mfma_f32_16x16x32_bf16 v[52:55], a[116:119], a[12:15], v[52:55]
    ds_read_b64_tr_b16 a[112:113], v200 offset:16384
    s_add_u32 s72, s69, 0
    global_load_lds_dwordx4 v236, s[72:73] offset:0
    v_mfma_f32_16x16x32_bf16 v[56:59], a[120:123], a[0:3], 0
    ds_read_b64_tr_b16 a[114:115], v200 offset:18432
    v_accvgpr_write_b32 a72, v80
    v_mfma_f32_16x16x32_bf16 v[56:59], a[124:127], a[8:11], v[56:59]
    ds_read_b64_tr_b16 a[116:117], v200 offset:20480
    v_accvgpr_write_b32 a73, v81
    v_mfma_f32_16x16x32_bf16 v[60:63], a[120:123], a[4:7], 0
    ds_read_b64_tr_b16 a[118:119], v200 offset:22528
    v_accvgpr_write_b32 a74, v82
    v_mfma_f32_16x16x32_bf16 v[60:63], a[124:127], a[12:15], v[60:63]
    ds_read_b64_tr_b16 a[120:121], v201 offset:16384
    global_load_lds_dwordx4 v237, s[72:73] offset:1024
    s_waitcnt lgkmcnt(13)
    v_mfma_f32_16x16x32_bf16 v[32:35], a[128:131], a[16:19], v[32:35]
    ds_read_b64_tr_b16 a[122:123], v201 offset:18432
    v_accvgpr_write_b32 a75, v83
    v_mfma_f32_16x16x32_bf16 v[32:35], a[132:135], a[24:27], v[32:35]
    ds_read_b64_tr_b16 a[124:125], v201 offset:20480
    v_cvt_pk_bf16_f32 v84, v4, v5
    v_mfma_f32_16x16x32_bf16 v[36:39], a[128:131], a[20:23], v[36:39]
    ds_read_b64_tr_b16 a[126:127], v201 offset:22528
    v_cvt_pk_bf16_f32 v85, v6, v7
    v_mfma_f32_16x16x32_bf16 v[36:39], a[132:135], a[28:31], v[36:39]
    ds_read_b64_tr_b16 a[128:129], v202 offset:16384
    global_load_lds_dwordx4 v238, s[72:73] offset:2048
    v_mfma_f32_16x16x32_bf16 v[40:43], a[136:139], a[16:19], v[40:43]
    ds_read_b64_tr_b16 a[130:131], v202 offset:18432
    v_cvt_pk_bf16_f32 v86, v12, v13
    v_mfma_f32_16x16x32_bf16 v[40:43], a[140:143], a[24:27], v[40:43]
    ds_read_b64_tr_b16 a[132:133], v202 offset:20480
    v_cvt_pk_bf16_f32 v87, v14, v15
    v_mfma_f32_16x16x32_bf16 v[44:47], a[136:139], a[20:23], v[44:47]
    ds_read_b64_tr_b16 a[134:135], v202 offset:22528
    v_accvgpr_write_b32 a76, v84
    v_mfma_f32_16x16x32_bf16 v[44:47], a[140:143], a[28:31], v[44:47]
    ds_read_b64_tr_b16 a[136:137], v203 offset:16384
    global_load_lds_dwordx4 v239, s[72:73] offset:3072
    s_waitcnt lgkmcnt(13)
    v_mfma_f32_16x16x32_bf16 v[48:51], a[144:147], a[16:19], v[48:51]
    ds_read_b64_tr_b16 a[138:139], v203 offset:18432
    v_accvgpr_write_b32 a77, v85
    v_mfma_f32_16x16x32_bf16 v[48:51], a[148:151], a[24:27], v[48:51]
    ds_read_b64_tr_b16 a[140:141], v203 offset:20480
    v_accvgpr_write_b32 a78, v86
    v_mfma_f32_16x16x32_bf16 v[52:55], a[144:147], a[20:23], v[52:55]
    ds_read_b64_tr_b16 a[142:143], v203 offset:22528
    v_accvgpr_write_b32 a79, v87
    v_mfma_f32_16x16x32_bf16 v[52:55], a[148:151], a[28:31], v[52:55]
    s_waitcnt vmcnt(8)
    s_barrier
    ds_read_b64_tr_b16 a[144:145], v200 offset:32768
    s_add_u32 m0, s42, 98304
    s_add_u32 s72, s69, 16384
    v_cvt_pk_bf16_f32 v80, v16, v17
    v_mfma_f32_16x16x32_bf16 v[56:59], a[152:155], a[16:19], v[56:59]
    ds_read_b64_tr_b16 a[146:147], v200 offset:34816
    global_load_lds_dwordx4 v236, s[72:73] offset:0
    v_mfma_f32_16x16x32_bf16 v[56:59], a[156:159], a[24:27], v[56:59]
    ds_read_b64_tr_b16 a[148:149], v201 offset:32768
    v_cvt_pk_bf16_f32 v81, v18, v19
    v_mfma_f32_16x16x32_bf16 v[60:63], a[152:155], a[20:23], v[60:63]
    ds_read_b64_tr_b16 a[150:151], v201 offset:34816
    v_cvt_pk_bf16_f32 v82, v24, v25
    v_mfma_f32_16x16x32_bf16 v[60:63], a[156:159], a[28:31], v[60:63]
    ds_read_b64_tr_b16 a[152:153], v202 offset:32768
    v_cvt_pk_bf16_f32 v83, v26, v27
    s_waitcnt lgkmcnt(13)
    v_mfma_f32_16x16x32_bf16 v[32:35], a[112:115], a[32:35], v[32:35]
    ds_read_b64_tr_b16 a[154:155], v202 offset:34816
    global_load_lds_dwordx4 v237, s[72:73] offset:1024
    v_mfma_f32_16x16x32_bf16 v[32:35], a[116:119], a[40:43], v[32:35]
    ds_read_b64_tr_b16 a[156:157], v203 offset:32768
    v_accvgpr_write_b32 a80, v80
    v_mfma_f32_16x16x32_bf16 v[36:39], a[112:115], a[36:39], v[36:39]
    ds_read_b64_tr_b16 a[158:159], v203 offset:34816
    v_accvgpr_write_b32 a81, v81
    v_mfma_f32_16x16x32_bf16 v[36:39], a[116:119], a[44:47], v[36:39]
    ds_read_b64_tr_b16 a[112:113], v208 offset:36864
    v_accvgpr_write_b32 a82, v82
    v_mfma_f32_16x16x32_bf16 v[40:43], a[120:123], a[32:35], v[40:43]
    ds_read_b64_tr_b16 a[114:115], v208 offset:38912
    global_load_lds_dwordx4 v238, s[72:73] offset:2048
    v_mfma_f32_16x16x32_bf16 v[40:43], a[124:127], a[40:43], v[40:43]
    ds_read_b64_tr_b16 a[116:117], v208 offset:45056
    v_accvgpr_write_b32 a83, v83
    v_mfma_f32_16x16x32_bf16 v[44:47], a[120:123], a[36:39], v[44:47]
    ds_read_b64_tr_b16 a[118:119], v208 offset:47104
    v_cvt_pk_bf16_f32 v84, v20, v21
    v_mfma_f32_16x16x32_bf16 v[44:47], a[124:127], a[44:47], v[44:47]
    ds_read_b64_tr_b16 a[120:121], v209 offset:36864
    v_cvt_pk_bf16_f32 v85, v22, v23
    s_waitcnt lgkmcnt(13)
    v_mfma_f32_16x16x32_bf16 v[48:51], a[128:131], a[32:35], v[48:51]
    ds_read_b64_tr_b16 a[122:123], v209 offset:38912
    global_load_lds_dwordx4 v239, s[72:73] offset:3072
    v_mfma_f32_16x16x32_bf16 v[48:51], a[132:135], a[40:43], v[48:51]
    ds_read_b64_tr_b16 a[124:125], v209 offset:45056
    s_add_u32 m0, s42, 114688
    v_cvt_pk_bf16_f32 v86, v28, v29
    v_mfma_f32_16x16x32_bf16 v[52:55], a[128:131], a[36:39], v[52:55]
    ds_read_b64_tr_b16 a[126:127], v209 offset:47104
    s_add_u32 s72, s69, 32768
    v_cvt_pk_bf16_f32 v87, v30, v31
    v_mfma_f32_16x16x32_bf16 v[52:55], a[132:135], a[44:47], v[52:55]
    ds_read_b64_tr_b16 a[128:129], v208 offset:49152
    global_load_lds_dwordx4 v236, s[72:73] offset:0
    v_accvgpr_write_b32 a84, v84
    v_mfma_f32_16x16x32_bf16 v[56:59], a[136:139], a[32:35], v[56:59]
    ds_read_b64_tr_b16 a[130:131], v208 offset:51200
    v_accvgpr_write_b32 a85, v85
    v_mfma_f32_16x16x32_bf16 v[56:59], a[140:143], a[40:43], v[56:59]
    ds_read_b64_tr_b16 a[132:133], v208 offset:53248
    v_accvgpr_write_b32 a86, v86
    v_mfma_f32_16x16x32_bf16 v[60:63], a[136:139], a[36:39], v[60:63]
    ds_read_b64_tr_b16 a[134:135], v208 offset:55296
    v_accvgpr_write_b32 a87, v87
    v_mfma_f32_16x16x32_bf16 v[60:63], a[140:143], a[44:47], v[60:63]
    ds_read_b64_tr_b16 a[136:137], v209 offset:49152
    global_load_lds_dwordx4 v237, s[72:73] offset:1024
    s_waitcnt lgkmcnt(15)
    v_mfma_f32_16x16x32_bf16 v[32:35], a[144:147], a[48:51], v[32:35]
    ds_read_b64_tr_b16 a[138:139], v209 offset:51200
    ds_read_b64_tr_b16 a[140:141], v209 offset:53248
    v_mfma_f32_16x16x32_bf16 v[36:39], a[144:147], a[52:55], v[36:39]
    ds_read_b64_tr_b16 a[142:143], v209 offset:55296
    v_mfma_f32_16x16x32_bf16 v[40:43], a[148:151], a[48:51], v[40:43]
    v_mfma_f32_16x16x32_bf16 v[44:47], a[148:151], a[52:55], v[44:47]
    ds_read_b64_tr_b16 a[144:145], v208 offset:57344
    ds_read_b64_tr_b16 a[146:147], v208 offset:59392
    global_load_lds_dwordx4 v238, s[72:73] offset:2048
    s_waitcnt lgkmcnt(15)
    v_mfma_f32_16x16x32_bf16 v[48:51], a[152:155], a[48:51], v[48:51]
    ds_read_b64_tr_b16 a[148:149], v208 offset:61440
    ds_read_b64_tr_b16 a[150:151], v208 offset:63488
    v_mfma_f32_16x16x32_bf16 v[52:55], a[152:155], a[52:55], v[52:55]
    v_mfma_f32_16x16x32_bf16 v[56:59], a[156:159], a[48:51], v[56:59]
    v_mfma_f32_16x16x32_bf16 v[60:63], a[156:159], a[52:55], v[60:63]
    ds_read_b64_tr_b16 a[152:153], v209 offset:57344
    ds_read_b64_tr_b16 a[154:155], v209 offset:59392
    global_load_lds_dwordx4 v239, s[72:73] offset:3072
    s_waitcnt lgkmcnt(14)
    v_mfma_f32_16x16x32_bf16 v[96:99], a[112:115], a[0:3], 0
    ds_read_b64_tr_b16 a[156:157], v209 offset:61440
    v_mfma_f32_16x16x32_bf16 v[96:99], a[116:119], a[8:11], v[96:99]
    ds_read_b64_tr_b16 a[158:159], v209 offset:63488
    v_mfma_f32_16x16x32_bf16 v[100:103], a[112:115], a[4:7], 0
    v_mfma_f32_16x16x32_bf16 v[100:103], a[116:119], a[12:15], v[100:103]
    s_waitcnt vmcnt(8)
    s_barrier
    ds_read_b64_tr_b16 a[112:113], v210 offset:0
    s_and_b32 s100, s24, 0x0fffffff
    v_add_u32 v233, s100, v244
    s_mov_b32 s100, 512
    v_mad_u32_u24 v232, v243, s100, v233
    v_add_u32 v233, 3072, v232
    v_add_u32 v234, 6144, v232
    v_add_u32 v235, 9216, v232
    s_mov_b32 s71, s25
    s_and_b32 s68, s24, 0xf0000000
    s_add_u32 s68, s68, s57
    s_add_u32 m0, s42, 0
    s_add_u32 s70, s68, 0
    v_mfma_f32_16x16x32_bf16 v[104:107], a[120:123], a[0:3], 0
    ds_read_b64_tr_b16 a[114:115], v210 offset:2048
    global_load_lds_dwordx4 v232, s[70:71] offset:0
    v_mfma_f32_16x16x32_bf16 v[104:107], a[124:127], a[8:11], v[104:107]
    ds_read_b64_tr_b16 a[116:117], v211 offset:0
    v_mfma_f32_16x16x32_bf16 v[108:111], a[120:123], a[4:7], 0
    ds_read_b64_tr_b16 a[118:119], v211 offset:2048
    v_cvt_pk_bf16_f32 v80, v32, v33
    v_mfma_f32_16x16x32_bf16 v[108:111], a[124:127], a[12:15], v[108:111]
    ds_read_b128 a[120:123], v220 offset:16384
    v_cvt_pk_bf16_f32 v81, v34, v35
    s_waitcnt lgkmcnt(13)
    v_mfma_f32_16x16x32_bf16 v[96:99], a[128:131], a[16:19], v[96:99]
    ds_read_b128 a[124:127], v221 offset:16384
    v_cvt_pk_bf16_f32 v82, v40, v41
    v_mfma_f32_16x16x32_bf16 v[96:99], a[132:135], a[24:27], v[96:99]
    global_load_lds_dwordx4 v233, s[70:71] offset:1024
    v_cvt_pk_bf16_f32 v83, v42, v43
    v_mfma_f32_16x16x32_bf16 v[100:103], a[128:131], a[20:23], v[100:103]
    v_accvgpr_write_b32 a88, v80
    v_accvgpr_write_b32 a89, v81
    v_mfma_f32_16x16x32_bf16 v[100:103], a[132:135], a[28:31], v[100:103]
    ds_read_b128 a[128:131], v222 offset:16384
    v_accvgpr_write_b32 a90, v82
    v_mfma_f32_16x16x32_bf16 v[104:107], a[136:139], a[16:19], v[104:107]
    ds_read_b128 a[132:135], v223 offset:16384
    v_accvgpr_write_b32 a91, v83
    v_mfma_f32_16x16x32_bf16 v[104:107], a[140:143], a[24:27], v[104:107]
    global_load_lds_dwordx4 v234, s[70:71] offset:2048
    v_cvt_pk_bf16_f32 v84, v36, v37
    v_mfma_f32_16x16x32_bf16 v[108:111], a[136:139], a[20:23], v[108:111]
    v_cvt_pk_bf16_f32 v85, v38, v39
    v_cvt_pk_bf16_f32 v86, v44, v45
    v_mfma_f32_16x16x32_bf16 v[108:111], a[140:143], a[28:31], v[108:111]
    ds_read_b128 a[136:139], v220 offset:16640
    s_waitcnt lgkmcnt(9)
    v_mfma_f32_16x16x32_bf16 v[96:99], a[144:147], a[32:35], v[96:99]
    ds_read_b128 a[140:143], v221 offset:16640
    v_cvt_pk_bf16_f32 v87, v46, v47
    v_mfma_f32_16x16x32_bf16 v[96:99], a[148:151], a[40:43], v[96:99]
    global_load_lds_dwordx4 v235, s[70:71] offset:3072
    v_accvgpr_write_b32 a92, v84
    v_mfma_f32_16x16x32_bf16 v[100:103], a[144:147], a[36:39], v[100:103]
    v_accvgpr_write_b32 a93, v85
    v_accvgpr_write_b32 a94, v86
    v_mfma_f32_16x16x32_bf16 v[100:103], a[148:151], a[44:47], v[100:103]
    ds_read_b128 a[144:147], v222 offset:16640
    s_add_u32 m0, s42, 16384
    v_mfma_f32_16x16x32_bf16 v[104:107], a[152:155], a[32:35], v[104:107]
    ds_read_b128 a[148:151], v223 offset:16640
    s_add_u32 s72, s69, 49152
    v_mfma_f32_16x16x32_bf16 v[104:107], a[156:159], a[40:43], v[104:107]
    global_load_lds_dwordx4 v236, s[72:73] offset:0
    v_accvgpr_write_b32 a95, v87
    v_cvt_pk_bf16_f32 v80, v48, v49
    v_mfma_f32_16x16x32_bf16 v[108:111], a[152:155], a[36:39], v[108:111]
    v_cvt_pk_bf16_f32 v81, v50, v51
    v_cvt_pk_bf16_f32 v82, v56, v57
    v_mfma_f32_16x16x32_bf16 v[108:111], a[156:159], a[44:47], v[108:111]
    ds_read_b128 a[152:155], v220 offset:24576
    s_waitcnt lgkmcnt(9)
    v_mfma_f32_16x16x32_bf16 v[96:99], a[112:115], a[48:51], v[96:99]
    ds_read_b128 a[156:159], v221 offset:24576
    v_cvt_pk_bf16_f32 v83, v58, v59
    v_mfma_f32_16x16x32_bf16 v[100:103], a[112:115], a[52:55], v[100:103]
    v_accvgpr_write_b32 a96, v80
    v_accvgpr_write_b32 a97, v81
    v_mfma_f32_16x16x32_bf16 v[104:107], a[116:119], a[48:51], v[104:107]
    global_load_lds_dwordx4 v237, s[72:73] offset:1024
    v_accvgpr_write_b32 a98, v82
    v_mfma_f32_16x16x32_bf16 v[108:111], a[116:119], a[52:55], v[108:111]
    ds_read_b128 a[112:115], v222 offset:24576
    ds_read_b128 a[116:119], v223 offset:24576
    s_waitcnt lgkmcnt(8)
    v_mfma_f32_16x16x32_bf16 v[128:131], a[120:123], a[192:195], 0
    v_accvgpr_write_b32 a99, v83
    v_cvt_pk_bf16_f32 v84, v52, v53
    v_mfma_f32_16x16x32_bf16 v[128:131], a[124:127], a[200:203], v[128:131]
    v_cvt_pk_bf16_f32 v85, v54, v55
    v_cvt_pk_bf16_f32 v86, v60, v61
    v_mfma_f32_16x16x32_bf16 v[136:139], a[120:123], a[196:199], 0
    global_load_lds_dwordx4 v238, s[72:73] offset:2048
    v_cvt_pk_bf16_f32 v87, v62, v63
    v_mfma_f32_16x16x32_bf16 v[136:139], a[124:127], a[204:207], v[136:139]
    ds_read_b128 a[120:123], v220 offset:24832
    v_accvgpr_write_b32 a100, v84
    v_mfma_f32_16x16x32_bf16 v[128:131], a[128:131], a[208:211], v[128:131]
    ds_read_b128 a[124:127], v221 offset:24832
    v_accvgpr_write_b32 a101, v85
    v_mfma_f32_16x16x32_bf16 v[128:131], a[132:135], a[216:219], v[128:131]
    v_accvgpr_write_b32 a102, v86
    v_accvgpr_write_b32 a103, v87
    v_mfma_f32_16x16x32_bf16 v[136:139], a[128:131], a[212:215], v[136:139]
    global_load_lds_dwordx4 v239, s[72:73] offset:3072
    v_mfma_f32_16x16x32_bf16 v[136:139], a[132:135], a[220:223], v[136:139]
    ds_read_b128 a[128:131], v222 offset:24832
    s_waitcnt lgkmcnt(7)
    v_mfma_f32_16x16x32_bf16 v[128:131], a[136:139], a[224:227], v[128:131]
    ds_read_b128 a[132:135], v223 offset:24832
    v_mfma_f32_16x16x32_bf16 v[128:131], a[140:143], a[232:235], v[128:131]
    v_mfma_f32_16x16x32_bf16 v[136:139], a[136:139], a[228:231], v[136:139]
    v_mfma_f32_16x16x32_bf16 v[136:139], a[140:143], a[236:239], v[136:139]
    s_waitcnt vmcnt(8)
    s_barrier
    ds_read_b128 a[136:139], v220 offset:32768
    s_add_u32 m0, s42, 32768
    s_add_u32 s70, s68, 16384
    v_mfma_f32_16x16x32_bf16 v[128:131], a[144:147], a[240:243], v[128:131]
    ds_read_b128 a[140:143], v221 offset:32768
    global_load_lds_dwordx4 v232, s[70:71] offset:0
    v_cvt_pk_bf16_f32 v80, v96, v97
    v_mfma_f32_16x16x32_bf16 v[128:131], a[148:151], a[248:251], v[128:131]
    v_cvt_pk_bf16_f32 v81, v98, v99
    v_cvt_pk_bf16_f32 v82, v104, v105
    v_mfma_f32_16x16x32_bf16 v[136:139], a[144:147], a[244:247], v[136:139]
    v_cvt_pk_bf16_f32 v83, v106, v107
    v_accvgpr_write_b32 a104, v80
    v_mfma_f32_16x16x32_bf16 v[136:139], a[148:151], a[252:255], v[136:139]
    ds_read_b128 a[144:147], v222 offset:32768
    s_waitcnt lgkmcnt(7)
    v_mfma_f32_16x16x32_bf16 v[132:135], a[152:155], a[192:195], 0
    ds_read_b128 a[148:151], v223 offset:32768
    v_accvgpr_write_b32 a105, v81
    v_mfma_f32_16x16x32_bf16 v[132:135], a[156:159], a[200:203], v[132:135]
    v_accvgpr_write_b32 a106, v82
    v_accvgpr_write_b32 a107, v83
    v_mfma_f32_16x16x32_bf16 v[140:143], a[152:155], a[196:199], 0
    v_cvt_pk_bf16_f32 v84, v100, v101
    v_cvt_pk_bf16_f32 v85, v102, v103
    v_mfma_f32_16x16x32_bf16 v[140:143], a[156:159], a[204:207], v[140:143]
    ds_read_b128 a[152:155], v220 offset:33024
    v_cvt_pk_bf16_f32 v86, v108, v109
    v_mfma_f32_16x16x32_bf16 v[132:135], a[112:115], a[208:211], v[132:135]
    ds_read_b128 a[156:159], v221 offset:33024
    global_load_lds_dwordx4 v233, s[70:71] offset:1024
    v_mfma_f32_16x16x32_bf16 v[132:135], a[116:119], a[216:219], v[132:135]
    v_cvt_pk_bf16_f32 v87, v110, v111
    v_accvgpr_write_b32 a108, v84
    v_mfma_f32_16x16x32_bf16 v[140:143], a[112:115], a[212:215], v[140:143]
    v_accvgpr_write_b32 a109, v85
    v_accvgpr_write_b32 a110, v86
    v_mfma_f32_16x16x32_bf16 v[140:143], a[116:119], a[220:223], v[140:143]
    ds_read_b128 a[112:115], v222 offset:33024
    s_waitcnt lgkmcnt(7)
    v_mfma_f32_16x16x32_bf16 v[132:135], a[120:123], a[224:227], v[132:135]
    ds_read_b128 a[116:119], v223 offset:33024
    v_accvgpr_write_b32 a111, v87
    v_mfma_f32_16x16x32_bf16 v[132:135], a[124:127], a[232:235], v[132:135]
    v_mfma_f32_16x16x32_bf16 v[140:143], a[120:123], a[228:231], v[140:143]
    v_mfma_f32_16x16x32_bf16 v[140:143], a[124:127], a[236:239], v[140:143]
    ds_read_b128 a[120:123], v220 offset:40960
    v_mfma_f32_16x16x32_bf16 v[132:135], a[128:131], a[240:243], v[132:135]
    ds_read_b128 a[124:127], v221 offset:40960
    global_load_lds_dwordx4 v234, s[70:71] offset:2048
    v_mfma_f32_16x16x32_bf16 v[132:135], a[132:135], a[248:251], v[132:135]
    v_mfma_f32_16x16x32_bf16 v[140:143], a[128:131], a[244:247], v[140:143]
    v_mfma_f32_16x16x32_bf16 v[140:143], a[132:135], a[252:255], v[140:143]
    ds_read_b128 a[128:131], v222 offset:40960
    s_waitcnt lgkmcnt(7)
    v_mfma_f32_16x16x32_bf16 v[144:147], a[136:139], a[192:195], 0
    ds_read_b128 a[132:135], v223 offset:40960
    v_mfma_f32_16x16x32_bf16 v[144:147], a[140:143], a[200:203], v[144:147]
    v_mfma_f32_16x16x32_bf16 v[152:155], a[136:139], a[196:199], 0
    v_mfma_f32_16x16x32_bf16 v[152:155], a[140:143], a[204:207], v[152:155]
    ds_read_b128 a[136:139], v220 offset:41216
    v_mfma_f32_16x16x32_bf16 v[144:147], a[144:147], a[208:211], v[144:147]
    ds_read_b128 a[140:143], v221 offset:41216
    global_load_lds_dwordx4 v235, s[70:71] offset:3072
    v_mfma_f32_16x16x32_bf16 v[144:147], a[148:151], a[216:219], v[144:147]
    v_mfma_f32_16x16x32_bf16 v[152:155], a[144:147], a[212:215], v[152:155]
    s_add_u32 m0, s42, 49152
    v_max3_f32 v184, v128, v129, v130
    v_mfma_f32_16x16x32_bf16 v[152:155], a[148:151], a[220:223], v[152:155]
    ds_read_b128 a[144:147], v222 offset:41216
    v_max3_f32 v184, v184, v131, v132
    v_max3_f32 v184, v184, v133, v134
    v_max_f32 v184, v184, v135
    s_waitcnt lgkmcnt(7)
    v_mfma_f32_16x16x32_bf16 v[144:147], a[152:155], a[224:227], v[144:147]
    ds_read_b128 a[148:151], v223 offset:41216
    v_max3_f32 v185, v136, v137, v138
    v_max3_f32 v185, v185, v139, v140
    v_max3_f32 v185, v185, v141, v142
    v_max_f32 v185, v185, v143
    v_mfma_f32_16x16x32_bf16 v[144:147], a[156:159], a[232:235], v[144:147]
    s_add_u32 s72, s69, 65536
    v_mov_b32 v186, v184
    v_mov_b32 v187, v185
    s_nop 0
    s_nop 0
    v_mfma_f32_16x16x32_bf16 v[152:155], a[152:155], a[228:231], v[152:155]
    v_permlane16_swap_b32 v184, v186
    v_permlane16_swap_b32 v185, v187
    s_nop 0
    s_nop 0
    v_mfma_f32_16x16x32_bf16 v[152:155], a[156:159], a[236:239], v[152:155]
    ds_read_b128 a[152:155], v220 offset:49152
    global_load_lds_dwordx4 v236, s[72:73] offset:0
    v_max_f32 v184, v184, v186
    v_max_f32 v185, v185, v187
    v_mov_b32 v186, v184
    v_mov_b32 v187, v185
    v_mfma_f32_16x16x32_bf16 v[144:147], a[112:115], a[240:243], v[144:147]
    ds_read_b128 a[156:159], v221 offset:49152
    s_nop 0
    s_nop 0
    v_permlane32_swap_b32 v184, v186
    v_permlane32_swap_b32 v185, v187
    v_mfma_f32_16x16x32_bf16 v[144:147], a[116:119], a[248:251], v[144:147]
    s_nop 0
    s_nop 0
    v_max_f32 v184, v184, v186
    v_mfma_f32_16x16x32_bf16 v[152:155], a[112:115], a[244:247], v[152:155]
    v_max_f32 v185, v185, v187
    v_sub_f32 v176, 0, v184
    v_sub_f32 v177, 0, v184
    v_sub_f32 v178, 0, v184
    v_mfma_f32_16x16x32_bf16 v[152:155], a[116:119], a[252:255], v[152:155]
    ds_read_b128 a[112:115], v222 offset:49152
    v_sub_f32 v179, 0, v184
    v_sub_f32 v180, 0, v185
    v_sub_f32 v181, 0, v185
    v_sub_f32 v182, 0, v185
    s_waitcnt lgkmcnt(7)
    v_mfma_f32_16x16x32_bf16 v[148:151], a[120:123], a[192:195], 0
    ds_read_b128 a[116:119], v223 offset:49152
    v_sub_f32 v183, 0, v185
    v_add_f32 v128, v176, v128
    v_add_f32 v129, v176, v129
    v_add_f32 v130, v176, v130
    v_mfma_f32_16x16x32_bf16 v[148:151], a[124:127], a[200:203], v[148:151]
    v_add_f32 v131, v176, v131
    v_add_f32 v132, v176, v132
    v_add_f32 v133, v176, v133
    v_add_f32 v134, v176, v134
    v_mfma_f32_16x16x32_bf16 v[156:159], a[120:123], a[196:199], 0
    v_add_f32 v135, v176, v135
    v_add_f32 v136, v180, v136
    v_add_f32 v137, v180, v137
    v_add_f32 v138, v180, v138
    v_mfma_f32_16x16x32_bf16 v[156:159], a[124:127], a[204:207], v[156:159]
    ds_read_b128 a[120:123], v220 offset:49408
    global_load_lds_dwordx4 v237, s[72:73] offset:1024
    v_add_f32 v139, v180, v139
    v_add_f32 v140, v180, v140
    v_add_f32 v141, v180, v141
    v_mfma_f32_16x16x32_bf16 v[148:151], a[128:131], a[208:211], v[148:151]
    ds_read_b128 a[124:127], v221 offset:49408
    v_add_f32 v142, v180, v142
    v_add_f32 v143, v180, v143
    v_mov_b32 v192, 0
    v_mov_b32 v193, 0
    v_mfma_f32_16x16x32_bf16 v[148:151], a[132:135], a[216:219], v[148:151]
    v_exp_f32 v184, v128
    v_exp_f32 v185, v129
    v_exp_f32 v186, v130
    v_exp_f32 v187, v131
    v_mfma_f32_16x16x32_bf16 v[156:159], a[128:131], a[212:215], v[156:159]
    v_add_f32 v194, v184, v185
    v_cvt_pk_bf16_f32 v160, v184, v185
    v_add_f32 v194, v194, v186
    v_cvt_pk_bf16_f32 v161, v186, v187
    v_mfma_f32_16x16x32_bf16 v[156:159], a[132:135], a[220:223], v[156:159]
    ds_read_b128 a[128:131], v222 offset:49408
    v_add_f32 v194, v194, v187
    v_exp_f32 v188, v132
    v_exp_f32 v189, v133
    v_exp_f32 v190, v134
    s_waitcnt lgkmcnt(7)
    v_mfma_f32_16x16x32_bf16 v[148:151], a[136:139], a[224:227], v[148:151]
    ds_read_b128 a[132:135], v223 offset:49408
    v_exp_f32 v191, v135
    v_add_f32 v194, v194, v188
    v_cvt_pk_bf16_f32 v162, v188, v189
    v_add_f32 v194, v194, v189
    v_mfma_f32_16x16x32_bf16 v[148:151], a[140:143], a[232:235], v[148:151]
    v_add_f32 v194, v194, v190
    v_cvt_pk_bf16_f32 v163, v190, v191
    v_add_f32 v194, v194, v191
    v_mfma_f32_16x16x32_bf16 v[156:159], a[136:139], a[228:231], v[156:159]
    v_exp_f32 v184, v136
    v_exp_f32 v185, v137
    v_exp_f32 v186, v138
    v_exp_f32 v187, v139
    v_mfma_f32_16x16x32_bf16 v[156:159], a[140:143], a[236:239], v[156:159]
    ds_read_b128 a[136:139], v220 offset:57344
    global_load_lds_dwordx4 v238, s[72:73] offset:2048
    v_add_f32 v195, v184, v185
    v_cvt_pk_bf16_f32 v164, v184, v185
    v_add_f32 v195, v195, v186
    v_cvt_pk_bf16_f32 v165, v186, v187
    v_mfma_f32_16x16x32_bf16 v[148:151], a[144:147], a[240:243], v[148:151]
    ds_read_b128 a[140:143], v221 offset:57344
    v_add_f32 v195, v195, v187
    v_exp_f32 v188, v140
    v_exp_f32 v189, v141
    v_exp_f32 v190, v142
    v_mfma_f32_16x16x32_bf16 v[148:151], a[148:151], a[248:251], v[148:151]
    v_exp_f32 v191, v143
    v_add_f32 v195, v195, v188
    v_cvt_pk_bf16_f32 v166, v188, v189
    v_add_f32 v195, v195, v189
    v_mfma_f32_16x16x32_bf16 v[156:159], a[144:147], a[244:247], v[156:159]
    v_add_f32 v195, v195, v190
    v_cvt_pk_bf16_f32 v167, v190, v191
    v_add_f32 v195, v195, v191
    v_mfma_f32_16x16x32_bf16 v[156:159], a[148:151], a[252:255], v[156:159]
    ds_read_b128 a[144:147], v222 offset:57344
    v_add_f32 v192, v192, v194
    v_add_f32 v193, v193, v195
    s_waitcnt lgkmcnt(7)
    v_mfma_f32_16x16x32_bf16 v[128:131], a[152:155], a[192:195], v[176:179]
    ds_read_b128 a[148:151], v223 offset:57344
    v_mfma_f32_16x16x32_bf16 v[128:131], a[156:159], a[200:203], v[128:131]
    v_mfma_f32_16x16x32_bf16 v[136:139], a[152:155], a[196:199], v[180:183]
    v_mfma_f32_16x16x32_bf16 v[136:139], a[156:159], a[204:207], v[136:139]
    ds_read_b128 a[152:155], v220 offset:57600
    global_load_lds_dwordx4 v239, s[72:73] offset:3072
    v_mfma_f32_16x16x32_bf16 v[128:131], a[112:115], a[208:211], v[128:131]
    ds_read_b128 a[156:159], v221 offset:57600
    s_load_dwordx2 s[12:13], s[0:1], 80
    v_mfma_f32_16x16x32_bf16 v[128:131], a[116:119], a[216:219], v[128:131]
    v_mfma_f32_16x16x32_bf16 v[136:139], a[112:115], a[212:215], v[136:139]
    v_add_f32 v144, v176, v144
    v_add_f32 v145, v176, v145
    v_mfma_f32_16x16x32_bf16 v[136:139], a[116:119], a[220:223], v[136:139]
    ds_read_b128 a[112:115], v222 offset:57600
    s_waitcnt lgkmcnt(7)
    v_mfma_f32_16x16x32_bf16 v[128:131], a[120:123], a[224:227], v[128:131]
    ds_read_b128 a[116:119], v223 offset:57600
    v_add_f32 v146, v176, v146
    v_mfma_f32_16x16x32_bf16 v[128:131], a[124:127], a[232:235], v[128:131]
    v_add_f32 v147, v176, v147
    v_add_f32 v148, v176, v148
    v_mfma_f32_16x16x32_bf16 v[136:139], a[120:123], a[228:231], v[136:139]
    v_add_f32 v149, v176, v149
    v_add_f32 v150, v176, v150
    v_mfma_f32_16x16x32_bf16 v[136:139], a[124:127], a[236:239], v[136:139]
    s_waitcnt vmcnt(8)
    s_barrier
    ds_read_b64_tr_b16 a[120:121], v224 offset:0
    s_add_u32 m0, s42, 65536
    s_add_u32 s70, s68, 32768
    v_mfma_f32_16x16x32_bf16 v[128:131], a[128:131], a[240:243], v[128:131]
    ds_read_b64_tr_b16 a[122:123], v224 offset:2048
    global_load_lds_dwordx4 v232, s[70:71] offset:0
    v_mfma_f32_16x16x32_bf16 v[128:131], a[132:135], a[248:251], v[128:131]
    ds_read_b64_tr_b16 a[124:125], v225 offset:0
    v_add_f32 v151, v176, v151
    v_mfma_f32_16x16x32_bf16 v[136:139], a[128:131], a[244:247], v[136:139]
    ds_read_b64_tr_b16 a[126:127], v225 offset:2048
    v_add_f32 v152, v180, v152
    v_mfma_f32_16x16x32_bf16 v[136:139], a[132:135], a[252:255], v[136:139]
    ds_read_b64_tr_b16 a[128:129], v226 offset:0
    s_waitcnt lgkmcnt(9)
    v_mfma_f32_16x16x32_bf16 v[132:135], a[136:139], a[192:195], v[176:179]
    ds_read_b64_tr_b16 a[130:131], v226 offset:2048
    v_add_f32 v153, v180, v153
    v_mfma_f32_16x16x32_bf16 v[132:135], a[140:143], a[200:203], v[132:135]
    ds_read_b64_tr_b16 a[132:133], v227 offset:0
    v_add_f32 v154, v180, v154
    v_mfma_f32_16x16x32_bf16 v[140:143], a[136:139], a[196:199], v[180:183]
    ds_read_b64_tr_b16 a[134:135], v227 offset:2048
    v_add_f32 v155, v180, v155
    v_mfma_f32_16x16x32_bf16 v[140:143], a[140:143], a[204:207], v[140:143]
    ds_read_b64_tr_b16 a[136:137], v224 offset:4096
    v_add_f32 v156, v180, v156
    v_mfma_f32_16x16x32_bf16 v[132:135], a[144:147], a[208:211], v[132:135]
    ds_read_b64_tr_b16 a[138:139], v224 offset:6144
    global_load_lds_dwordx4 v233, s[70:71] offset:1024
    v_add_f32 v157, v180, v157
    v_mfma_f32_16x16x32_bf16 v[132:135], a[148:151], a[216:219], v[132:135]
    ds_read_b64_tr_b16 a[140:141], v225 offset:4096
    v_add_f32 v158, v180, v158
    v_mfma_f32_16x16x32_bf16 v[140:143], a[144:147], a[212:215], v[140:143]
    ds_read_b64_tr_b16 a[142:143], v225 offset:6144
    v_add_f32 v159, v180, v159
    v_mfma_f32_16x16x32_bf16 v[140:143], a[148:151], a[220:223], v[140:143]
    ds_read_b64_tr_b16 a[144:145], v226 offset:4096
    v_exp_f32 v184, v144
    s_waitcnt lgkmcnt(13)
    v_mfma_f32_16x16x32_bf16 v[132:135], a[152:155], a[224:227], v[132:135]
    ds_read_b64_tr_b16 a[146:147], v226 offset:6144
    v_exp_f32 v185, v145
    s_waitcnt lgkmcnt(0)
    s_mov_b32 s14, 256
    s_mov_b32 s15, 0x00020000
    v_mov_b32 v241, 0x7ffffff0
    v_mov_b32 v252, s2
    s_lshl_b32 s100, s38, 6
    v_add_u32 v253, s100, v249
    v_cmp_eq_u32 vcc, 0, v253
    s_nop 1
    v_cndmask_b32 v241, v241, v252, vcc
    v_mfma_f32_16x16x32_bf16 v[132:135], a[156:159], a[232:235], v[132:135]
    ds_read_b64_tr_b16 a[148:149], v227 offset:4096
    v_exp_f32 v186, v146
    v_mfma_f32_16x16x32_bf16 v[140:143], a[152:155], a[228:231], v[140:143]
    ds_read_b64_tr_b16 a[150:151], v227 offset:6144
    v_exp_f32 v187, v147
    v_mfma_f32_16x16x32_bf16 v[140:143], a[156:159], a[236:239], v[140:143]
    ds_read_b64_tr_b16 a[152:153], v224 offset:8192
    v_add_f32 v194, v184, v185
    v_mfma_f32_16x16x32_bf16 v[132:135], a[112:115], a[240:243], v[132:135]
    ds_read_b64_tr_b16 a[154:155], v224 offset:10240
    global_load_lds_dwordx4 v234, s[70:71] offset:2048
    v_cvt_pk_bf16_f32 v168, v184, v185
    v_mfma_f32_16x16x32_bf16 v[132:135], a[116:119], a[248:251], v[132:135]
    ds_read_b64_tr_b16 a[156:157], v225 offset:8192
    v_add_f32 v194, v194, v186
    v_mfma_f32_16x16x32_bf16 v[140:143], a[112:115], a[244:247], v[140:143]
    ds_read_b64_tr_b16 a[158:159], v225 offset:10240
    v_cvt_pk_bf16_f32 v169, v186, v187
    v_mfma_f32_16x16x32_bf16 v[140:143], a[116:119], a[252:255], v[140:143]
    ds_read_b64_tr_b16 a[112:113], v226 offset:8192
    v_add_f32 v194, v194, v187
    v_mfma_f32_16x16x32_bf16 v[0:3], a[120:123], v[160:163], 0
    ds_read_b64_tr_b16 a[114:115], v226 offset:10240
    v_exp_f32 v188, v148
    v_mfma_f32_16x16x32_bf16 v[8:11], a[120:123], v[164:167], 0
    ds_read_b64_tr_b16 a[116:117], v227 offset:8192
    v_exp_f32 v189, v149
    v_mfma_f32_16x16x32_bf16 v[4:7], a[124:127], v[160:163], 0
    ds_read_b64_tr_b16 a[118:119], v227 offset:10240
    v_exp_f32 v190, v150
    v_mfma_f32_16x16x32_bf16 v[12:15], a[124:127], v[164:167], 0
    ds_read_b64_tr_b16 a[120:121], v224 offset:12288
    v_exp_f32 v191, v151
    v_mfma_f32_16x16x32_bf16 v[16:19], a[128:131], v[160:163], 0
    ds_read_b64_tr_b16 a[122:123], v224 offset:14336
    global_load_lds_dwordx4 v235, s[70:71] offset:3072
    v_add_f32 v194, v194, v188
    v_mfma_f32_16x16x32_bf16 v[24:27], a[128:131], v[164:167], 0
    ds_read_b64_tr_b16 a[124:125], v225 offset:12288
    v_cvt_pk_bf16_f32 v170, v188, v189
    v_mfma_f32_16x16x32_bf16 v[20:23], a[132:135], v[160:163], 0
    ds_read_b64_tr_b16 a[126:127], v225 offset:14336
    s_add_u32 m0, s42, 81920
    v_add_f32 v194, v194, v189
    v_mfma_f32_16x16x32_bf16 v[28:31], a[132:135], v[164:167], 0
    ds_read_b64_tr_b16 a[128:129], v226 offset:12288
    v_add_f32 v194, v194, v190
    s_waitcnt lgkmcnt(13)
    v_mfma_f32_16x16x32_bf16 v[32:35], a[136:139], v[160:163], 0
    ds_read_b64_tr_b16 a[130:131], v226 offset:14336
    v_cvt_pk_bf16_f32 v171, v190, v191
    s_add_u32 s98, s66, s90
    buffer_store_dwordx4 a[56:59], v240, s[32:35], s98 offen offset:0 sc1
    v_mfma_f32_16x16x32_bf16 v[40:43], a[136:139], v[164:167], 0
    ds_read_b64_tr_b16 a[132:133], v227 offset:12288
    s_add_u32 s72, s69, 81920
    v_add_f32 v194, v194, v191
    v_mfma_f32_16x16x32_bf16 v[36:39], a[140:143], v[160:163], 0
    ds_read_b64_tr_b16 a[134:135], v227 offset:14336
    v_exp_f32 v184, v152
    v_mfma_f32_16x16x32_bf16 v[44:47], a[140:143], v[164:167], 0
    ds_read_b128 a[136:139], v216 offset:16384
    global_load_lds_dwordx4 v236, s[72:73] offset:0
    v_exp_f32 v185, v153
    v_mfma_f32_16x16x32_bf16 v[48:51], a[144:147], v[160:163], 0
    ds_read_b128 a[140:143], v217 offset:16384
    v_exp_f32 v186, v154
    v_mfma_f32_16x16x32_bf16 v[56:59], a[144:147], v[164:167], 0
    v_exp_f32 v187, v155
    v_mfma_f32_16x16x32_bf16 v[52:55], a[148:151], v[160:163], 0
    v_add_f32 v195, v184, v185
    v_cvt_pk_bf16_f32 v172, v184, v185
    v_mfma_f32_16x16x32_bf16 v[60:63], a[148:151], v[164:167], 0
    ds_read_b128 a[144:147], v218 offset:16384
    s_waitcnt lgkmcnt(11)
    v_mfma_f32_16x16x32_bf16 v[64:67], a[152:155], v[160:163], 0
    ds_read_b128 a[148:151], v219 offset:16384
    v_add_f32 v195, v195, v186
    v_mfma_f32_16x16x32_bf16 v[72:75], a[152:155], v[164:167], 0
    v_cvt_pk_bf16_f32 v173, v186, v187
    v_add_f32 v195, v195, v187
    v_mfma_f32_16x16x32_bf16 v[68:71], a[156:159], v[160:163], 0
    v_exp_f32 v188, v156
    v_mfma_f32_16x16x32_bf16 v[76:79], a[156:159], v[164:167], 0
    ds_read_b128 a[152:155], v216 offset:16640
    global_load_lds_dwordx4 v237, s[72:73] offset:1024
    v_mfma_f32_16x16x32_bf16 v[80:83], a[112:115], v[160:163], 0
    ds_read_b128 a[156:159], v217 offset:16640
    v_exp_f32 v189, v157
    s_add_u32 s98, s66, s90
    buffer_store_dwordx4 a[60:63], v240, s[32:35], s98 offen offset:1024 sc1
    v_mfma_f32_16x16x32_bf16 v[88:91], a[112:115], v[164:167], 0
    v_exp_f32 v190, v158
    v_mfma_f32_16x16x32_bf16 v[84:87], a[116:119], v[160:163], 0
    v_exp_f32 v191, v159
    v_mfma_f32_16x16x32_bf16 v[92:95], a[116:119], v[164:167], 0
    ds_read_b128 a[112:115], v218 offset:16640
    v_add_f32 v195, v195, v188
    s_waitcnt lgkmcnt(7)
    v_mfma_f32_16x16x32_bf16 v[96:99], a[120:123], v[160:163], 0
    ds_read_b128 a[116:119], v219 offset:16640
    v_cvt_pk_bf16_f32 v174, v188, v189
    v_mfma_f32_16x16x32_bf16 v[104:107], a[120:123], v[164:167], 0
    v_add_f32 v195, v195, v189
    v_add_f32 v195, v195, v190
    v_mfma_f32_16x16x32_bf16 v[100:103], a[124:127], v[160:163], 0
    v_cvt_pk_bf16_f32 v175, v190, v191
    v_add_f32 v195, v195, v191
    v_mfma_f32_16x16x32_bf16 v[108:111], a[124:127], v[164:167], 0
    ds_read_b128 a[120:123], v216 offset:24576
    global_load_lds_dwordx4 v238, s[72:73] offset:2048
    v_mfma_f32_16x16x32_bf16 v[112:115], a[128:131], v[160:163], 0
    ds_read_b128 a[124:127], v217 offset:24576
    v_mfma_f32_16x16x32_bf16 v[120:123], a[128:131], v[164:167], 0
    v_mfma_f32_16x16x32_bf16 v[116:119], a[132:135], v[160:163], 0
    v_mfma_f32_16x16x32_bf16 v[124:127], a[132:135], v[164:167], 0
    ds_read_b128 a[128:131], v218 offset:24576
    v_max_f32 v196, v194, v195
    v_cmp_lt_f32 vcc, s101, v196
    s_nop 3
    s_cbranch_vccnz L_slow_1
L_back_1:
    v_add_f32 v192, v192, v194
    v_add_f32 v193, v193, v195
    s_waitcnt lgkmcnt(7)
    v_mfma_f32_16x16x32_bf16 v[144:147], a[136:139], a[192:195], v[176:179]
    ds_read_b128 a[132:135], v219 offset:24576
    v_mfma_f32_16x16x32_bf16 v[144:147], a[140:143], a[200:203], v[144:147]
    v_exp_f32 v184, v128
    v_mfma_f32_16x16x32_bf16 v[152:155], a[136:139], a[196:199], v[180:183]
    v_exp_f32 v185, v129
    v_mfma_f32_16x16x32_bf16 v[152:155], a[140:143], a[204:207], v[152:155]
    ds_read_b128 a[136:139], v216 offset:24832
    global_load_lds_dwordx4 v239, s[72:73] offset:3072
    v_mfma_f32_16x16x32_bf16 v[144:147], a[144:147], a[208:211], v[144:147]
    ds_read_b128 a[140:143], v217 offset:24832
    v_mfma_f32_16x16x32_bf16 v[144:147], a[148:151], a[216:219], v[144:147]
    v_exp_f32 v186, v130
    v_mfma_f32_16x16x32_bf16 v[152:155], a[144:147], a[212:215], v[152:155]
    v_exp_f32 v187, v131
    v_mfma_f32_16x16x32_bf16 v[152:155], a[148:151], a[220:223], v[152:155]
    ds_read_b128 a[144:147], v218 offset:24832
    s_waitcnt lgkmcnt(7)
    v_mfma_f32_16x16x32_bf16 v[144:147], a[152:155], a[224:227], v[144:147]
    ds_read_b128 a[148:151], v219 offset:24832
    v_add_f32 v194, v184, v185
    v_mfma_f32_16x16x32_bf16 v[144:147], a[156:159], a[232:235], v[144:147]
    v_cvt_pk_bf16_f32 v160, v184, v185
    v_add_f32 v194, v194, v186
    v_mfma_f32_16x16x32_bf16 v[152:155], a[152:155], a[228:231], v[152:155]
    v_cvt_pk_bf16_f32 v161, v186, v187
    v_add_f32 v194, v194, v187
    v_mfma_f32_16x16x32_bf16 v[152:155], a[156:159], a[236:239], v[152:155]
    s_waitcnt vmcnt(10)
    s_barrier
    ds_read_b64_tr_b16 a[152:153], v224 offset:32768
    s_add_u32 m0, s42, 98304
    s_add_u32 s70, s68, 49152
    v_mfma_f32_16x16x32_bf16 v[144:147], a[112:115], a[240:243], v[144:147]
    ds_read_b64_tr_b16 a[154:155], v224 offset:34816
    global_load_lds_dwordx4 v232, s[70:71] offset:0
    v_mfma_f32_16x16x32_bf16 v[144:147], a[116:119], a[248:251], v[144:147]
    ds_read_b64_tr_b16 a[156:157], v225 offset:32768
    v_mfma_f32_16x16x32_bf16 v[152:155], a[112:115], a[244:247], v[152:155]
    ds_read_b64_tr_b16 a[158:159], v225 offset:34816
    v_mfma_f32_16x16x32_bf16 v[152:155], a[116:119], a[252:255], v[152:155]
    ds_read_b64_tr_b16 a[112:113], v226 offset:32768
    s_waitcnt lgkmcnt(9)
    v_mfma_f32_16x16x32_bf16 v[148:151], a[120:123], a[192:195], v[176:179]
    ds_read_b64_tr_b16 a[114:115], v226 offset:34816
    v_exp_f32 v188, v132
    v_mfma_f32_16x16x32_bf16 v[148:151], a[124:127], a[200:203], v[148:151]
    ds_read_b64_tr_b16 a[116:117], v227 offset:32768
    v_exp_f32 v189, v133
    v_mfma_f32_16x16x32_bf16 v[156:159], a[120:123], a[196:199], v[180:183]
    ds_read_b64_tr_b16 a[118:119], v227 offset:34816
    v_mfma_f32_16x16x32_bf16 v[156:159], a[124:127], a[204:207], v[156:159]
    ds_read_b64_tr_b16 a[120:121], v224 offset:36864
    v_exp_f32 v190, v134
    v_mfma_f32_16x16x32_bf16 v[148:151], a[128:131], a[208:211], v[148:151]
    ds_read_b64_tr_b16 a[122:123], v224 offset:38912
    global_load_lds_dwordx4 v233, s[70:71] offset:1024
    v_exp_f32 v191, v135
    v_mfma_f32_16x16x32_bf16 v[148:151], a[132:135], a[216:219], v[148:151]
    ds_read_b64_tr_b16 a[124:125], v225 offset:36864
    v_add_f32 v194, v194, v188
    v_mfma_f32_16x16x32_bf16 v[156:159], a[128:131], a[212:215], v[156:159]
    ds_read_b64_tr_b16 a[126:127], v225 offset:38912
    v_cvt_pk_bf16_f32 v162, v188, v189
    v_mfma_f32_16x16x32_bf16 v[156:159], a[132:135], a[220:223], v[156:159]
    ds_read_b64_tr_b16 a[128:129], v226 offset:36864
    s_waitcnt lgkmcnt(13)
    v_mfma_f32_16x16x32_bf16 v[148:151], a[136:139], a[224:227], v[148:151]
    ds_read_b64_tr_b16 a[130:131], v226 offset:38912
    v_add_f32 v194, v194, v189
    v_mfma_f32_16x16x32_bf16 v[148:151], a[140:143], a[232:235], v[148:151]
    ds_read_b64_tr_b16 a[132:133], v227 offset:36864
    v_add_f32 v194, v194, v190
    v_mfma_f32_16x16x32_bf16 v[156:159], a[136:139], a[228:231], v[156:159]
    ds_read_b64_tr_b16 a[134:135], v227 offset:38912
    v_cvt_pk_bf16_f32 v163, v190, v191
    v_mfma_f32_16x16x32_bf16 v[156:159], a[140:143], a[236:239], v[156:159]
    ds_read_b64_tr_b16 a[136:137], v224 offset:40960
    v_add_f32 v194, v194, v191
    v_mfma_f32_16x16x32_bf16 v[148:151], a[144:147], a[240:243], v[148:151]
    ds_read_b64_tr_b16 a[138:139], v224 offset:43008
    global_load_lds_dwordx4 v234, s[70:71] offset:2048
    v_mfma_f32_16x16x32_bf16 v[148:151], a[148:151], a[248:251], v[148:151]
    ds_read_b64_tr_b16 a[140:141], v225 offset:40960
    v_mfma_f32_16x16x32_bf16 v[156:159], a[144:147], a[244:247], v[156:159]
    ds_read_b64_tr_b16 a[142:143], v225 offset:43008
    v_mfma_f32_16x16x32_bf16 v[156:159], a[148:151], a[252:255], v[156:159]
    ds_read_b64_tr_b16 a[144:145], v226 offset:40960
    v_exp_f32 v184, v136
    s_waitcnt lgkmcnt(13)
    v_mfma_f32_16x16x32_bf16 v[0:3], a[152:155], v[168:171], v[0:3]
    ds_read_b64_tr_b16 a[146:147], v226 offset:43008
    v_mfma_f32_16x16x32_bf16 v[8:11], a[152:155], v[172:175], v[8:11]
    ds_read_b64_tr_b16 a[148:149], v227 offset:40960
    v_exp_f32 v185, v137
    v_mfma_f32_16x16x32_bf16 v[4:7], a[156:159], v[168:171], v[4:7]
    ds_read_b64_tr_b16 a[150:151], v227 offset:43008
    v_mfma_f32_16x16x32_bf16 v[12:15], a[156:159], v[172:175], v[12:15]
    ds_read_b64_tr_b16 a[152:153], v224 offset:45056
    v_exp_f32 v186, v138
    v_mfma_f32_16x16x32_bf16 v[16:19], a[112:115], v[168:171], v[16:19]
    ds_read_b64_tr_b16 a[154:155], v224 offset:47104
    global_load_lds_dwordx4 v235, s[70:71] offset:3072
    v_exp_f32 v187, v139
    v_mfma_f32_16x16x32_bf16 v[24:27], a[112:115], v[172:175], v[24:27]
    ds_read_b64_tr_b16 a[156:157], v225 offset:45056
    v_add_f32 v195, v184, v185
    v_mfma_f32_16x16x32_bf16 v[20:23], a[116:119], v[168:171], v[20:23]
    ds_read_b64_tr_b16 a[158:159], v225 offset:47104
    s_add_u32 m0, s42, 114688
    v_mfma_f32_16x16x32_bf16 v[28:31], a[116:119], v[172:175], v[28:31]
    ds_read_b64_tr_b16 a[112:113], v226 offset:45056
    v_cvt_pk_bf16_f32 v164, v184, v185
    s_waitcnt lgkmcnt(13)
    v_mfma_f32_16x16x32_bf16 v[32:35], a[120:123], v[168:171], v[32:35]
    ds_read_b64_tr_b16 a[114:115], v226 offset:47104
    s_add_u32 s98, s66, s90
    buffer_store_dwordx4 a[64:67], v240, s[32:35], s98 offen offset:2048 sc1
    v_mfma_f32_16x16x32_bf16 v[40:43], a[120:123], v[172:175], v[40:43]
    ds_read_b64_tr_b16 a[116:117], v227 offset:45056
    s_add_u32 s72, s69, 98304
    v_add_f32 v195, v195, v186
    v_mfma_f32_16x16x32_bf16 v[36:39], a[124:127], v[168:171], v[36:39]
    ds_read_b64_tr_b16 a[118:119], v227 offset:47104
    v_cvt_pk_bf16_f32 v165, v186, v187
    v_mfma_f32_16x16x32_bf16 v[44:47], a[124:127], v[172:175], v[44:47]
    ds_read_b128 a[120:123], v216 offset:49152
    global_load_lds_dwordx4 v236, s[72:73] offset:0
    v_mfma_f32_16x16x32_bf16 v[48:51], a[128:131], v[168:171], v[48:51]
    ds_read_b128 a[124:127], v217 offset:49152
    v_add_f32 v195, v195, v187
    v_mfma_f32_16x16x32_bf16 v[56:59], a[128:131], v[172:175], v[56:59]
    v_exp_f32 v188, v140
    v_mfma_f32_16x16x32_bf16 v[52:55], a[132:135], v[168:171], v[52:55]
    v_exp_f32 v189, v141
    v_mfma_f32_16x16x32_bf16 v[60:63], a[132:135], v[172:175], v[60:63]
    ds_read_b128 a[128:131], v218 offset:49152
    s_waitcnt lgkmcnt(11)
    v_mfma_f32_16x16x32_bf16 v[64:67], a[136:139], v[168:171], v[64:67]
    ds_read_b128 a[132:135], v219 offset:49152
    v_mfma_f32_16x16x32_bf16 v[72:75], a[136:139], v[172:175], v[72:75]
    v_exp_f32 v190, v142
    v_mfma_f32_16x16x32_bf16 v[68:71], a[140:143], v[168:171], v[68:71]
    v_exp_f32 v191, v143
    v_mfma_f32_16x16x32_bf16 v[76:79], a[140:143], v[172:175], v[76:79]
    ds_read_b128 a[136:139], v216 offset:49408
    global_load_lds_dwordx4 v237, s[72:73] offset:1024
    v_mfma_f32_16x16x32_bf16 v[80:83], a[144:147], v[168:171], v[80:83]
    ds_read_b128 a[140:143], v217 offset:49408
    v_add_f32 v195, v195, v188
    s_add_u32 s98, s66, s90
    buffer_store_dwordx4 a[68:71], v240, s[32:35], s98 offen offset:3072 sc1
    v_mfma_f32_16x16x32_bf16 v[88:91], a[144:147], v[172:175], v[88:91]
    v_cvt_pk_bf16_f32 v166, v188, v189
    v_add_f32 v195, v195, v189
    v_mfma_f32_16x16x32_bf16 v[84:87], a[148:151], v[168:171], v[84:87]
    v_add_f32 v195, v195, v190
    v_cvt_pk_bf16_f32 v167, v190, v191
    v_mfma_f32_16x16x32_bf16 v[92:95], a[148:151], v[172:175], v[92:95]
    ds_read_b128 a[144:147], v218 offset:49408
    s_waitcnt lgkmcnt(7)
    v_mfma_f32_16x16x32_bf16 v[96:99], a[152:155], v[168:171], v[96:99]
    ds_read_b128 a[148:151], v219 offset:49408
    v_add_f32 v195, v195, v191
    v_mfma_f32_16x16x32_bf16 v[104:107], a[152:155], v[172:175], v[104:107]
    v_mfma_f32_16x16x32_bf16 v[100:103], a[156:159], v[168:171], v[100:103]
    v_mfma_f32_16x16x32_bf16 v[108:111], a[156:159], v[172:175], v[108:111]
    ds_read_b128 a[152:155], v216 offset:57344
    global_load_lds_dwordx4 v238, s[72:73] offset:2048
    v_mfma_f32_16x16x32_bf16 v[112:115], a[112:115], v[168:171], v[112:115]
    ds_read_b128 a[156:159], v217 offset:57344
    v_mfma_f32_16x16x32_bf16 v[120:123], a[112:115], v[172:175], v[120:123]
    v_mfma_f32_16x16x32_bf16 v[116:119], a[116:119], v[168:171], v[116:119]
    v_mfma_f32_16x16x32_bf16 v[124:127], a[116:119], v[172:175], v[124:127]
    ds_read_b128 a[112:115], v218 offset:57344
    v_max_f32 v196, v194, v195
    v_cmp_lt_f32 vcc, s101, v196
    s_nop 3
    s_cbranch_vccnz L_slow_2
L_back_2:
    v_add_f32 v192, v192, v194
    v_add_f32 v193, v193, v195
    s_waitcnt lgkmcnt(7)
    v_mfma_f32_16x16x32_bf16 v[128:131], a[120:123], a[192:195], v[176:179]
    ds_read_b128 a[116:119], v219 offset:57344
    v_mfma_f32_16x16x32_bf16 v[128:131], a[124:127], a[200:203], v[128:131]
    v_exp_f32 v184, v144
    v_mfma_f32_16x16x32_bf16 v[136:139], a[120:123], a[196:199], v[180:183]
    v_exp_f32 v185, v145
    v_mfma_f32_16x16x32_bf16 v[136:139], a[124:127], a[204:207], v[136:139]
    ds_read_b128 a[120:123], v216 offset:57600
    global_load_lds_dwordx4 v239, s[72:73] offset:3072
    v_mfma_f32_16x16x32_bf16 v[128:131], a[128:131], a[208:211], v[128:131]
    ds_read_b128 a[124:127], v217 offset:57600
    v_mfma_f32_16x16x32_bf16 v[128:131], a[132:135], a[216:219], v[128:131]
    v_exp_f32 v186, v146
    v_mfma_f32_16x16x32_bf16 v[136:139], a[128:131], a[212:215], v[136:139]
    v_exp_f32 v187, v147
    v_mfma_f32_16x16x32_bf16 v[136:139], a[132:135], a[220:223], v[136:139]
    ds_read_b128 a[128:131], v218 offset:57600
    s_waitcnt lgkmcnt(7)
    v_mfma_f32_16x16x32_bf16 v[128:131], a[136:139], a[224:227], v[128:131]
    ds_read_b128 a[132:135], v219 offset:57600
    v_add_f32 v194, v184, v185
    v_mfma_f32_16x16x32_bf16 v[128:131], a[140:143], a[232:235], v[128:131]
    v_cvt_pk_bf16_f32 v168, v184, v185
    v_add_f32 v194, v194, v186
    v_mfma_f32_16x16x32_bf16 v[136:139], a[136:139], a[228:231], v[136:139]
    v_cvt_pk_bf16_f32 v169, v186, v187
    v_add_f32 v194, v194, v187
    v_mfma_f32_16x16x32_bf16 v[136:139], a[140:143], a[236:239], v[136:139]
    s_waitcnt vmcnt(10)
    s_barrier
    ds_read_b64_tr_b16 a[136:137], v228 offset:0
    s_add_u32 m0, s42, 0
    s_add_u32 s70, s68, 65536
    v_mfma_f32_16x16x32_bf16 v[128:131], a[144:147], a[240:243], v[128:131]
    ds_read_b64_tr_b16 a[138:139], v228 offset:2048
    global_load_lds_dwordx4 v232, s[70:71] offset:0
    v_mfma_f32_16x16x32_bf16 v[128:131], a[148:151], a[248:251], v[128:131]
    ds_read_b64_tr_b16 a[140:141], v229 offset:0
    v_mfma_f32_16x16x32_bf16 v[136:139], a[144:147], a[244:247], v[136:139]
    ds_read_b64_tr_b16 a[142:143], v229 offset:2048
    v_mfma_f32_16x16x32_bf16 v[136:139], a[148:151], a[252:255], v[136:139]
    ds_read_b64_tr_b16 a[144:145], v230 offset:0
    s_waitcnt lgkmcnt(9)
    v_mfma_f32_16x16x32_bf16 v[132:135], a[152:155], a[192:195], v[176:179]
    ds_read_b64_tr_b16 a[146:147], v230 offset:2048
    v_exp_f32 v188, v148
    v_mfma_f32_16x16x32_bf16 v[132:135], a[156:159], a[200:203], v[132:135]
    ds_read_b64_tr_b16 a[148:149], v231 offset:0
    v_exp_f32 v189, v149
    v_mfma_f32_16x16x32_bf16 v[140:143], a[152:155], a[196:199], v[180:183]
    ds_read_b64_tr_b16 a[150:151], v231 offset:2048
    v_mfma_f32_16x16x32_bf16 v[140:143], a[156:159], a[204:207], v[140:143]
    ds_read_b64_tr_b16 a[152:153], v228 offset:4096
    v_exp_f32 v190, v150
    v_mfma_f32_16x16x32_bf16 v[132:135], a[112:115], a[208:211], v[132:135]
    ds_read_b64_tr_b16 a[154:155], v228 offset:6144
    global_load_lds_dwordx4 v233, s[70:71] offset:1024
    v_exp_f32 v191, v151
    v_mfma_f32_16x16x32_bf16 v[132:135], a[116:119], a[216:219], v[132:135]
    ds_read_b64_tr_b16 a[156:157], v229 offset:4096
    v_add_f32 v194, v194, v188
    v_mfma_f32_16x16x32_bf16 v[140:143], a[112:115], a[212:215], v[140:143]
    ds_read_b64_tr_b16 a[158:159], v229 offset:6144
    v_cvt_pk_bf16_f32 v170, v188, v189
    v_mfma_f32_16x16x32_bf16 v[140:143], a[116:119], a[220:223], v[140:143]
    ds_read_b64_tr_b16 a[112:113], v230 offset:4096
    s_waitcnt lgkmcnt(13)
    v_mfma_f32_16x16x32_bf16 v[132:135], a[120:123], a[224:227], v[132:135]
    ds_read_b64_tr_b16 a[114:115], v230 offset:6144
    v_add_f32 v194, v194, v189
    v_mfma_f32_16x16x32_bf16 v[132:135], a[124:127], a[232:235], v[132:135]
    ds_read_b64_tr_b16 a[116:117], v231 offset:4096
    v_add_f32 v194, v194, v190
    v_mfma_f32_16x16x32_bf16 v[140:143], a[120:123], a[228:231], v[140:143]
    ds_read_b64_tr_b16 a[118:119], v231 offset:6144
    v_cvt_pk_bf16_f32 v171, v190, v191
    v_mfma_f32_16x16x32_bf16 v[140:143], a[124:127], a[236:239], v[140:143]
    ds_read_b64_tr_b16 a[120:121], v228 offset:8192
    v_add_f32 v194, v194, v191
    v_mfma_f32_16x16x32_bf16 v[132:135], a[128:131], a[240:243], v[132:135]
    ds_read_b64_tr_b16 a[122:123], v228 offset:10240
    global_load_lds_dwordx4 v234, s[70:71] offset:2048
    v_mfma_f32_16x16x32_bf16 v[132:135], a[132:135], a[248:251], v[132:135]
    ds_read_b64_tr_b16 a[124:125], v229 offset:8192
    v_mfma_f32_16x16x32_bf16 v[140:143], a[128:131], a[244:247], v[140:143]
    ds_read_b64_tr_b16 a[126:127], v229 offset:10240
    v_mfma_f32_16x16x32_bf16 v[140:143], a[132:135], a[252:255], v[140:143]
    ds_read_b64_tr_b16 a[128:129], v230 offset:8192
    v_exp_f32 v184, v152
    s_waitcnt lgkmcnt(13)
    v_mfma_f32_16x16x32_bf16 v[0:3], a[136:139], v[160:163], v[0:3]
    ds_read_b64_tr_b16 a[130:131], v230 offset:10240
    v_mfma_f32_16x16x32_bf16 v[8:11], a[136:139], v[164:167], v[8:11]
    ds_read_b64_tr_b16 a[132:133], v231 offset:8192
    v_exp_f32 v185, v153
    v_mfma_f32_16x16x32_bf16 v[4:7], a[140:143], v[160:163], v[4:7]
    ds_read_b64_tr_b16 a[134:135], v231 offset:10240
    v_mfma_f32_16x16x32_bf16 v[12:15], a[140:143], v[164:167], v[12:15]
    ds_read_b64_tr_b16 a[136:137], v228 offset:12288
    v_exp_f32 v186, v154
    v_mfma_f32_16x16x32_bf16 v[16:19], a[144:147], v[160:163], v[16:19]
    ds_read_b64_tr_b16 a[138:139], v228 offset:14336
    global_load_lds_dwordx4 v235, s[70:71] offset:3072
    v_exp_f32 v187, v155
    v_mfma_f32_16x16x32_bf16 v[24:27], a[144:147], v[164:167], v[24:27]
    ds_read_b64_tr_b16 a[140:141], v229 offset:12288
    v_add_f32 v195, v184, v185
    v_mfma_f32_16x16x32_bf16 v[20:23], a[148:151], v[160:163], v[20:23]
    ds_read_b64_tr_b16 a[142:143], v229 offset:14336
    s_add_u32 m0, s42, 16384
    v_mfma_f32_16x16x32_bf16 v[28:31], a[148:151], v[164:167], v[28:31]
    ds_read_b64_tr_b16 a[144:145], v230 offset:12288
    v_cvt_pk_bf16_f32 v172, v184, v185
    s_waitcnt lgkmcnt(13)
    v_mfma_f32_16x16x32_bf16 v[32:35], a[152:155], v[160:163], v[32:35]
    ds_read_b64_tr_b16 a[146:147], v230 offset:14336
    s_add_u32 s98, s66, s91
    buffer_store_dwordx4 a[72:75], v240, s[32:35], s98 offen offset:0 sc1
    v_mfma_f32_16x16x32_bf16 v[40:43], a[152:155], v[164:167], v[40:43]
    ds_read_b64_tr_b16 a[148:149], v231 offset:12288
    s_add_u32 s72, s69, 114688
    v_add_f32 v195, v195, v186
    v_mfma_f32_16x16x32_bf16 v[36:39], a[156:159], v[160:163], v[36:39]
    ds_read_b64_tr_b16 a[150:151], v231 offset:14336
    v_cvt_pk_bf16_f32 v173, v186, v187
    v_mfma_f32_16x16x32_bf16 v[44:47], a[156:159], v[164:167], v[44:47]
    ds_read_b128 a[152:155], v220 offset:16384
    global_load_lds_dwordx4 v236, s[72:73] offset:0
    v_mfma_f32_16x16x32_bf16 v[48:51], a[112:115], v[160:163], v[48:51]
    ds_read_b128 a[156:159], v221 offset:16384
    v_add_f32 v195, v195, v187
    v_mfma_f32_16x16x32_bf16 v[56:59], a[112:115], v[164:167], v[56:59]
    v_exp_f32 v188, v156
    v_mfma_f32_16x16x32_bf16 v[52:55], a[116:119], v[160:163], v[52:55]
    v_exp_f32 v189, v157
    v_mfma_f32_16x16x32_bf16 v[60:63], a[116:119], v[164:167], v[60:63]
    ds_read_b128 a[112:115], v222 offset:16384
    s_waitcnt lgkmcnt(11)
    v_mfma_f32_16x16x32_bf16 v[64:67], a[120:123], v[160:163], v[64:67]
    ds_read_b128 a[116:119], v223 offset:16384
    v_mfma_f32_16x16x32_bf16 v[72:75], a[120:123], v[164:167], v[72:75]
    v_exp_f32 v190, v158
    v_mfma_f32_16x16x32_bf16 v[68:71], a[124:127], v[160:163], v[68:71]
    v_exp_f32 v191, v159
    v_mfma_f32_16x16x32_bf16 v[76:79], a[124:127], v[164:167], v[76:79]
    ds_read_b128 a[120:123], v220 offset:16640
    global_load_lds_dwordx4 v237, s[72:73] offset:1024
    v_mfma_f32_16x16x32_bf16 v[80:83], a[128:131], v[160:163], v[80:83]
    ds_read_b128 a[124:127], v221 offset:16640
    v_add_f32 v195, v195, v188
    s_add_u32 s98, s66, s91
    buffer_store_dwordx4 a[76:79], v240, s[32:35], s98 offen offset:1024 sc1
    v_mfma_f32_16x16x32_bf16 v[88:91], a[128:131], v[164:167], v[88:91]
    v_cvt_pk_bf16_f32 v174, v188, v189
    v_add_f32 v195, v195, v189
    v_mfma_f32_16x16x32_bf16 v[84:87], a[132:135], v[160:163], v[84:87]
    v_add_f32 v195, v195, v190
    v_cvt_pk_bf16_f32 v175, v190, v191
    v_mfma_f32_16x16x32_bf16 v[92:95], a[132:135], v[164:167], v[92:95]
    ds_read_b128 a[128:131], v222 offset:16640
    s_waitcnt lgkmcnt(7)
    v_mfma_f32_16x16x32_bf16 v[96:99], a[136:139], v[160:163], v[96:99]
    ds_read_b128 a[132:135], v223 offset:16640
    v_add_f32 v195, v195, v191
    v_mfma_f32_16x16x32_bf16 v[104:107], a[136:139], v[164:167], v[104:107]
    v_mfma_f32_16x16x32_bf16 v[100:103], a[140:143], v[160:163], v[100:103]
    v_mfma_f32_16x16x32_bf16 v[108:111], a[140:143], v[164:167], v[108:111]
    ds_read_b128 a[136:139], v220 offset:24576
    global_load_lds_dwordx4 v238, s[72:73] offset:2048
    v_mfma_f32_16x16x32_bf16 v[112:115], a[144:147], v[160:163], v[112:115]
    ds_read_b128 a[140:143], v221 offset:24576
    v_mfma_f32_16x16x32_bf16 v[120:123], a[144:147], v[164:167], v[120:123]
    v_mfma_f32_16x16x32_bf16 v[116:119], a[148:151], v[160:163], v[116:119]
    v_mfma_f32_16x16x32_bf16 v[124:127], a[148:151], v[164:167], v[124:127]
    ds_read_b128 a[144:147], v222 offset:24576
    v_max_f32 v196, v194, v195
    v_cmp_lt_f32 vcc, s101, v196
    s_nop 3
    s_cbranch_vccnz L_slow_3
L_back_3:
    v_add_f32 v192, v192, v194
    v_add_f32 v193, v193, v195
    s_waitcnt lgkmcnt(7)
    v_mfma_f32_16x16x32_bf16 v[144:147], a[152:155], a[192:195], v[176:179]
    ds_read_b128 a[148:151], v223 offset:24576
    v_mfma_f32_16x16x32_bf16 v[144:147], a[156:159], a[200:203], v[144:147]
    v_exp_f32 v184, v128
    v_mfma_f32_16x16x32_bf16 v[152:155], a[152:155], a[196:199], v[180:183]
    v_exp_f32 v185, v129
    v_mfma_f32_16x16x32_bf16 v[152:155], a[156:159], a[204:207], v[152:155]
    ds_read_b128 a[152:155], v220 offset:24832
    global_load_lds_dwordx4 v239, s[72:73] offset:3072
    v_mfma_f32_16x16x32_bf16 v[144:147], a[112:115], a[208:211], v[144:147]
    ds_read_b128 a[156:159], v221 offset:24832
    v_mfma_f32_16x16x32_bf16 v[144:147], a[116:119], a[216:219], v[144:147]
    v_exp_f32 v186, v130
    v_mfma_f32_16x16x32_bf16 v[152:155], a[112:115], a[212:215], v[152:155]
    v_exp_f32 v187, v131
    v_mfma_f32_16x16x32_bf16 v[152:155], a[116:119], a[220:223], v[152:155]
    ds_read_b128 a[112:115], v222 offset:24832
    s_waitcnt lgkmcnt(7)
    v_mfma_f32_16x16x32_bf16 v[144:147], a[120:123], a[224:227], v[144:147]
    ds_read_b128 a[116:119], v223 offset:24832
    v_add_f32 v194, v184, v185
    v_mfma_f32_16x16x32_bf16 v[144:147], a[124:127], a[232:235], v[144:147]
    v_cvt_pk_bf16_f32 v160, v184, v185
    v_add_f32 v194, v194, v186
    v_mfma_f32_16x16x32_bf16 v[152:155], a[120:123], a[228:231], v[152:155]
    v_cvt_pk_bf16_f32 v161, v186, v187
    v_add_f32 v194, v194, v187
    v_mfma_f32_16x16x32_bf16 v[152:155], a[124:127], a[236:239], v[152:155]
    s_waitcnt vmcnt(10)
    s_barrier
    ds_read_b64_tr_b16 a[120:121], v228 offset:32768
    s_add_u32 m0, s42, 32768
    s_add_u32 s70, s68, 81920
    v_mfma_f32_16x16x32_bf16 v[144:147], a[128:131], a[240:243], v[144:147]
    ds_read_b64_tr_b16 a[122:123], v228 offset:34816
    global_load_lds_dwordx4 v232, s[70:71] offset:0
    v_mfma_f32_16x16x32_bf16 v[144:147], a[132:135], a[248:251], v[144:147]
    ds_read_b64_tr_b16 a[124:125], v229 offset:32768
    v_mfma_f32_16x16x32_bf16 v[152:155], a[128:131], a[244:247], v[152:155]
    ds_read_b64_tr_b16 a[126:127], v229 offset:34816
    v_mfma_f32_16x16x32_bf16 v[152:155], a[132:135], a[252:255], v[152:155]
    ds_read_b64_tr_b16 a[128:129], v230 offset:32768
    s_waitcnt lgkmcnt(9)
    v_mfma_f32_16x16x32_bf16 v[148:151], a[136:139], a[192:195], v[176:179]
    ds_read_b64_tr_b16 a[130:131], v230 offset:34816
    v_exp_f32 v188, v132
    v_mfma_f32_16x16x32_bf16 v[148:151], a[140:143], a[200:203], v[148:151]
    ds_read_b64_tr_b16 a[132:133], v231 offset:32768
    v_exp_f32 v189, v133
    v_mfma_f32_16x16x32_bf16 v[156:159], a[136:139], a[196:199], v[180:183]
    ds_read_b64_tr_b16 a[134:135], v231 offset:34816
    v_mfma_f32_16x16x32_bf16 v[156:159], a[140:143], a[204:207], v[156:159]
    ds_read_b64_tr_b16 a[136:137], v228 offset:36864
    v_exp_f32 v190, v134
    v_mfma_f32_16x16x32_bf16 v[148:151], a[144:147], a[208:211], v[148:151]
    ds_read_b64_tr_b16 a[138:139], v228 offset:38912
    global_load_lds_dwordx4 v233, s[70:71] offset:1024
    v_exp_f32 v191, v135
    v_mfma_f32_16x16x32_bf16 v[148:151], a[148:151], a[216:219], v[148:151]
    ds_read_b64_tr_b16 a[140:141], v229 offset:36864
    v_add_f32 v194, v194, v188
    v_mfma_f32_16x16x32_bf16 v[156:159], a[144:147], a[212:215], v[156:159]
    ds_read_b64_tr_b16 a[142:143], v229 offset:38912
    v_cvt_pk_bf16_f32 v162, v188, v189
    v_mfma_f32_16x16x32_bf16 v[156:159], a[148:151], a[220:223], v[156:159]
    ds_read_b64_tr_b16 a[144:145], v230 offset:36864
    s_waitcnt lgkmcnt(13)
    v_mfma_f32_16x16x32_bf16 v[148:151], a[152:155], a[224:227], v[148:151]
    ds_read_b64_tr_b16 a[146:147], v230 offset:38912
    v_add_f32 v194, v194, v189
    v_mfma_f32_16x16x32_bf16 v[148:151], a[156:159], a[232:235], v[148:151]
    ds_read_b64_tr_b16 a[148:149], v231 offset:36864
    v_add_f32 v194, v194, v190
    v_mfma_f32_16x16x32_bf16 v[156:159], a[152:155], a[228:231], v[156:159]
    ds_read_b64_tr_b16 a[150:151], v231 offset:38912
    v_cvt_pk_bf16_f32 v163, v190, v191
    v_mfma_f32_16x16x32_bf16 v[156:159], a[156:159], a[236:239], v[156:159]
    ds_read_b64_tr_b16 a[152:153], v228 offset:40960
    v_add_f32 v194, v194, v191
    v_mfma_f32_16x16x32_bf16 v[148:151], a[112:115], a[240:243], v[148:151]
    ds_read_b64_tr_b16 a[154:155], v228 offset:43008
    global_load_lds_dwordx4 v234, s[70:71] offset:2048
    v_mfma_f32_16x16x32_bf16 v[148:151], a[116:119], a[248:251], v[148:151]
    ds_read_b64_tr_b16 a[156:157], v229 offset:40960
    v_mfma_f32_16x16x32_bf16 v[156:159], a[112:115], a[244:247], v[156:159]
    ds_read_b64_tr_b16 a[158:159], v229 offset:43008
    v_mfma_f32_16x16x32_bf16 v[156:159], a[116:119], a[252:255], v[156:159]
    ds_read_b64_tr_b16 a[112:113], v230 offset:40960
    v_exp_f32 v184, v136
    s_waitcnt lgkmcnt(13)
    v_mfma_f32_16x16x32_bf16 v[0:3], a[120:123], v[168:171], v[0:3]
    ds_read_b64_tr_b16 a[114:115], v230 offset:43008
    v_mfma_f32_16x16x32_bf16 v[8:11], a[120:123], v[172:175], v[8:11]
    ds_read_b64_tr_b16 a[116:117], v231 offset:40960
    v_exp_f32 v185, v137
    v_mfma_f32_16x16x32_bf16 v[4:7], a[124:127], v[168:171], v[4:7]
    ds_read_b64_tr_b16 a[118:119], v231 offset:43008
    v_mfma_f32_16x16x32_bf16 v[12:15], a[124:127], v[172:175], v[12:15]
    ds_read_b64_tr_b16 a[120:121], v228 offset:45056
    v_exp_f32 v186, v138
    v_mfma_f32_16x16x32_bf16 v[16:19], a[128:131], v[168:171], v[16:19]
    ds_read_b64_tr_b16 a[122:123], v228 offset:47104
    global_load_lds_dwordx4 v235, s[70:71] offset:3072
    v_exp_f32 v187, v139
    v_mfma_f32_16x16x32_bf16 v[24:27], a[128:131], v[172:175], v[24:27]
    ds_read_b64_tr_b16 a[124:125], v229 offset:45056
    v_add_f32 v195, v184, v185
    v_mfma_f32_16x16x32_bf16 v[20:23], a[132:135], v[168:171], v[20:23]
    ds_read_b64_tr_b16 a[126:127], v229 offset:47104
    s_add_u32 m0, s42, 49152
    v_mfma_f32_16x16x32_bf16 v[28:31], a[132:135], v[172:175], v[28:31]
    ds_read_b64_tr_b16 a[128:129], v230 offset:45056
    v_cvt_pk_bf16_f32 v164, v184, v185
    s_waitcnt lgkmcnt(13)
    v_mfma_f32_16x16x32_bf16 v[32:35], a[136:139], v[168:171], v[32:35]
    ds_read_b64_tr_b16 a[130:131], v230 offset:47104
    s_add_u32 s98, s66, s91
    buffer_store_dwordx4 a[80:83], v240, s[32:35], s98 offen offset:2048 sc1
    v_mfma_f32_16x16x32_bf16 v[40:43], a[136:139], v[172:175], v[40:43]
    ds_read_b64_tr_b16 a[132:133], v231 offset:45056
    s_add_u32 s72, s69, 131072
    v_add_f32 v195, v195, v186
    v_mfma_f32_16x16x32_bf16 v[36:39], a[140:143], v[168:171], v[36:39]
    ds_read_b64_tr_b16 a[134:135], v231 offset:47104
    v_cvt_pk_bf16_f32 v165, v186, v187
    v_mfma_f32_16x16x32_bf16 v[44:47], a[140:143], v[172:175], v[44:47]
    ds_read_b128 a[136:139], v220 offset:49152
    global_load_lds_dwordx4 v236, s[72:73] offset:0
    v_mfma_f32_16x16x32_bf16 v[48:51], a[144:147], v[168:171], v[48:51]
    ds_read_b128 a[140:143], v221 offset:49152
    v_add_f32 v195, v195, v187
    v_mfma_f32_16x16x32_bf16 v[56:59], a[144:147], v[172:175], v[56:59]
    v_exp_f32 v188, v140
    v_mfma_f32_16x16x32_bf16 v[52:55], a[148:151], v[168:171], v[52:55]
    v_exp_f32 v189, v141
    v_mfma_f32_16x16x32_bf16 v[60:63], a[148:151], v[172:175], v[60:63]
    ds_read_b128 a[144:147], v222 offset:49152
    s_waitcnt lgkmcnt(11)
    v_mfma_f32_16x16x32_bf16 v[64:67], a[152:155], v[168:171], v[64:67]
    ds_read_b128 a[148:151], v223 offset:49152
    v_mfma_f32_16x16x32_bf16 v[72:75], a[152:155], v[172:175], v[72:75]
    v_exp_f32 v190, v142
    v_mfma_f32_16x16x32_bf16 v[68:71], a[156:159], v[168:171], v[68:71]
    v_exp_f32 v191, v143
    v_mfma_f32_16x16x32_bf16 v[76:79], a[156:159], v[172:175], v[76:79]
    ds_read_b128 a[152:155], v220 offset:49408
    global_load_lds_dwordx4 v237, s[72:73] offset:1024
    v_mfma_f32_16x16x32_bf16 v[80:83], a[112:115], v[168:171], v[80:83]
    ds_read_b128 a[156:159], v221 offset:49408
    v_add_f32 v195, v195, v188
    s_add_u32 s98, s66, s91
    buffer_store_dwordx4 a[84:87], v240, s[32:35], s98 offen offset:3072 sc1
    v_mfma_f32_16x16x32_bf16 v[88:91], a[112:115], v[172:175], v[88:91]
    v_cvt_pk_bf16_f32 v166, v188, v189
    v_add_f32 v195, v195, v189
    v_mfma_f32_16x16x32_bf16 v[84:87], a[116:119], v[168:171], v[84:87]
    v_add_f32 v195, v195, v190
    v_cvt_pk_bf16_f32 v167, v190, v191
    v_mfma_f32_16x16x32_bf16 v[92:95], a[116:119], v[172:175], v[92:95]
    ds_read_b128 a[112:115], v222 offset:49408
    s_waitcnt lgkmcnt(7)
    v_mfma_f32_16x16x32_bf16 v[96:99], a[120:123], v[168:171], v[96:99]
    ds_read_b128 a[116:119], v223 offset:49408
    v_add_f32 v195, v195, v191
    v_mfma_f32_16x16x32_bf16 v[104:107], a[120:123], v[172:175], v[104:107]
    v_mfma_f32_16x16x32_bf16 v[100:103], a[124:127], v[168:171], v[100:103]
    v_mfma_f32_16x16x32_bf16 v[108:111], a[124:127], v[172:175], v[108:111]
    ds_read_b128 a[120:123], v220 offset:57344
    global_load_lds_dwordx4 v238, s[72:73] offset:2048
    v_mfma_f32_16x16x32_bf16 v[112:115], a[128:131], v[168:171], v[112:115]
    ds_read_b128 a[124:127], v221 offset:57344
    v_mfma_f32_16x16x32_bf16 v[120:123], a[128:131], v[172:175], v[120:123]
    v_mfma_f32_16x16x32_bf16 v[116:119], a[132:135], v[168:171], v[116:119]
    v_mfma_f32_16x16x32_bf16 v[124:127], a[132:135], v[172:175], v[124:127]
    ds_read_b128 a[128:131], v222 offset:57344
    v_max_f32 v196, v194, v195
    v_cmp_lt_f32 vcc, s101, v196
    s_nop 3
    s_cbranch_vccnz L_slow_4
L_back_4:
    v_add_f32 v192, v192, v194
    v_add_f32 v193, v193, v195
    s_waitcnt lgkmcnt(7)
    v_mfma_f32_16x16x32_bf16 v[128:131], a[136:139], a[192:195], v[176:179]
    ds_read_b128 a[132:135], v223 offset:57344
    v_mfma_f32_16x16x32_bf16 v[128:131], a[140:143], a[200:203], v[128:131]
    v_exp_f32 v184, v144
    v_mfma_f32_16x16x32_bf16 v[136:139], a[136:139], a[196:199], v[180:183]
    v_exp_f32 v185, v145
    v_mfma_f32_16x16x32_bf16 v[136:139], a[140:143], a[204:207], v[136:139]
    ds_read_b128 a[136:139], v220 offset:57600
    global_load_lds_dwordx4 v239, s[72:73] offset:3072
    v_mfma_f32_16x16x32_bf16 v[128:131], a[144:147], a[208:211], v[128:131]
    ds_read_b128 a[140:143], v221 offset:57600
    v_mfma_f32_16x16x32_bf16 v[128:131], a[148:151], a[216:219], v[128:131]
    v_exp_f32 v186, v146
    v_mfma_f32_16x16x32_bf16 v[136:139], a[144:147], a[212:215], v[136:139]
    v_exp_f32 v187, v147
    v_mfma_f32_16x16x32_bf16 v[136:139], a[148:151], a[220:223], v[136:139]
    ds_read_b128 a[144:147], v222 offset:57600
    s_waitcnt lgkmcnt(7)
    v_mfma_f32_16x16x32_bf16 v[128:131], a[152:155], a[224:227], v[128:131]
    ds_read_b128 a[148:151], v223 offset:57600
    v_add_f32 v194, v184, v185
    v_mfma_f32_16x16x32_bf16 v[128:131], a[156:159], a[232:235], v[128:131]
    v_cvt_pk_bf16_f32 v168, v184, v185
    v_add_f32 v194, v194, v186
    v_mfma_f32_16x16x32_bf16 v[136:139], a[152:155], a[228:231], v[136:139]
    v_cvt_pk_bf16_f32 v169, v186, v187
    v_add_f32 v194, v194, v187
    v_mfma_f32_16x16x32_bf16 v[136:139], a[156:159], a[236:239], v[136:139]
    s_waitcnt vmcnt(10)
    s_barrier
    ds_read_b64_tr_b16 a[152:153], v224 offset:0
    s_add_u32 m0, s42, 65536
    s_add_u32 s70, s68, 98304
    v_mfma_f32_16x16x32_bf16 v[128:131], a[112:115], a[240:243], v[128:131]
    ds_read_b64_tr_b16 a[154:155], v224 offset:2048
    global_load_lds_dwordx4 v232, s[70:71] offset:0
    v_mfma_f32_16x16x32_bf16 v[128:131], a[116:119], a[248:251], v[128:131]
    ds_read_b64_tr_b16 a[156:157], v225 offset:0
    v_mfma_f32_16x16x32_bf16 v[136:139], a[112:115], a[244:247], v[136:139]
    ds_read_b64_tr_b16 a[158:159], v225 offset:2048
    v_mfma_f32_16x16x32_bf16 v[136:139], a[116:119], a[252:255], v[136:139]
    ds_read_b64_tr_b16 a[112:113], v226 offset:0
    s_waitcnt lgkmcnt(9)
    v_mfma_f32_16x16x32_bf16 v[132:135], a[120:123], a[192:195], v[176:179]
    ds_read_b64_tr_b16 a[114:115], v226 offset:2048
    v_exp_f32 v188, v148
    v_mfma_f32_16x16x32_bf16 v[132:135], a[124:127], a[200:203], v[132:135]
    ds_read_b64_tr_b16 a[116:117], v227 offset:0
    v_exp_f32 v189, v149
    v_mfma_f32_16x16x32_bf16 v[140:143], a[120:123], a[196:199], v[180:183]
    ds_read_b64_tr_b16 a[118:119], v227 offset:2048
    v_mfma_f32_16x16x32_bf16 v[140:143], a[124:127], a[204:207], v[140:143]
    ds_read_b64_tr_b16 a[120:121], v224 offset:4096
    v_exp_f32 v190, v150
    v_mfma_f32_16x16x32_bf16 v[132:135], a[128:131], a[208:211], v[132:135]
    ds_read_b64_tr_b16 a[122:123], v224 offset:6144
    global_load_lds_dwordx4 v233, s[70:71] offset:1024
    v_exp_f32 v191, v151
    v_mfma_f32_16x16x32_bf16 v[132:135], a[132:135], a[216:219], v[132:135]
    ds_read_b64_tr_b16 a[124:125], v225 offset:4096
    v_add_f32 v194, v194, v188
    v_mfma_f32_16x16x32_bf16 v[140:143], a[128:131], a[212:215], v[140:143]
    ds_read_b64_tr_b16 a[126:127], v225 offset:6144
    v_cvt_pk_bf16_f32 v170, v188, v189
    v_mfma_f32_16x16x32_bf16 v[140:143], a[132:135], a[220:223], v[140:143]
    ds_read_b64_tr_b16 a[128:129], v226 offset:4096
    s_waitcnt lgkmcnt(13)
    v_mfma_f32_16x16x32_bf16 v[132:135], a[136:139], a[224:227], v[132:135]
    ds_read_b64_tr_b16 a[130:131], v226 offset:6144
    v_add_f32 v194, v194, v189
    v_mfma_f32_16x16x32_bf16 v[132:135], a[140:143], a[232:235], v[132:135]
    ds_read_b64_tr_b16 a[132:133], v227 offset:4096
    v_add_f32 v194, v194, v190
    v_mfma_f32_16x16x32_bf16 v[140:143], a[136:139], a[228:231], v[140:143]
    ds_read_b64_tr_b16 a[134:135], v227 offset:6144
    v_cvt_pk_bf16_f32 v171, v190, v191
    v_mfma_f32_16x16x32_bf16 v[140:143], a[140:143], a[236:239], v[140:143]
    ds_read_b64_tr_b16 a[136:137], v224 offset:8192
    v_add_f32 v194, v194, v191
    v_mfma_f32_16x16x32_bf16 v[132:135], a[144:147], a[240:243], v[132:135]
    ds_read_b64_tr_b16 a[138:139], v224 offset:10240
    global_load_lds_dwordx4 v234, s[70:71] offset:2048
    v_mfma_f32_16x16x32_bf16 v[132:135], a[148:151], a[248:251], v[132:135]
    ds_read_b64_tr_b16 a[140:141], v225 offset:8192
    v_mfma_f32_16x16x32_bf16 v[140:143], a[144:147], a[244:247], v[140:143]
    ds_read_b64_tr_b16 a[142:143], v225 offset:10240
    v_mfma_f32_16x16x32_bf16 v[140:143], a[148:151], a[252:255], v[140:143]
    ds_read_b64_tr_b16 a[144:145], v226 offset:8192
    v_exp_f32 v184, v152
    s_waitcnt lgkmcnt(13)
    v_mfma_f32_16x16x32_bf16 v[0:3], a[152:155], v[160:163], v[0:3]
    ds_read_b64_tr_b16 a[146:147], v226 offset:10240
    v_mfma_f32_16x16x32_bf16 v[8:11], a[152:155], v[164:167], v[8:11]
    ds_read_b64_tr_b16 a[148:149], v227 offset:8192
    v_exp_f32 v185, v153
    v_mfma_f32_16x16x32_bf16 v[4:7], a[156:159], v[160:163], v[4:7]
    ds_read_b64_tr_b16 a[150:151], v227 offset:10240
    v_mfma_f32_16x16x32_bf16 v[12:15], a[156:159], v[164:167], v[12:15]
    ds_read_b64_tr_b16 a[152:153], v224 offset:12288
    v_exp_f32 v186, v154
    v_mfma_f32_16x16x32_bf16 v[16:19], a[112:115], v[160:163], v[16:19]
    ds_read_b64_tr_b16 a[154:155], v224 offset:14336
    global_load_lds_dwordx4 v235, s[70:71] offset:3072
    v_exp_f32 v187, v155
    v_mfma_f32_16x16x32_bf16 v[24:27], a[112:115], v[164:167], v[24:27]
    ds_read_b64_tr_b16 a[156:157], v225 offset:12288
    v_add_f32 v195, v184, v185
    v_mfma_f32_16x16x32_bf16 v[20:23], a[116:119], v[160:163], v[20:23]
    ds_read_b64_tr_b16 a[158:159], v225 offset:14336
    s_add_u32 m0, s42, 81920
    v_mfma_f32_16x16x32_bf16 v[28:31], a[116:119], v[164:167], v[28:31]
    ds_read_b64_tr_b16 a[112:113], v226 offset:12288
    v_cvt_pk_bf16_f32 v172, v184, v185
    s_waitcnt lgkmcnt(13)
    v_mfma_f32_16x16x32_bf16 v[32:35], a[120:123], v[160:163], v[32:35]
    ds_read_b64_tr_b16 a[114:115], v226 offset:14336
    s_add_u32 s98, s66, s92
    buffer_store_dwordx4 a[88:91], v240, s[32:35], s98 offen offset:0 sc1
    v_mfma_f32_16x16x32_bf16 v[40:43], a[120:123], v[164:167], v[40:43]
    ds_read_b64_tr_b16 a[116:117], v227 offset:12288
    s_add_u32 s72, s69, 147456
    v_add_f32 v195, v195, v186
    v_mfma_f32_16x16x32_bf16 v[36:39], a[124:127], v[160:163], v[36:39]
    ds_read_b64_tr_b16 a[118:119], v227 offset:14336
    v_cvt_pk_bf16_f32 v173, v186, v187
    v_mfma_f32_16x16x32_bf16 v[44:47], a[124:127], v[164:167], v[44:47]
    ds_read_b128 a[120:123], v216 offset:16384
    global_load_lds_dwordx4 v236, s[72:73] offset:0
    v_mfma_f32_16x16x32_bf16 v[48:51], a[128:131], v[160:163], v[48:51]
    ds_read_b128 a[124:127], v217 offset:16384
    v_add_f32 v195, v195, v187
    v_mfma_f32_16x16x32_bf16 v[56:59], a[128:131], v[164:167], v[56:59]
    v_exp_f32 v188, v156
    v_mfma_f32_16x16x32_bf16 v[52:55], a[132:135], v[160:163], v[52:55]
    v_exp_f32 v189, v157
    v_mfma_f32_16x16x32_bf16 v[60:63], a[132:135], v[164:167], v[60:63]
    ds_read_b128 a[128:131], v218 offset:16384
    s_waitcnt lgkmcnt(11)
    v_mfma_f32_16x16x32_bf16 v[64:67], a[136:139], v[160:163], v[64:67]
    ds_read_b128 a[132:135], v219 offset:16384
    v_mfma_f32_16x16x32_bf16 v[72:75], a[136:139], v[164:167], v[72:75]
    v_exp_f32 v190, v158
    v_mfma_f32_16x16x32_bf16 v[68:71], a[140:143], v[160:163], v[68:71]
    v_exp_f32 v191, v159
    v_mfma_f32_16x16x32_bf16 v[76:79], a[140:143], v[164:167], v[76:79]
    ds_read_b128 a[136:139], v216 offset:16640
    global_load_lds_dwordx4 v237, s[72:73] offset:1024
    v_mfma_f32_16x16x32_bf16 v[80:83], a[144:147], v[160:163], v[80:83]
    ds_read_b128 a[140:143], v217 offset:16640
    v_add_f32 v195, v195, v188
    s_add_u32 s98, s66, s92
    buffer_store_dwordx4 a[92:95], v240, s[32:35], s98 offen offset:1024 sc1
    v_mfma_f32_16x16x32_bf16 v[88:91], a[144:147], v[164:167], v[88:91]
    v_cvt_pk_bf16_f32 v174, v188, v189
    v_add_f32 v195, v195, v189
    v_mfma_f32_16x16x32_bf16 v[84:87], a[148:151], v[160:163], v[84:87]
    v_add_f32 v195, v195, v190
    v_cvt_pk_bf16_f32 v175, v190, v191
    v_mfma_f32_16x16x32_bf16 v[92:95], a[148:151], v[164:167], v[92:95]
    ds_read_b128 a[144:147], v218 offset:16640
    s_waitcnt lgkmcnt(7)
    v_mfma_f32_16x16x32_bf16 v[96:99], a[152:155], v[160:163], v[96:99]
    ds_read_b128 a[148:151], v219 offset:16640
    v_add_f32 v195, v195, v191
    v_mfma_f32_16x16x32_bf16 v[104:107], a[152:155], v[164:167], v[104:107]
    v_mfma_f32_16x16x32_bf16 v[100:103], a[156:159], v[160:163], v[100:103]
    v_mfma_f32_16x16x32_bf16 v[108:111], a[156:159], v[164:167], v[108:111]
    ds_read_b128 a[152:155], v216 offset:24576
    global_load_lds_dwordx4 v238, s[72:73] offset:2048
    v_mfma_f32_16x16x32_bf16 v[112:115], a[112:115], v[160:163], v[112:115]
    ds_read_b128 a[156:159], v217 offset:24576
    v_mfma_f32_16x16x32_bf16 v[120:123], a[112:115], v[164:167], v[120:123]
    v_mfma_f32_16x16x32_bf16 v[116:119], a[116:119], v[160:163], v[116:119]
    v_mfma_f32_16x16x32_bf16 v[124:127], a[116:119], v[164:167], v[124:127]
    ds_read_b128 a[112:115], v218 offset:24576
    v_max_f32 v196, v194, v195
    v_cmp_lt_f32 vcc, s101, v196
    s_nop 3
    s_cbranch_vccnz L_slow_5
L_back_5:
    v_add_f32 v192, v192, v194
    v_add_f32 v193, v193, v195
    s_waitcnt lgkmcnt(7)
    v_mfma_f32_16x16x32_bf16 v[144:147], a[120:123], a[192:195], v[176:179]
    ds_read_b128 a[116:119], v219 offset:24576
    v_mfma_f32_16x16x32_bf16 v[144:147], a[124:127], a[200:203], v[144:147]
    v_exp_f32 v184, v128
    v_mfma_f32_16x16x32_bf16 v[152:155], a[120:123], a[196:199], v[180:183]
    v_exp_f32 v185, v129
    v_mfma_f32_16x16x32_bf16 v[152:155], a[124:127], a[204:207], v[152:155]
    ds_read_b128 a[120:123], v216 offset:24832
    global_load_lds_dwordx4 v239, s[72:73] offset:3072
    v_mfma_f32_16x16x32_bf16 v[144:147], a[128:131], a[208:211], v[144:147]
    ds_read_b128 a[124:127], v217 offset:24832
    v_mfma_f32_16x16x32_bf16 v[144:147], a[132:135], a[216:219], v[144:147]
    v_exp_f32 v186, v130
    v_mfma_f32_16x16x32_bf16 v[152:155], a[128:131], a[212:215], v[152:155]
    v_exp_f32 v187, v131
    v_mfma_f32_16x16x32_bf16 v[152:155], a[132:135], a[220:223], v[152:155]
    ds_read_b128 a[128:131], v218 offset:24832
    s_waitcnt lgkmcnt(7)
    v_mfma_f32_16x16x32_bf16 v[144:147], a[136:139], a[224:227], v[144:147]
    ds_read_b128 a[132:135], v219 offset:24832
    v_add_f32 v194, v184, v185
    v_mfma_f32_16x16x32_bf16 v[144:147], a[140:143], a[232:235], v[144:147]
    v_cvt_pk_bf16_f32 v160, v184, v185
    v_add_f32 v194, v194, v186
    v_mfma_f32_16x16x32_bf16 v[152:155], a[136:139], a[228:231], v[152:155]
    v_cvt_pk_bf16_f32 v161, v186, v187
    v_add_f32 v194, v194, v187
    v_mfma_f32_16x16x32_bf16 v[152:155], a[140:143], a[236:239], v[152:155]
    s_waitcnt vmcnt(10)
    s_barrier
    ds_read_b64_tr_b16 a[136:137], v224 offset:32768
    s_add_u32 m0, s42, 98304
    s_add_u32 s70, s68, 114688
    v_mfma_f32_16x16x32_bf16 v[144:147], a[144:147], a[240:243], v[144:147]
    ds_read_b64_tr_b16 a[138:139], v224 offset:34816
    global_load_lds_dwordx4 v232, s[70:71] offset:0
    v_mfma_f32_16x16x32_bf16 v[144:147], a[148:151], a[248:251], v[144:147]
    ds_read_b64_tr_b16 a[140:141], v225 offset:32768
    v_mfma_f32_16x16x32_bf16 v[152:155], a[144:147], a[244:247], v[152:155]
    ds_read_b64_tr_b16 a[142:143], v225 offset:34816
    v_mfma_f32_16x16x32_bf16 v[152:155], a[148:151], a[252:255], v[152:155]
    ds_read_b64_tr_b16 a[144:145], v226 offset:32768
    s_waitcnt lgkmcnt(9)
    v_mfma_f32_16x16x32_bf16 v[148:151], a[152:155], a[192:195], v[176:179]
    ds_read_b64_tr_b16 a[146:147], v226 offset:34816
    v_exp_f32 v188, v132
    v_mfma_f32_16x16x32_bf16 v[148:151], a[156:159], a[200:203], v[148:151]
    ds_read_b64_tr_b16 a[148:149], v227 offset:32768
    v_exp_f32 v189, v133
    v_mfma_f32_16x16x32_bf16 v[156:159], a[152:155], a[196:199], v[180:183]
    ds_read_b64_tr_b16 a[150:151], v227 offset:34816
    v_mfma_f32_16x16x32_bf16 v[156:159], a[156:159], a[204:207], v[156:159]
    ds_read_b64_tr_b16 a[152:153], v224 offset:36864
    v_exp_f32 v190, v134
    v_mfma_f32_16x16x32_bf16 v[148:151], a[112:115], a[208:211], v[148:151]
    ds_read_b64_tr_b16 a[154:155], v224 offset:38912
    global_load_lds_dwordx4 v233, s[70:71] offset:1024
    v_exp_f32 v191, v135
    v_mfma_f32_16x16x32_bf16 v[148:151], a[116:119], a[216:219], v[148:151]
    ds_read_b64_tr_b16 a[156:157], v225 offset:36864
    v_add_f32 v194, v194, v188
    v_mfma_f32_16x16x32_bf16 v[156:159], a[112:115], a[212:215], v[156:159]
    ds_read_b64_tr_b16 a[158:159], v225 offset:38912
    v_cvt_pk_bf16_f32 v162, v188, v189
    v_mfma_f32_16x16x32_bf16 v[156:159], a[116:119], a[220:223], v[156:159]
    ds_read_b64_tr_b16 a[112:113], v226 offset:36864
    s_waitcnt lgkmcnt(13)
    v_mfma_f32_16x16x32_bf16 v[148:151], a[120:123], a[224:227], v[148:151]
    ds_read_b64_tr_b16 a[114:115], v226 offset:38912
    v_add_f32 v194, v194, v189
    v_mfma_f32_16x16x32_bf16 v[148:151], a[124:127], a[232:235], v[148:151]
    ds_read_b64_tr_b16 a[116:117], v227 offset:36864
    v_add_f32 v194, v194, v190
    v_mfma_f32_16x16x32_bf16 v[156:159], a[120:123], a[228:231], v[156:159]
    ds_read_b64_tr_b16 a[118:119], v227 offset:38912
    v_cvt_pk_bf16_f32 v163, v190, v191
    v_mfma_f32_16x16x32_bf16 v[156:159], a[124:127], a[236:239], v[156:159]
    ds_read_b64_tr_b16 a[120:121], v224 offset:40960
    v_add_f32 v194, v194, v191
    v_mfma_f32_16x16x32_bf16 v[148:151], a[128:131], a[240:243], v[148:151]
    ds_read_b64_tr_b16 a[122:123], v224 offset:43008
    global_load_lds_dwordx4 v234, s[70:71] offset:2048
    v_mfma_f32_16x16x32_bf16 v[148:151], a[132:135], a[248:251], v[148:151]
    ds_read_b64_tr_b16 a[124:125], v225 offset:40960
    v_mfma_f32_16x16x32_bf16 v[156:159], a[128:131], a[244:247], v[156:159]
    ds_read_b64_tr_b16 a[126:127], v225 offset:43008
    v_mfma_f32_16x16x32_bf16 v[156:159], a[132:135], a[252:255], v[156:159]
    ds_read_b64_tr_b16 a[128:129], v226 offset:40960
    v_exp_f32 v184, v136
    s_waitcnt lgkmcnt(13)
    v_mfma_f32_16x16x32_bf16 v[0:3], a[136:139], v[168:171], v[0:3]
    ds_read_b64_tr_b16 a[130:131], v226 offset:43008
    v_mfma_f32_16x16x32_bf16 v[8:11], a[136:139], v[172:175], v[8:11]
    ds_read_b64_tr_b16 a[132:133], v227 offset:40960
    v_exp_f32 v185, v137
    v_mfma_f32_16x16x32_bf16 v[4:7], a[140:143], v[168:171], v[4:7]
    ds_read_b64_tr_b16 a[134:135], v227 offset:43008
    v_mfma_f32_16x16x32_bf16 v[12:15], a[140:143], v[172:175], v[12:15]
    ds_read_b64_tr_b16 a[136:137], v224 offset:45056
    v_exp_f32 v186, v138
    v_mfma_f32_16x16x32_bf16 v[16:19], a[144:147], v[168:171], v[16:19]
    ds_read_b64_tr_b16 a[138:139], v224 offset:47104
    global_load_lds_dwordx4 v235, s[70:71] offset:3072
    v_exp_f32 v187, v139
    v_mfma_f32_16x16x32_bf16 v[24:27], a[144:147], v[172:175], v[24:27]
    ds_read_b64_tr_b16 a[140:141], v225 offset:45056
    v_add_f32 v195, v184, v185
    v_mfma_f32_16x16x32_bf16 v[20:23], a[148:151], v[168:171], v[20:23]
    ds_read_b64_tr_b16 a[142:143], v225 offset:47104
    s_add_u32 m0, s42, 114688
    v_mfma_f32_16x16x32_bf16 v[28:31], a[148:151], v[172:175], v[28:31]
    ds_read_b64_tr_b16 a[144:145], v226 offset:45056
    v_cvt_pk_bf16_f32 v164, v184, v185
    s_waitcnt lgkmcnt(13)
    v_mfma_f32_16x16x32_bf16 v[32:35], a[152:155], v[168:171], v[32:35]
    ds_read_b64_tr_b16 a[146:147], v226 offset:47104
    s_add_u32 s98, s66, s92
    buffer_store_dwordx4 a[96:99], v240, s[32:35], s98 offen offset:2048 sc1
    v_mfma_f32_16x16x32_bf16 v[40:43], a[152:155], v[172:175], v[40:43]
    ds_read_b64_tr_b16 a[148:149], v227 offset:45056
    s_add_u32 s72, s69, 163840
    v_add_f32 v195, v195, v186
    v_mfma_f32_16x16x32_bf16 v[36:39], a[156:159], v[168:171], v[36:39]
    ds_read_b64_tr_b16 a[150:151], v227 offset:47104
    v_cvt_pk_bf16_f32 v165, v186, v187
    v_mfma_f32_16x16x32_bf16 v[44:47], a[156:159], v[172:175], v[44:47]
    ds_read_b128 a[152:155], v216 offset:49152
    global_load_lds_dwordx4 v236, s[72:73] offset:0
    v_mfma_f32_16x16x32_bf16 v[48:51], a[112:115], v[168:171], v[48:51]
    ds_read_b128 a[156:159], v217 offset:49152
    v_add_f32 v195, v195, v187
    v_mfma_f32_16x16x32_bf16 v[56:59], a[112:115], v[172:175], v[56:59]
    v_exp_f32 v188, v140
    v_mfma_f32_16x16x32_bf16 v[52:55], a[116:119], v[168:171], v[52:55]
    v_exp_f32 v189, v141
    v_mfma_f32_16x16x32_bf16 v[60:63], a[116:119], v[172:175], v[60:63]
    ds_read_b128 a[112:115], v218 offset:49152
    s_waitcnt lgkmcnt(11)
    v_mfma_f32_16x16x32_bf16 v[64:67], a[120:123], v[168:171], v[64:67]
    ds_read_b128 a[116:119], v219 offset:49152
    v_mfma_f32_16x16x32_bf16 v[72:75], a[120:123], v[172:175], v[72:75]
    v_exp_f32 v190, v142
    v_mfma_f32_16x16x32_bf16 v[68:71], a[124:127], v[168:171], v[68:71]
    v_exp_f32 v191, v143
    v_mfma_f32_16x16x32_bf16 v[76:79], a[124:127], v[172:175], v[76:79]
    ds_read_b128 a[120:123], v216 offset:49408
    global_load_lds_dwordx4 v237, s[72:73] offset:1024
    v_mfma_f32_16x16x32_bf16 v[80:83], a[128:131], v[168:171], v[80:83]
    ds_read_b128 a[124:127], v217 offset:49408
    v_add_f32 v195, v195, v188
    s_add_u32 s98, s66, s92
    buffer_store_dwordx4 a[100:103], v240, s[32:35], s98 offen offset:3072 sc1
    v_mfma_f32_16x16x32_bf16 v[88:91], a[128:131], v[172:175], v[88:91]
    v_cvt_pk_bf16_f32 v166, v188, v189
    v_add_f32 v195, v195, v189
    v_mfma_f32_16x16x32_bf16 v[84:87], a[132:135], v[168:171], v[84:87]
    v_add_f32 v195, v195, v190
    v_cvt_pk_bf16_f32 v167, v190, v191
    v_mfma_f32_16x16x32_bf16 v[92:95], a[132:135], v[172:175], v[92:95]
    ds_read_b128 a[128:131], v218 offset:49408
    s_waitcnt lgkmcnt(7)
    v_mfma_f32_16x16x32_bf16 v[96:99], a[136:139], v[168:171], v[96:99]
    ds_read_b128 a[132:135], v219 offset:49408
    v_add_f32 v195, v195, v191
    v_mfma_f32_16x16x32_bf16 v[104:107], a[136:139], v[172:175], v[104:107]
    v_mfma_f32_16x16x32_bf16 v[100:103], a[140:143], v[168:171], v[100:103]
    v_mfma_f32_16x16x32_bf16 v[108:111], a[140:143], v[172:175], v[108:111]
    ds_read_b128 a[136:139], v216 offset:57344
    global_load_lds_dwordx4 v238, s[72:73] offset:2048
    v_mfma_f32_16x16x32_bf16 v[112:115], a[144:147], v[168:171], v[112:115]
    ds_read_b128 a[140:143], v217 offset:57344
    v_mfma_f32_16x16x32_bf16 v[120:123], a[144:147], v[172:175], v[120:123]
    v_mfma_f32_16x16x32_bf16 v[116:119], a[148:151], v[168:171], v[116:119]
    v_mfma_f32_16x16x32_bf16 v[124:127], a[148:151], v[172:175], v[124:127]
    ds_read_b128 a[144:147], v218 offset:57344
    v_max_f32 v196, v194, v195
    v_cmp_lt_f32 vcc, s101, v196
    s_nop 3
    s_cbranch_vccnz L_slow_6
L_back_6:
    v_add_f32 v192, v192, v194
    v_add_f32 v193, v193, v195
    s_waitcnt lgkmcnt(7)
    v_mfma_f32_16x16x32_bf16 v[128:131], a[152:155], a[192:195], v[176:179]
    ds_read_b128 a[148:151], v219 offset:57344
    v_mfma_f32_16x16x32_bf16 v[128:131], a[156:159], a[200:203], v[128:131]
    v_exp_f32 v184, v144
    v_mfma_f32_16x16x32_bf16 v[136:139], a[152:155], a[196:199], v[180:183]
    buffer_load_dword v198, v199, s[28:31], s43 offen offset:0
    v_mfma_f32_16x16x32_bf16 v[136:139], a[156:159], a[204:207], v[136:139]
    ds_read_b128 a[152:155], v216 offset:57600
    global_load_lds_dwordx4 v239, s[72:73] offset:3072
    v_exp_f32 v185, v145
    v_mfma_f32_16x16x32_bf16 v[128:131], a[112:115], a[208:211], v[128:131]
    ds_read_b128 a[156:159], v217 offset:57600
    v_mfma_f32_16x16x32_bf16 v[128:131], a[116:119], a[216:219], v[128:131]
    v_exp_f32 v186, v146
    v_mfma_f32_16x16x32_bf16 v[136:139], a[112:115], a[212:215], v[136:139]
    v_exp_f32 v187, v147
    v_mfma_f32_16x16x32_bf16 v[136:139], a[116:119], a[220:223], v[136:139]
    ds_read_b128 a[112:115], v218 offset:57600
    s_waitcnt lgkmcnt(7)
    v_mfma_f32_16x16x32_bf16 v[128:131], a[120:123], a[224:227], v[128:131]
    ds_read_b128 a[116:119], v219 offset:57600
    v_add_f32 v194, v184, v185
    v_mfma_f32_16x16x32_bf16 v[128:131], a[124:127], a[232:235], v[128:131]
    v_cvt_pk_bf16_f32 v168, v184, v185
    v_add_f32 v194, v194, v186
    v_mfma_f32_16x16x32_bf16 v[136:139], a[120:123], a[228:231], v[136:139]
    v_cvt_pk_bf16_f32 v169, v186, v187
    v_add_f32 v194, v194, v187
    v_mfma_f32_16x16x32_bf16 v[136:139], a[124:127], a[236:239], v[136:139]
    s_waitcnt vmcnt(11)
    s_barrier
    ds_read_b64_tr_b16 a[120:121], v228 offset:0
    s_add_u32 m0, s42, 0
    s_add_u32 s70, s68, 131072
    v_mfma_f32_16x16x32_bf16 v[128:131], a[128:131], a[240:243], v[128:131]
    ds_read_b64_tr_b16 a[122:123], v228 offset:2048
    global_load_lds_dwordx4 v232, s[70:71] offset:0
    v_mfma_f32_16x16x32_bf16 v[128:131], a[132:135], a[248:251], v[128:131]
    ds_read_b64_tr_b16 a[124:125], v229 offset:0
    v_mfma_f32_16x16x32_bf16 v[136:139], a[128:131], a[244:247], v[136:139]
    ds_read_b64_tr_b16 a[126:127], v229 offset:2048
    v_mfma_f32_16x16x32_bf16 v[136:139], a[132:135], a[252:255], v[136:139]
    ds_read_b64_tr_b16 a[128:129], v230 offset:0
    s_waitcnt lgkmcnt(9)
    v_mfma_f32_16x16x32_bf16 v[132:135], a[136:139], a[192:195], v[176:179]
    ds_read_b64_tr_b16 a[130:131], v230 offset:2048
    v_exp_f32 v188, v148
    v_mfma_f32_16x16x32_bf16 v[132:135], a[140:143], a[200:203], v[132:135]
    ds_read_b64_tr_b16 a[132:133], v231 offset:0
    v_exp_f32 v189, v149
    v_mfma_f32_16x16x32_bf16 v[140:143], a[136:139], a[196:199], v[180:183]
    ds_read_b64_tr_b16 a[134:135], v231 offset:2048
    v_mfma_f32_16x16x32_bf16 v[140:143], a[140:143], a[204:207], v[140:143]
    ds_read_b64_tr_b16 a[136:137], v228 offset:4096
    v_exp_f32 v190, v150
    v_mfma_f32_16x16x32_bf16 v[132:135], a[144:147], a[208:211], v[132:135]
    ds_read_b64_tr_b16 a[138:139], v228 offset:6144
    global_load_lds_dwordx4 v233, s[70:71] offset:1024
    v_exp_f32 v191, v151
    v_mfma_f32_16x16x32_bf16 v[132:135], a[148:151], a[216:219], v[132:135]
    ds_read_b64_tr_b16 a[140:141], v229 offset:4096
    v_add_f32 v194, v194, v188
    v_mfma_f32_16x16x32_bf16 v[140:143], a[144:147], a[212:215], v[140:143]
    ds_read_b64_tr_b16 a[142:143], v229 offset:6144
    v_cvt_pk_bf16_f32 v170, v188, v189
    v_mfma_f32_16x16x32_bf16 v[140:143], a[148:151], a[220:223], v[140:143]
    ds_read_b64_tr_b16 a[144:145], v230 offset:4096
    s_waitcnt lgkmcnt(13)
    v_mfma_f32_16x16x32_bf16 v[132:135], a[152:155], a[224:227], v[132:135]
    ds_read_b64_tr_b16 a[146:147], v230 offset:6144
    v_add_f32 v194, v194, v189
    v_mfma_f32_16x16x32_bf16 v[132:135], a[156:159], a[232:235], v[132:135]
    ds_read_b64_tr_b16 a[148:149], v231 offset:4096
    v_add_f32 v194, v194, v190
    v_mfma_f32_16x16x32_bf16 v[140:143], a[152:155], a[228:231], v[140:143]
    ds_read_b64_tr_b16 a[150:151], v231 offset:6144
    v_cvt_pk_bf16_f32 v171, v190, v191
    v_mfma_f32_16x16x32_bf16 v[140:143], a[156:159], a[236:239], v[140:143]
    ds_read_b64_tr_b16 a[152:153], v228 offset:8192
    v_add_f32 v194, v194, v191
    v_mfma_f32_16x16x32_bf16 v[132:135], a[112:115], a[240:243], v[132:135]
    ds_read_b64_tr_b16 a[154:155], v228 offset:10240
    global_load_lds_dwordx4 v234, s[70:71] offset:2048
    v_mfma_f32_16x16x32_bf16 v[132:135], a[116:119], a[248:251], v[132:135]
    ds_read_b64_tr_b16 a[156:157], v229 offset:8192
    v_mfma_f32_16x16x32_bf16 v[140:143], a[112:115], a[244:247], v[140:143]
    ds_read_b64_tr_b16 a[158:159], v229 offset:10240
    v_mfma_f32_16x16x32_bf16 v[140:143], a[116:119], a[252:255], v[140:143]
    ds_read_b64_tr_b16 a[112:113], v230 offset:8192
    v_exp_f32 v184, v152
    s_waitcnt lgkmcnt(13)
    v_mfma_f32_16x16x32_bf16 v[0:3], a[120:123], v[160:163], v[0:3]
    ds_read_b64_tr_b16 a[114:115], v230 offset:10240
    v_mfma_f32_16x16x32_bf16 v[8:11], a[120:123], v[164:167], v[8:11]
    ds_read_b64_tr_b16 a[116:117], v231 offset:8192
    v_exp_f32 v185, v153
    v_mfma_f32_16x16x32_bf16 v[4:7], a[124:127], v[160:163], v[4:7]
    ds_read_b64_tr_b16 a[118:119], v231 offset:10240
    v_mfma_f32_16x16x32_bf16 v[12:15], a[124:127], v[164:167], v[12:15]
    ds_read_b64_tr_b16 a[120:121], v228 offset:12288
    v_exp_f32 v186, v154
    v_mfma_f32_16x16x32_bf16 v[16:19], a[128:131], v[160:163], v[16:19]
    ds_read_b64_tr_b16 a[122:123], v228 offset:14336
    global_load_lds_dwordx4 v235, s[70:71] offset:3072
    v_exp_f32 v187, v155
    v_mfma_f32_16x16x32_bf16 v[24:27], a[128:131], v[164:167], v[24:27]
    ds_read_b64_tr_b16 a[124:125], v229 offset:12288
    v_add_f32 v195, v184, v185
    v_mfma_f32_16x16x32_bf16 v[20:23], a[132:135], v[160:163], v[20:23]
    ds_read_b64_tr_b16 a[126:127], v229 offset:14336
    s_add_u32 m0, s42, 16384
    v_mfma_f32_16x16x32_bf16 v[28:31], a[132:135], v[164:167], v[28:31]
    ds_read_b64_tr_b16 a[128:129], v230 offset:12288
    v_cvt_pk_bf16_f32 v172, v184, v185
    s_waitcnt lgkmcnt(13)
    v_mfma_f32_16x16x32_bf16 v[32:35], a[136:139], v[160:163], v[32:35]
    ds_read_b64_tr_b16 a[130:131], v230 offset:14336
    s_add_u32 s98, s66, s93
    buffer_store_dwordx4 a[104:107], v240, s[32:35], s98 offen offset:0 sc1
    v_mfma_f32_16x16x32_bf16 v[40:43], a[136:139], v[164:167], v[40:43]
    ds_read_b64_tr_b16 a[132:133], v231 offset:12288
    s_add_u32 s72, s69, 180224
    v_add_f32 v195, v195, v186
    v_mfma_f32_16x16x32_bf16 v[36:39], a[140:143], v[160:163], v[36:39]
    ds_read_b64_tr_b16 a[134:135], v231 offset:14336
    v_cvt_pk_bf16_f32 v173, v186, v187
    v_mfma_f32_16x16x32_bf16 v[44:47], a[140:143], v[164:167], v[44:47]
    ds_read_b128 a[136:139], v220 offset:16384
    global_load_lds_dwordx4 v236, s[72:73] offset:0
    v_mfma_f32_16x16x32_bf16 v[48:51], a[144:147], v[160:163], v[48:51]
    ds_read_b128 a[140:143], v221 offset:16384
    v_add_f32 v195, v195, v187
    v_mfma_f32_16x16x32_bf16 v[56:59], a[144:147], v[164:167], v[56:59]
    v_exp_f32 v188, v156
    v_mfma_f32_16x16x32_bf16 v[52:55], a[148:151], v[160:163], v[52:55]
    v_exp_f32 v189, v157
    v_mfma_f32_16x16x32_bf16 v[60:63], a[148:151], v[164:167], v[60:63]
    ds_read_b128 a[144:147], v222 offset:16384
    s_waitcnt lgkmcnt(11)
    v_mfma_f32_16x16x32_bf16 v[64:67], a[152:155], v[160:163], v[64:67]
    ds_read_b128 a[148:151], v223 offset:16384
    v_mfma_f32_16x16x32_bf16 v[72:75], a[152:155], v[164:167], v[72:75]
    v_exp_f32 v190, v158
    v_mfma_f32_16x16x32_bf16 v[68:71], a[156:159], v[160:163], v[68:71]
    v_exp_f32 v191, v159
    v_mfma_f32_16x16x32_bf16 v[76:79], a[156:159], v[164:167], v[76:79]
    ds_read_b128 a[152:155], v220 offset:16640
    global_load_lds_dwordx4 v237, s[72:73] offset:1024
    v_mfma_f32_16x16x32_bf16 v[80:83], a[112:115], v[160:163], v[80:83]
    ds_read_b128 a[156:159], v221 offset:16640
    v_add_f32 v195, v195, v188
    s_add_u32 s98, s66, s93
    buffer_store_dwordx4 a[108:111], v240, s[32:35], s98 offen offset:1024 sc1
    v_mfma_f32_16x16x32_bf16 v[88:91], a[112:115], v[164:167], v[88:91]
    v_cvt_pk_bf16_f32 v174, v188, v189
    v_add_f32 v195, v195, v189
    v_mfma_f32_16x16x32_bf16 v[84:87], a[116:119], v[160:163], v[84:87]
    v_add_f32 v195, v195, v190
    v_cvt_pk_bf16_f32 v175, v190, v191
    v_mfma_f32_16x16x32_bf16 v[92:95], a[116:119], v[164:167], v[92:95]
    ds_read_b128 a[112:115], v222 offset:16640
    s_waitcnt lgkmcnt(7)
    v_mfma_f32_16x16x32_bf16 v[96:99], a[120:123], v[160:163], v[96:99]
    ds_read_b128 a[116:119], v223 offset:16640
    v_add_f32 v195, v195, v191
    v_mfma_f32_16x16x32_bf16 v[104:107], a[120:123], v[164:167], v[104:107]
    v_mfma_f32_16x16x32_bf16 v[100:103], a[124:127], v[160:163], v[100:103]
    v_mfma_f32_16x16x32_bf16 v[108:111], a[124:127], v[164:167], v[108:111]
    ds_read_b128 a[120:123], v220 offset:24576
    global_load_lds_dwordx4 v238, s[72:73] offset:2048
    v_mfma_f32_16x16x32_bf16 v[112:115], a[128:131], v[160:163], v[112:115]
    ds_read_b128 a[124:127], v221 offset:24576
    v_mfma_f32_16x16x32_bf16 v[120:123], a[128:131], v[164:167], v[120:123]
    v_mfma_f32_16x16x32_bf16 v[116:119], a[132:135], v[160:163], v[116:119]
    v_mfma_f32_16x16x32_bf16 v[124:127], a[132:135], v[164:167], v[124:127]
    ds_read_b128 a[128:131], v222 offset:24576
    v_max_f32 v196, v194, v195
    v_cmp_lt_f32 vcc, s101, v196
    s_nop 3
    s_cbranch_vccnz L_slow_7
L_back_7:
    v_add_f32 v192, v192, v194
    v_add_f32 v193, v193, v195
    s_waitcnt lgkmcnt(7)
    v_mfma_f32_16x16x32_bf16 v[144:147], a[136:139], a[192:195], v[176:179]
    ds_read_b128 a[132:135], v223 offset:24576
    v_mfma_f32_16x16x32_bf16 v[144:147], a[140:143], a[200:203], v[144:147]
    v_exp_f32 v184, v128
    v_mfma_f32_16x16x32_bf16 v[152:155], a[136:139], a[196:199], v[180:183]
    v_exp_f32 v185, v129
    v_mfma_f32_16x16x32_bf16 v[152:155], a[140:143], a[204:207], v[152:155]
    ds_read_b128 a[136:139], v220 offset:24832
    global_load_lds_dwordx4 v239, s[72:73] offset:3072
    v_mfma_f32_16x16x32_bf16 v[144:147], a[144:147], a[208:211], v[144:147]
    ds_read_b128 a[140:143], v221 offset:24832
    v_mfma_f32_16x16x32_bf16 v[144:147], a[148:151], a[216:219], v[144:147]
    v_exp_f32 v186, v130
    v_mfma_f32_16x16x32_bf16 v[152:155], a[144:147], a[212:215], v[152:155]
    v_exp_f32 v187, v131
    v_mfma_f32_16x16x32_bf16 v[152:155], a[148:151], a[220:223], v[152:155]
    ds_read_b128 a[144:147], v222 offset:24832
    s_waitcnt lgkmcnt(7)
    v_mfma_f32_16x16x32_bf16 v[144:147], a[152:155], a[224:227], v[144:147]
    ds_read_b128 a[148:151], v223 offset:24832
    v_add_f32 v194, v184, v185
    v_mfma_f32_16x16x32_bf16 v[144:147], a[156:159], a[232:235], v[144:147]
    v_cvt_pk_bf16_f32 v160, v184, v185
    v_add_f32 v194, v194, v186
    v_mfma_f32_16x16x32_bf16 v[152:155], a[152:155], a[228:231], v[152:155]
    v_cvt_pk_bf16_f32 v161, v186, v187
    v_add_f32 v194, v194, v187
    v_mfma_f32_16x16x32_bf16 v[152:155], a[156:159], a[236:239], v[152:155]
    s_waitcnt vmcnt(10)
    s_barrier
    ds_read_b64_tr_b16 a[152:153], v228 offset:32768
    s_add_u32 m0, s42, 32768
    s_add_u32 s70, s68, 147456
    v_mfma_f32_16x16x32_bf16 v[144:147], a[112:115], a[240:243], v[144:147]
    ds_read_b64_tr_b16 a[154:155], v228 offset:34816
    global_load_lds_dwordx4 v232, s[70:71] offset:0
    v_mfma_f32_16x16x32_bf16 v[144:147], a[116:119], a[248:251], v[144:147]
    ds_read_b64_tr_b16 a[156:157], v229 offset:32768
    v_mfma_f32_16x16x32_bf16 v[152:155], a[112:115], a[244:247], v[152:155]
    ds_read_b64_tr_b16 a[158:159], v229 offset:34816
    v_mfma_f32_16x16x32_bf16 v[152:155], a[116:119], a[252:255], v[152:155]
    ds_read_b64_tr_b16 a[112:113], v230 offset:32768
    s_waitcnt lgkmcnt(9)
    v_mfma_f32_16x16x32_bf16 v[148:151], a[120:123], a[192:195], v[176:179]
    ds_read_b64_tr_b16 a[114:115], v230 offset:34816
    v_exp_f32 v188, v132
    v_mfma_f32_16x16x32_bf16 v[148:151], a[124:127], a[200:203], v[148:151]
    ds_read_b64_tr_b16 a[116:117], v231 offset:32768
    v_exp_f32 v189, v133
    v_mfma_f32_16x16x32_bf16 v[156:159], a[120:123], a[196:199], v[180:183]
    ds_read_b64_tr_b16 a[118:119], v231 offset:34816
    v_mfma_f32_16x16x32_bf16 v[156:159], a[124:127], a[204:207], v[156:159]
    ds_read_b64_tr_b16 a[120:121], v228 offset:36864
    v_exp_f32 v190, v134
    v_mfma_f32_16x16x32_bf16 v[148:151], a[128:131], a[208:211], v[148:151]
    ds_read_b64_tr_b16 a[122:123], v228 offset:38912
    global_load_lds_dwordx4 v233, s[70:71] offset:1024
    v_exp_f32 v191, v135
    v_mfma_f32_16x16x32_bf16 v[148:151], a[132:135], a[216:219], v[148:151]
    ds_read_b64_tr_b16 a[124:125], v229 offset:36864
    v_add_f32 v194, v194, v188
    v_mfma_f32_16x16x32_bf16 v[156:159], a[128:131], a[212:215], v[156:159]
    ds_read_b64_tr_b16 a[126:127], v229 offset:38912
    v_cvt_pk_bf16_f32 v162, v188, v189
    v_mfma_f32_16x16x32_bf16 v[156:159], a[132:135], a[220:223], v[156:159]
    ds_read_b64_tr_b16 a[128:129], v230 offset:36864
    s_waitcnt lgkmcnt(13)
    v_mfma_f32_16x16x32_bf16 v[148:151], a[136:139], a[224:227], v[148:151]
    ds_read_b64_tr_b16 a[130:131], v230 offset:38912
    v_add_f32 v194, v194, v189
    v_mfma_f32_16x16x32_bf16 v[148:151], a[140:143], a[232:235], v[148:151]
    ds_read_b64_tr_b16 a[132:133], v231 offset:36864
    v_add_f32 v194, v194, v190
    v_mfma_f32_16x16x32_bf16 v[156:159], a[136:139], a[228:231], v[156:159]
    ds_read_b64_tr_b16 a[134:135], v231 offset:38912
    v_cvt_pk_bf16_f32 v163, v190, v191
    v_mfma_f32_16x16x32_bf16 v[156:159], a[140:143], a[236:239], v[156:159]
    ds_read_b64_tr_b16 a[136:137], v228 offset:40960
    v_add_f32 v194, v194, v191
    v_mfma_f32_16x16x32_bf16 v[148:151], a[144:147], a[240:243], v[148:151]
    ds_read_b64_tr_b16 a[138:139], v228 offset:43008
    global_load_lds_dwordx4 v234, s[70:71] offset:2048
    v_mfma_f32_16x16x32_bf16 v[148:151], a[148:151], a[248:251], v[148:151]
    ds_read_b64_tr_b16 a[140:141], v229 offset:40960
    v_mfma_f32_16x16x32_bf16 v[156:159], a[144:147], a[244:247], v[156:159]
    ds_read_b64_tr_b16 a[142:143], v229 offset:43008
    v_mfma_f32_16x16x32_bf16 v[156:159], a[148:151], a[252:255], v[156:159]
    ds_read_b64_tr_b16 a[144:145], v230 offset:40960
    v_exp_f32 v184, v136
    s_waitcnt lgkmcnt(13)
    v_mfma_f32_16x16x32_bf16 v[0:3], a[152:155], v[168:171], v[0:3]
    ds_read_b64_tr_b16 a[146:147], v230 offset:43008
    v_mfma_f32_16x16x32_bf16 v[8:11], a[152:155], v[172:175], v[8:11]
    ds_read_b64_tr_b16 a[148:149], v231 offset:40960
    v_exp_f32 v185, v137
    v_mfma_f32_16x16x32_bf16 v[4:7], a[156:159], v[168:171], v[4:7]
    ds_read_b64_tr_b16 a[150:151], v231 offset:43008
    v_mfma_f32_16x16x32_bf16 v[12:15], a[156:159], v[172:175], v[12:15]
    ds_read_b64_tr_b16 a[152:153], v228 offset:45056
    v_exp_f32 v186, v138
    v_mfma_f32_16x16x32_bf16 v[16:19], a[112:115], v[168:171], v[16:19]
    ds_read_b64_tr_b16 a[154:155], v228 offset:47104
    global_load_lds_dwordx4 v235, s[70:71] offset:3072
    v_exp_f32 v187, v139
    v_mfma_f32_16x16x32_bf16 v[24:27], a[112:115], v[172:175], v[24:27]
    ds_read_b64_tr_b16 a[156:157], v229 offset:45056
    v_add_f32 v195, v184, v185
    v_mfma_f32_16x16x32_bf16 v[20:23], a[116:119], v[168:171], v[20:23]
    ds_read_b64_tr_b16 a[158:159], v229 offset:47104
    s_add_u32 m0, s42, 49152
    v_mfma_f32_16x16x32_bf16 v[28:31], a[116:119], v[172:175], v[28:31]
    ds_read_b64_tr_b16 a[112:113], v230 offset:45056
    v_cvt_pk_bf16_f32 v164, v184, v185
    s_waitcnt lgkmcnt(13)
    v_mfma_f32_16x16x32_bf16 v[32:35], a[120:123], v[168:171], v[32:35]
    ds_read_b64_tr_b16 a[114:115], v230 offset:47104
    v_add_f32 v195, v195, v186
    v_mfma_f32_16x16x32_bf16 v[40:43], a[120:123], v[172:175], v[40:43]
    ds_read_b64_tr_b16 a[116:117], v231 offset:45056
    s_add_u32 s72, s69, 196608
    v_mfma_f32_16x16x32_bf16 v[36:39], a[124:127], v[168:171], v[36:39]
    ds_read_b64_tr_b16 a[118:119], v231 offset:47104
    v_cvt_pk_bf16_f32 v165, v186, v187
    v_mfma_f32_16x16x32_bf16 v[44:47], a[124:127], v[172:175], v[44:47]
    ds_read_b128 a[120:123], v220 offset:49152
    global_load_lds_dwordx4 v236, s[72:73] offset:0
    v_mfma_f32_16x16x32_bf16 v[48:51], a[128:131], v[168:171], v[48:51]
    ds_read_b128 a[124:127], v221 offset:49152
    v_add_f32 v195, v195, v187
    v_mfma_f32_16x16x32_bf16 v[56:59], a[128:131], v[172:175], v[56:59]
    v_exp_f32 v188, v140
    v_mfma_f32_16x16x32_bf16 v[52:55], a[132:135], v[168:171], v[52:55]
    v_exp_f32 v189, v141
    v_mfma_f32_16x16x32_bf16 v[60:63], a[132:135], v[172:175], v[60:63]
    ds_read_b128 a[128:131], v222 offset:49152
    s_waitcnt lgkmcnt(11)
    v_mfma_f32_16x16x32_bf16 v[64:67], a[136:139], v[168:171], v[64:67]
    ds_read_b128 a[132:135], v223 offset:49152
    v_mfma_f32_16x16x32_bf16 v[72:75], a[136:139], v[172:175], v[72:75]
    v_exp_f32 v190, v142
    v_mfma_f32_16x16x32_bf16 v[68:71], a[140:143], v[168:171], v[68:71]
    v_exp_f32 v191, v143
    v_mfma_f32_16x16x32_bf16 v[76:79], a[140:143], v[172:175], v[76:79]
    ds_read_b128 a[136:139], v220 offset:49408
    global_load_lds_dwordx4 v237, s[72:73] offset:1024
    v_mfma_f32_16x16x32_bf16 v[80:83], a[144:147], v[168:171], v[80:83]
    ds_read_b128 a[140:143], v221 offset:49408
    v_add_f32 v195, v195, v188
    v_mfma_f32_16x16x32_bf16 v[88:91], a[144:147], v[172:175], v[88:91]
    v_cvt_pk_bf16_f32 v166, v188, v189
    v_add_f32 v195, v195, v189
    v_mfma_f32_16x16x32_bf16 v[84:87], a[148:151], v[168:171], v[84:87]
    v_add_f32 v195, v195, v190
    v_cvt_pk_bf16_f32 v167, v190, v191
    v_mfma_f32_16x16x32_bf16 v[92:95], a[148:151], v[172:175], v[92:95]
    ds_read_b128 a[144:147], v222 offset:49408
    s_waitcnt lgkmcnt(7)
    v_mfma_f32_16x16x32_bf16 v[96:99], a[152:155], v[168:171], v[96:99]
    ds_read_b128 a[148:151], v223 offset:49408
    v_add_f32 v195, v195, v191
    v_mfma_f32_16x16x32_bf16 v[104:107], a[152:155], v[172:175], v[104:107]
    v_mfma_f32_16x16x32_bf16 v[100:103], a[156:159], v[168:171], v[100:103]
    v_mfma_f32_16x16x32_bf16 v[108:111], a[156:159], v[172:175], v[108:111]
    ds_read_b128 a[152:155], v220 offset:57344
    global_load_lds_dwordx4 v238, s[72:73] offset:2048
    v_mfma_f32_16x16x32_bf16 v[112:115], a[112:115], v[168:171], v[112:115]
    ds_read_b128 a[156:159], v221 offset:57344
    v_mfma_f32_16x16x32_bf16 v[120:123], a[112:115], v[172:175], v[120:123]
    v_mfma_f32_16x16x32_bf16 v[116:119], a[116:119], v[168:171], v[116:119]
    v_mfma_f32_16x16x32_bf16 v[124:127], a[116:119], v[172:175], v[124:127]
    ds_read_b128 a[112:115], v222 offset:57344
    v_max_f32 v196, v194, v195
    v_cmp_lt_f32 vcc, s101, v196
    s_nop 3
    s_cbranch_vccnz L_slow_8
L_back_8:
    v_add_f32 v192, v192, v194
    v_add_f32 v193, v193, v195
    s_waitcnt lgkmcnt(7)
    v_mfma_f32_16x16x32_bf16 v[128:131], a[120:123], a[192:195], v[176:179]
    ds_read_b128 a[116:119], v223 offset:57344
    v_mfma_f32_16x16x32_bf16 v[128:131], a[124:127], a[200:203], v[128:131]
    v_exp_f32 v184, v144
    v_mfma_f32_16x16x32_bf16 v[136:139], a[120:123], a[196:199], v[180:183]
    v_exp_f32 v185, v145
    v_mfma_f32_16x16x32_bf16 v[136:139], a[124:127], a[204:207], v[136:139]
    ds_read_b128 a[120:123], v220 offset:57600
    global_load_lds_dwordx4 v239, s[72:73] offset:3072
    v_mfma_f32_16x16x32_bf16 v[128:131], a[128:131], a[208:211], v[128:131]
    ds_read_b128 a[124:127], v221 offset:57600
    v_mfma_f32_16x16x32_bf16 v[128:131], a[132:135], a[216:219], v[128:131]
    v_exp_f32 v186, v146
    v_mfma_f32_16x16x32_bf16 v[136:139], a[128:131], a[212:215], v[136:139]
    v_exp_f32 v187, v147
    v_mfma_f32_16x16x32_bf16 v[136:139], a[132:135], a[220:223], v[136:139]
    ds_read_b128 a[128:131], v222 offset:57600
    s_waitcnt lgkmcnt(7)
    v_mfma_f32_16x16x32_bf16 v[128:131], a[136:139], a[224:227], v[128:131]
    ds_read_b128 a[132:135], v223 offset:57600
    v_add_f32 v194, v184, v185
    v_mfma_f32_16x16x32_bf16 v[128:131], a[140:143], a[232:235], v[128:131]
    v_cvt_pk_bf16_f32 v168, v184, v185
    v_add_f32 v194, v194, v186
    v_mfma_f32_16x16x32_bf16 v[136:139], a[136:139], a[228:231], v[136:139]
    v_cvt_pk_bf16_f32 v169, v186, v187
    v_add_f32 v194, v194, v187
    v_mfma_f32_16x16x32_bf16 v[136:139], a[140:143], a[236:239], v[136:139]
    s_waitcnt vmcnt(8)
    s_barrier
    ds_read_b64_tr_b16 a[136:137], v224 offset:0
    s_add_u32 m0, s42, 65536
    s_add_u32 s70, s68, 163840
    v_mfma_f32_16x16x32_bf16 v[128:131], a[144:147], a[240:243], v[128:131]
    ds_read_b64_tr_b16 a[138:139], v224 offset:2048
    global_load_lds_dwordx4 v232, s[70:71] offset:0
    v_mfma_f32_16x16x32_bf16 v[128:131], a[148:151], a[248:251], v[128:131]
    ds_read_b64_tr_b16 a[140:141], v225 offset:0
    v_mfma_f32_16x16x32_bf16 v[136:139], a[144:147], a[244:247], v[136:139]
    ds_read_b64_tr_b16 a[142:143], v225 offset:2048
    v_mfma_f32_16x16x32_bf16 v[136:139], a[148:151], a[252:255], v[136:139]
    ds_read_b64_tr_b16 a[144:145], v226 offset:0
    s_waitcnt lgkmcnt(9)
    v_mfma_f32_16x16x32_bf16 v[132:135], a[152:155], a[192:195], v[176:179]
    ds_read_b64_tr_b16 a[146:147], v226 offset:2048
    v_exp_f32 v188, v148
    v_mfma_f32_16x16x32_bf16 v[132:135], a[156:159], a[200:203], v[132:135]
    ds_read_b64_tr_b16 a[148:149], v227 offset:0
    v_exp_f32 v189, v149
    v_mfma_f32_16x16x32_bf16 v[140:143], a[152:155], a[196:199], v[180:183]
    ds_read_b64_tr_b16 a[150:151], v227 offset:2048
    v_mfma_f32_16x16x32_bf16 v[140:143], a[156:159], a[204:207], v[140:143]
    ds_read_b64_tr_b16 a[152:153], v224 offset:4096
    v_exp_f32 v190, v150
    v_mfma_f32_16x16x32_bf16 v[132:135], a[112:115], a[208:211], v[132:135]
    ds_read_b64_tr_b16 a[154:155], v224 offset:6144
    global_load_lds_dwordx4 v233, s[70:71] offset:1024
    v_exp_f32 v191, v151
    v_mfma_f32_16x16x32_bf16 v[132:135], a[116:119], a[216:219], v[132:135]
    ds_read_b64_tr_b16 a[156:157], v225 offset:4096
    v_add_f32 v194, v194, v188
    v_mfma_f32_16x16x32_bf16 v[140:143], a[112:115], a[212:215], v[140:143]
    ds_read_b64_tr_b16 a[158:159], v225 offset:6144
    v_cvt_pk_bf16_f32 v170, v188, v189
    v_mfma_f32_16x16x32_bf16 v[140:143], a[116:119], a[220:223], v[140:143]
    ds_read_b64_tr_b16 a[112:113], v226 offset:4096
    s_waitcnt lgkmcnt(13)
    v_mfma_f32_16x16x32_bf16 v[132:135], a[120:123], a[224:227], v[132:135]
    ds_read_b64_tr_b16 a[114:115], v226 offset:6144
    v_add_f32 v194, v194, v189
    v_mfma_f32_16x16x32_bf16 v[132:135], a[124:127], a[232:235], v[132:135]
    ds_read_b64_tr_b16 a[116:117], v227 offset:4096
    v_add_f32 v194, v194, v190
    v_mfma_f32_16x16x32_bf16 v[140:143], a[120:123], a[228:231], v[140:143]
    ds_read_b64_tr_b16 a[118:119], v227 offset:6144
    v_cvt_pk_bf16_f32 v171, v190, v191
    v_mfma_f32_16x16x32_bf16 v[140:143], a[124:127], a[236:239], v[140:143]
    ds_read_b64_tr_b16 a[120:121], v224 offset:8192
    v_add_f32 v194, v194, v191
    v_mfma_f32_16x16x32_bf16 v[132:135], a[128:131], a[240:243], v[132:135]
    ds_read_b64_tr_b16 a[122:123], v224 offset:10240
    global_load_lds_dwordx4 v234, s[70:71] offset:2048
    v_mfma_f32_16x16x32_bf16 v[132:135], a[132:135], a[248:251], v[132:135]
    ds_read_b64_tr_b16 a[124:125], v225 offset:8192
    v_mfma_f32_16x16x32_bf16 v[140:143], a[128:131], a[244:247], v[140:143]
    ds_read_b64_tr_b16 a[126:127], v225 offset:10240
    v_mfma_f32_16x16x32_bf16 v[140:143], a[132:135], a[252:255], v[140:143]
    ds_read_b64_tr_b16 a[128:129], v226 offset:8192
    v_exp_f32 v184, v152
    s_waitcnt lgkmcnt(13)
    v_mfma_f32_16x16x32_bf16 v[0:3], a[136:139], v[160:163], v[0:3]
    ds_read_b64_tr_b16 a[130:131], v226 offset:10240
    v_mfma_f32_16x16x32_bf16 v[8:11], a[136:139], v[164:167], v[8:11]
    ds_read_b64_tr_b16 a[132:133], v227 offset:8192
    v_exp_f32 v185, v153
    v_mfma_f32_16x16x32_bf16 v[4:7], a[140:143], v[160:163], v[4:7]
    ds_read_b64_tr_b16 a[134:135], v227 offset:10240
    v_mfma_f32_16x16x32_bf16 v[12:15], a[140:143], v[164:167], v[12:15]
    ds_read_b64_tr_b16 a[136:137], v224 offset:12288
    v_exp_f32 v186, v154
    v_mfma_f32_16x16x32_bf16 v[16:19], a[144:147], v[160:163], v[16:19]
    ds_read_b64_tr_b16 a[138:139], v224 offset:14336
    global_load_lds_dwordx4 v235, s[70:71] offset:3072
    v_exp_f32 v187, v155
    v_mfma_f32_16x16x32_bf16 v[24:27], a[144:147], v[164:167], v[24:27]
    ds_read_b64_tr_b16 a[140:141], v225 offset:12288
    v_add_f32 v195, v184, v185
    v_mfma_f32_16x16x32_bf16 v[20:23], a[148:151], v[160:163], v[20:23]
    ds_read_b64_tr_b16 a[142:143], v225 offset:14336
    s_add_u32 m0, s42, 81920
    v_mfma_f32_16x16x32_bf16 v[28:31], a[148:151], v[164:167], v[28:31]
    ds_read_b64_tr_b16 a[144:145], v226 offset:12288
    v_cvt_pk_bf16_f32 v172, v184, v185
    s_waitcnt lgkmcnt(13)
    v_mfma_f32_16x16x32_bf16 v[32:35], a[152:155], v[160:163], v[32:35]
    ds_read_b64_tr_b16 a[146:147], v226 offset:14336
    v_add_f32 v195, v195, v186
    v_mfma_f32_16x16x32_bf16 v[40:43], a[152:155], v[164:167], v[40:43]
    ds_read_b64_tr_b16 a[148:149], v227 offset:12288
    s_add_u32 s72, s69, 212992
    v_mfma_f32_16x16x32_bf16 v[36:39], a[156:159], v[160:163], v[36:39]
    ds_read_b64_tr_b16 a[150:151], v227 offset:14336
    v_cvt_pk_bf16_f32 v173, v186, v187
    v_mfma_f32_16x16x32_bf16 v[44:47], a[156:159], v[164:167], v[44:47]
    ds_read_b128 a[152:155], v216 offset:16384
    global_load_lds_dwordx4 v236, s[72:73] offset:0
    v_mfma_f32_16x16x32_bf16 v[48:51], a[112:115], v[160:163], v[48:51]
    ds_read_b128 a[156:159], v217 offset:16384
    v_add_f32 v195, v195, v187
    v_mfma_f32_16x16x32_bf16 v[56:59], a[112:115], v[164:167], v[56:59]
    v_exp_f32 v188, v156
    v_mfma_f32_16x16x32_bf16 v[52:55], a[116:119], v[160:163], v[52:55]
    v_exp_f32 v189, v157
    v_mfma_f32_16x16x32_bf16 v[60:63], a[116:119], v[164:167], v[60:63]
    ds_read_b128 a[112:115], v218 offset:16384
    s_waitcnt lgkmcnt(11)
    v_mfma_f32_16x16x32_bf16 v[64:67], a[120:123], v[160:163], v[64:67]
    ds_read_b128 a[116:119], v219 offset:16384
    v_mfma_f32_16x16x32_bf16 v[72:75], a[120:123], v[164:167], v[72:75]
    v_exp_f32 v190, v158
    v_mfma_f32_16x16x32_bf16 v[68:71], a[124:127], v[160:163], v[68:71]
    v_exp_f32 v191, v159
    v_mfma_f32_16x16x32_bf16 v[76:79], a[124:127], v[164:167], v[76:79]
    ds_read_b128 a[120:123], v216 offset:16640
    global_load_lds_dwordx4 v237, s[72:73] offset:1024
    v_mfma_f32_16x16x32_bf16 v[80:83], a[128:131], v[160:163], v[80:83]
    ds_read_b128 a[124:127], v217 offset:16640
    v_add_f32 v195, v195, v188
    v_mfma_f32_16x16x32_bf16 v[88:91], a[128:131], v[164:167], v[88:91]
    v_cvt_pk_bf16_f32 v174, v188, v189
    v_add_f32 v195, v195, v189
    v_mfma_f32_16x16x32_bf16 v[84:87], a[132:135], v[160:163], v[84:87]
    v_add_f32 v195, v195, v190
    v_cvt_pk_bf16_f32 v175, v190, v191
    v_mfma_f32_16x16x32_bf16 v[92:95], a[132:135], v[164:167], v[92:95]
    ds_read_b128 a[128:131], v218 offset:16640
    s_waitcnt lgkmcnt(7)
    v_mfma_f32_16x16x32_bf16 v[96:99], a[136:139], v[160:163], v[96:99]
    ds_read_b128 a[132:135], v219 offset:16640
    v_add_f32 v195, v195, v191
    v_mfma_f32_16x16x32_bf16 v[104:107], a[136:139], v[164:167], v[104:107]
    v_mfma_f32_16x16x32_bf16 v[100:103], a[140:143], v[160:163], v[100:103]
    v_mfma_f32_16x16x32_bf16 v[108:111], a[140:143], v[164:167], v[108:111]
    ds_read_b128 a[136:139], v216 offset:24576
    global_load_lds_dwordx4 v238, s[72:73] offset:2048
    v_mfma_f32_16x16x32_bf16 v[112:115], a[144:147], v[160:163], v[112:115]
    ds_read_b128 a[140:143], v217 offset:24576
    v_mfma_f32_16x16x32_bf16 v[120:123], a[144:147], v[164:167], v[120:123]
    v_mfma_f32_16x16x32_bf16 v[116:119], a[148:151], v[160:163], v[116:119]
    v_mfma_f32_16x16x32_bf16 v[124:127], a[148:151], v[164:167], v[124:127]
    ds_read_b128 a[144:147], v218 offset:24576
    v_max_f32 v196, v194, v195
    v_cmp_lt_f32 vcc, s101, v196
    s_nop 3
    s_cbranch_vccnz L_slow_9
L_back_9:
    v_add_f32 v192, v192, v194
    v_add_f32 v193, v193, v195
    s_waitcnt lgkmcnt(7)
    v_mfma_f32_16x16x32_bf16 v[144:147], a[152:155], a[192:195], v[176:179]
    ds_read_b128 a[148:151], v219 offset:24576
    v_mfma_f32_16x16x32_bf16 v[144:147], a[156:159], a[200:203], v[144:147]
    v_exp_f32 v184, v128
    v_mfma_f32_16x16x32_bf16 v[152:155], a[152:155], a[196:199], v[180:183]
    v_exp_f32 v185, v129
    v_mfma_f32_16x16x32_bf16 v[152:155], a[156:159], a[204:207], v[152:155]
    ds_read_b128 a[152:155], v216 offset:24832
    global_load_lds_dwordx4 v239, s[72:73] offset:3072
    v_mfma_f32_16x16x32_bf16 v[144:147], a[112:115], a[208:211], v[144:147]
    ds_read_b128 a[156:159], v217 offset:24832
    v_mfma_f32_16x16x32_bf16 v[144:147], a[116:119], a[216:219], v[144:147]
    v_exp_f32 v186, v130
    v_mfma_f32_16x16x32_bf16 v[152:155], a[112:115], a[212:215], v[152:155]
    v_exp_f32 v187, v131
    v_mfma_f32_16x16x32_bf16 v[152:155], a[116:119], a[220:223], v[152:155]
    ds_read_b128 a[112:115], v218 offset:24832
    s_waitcnt lgkmcnt(7)
    v_mfma_f32_16x16x32_bf16 v[144:147], a[120:123], a[224:227], v[144:147]
    ds_read_b128 a[116:119], v219 offset:24832
    v_add_f32 v194, v184, v185
    v_mfma_f32_16x16x32_bf16 v[144:147], a[124:127], a[232:235], v[144:147]
    v_cvt_pk_bf16_f32 v160, v184, v185
    v_add_f32 v194, v194, v186
    v_mfma_f32_16x16x32_bf16 v[152:155], a[120:123], a[228:231], v[152:155]
    v_cvt_pk_bf16_f32 v161, v186, v187
    v_add_f32 v194, v194, v187
    v_mfma_f32_16x16x32_bf16 v[152:155], a[124:127], a[236:239], v[152:155]
    s_waitcnt vmcnt(8)
    s_barrier
    ds_read_b64_tr_b16 a[120:121], v224 offset:32768
    v_mov_b32 v253, 1
    buffer_store_byte v253, v241, s[12:15], 0 offen offset:0 sc1
    s_add_u32 m0, s42, 98304
    s_add_u32 s70, s68, 180224
    v_mfma_f32_16x16x32_bf16 v[144:147], a[128:131], a[240:243], v[144:147]
    ds_read_b64_tr_b16 a[122:123], v224 offset:34816
    global_load_lds_dwordx4 v232, s[70:71] offset:0
    v_mfma_f32_16x16x32_bf16 v[144:147], a[132:135], a[248:251], v[144:147]
    ds_read_b64_tr_b16 a[124:125], v225 offset:32768
    v_mfma_f32_16x16x32_bf16 v[152:155], a[128:131], a[244:247], v[152:155]
    ds_read_b64_tr_b16 a[126:127], v225 offset:34816
    v_mfma_f32_16x16x32_bf16 v[152:155], a[132:135], a[252:255], v[152:155]
    ds_read_b64_tr_b16 a[128:129], v226 offset:32768
    s_waitcnt lgkmcnt(9)
    v_mfma_f32_16x16x32_bf16 v[148:151], a[136:139], a[192:195], v[176:179]
    ds_read_b64_tr_b16 a[130:131], v226 offset:34816
    v_exp_f32 v188, v132
    v_mfma_f32_16x16x32_bf16 v[148:151], a[140:143], a[200:203], v[148:151]
    ds_read_b64_tr_b16 a[132:133], v227 offset:32768
    v_exp_f32 v189, v133
    v_mfma_f32_16x16x32_bf16 v[156:159], a[136:139], a[196:199], v[180:183]
    ds_read_b64_tr_b16 a[134:135], v227 offset:34816
    v_mfma_f32_16x16x32_bf16 v[156:159], a[140:143], a[204:207], v[156:159]
    ds_read_b64_tr_b16 a[136:137], v224 offset:36864
    v_exp_f32 v190, v134
    v_mfma_f32_16x16x32_bf16 v[148:151], a[144:147], a[208:211], v[148:151]
    ds_read_b64_tr_b16 a[138:139], v224 offset:38912
    global_load_lds_dwordx4 v233, s[70:71] offset:1024
    v_exp_f32 v191, v135
    v_mfma_f32_16x16x32_bf16 v[148:151], a[148:151], a[216:219], v[148:151]
    ds_read_b64_tr_b16 a[140:141], v225 offset:36864
    v_add_f32 v194, v194, v188
    v_mfma_f32_16x16x32_bf16 v[156:159], a[144:147], a[212:215], v[156:159]
    ds_read_b64_tr_b16 a[142:143], v225 offset:38912
    v_cvt_pk_bf16_f32 v162, v188, v189
    v_mfma_f32_16x16x32_bf16 v[156:159], a[148:151], a[220:223], v[156:159]
    ds_read_b64_tr_b16 a[144:145], v226 offset:36864
    s_waitcnt lgkmcnt(13)
    v_mfma_f32_16x16x32_bf16 v[148:151], a[152:155], a[224:227], v[148:151]
    ds_read_b64_tr_b16 a[146:147], v226 offset:38912
    v_add_f32 v194, v194, v189
    v_mfma_f32_16x16x32_bf16 v[148:151], a[156:159], a[232:235], v[148:151]
    ds_read_b64_tr_b16 a[148:149], v227 offset:36864
    v_add_f32 v194, v194, v190
    v_mfma_f32_16x16x32_bf16 v[156:159], a[152:155], a[228:231], v[156:159]
    ds_read_b64_tr_b16 a[150:151], v227 offset:38912
    v_cvt_pk_bf16_f32 v163, v190, v191
    v_mfma_f32_16x16x32_bf16 v[156:159], a[156:159], a[236:239], v[156:159]
    ds_read_b64_tr_b16 a[152:153], v224 offset:40960
    v_add_f32 v194, v194, v191
    v_mfma_f32_16x16x32_bf16 v[148:151], a[112:115], a[240:243], v[148:151]
    ds_read_b64_tr_b16 a[154:155], v224 offset:43008
    global_load_lds_dwordx4 v234, s[70:71] offset:2048
    v_mfma_f32_16x16x32_bf16 v[148:151], a[116:119], a[248:251], v[148:151]
    ds_read_b64_tr_b16 a[156:157], v225 offset:40960
    v_mfma_f32_16x16x32_bf16 v[156:159], a[112:115], a[244:247], v[156:159]
    ds_read_b64_tr_b16 a[158:159], v225 offset:43008
    v_mfma_f32_16x16x32_bf16 v[156:159], a[116:119], a[252:255], v[156:159]
    ds_read_b64_tr_b16 a[112:113], v226 offset:40960
    v_exp_f32 v184, v136
    s_waitcnt lgkmcnt(13)
    v_mfma_f32_16x16x32_bf16 v[0:3], a[120:123], v[168:171], v[0:3]
    ds_read_b64_tr_b16 a[114:115], v226 offset:43008
    v_mfma_f32_16x16x32_bf16 v[8:11], a[120:123], v[172:175], v[8:11]
    ds_read_b64_tr_b16 a[116:117], v227 offset:40960
    v_exp_f32 v185, v137
    v_mfma_f32_16x16x32_bf16 v[4:7], a[124:127], v[168:171], v[4:7]
    ds_read_b64_tr_b16 a[118:119], v227 offset:43008
    v_mfma_f32_16x16x32_bf16 v[12:15], a[124:127], v[172:175], v[12:15]
    ds_read_b64_tr_b16 a[120:121], v224 offset:45056
    v_exp_f32 v186, v138
    v_mfma_f32_16x16x32_bf16 v[16:19], a[128:131], v[168:171], v[16:19]
    ds_read_b64_tr_b16 a[122:123], v224 offset:47104
    global_load_lds_dwordx4 v235, s[70:71] offset:3072
    v_exp_f32 v187, v139
    v_mfma_f32_16x16x32_bf16 v[24:27], a[128:131], v[172:175], v[24:27]
    ds_read_b64_tr_b16 a[124:125], v225 offset:45056
    v_add_f32 v195, v184, v185
    v_mfma_f32_16x16x32_bf16 v[20:23], a[132:135], v[168:171], v[20:23]
    ds_read_b64_tr_b16 a[126:127], v225 offset:47104
    s_add_u32 m0, s42, 114688
    v_mfma_f32_16x16x32_bf16 v[28:31], a[132:135], v[172:175], v[28:31]
    ds_read_b64_tr_b16 a[128:129], v226 offset:45056
    v_cvt_pk_bf16_f32 v164, v184, v185
    s_waitcnt lgkmcnt(13)
    v_mfma_f32_16x16x32_bf16 v[32:35], a[136:139], v[168:171], v[32:35]
    ds_read_b64_tr_b16 a[130:131], v226 offset:47104
    v_add_f32 v195, v195, v186
    v_mfma_f32_16x16x32_bf16 v[40:43], a[136:139], v[172:175], v[40:43]
    ds_read_b64_tr_b16 a[132:133], v227 offset:45056
    s_add_u32 s72, s69, 229376
    v_mfma_f32_16x16x32_bf16 v[36:39], a[140:143], v[168:171], v[36:39]
    ds_read_b64_tr_b16 a[134:135], v227 offset:47104
    v_cvt_pk_bf16_f32 v165, v186, v187
    v_mfma_f32_16x16x32_bf16 v[44:47], a[140:143], v[172:175], v[44:47]
    ds_read_b128 a[136:139], v216 offset:49152
    global_load_lds_dwordx4 v236, s[72:73] offset:0
    v_mfma_f32_16x16x32_bf16 v[48:51], a[144:147], v[168:171], v[48:51]
    ds_read_b128 a[140:143], v217 offset:49152
    v_add_f32 v195, v195, v187
    v_mfma_f32_16x16x32_bf16 v[56:59], a[144:147], v[172:175], v[56:59]
    v_exp_f32 v188, v140
    v_mfma_f32_16x16x32_bf16 v[52:55], a[148:151], v[168:171], v[52:55]
    v_exp_f32 v189, v141
    v_mfma_f32_16x16x32_bf16 v[60:63], a[148:151], v[172:175], v[60:63]
    ds_read_b128 a[144:147], v218 offset:49152
    s_waitcnt lgkmcnt(11)
    v_mfma_f32_16x16x32_bf16 v[64:67], a[152:155], v[168:171], v[64:67]
    ds_read_b128 a[148:151], v219 offset:49152
    v_mfma_f32_16x16x32_bf16 v[72:75], a[152:155], v[172:175], v[72:75]
    v_exp_f32 v190, v142
    v_mfma_f32_16x16x32_bf16 v[68:71], a[156:159], v[168:171], v[68:71]
    v_exp_f32 v191, v143
    v_mfma_f32_16x16x32_bf16 v[76:79], a[156:159], v[172:175], v[76:79]
    ds_read_b128 a[152:155], v216 offset:49408
    global_load_lds_dwordx4 v237, s[72:73] offset:1024
    v_mfma_f32_16x16x32_bf16 v[80:83], a[112:115], v[168:171], v[80:83]
    ds_read_b128 a[156:159], v217 offset:49408
    v_add_f32 v195, v195, v188
    v_mfma_f32_16x16x32_bf16 v[88:91], a[112:115], v[172:175], v[88:91]
    v_cvt_pk_bf16_f32 v166, v188, v189
    v_add_f32 v195, v195, v189
    v_mfma_f32_16x16x32_bf16 v[84:87], a[116:119], v[168:171], v[84:87]
    v_add_f32 v195, v195, v190
    v_cvt_pk_bf16_f32 v167, v190, v191
    v_mfma_f32_16x16x32_bf16 v[92:95], a[116:119], v[172:175], v[92:95]
    ds_read_b128 a[112:115], v218 offset:49408
    s_waitcnt lgkmcnt(7)
    v_mfma_f32_16x16x32_bf16 v[96:99], a[120:123], v[168:171], v[96:99]
    ds_read_b128 a[116:119], v219 offset:49408
    v_add_f32 v195, v195, v191
    v_mfma_f32_16x16x32_bf16 v[104:107], a[120:123], v[172:175], v[104:107]
    v_mfma_f32_16x16x32_bf16 v[100:103], a[124:127], v[168:171], v[100:103]
    v_mfma_f32_16x16x32_bf16 v[108:111], a[124:127], v[172:175], v[108:111]
    ds_read_b128 a[120:123], v216 offset:57344
    global_load_lds_dwordx4 v238, s[72:73] offset:2048
    v_mfma_f32_16x16x32_bf16 v[112:115], a[128:131], v[168:171], v[112:115]
    ds_read_b128 a[124:127], v217 offset:57344
    v_mfma_f32_16x16x32_bf16 v[120:123], a[128:131], v[172:175], v[120:123]
    v_mfma_f32_16x16x32_bf16 v[116:119], a[132:135], v[168:171], v[116:119]
    v_mfma_f32_16x16x32_bf16 v[124:127], a[132:135], v[172:175], v[124:127]
    ds_read_b128 a[128:131], v218 offset:57344
    v_max_f32 v196, v194, v195
    v_cmp_lt_f32 vcc, s101, v196
    s_nop 3
    s_cbranch_vccnz L_slow_10
L_back_10:
    v_add_f32 v192, v192, v194
    v_add_f32 v193, v193, v195
    s_waitcnt lgkmcnt(7)
    v_mfma_f32_16x16x32_bf16 v[128:131], a[136:139], a[192:195], v[176:179]
    ds_read_b128 a[132:135], v219 offset:57344
    v_mfma_f32_16x16x32_bf16 v[128:131], a[140:143], a[200:203], v[128:131]
    v_exp_f32 v184, v144
    v_mfma_f32_16x16x32_bf16 v[136:139], a[136:139], a[196:199], v[180:183]
    v_exp_f32 v185, v145
    v_mfma_f32_16x16x32_bf16 v[136:139], a[140:143], a[204:207], v[136:139]
    ds_read_b128 a[136:139], v216 offset:57600
    global_load_lds_dwordx4 v239, s[72:73] offset:3072
    v_mfma_f32_16x16x32_bf16 v[128:131], a[144:147], a[208:211], v[128:131]
    ds_read_b128 a[140:143], v217 offset:57600
    v_mfma_f32_16x16x32_bf16 v[128:131], a[148:151], a[216:219], v[128:131]
    v_exp_f32 v186, v146
    v_mfma_f32_16x16x32_bf16 v[136:139], a[144:147], a[212:215], v[136:139]
    v_exp_f32 v187, v147
    v_mfma_f32_16x16x32_bf16 v[136:139], a[148:151], a[220:223], v[136:139]
    ds_read_b128 a[144:147], v218 offset:57600
    s_waitcnt lgkmcnt(7)
    v_mfma_f32_16x16x32_bf16 v[128:131], a[152:155], a[224:227], v[128:131]
    ds_read_b128 a[148:151], v219 offset:57600
    v_add_f32 v194, v184, v185
    v_mfma_f32_16x16x32_bf16 v[128:131], a[156:159], a[232:235], v[128:131]
    v_cvt_pk_bf16_f32 v168, v184, v185
    v_add_f32 v194, v194, v186
    v_mfma_f32_16x16x32_bf16 v[136:139], a[152:155], a[228:231], v[136:139]
    v_cvt_pk_bf16_f32 v169, v186, v187
    v_add_f32 v194, v194, v187
    v_mfma_f32_16x16x32_bf16 v[136:139], a[156:159], a[236:239], v[136:139]
    s_waitcnt vmcnt(9)
    s_barrier
    ds_read_b64_tr_b16 a[152:153], v228 offset:0
    s_add_u32 m0, s42, 0
    s_add_u32 s70, s68, 196608
    v_mfma_f32_16x16x32_bf16 v[128:131], a[112:115], a[240:243], v[128:131]
    ds_read_b64_tr_b16 a[154:155], v228 offset:2048
    global_load_lds_dwordx4 v232, s[70:71] offset:0
    v_mfma_f32_16x16x32_bf16 v[128:131], a[116:119], a[248:251], v[128:131]
    ds_read_b64_tr_b16 a[156:157], v229 offset:0
    v_mfma_f32_16x16x32_bf16 v[136:139], a[112:115], a[244:247], v[136:139]
    ds_read_b64_tr_b16 a[158:159], v229 offset:2048
    v_mfma_f32_16x16x32_bf16 v[136:139], a[116:119], a[252:255], v[136:139]
    ds_read_b64_tr_b16 a[112:113], v230 offset:0
    s_waitcnt lgkmcnt(9)
    v_mfma_f32_16x16x32_bf16 v[132:135], a[120:123], a[192:195], v[176:179]
    ds_read_b64_tr_b16 a[114:115], v230 offset:2048
    v_exp_f32 v188, v148
    v_mfma_f32_16x16x32_bf16 v[132:135], a[124:127], a[200:203], v[132:135]
    ds_read_b64_tr_b16 a[116:117], v231 offset:0
    v_exp_f32 v189, v149
    v_mfma_f32_16x16x32_bf16 v[140:143], a[120:123], a[196:199], v[180:183]
    ds_read_b64_tr_b16 a[118:119], v231 offset:2048
    v_mfma_f32_16x16x32_bf16 v[140:143], a[124:127], a[204:207], v[140:143]
    ds_read_b64_tr_b16 a[120:121], v228 offset:4096
    v_exp_f32 v190, v150
    v_mfma_f32_16x16x32_bf16 v[132:135], a[128:131], a[208:211], v[132:135]
    ds_read_b64_tr_b16 a[122:123], v228 offset:6144
    global_load_lds_dwordx4 v233, s[70:71] offset:1024
    v_exp_f32 v191, v151
    v_mfma_f32_16x16x32_bf16 v[132:135], a[132:135], a[216:219], v[132:135]
    ds_read_b64_tr_b16 a[124:125], v229 offset:4096
    v_add_f32 v194, v194, v188
    v_mfma_f32_16x16x32_bf16 v[140:143], a[128:131], a[212:215], v[140:143]
    ds_read_b64_tr_b16 a[126:127], v229 offset:6144
    v_cvt_pk_bf16_f32 v170, v188, v189
    v_mfma_f32_16x16x32_bf16 v[140:143], a[132:135], a[220:223], v[140:143]
    ds_read_b64_tr_b16 a[128:129], v230 offset:4096
    s_waitcnt lgkmcnt(13)
    v_mfma_f32_16x16x32_bf16 v[132:135], a[136:139], a[224:227], v[132:135]
    ds_read_b64_tr_b16 a[130:131], v230 offset:6144
    v_add_f32 v194, v194, v189
    v_mfma_f32_16x16x32_bf16 v[132:135], a[140:143], a[232:235], v[132:135]
    ds_read_b64_tr_b16 a[132:133], v231 offset:4096
    v_add_f32 v194, v194, v190
    v_mfma_f32_16x16x32_bf16 v[140:143], a[136:139], a[228:231], v[140:143]
    ds_read_b64_tr_b16 a[134:135], v231 offset:6144
    v_cvt_pk_bf16_f32 v171, v190, v191
    v_mfma_f32_16x16x32_bf16 v[140:143], a[140:143], a[236:239], v[140:143]
    ds_read_b64_tr_b16 a[136:137], v228 offset:8192
    v_add_f32 v194, v194, v191
    v_mfma_f32_16x16x32_bf16 v[132:135], a[144:147], a[240:243], v[132:135]
    ds_read_b64_tr_b16 a[138:139], v228 offset:10240
    global_load_lds_dwordx4 v234, s[70:71] offset:2048
    v_mfma_f32_16x16x32_bf16 v[132:135], a[148:151], a[248:251], v[132:135]
    ds_read_b64_tr_b16 a[140:141], v229 offset:8192
    v_mfma_f32_16x16x32_bf16 v[140:143], a[144:147], a[244:247], v[140:143]
    ds_read_b64_tr_b16 a[142:143], v229 offset:10240
    v_mfma_f32_16x16x32_bf16 v[140:143], a[148:151], a[252:255], v[140:143]
    ds_read_b64_tr_b16 a[144:145], v230 offset:8192
    v_exp_f32 v184, v152
    s_waitcnt lgkmcnt(13)
    v_mfma_f32_16x16x32_bf16 v[0:3], a[152:155], v[160:163], v[0:3]
    ds_read_b64_tr_b16 a[146:147], v230 offset:10240
    v_mfma_f32_16x16x32_bf16 v[8:11], a[152:155], v[164:167], v[8:11]
    ds_read_b64_tr_b16 a[148:149], v231 offset:8192
    v_exp_f32 v185, v153
    v_mfma_f32_16x16x32_bf16 v[4:7], a[156:159], v[160:163], v[4:7]
    ds_read_b64_tr_b16 a[150:151], v231 offset:10240
    v_mfma_f32_16x16x32_bf16 v[12:15], a[156:159], v[164:167], v[12:15]
    ds_read_b64_tr_b16 a[152:153], v228 offset:12288
    v_exp_f32 v186, v154
    v_mfma_f32_16x16x32_bf16 v[16:19], a[112:115], v[160:163], v[16:19]
    ds_read_b64_tr_b16 a[154:155], v228 offset:14336
    global_load_lds_dwordx4 v235, s[70:71] offset:3072
    v_exp_f32 v187, v155
    v_mfma_f32_16x16x32_bf16 v[24:27], a[112:115], v[164:167], v[24:27]
    ds_read_b64_tr_b16 a[156:157], v229 offset:12288
    v_add_f32 v195, v184, v185
    v_mfma_f32_16x16x32_bf16 v[20:23], a[116:119], v[160:163], v[20:23]
    ds_read_b64_tr_b16 a[158:159], v229 offset:14336
    s_add_u32 m0, s42, 16384
    v_mfma_f32_16x16x32_bf16 v[28:31], a[116:119], v[164:167], v[28:31]
    ds_read_b64_tr_b16 a[112:113], v230 offset:12288
    v_cvt_pk_bf16_f32 v172, v184, v185
    s_waitcnt lgkmcnt(13)
    v_mfma_f32_16x16x32_bf16 v[32:35], a[120:123], v[160:163], v[32:35]
    ds_read_b64_tr_b16 a[114:115], v230 offset:14336
    v_add_f32 v195, v195, v186
    v_mfma_f32_16x16x32_bf16 v[40:43], a[120:123], v[164:167], v[40:43]
    ds_read_b64_tr_b16 a[116:117], v231 offset:12288
    s_add_u32 s72, s69, 245760
    v_mfma_f32_16x16x32_bf16 v[36:39], a[124:127], v[160:163], v[36:39]
    ds_read_b64_tr_b16 a[118:119], v231 offset:14336
    v_cvt_pk_bf16_f32 v173, v186, v187
    v_mfma_f32_16x16x32_bf16 v[44:47], a[124:127], v[164:167], v[44:47]
    ds_read_b128 a[120:123], v220 offset:16384
    global_load_lds_dwordx4 v236, s[72:73] offset:0
    v_mfma_f32_16x16x32_bf16 v[48:51], a[128:131], v[160:163], v[48:51]
    ds_read_b128 a[124:127], v221 offset:16384
    v_add_f32 v195, v195, v187
    v_mfma_f32_16x16x32_bf16 v[56:59], a[128:131], v[164:167], v[56:59]
    v_exp_f32 v188, v156
    v_mfma_f32_16x16x32_bf16 v[52:55], a[132:135], v[160:163], v[52:55]
    v_exp_f32 v189, v157
    v_mfma_f32_16x16x32_bf16 v[60:63], a[132:135], v[164:167], v[60:63]
    ds_read_b128 a[128:131], v222 offset:16384
    s_waitcnt lgkmcnt(11)
    v_mfma_f32_16x16x32_bf16 v[64:67], a[136:139], v[160:163], v[64:67]
    ds_read_b128 a[132:135], v223 offset:16384
    v_mfma_f32_16x16x32_bf16 v[72:75], a[136:139], v[164:167], v[72:75]
    v_exp_f32 v190, v158
    v_mfma_f32_16x16x32_bf16 v[68:71], a[140:143], v[160:163], v[68:71]
    v_exp_f32 v191, v159
    v_mfma_f32_16x16x32_bf16 v[76:79], a[140:143], v[164:167], v[76:79]
    ds_read_b128 a[136:139], v220 offset:16640
    global_load_lds_dwordx4 v237, s[72:73] offset:1024
    v_mfma_f32_16x16x32_bf16 v[80:83], a[144:147], v[160:163], v[80:83]
    ds_read_b128 a[140:143], v221 offset:16640
    v_add_f32 v195, v195, v188
    v_mfma_f32_16x16x32_bf16 v[88:91], a[144:147], v[164:167], v[88:91]
    v_cvt_pk_bf16_f32 v174, v188, v189
    v_add_f32 v195, v195, v189
    v_mfma_f32_16x16x32_bf16 v[84:87], a[148:151], v[160:163], v[84:87]
    v_add_f32 v195, v195, v190
    v_cvt_pk_bf16_f32 v175, v190, v191
    v_mfma_f32_16x16x32_bf16 v[92:95], a[148:151], v[164:167], v[92:95]
    ds_read_b128 a[144:147], v222 offset:16640
    s_waitcnt lgkmcnt(7)
    v_mfma_f32_16x16x32_bf16 v[96:99], a[152:155], v[160:163], v[96:99]
    ds_read_b128 a[148:151], v223 offset:16640
    v_add_f32 v195, v195, v191
    v_mfma_f32_16x16x32_bf16 v[104:107], a[152:155], v[164:167], v[104:107]
    v_mfma_f32_16x16x32_bf16 v[100:103], a[156:159], v[160:163], v[100:103]
    v_mfma_f32_16x16x32_bf16 v[108:111], a[156:159], v[164:167], v[108:111]
    ds_read_b128 a[152:155], v220 offset:24576
    global_load_lds_dwordx4 v238, s[72:73] offset:2048
    v_mfma_f32_16x16x32_bf16 v[112:115], a[112:115], v[160:163], v[112:115]
    ds_read_b128 a[156:159], v221 offset:24576
    v_mfma_f32_16x16x32_bf16 v[120:123], a[112:115], v[164:167], v[120:123]
    v_mfma_f32_16x16x32_bf16 v[116:119], a[116:119], v[160:163], v[116:119]
    v_mfma_f32_16x16x32_bf16 v[124:127], a[116:119], v[164:167], v[124:127]
    ds_read_b128 a[112:115], v222 offset:24576
    v_max_f32 v196, v194, v195
    v_cmp_lt_f32 vcc, s101, v196
    s_nop 3
    s_cbranch_vccnz L_slow_11
L_back_11:
    v_add_f32 v192, v192, v194
    v_add_f32 v193, v193, v195
    s_waitcnt lgkmcnt(7)
    v_mfma_f32_16x16x32_bf16 v[144:147], a[120:123], a[192:195], v[176:179]
    ds_read_b128 a[116:119], v223 offset:24576
    v_mfma_f32_16x16x32_bf16 v[144:147], a[124:127], a[200:203], v[144:147]
    v_exp_f32 v184, v128
    v_mfma_f32_16x16x32_bf16 v[152:155], a[120:123], a[196:199], v[180:183]
    v_exp_f32 v185, v129
    v_mfma_f32_16x16x32_bf16 v[152:155], a[124:127], a[204:207], v[152:155]
    ds_read_b128 a[120:123], v220 offset:24832
    global_load_lds_dwordx4 v239, s[72:73] offset:3072
    v_mfma_f32_16x16x32_bf16 v[144:147], a[128:131], a[208:211], v[144:147]
    ds_read_b128 a[124:127], v221 offset:24832
    v_mfma_f32_16x16x32_bf16 v[144:147], a[132:135], a[216:219], v[144:147]
    v_exp_f32 v186, v130
    v_mfma_f32_16x16x32_bf16 v[152:155], a[128:131], a[212:215], v[152:155]
    v_exp_f32 v187, v131
    v_mfma_f32_16x16x32_bf16 v[152:155], a[132:135], a[220:223], v[152:155]
    ds_read_b128 a[128:131], v222 offset:24832
    s_waitcnt lgkmcnt(7)
    v_mfma_f32_16x16x32_bf16 v[144:147], a[136:139], a[224:227], v[144:147]
    ds_read_b128 a[132:135], v223 offset:24832
    v_add_f32 v194, v184, v185
    v_mfma_f32_16x16x32_bf16 v[144:147], a[140:143], a[232:235], v[144:147]
    v_cvt_pk_bf16_f32 v160, v184, v185
    v_add_f32 v194, v194, v186
    v_mfma_f32_16x16x32_bf16 v[152:155], a[136:139], a[228:231], v[152:155]
    v_cvt_pk_bf16_f32 v161, v186, v187
    v_add_f32 v194, v194, v187
    v_mfma_f32_16x16x32_bf16 v[152:155], a[140:143], a[236:239], v[152:155]
    s_waitcnt vmcnt(8)
    s_barrier
    ds_read_b64_tr_b16 a[136:137], v228 offset:32768
    s_add_u32 m0, s42, 32768
    s_add_u32 s70, s68, 212992
    v_mfma_f32_16x16x32_bf16 v[144:147], a[144:147], a[240:243], v[144:147]
    ds_read_b64_tr_b16 a[138:139], v228 offset:34816
    global_load_lds_dwordx4 v232, s[70:71] offset:0
    v_mfma_f32_16x16x32_bf16 v[144:147], a[148:151], a[248:251], v[144:147]
    ds_read_b64_tr_b16 a[140:141], v229 offset:32768
    v_mfma_f32_16x16x32_bf16 v[152:155], a[144:147], a[244:247], v[152:155]
    ds_read_b64_tr_b16 a[142:143], v229 offset:34816
    v_mfma_f32_16x16x32_bf16 v[152:155], a[148:151], a[252:255], v[152:155]
    ds_read_b64_tr_b16 a[144:145], v230 offset:32768
    s_waitcnt lgkmcnt(9)
    v_mfma_f32_16x16x32_bf16 v[148:151], a[152:155], a[192:195], v[176:179]
    ds_read_b64_tr_b16 a[146:147], v230 offset:34816
    v_exp_f32 v188, v132
    v_mfma_f32_16x16x32_bf16 v[148:151], a[156:159], a[200:203], v[148:151]
    ds_read_b64_tr_b16 a[148:149], v231 offset:32768
    v_exp_f32 v189, v133
    v_mfma_f32_16x16x32_bf16 v[156:159], a[152:155], a[196:199], v[180:183]
    ds_read_b64_tr_b16 a[150:151], v231 offset:34816
    v_mfma_f32_16x16x32_bf16 v[156:159], a[156:159], a[204:207], v[156:159]
    ds_read_b64_tr_b16 a[152:153], v228 offset:36864
    v_exp_f32 v190, v134
    v_mfma_f32_16x16x32_bf16 v[148:151], a[112:115], a[208:211], v[148:151]
    ds_read_b64_tr_b16 a[154:155], v228 offset:38912
    global_load_lds_dwordx4 v233, s[70:71] offset:1024
    v_exp_f32 v191, v135
    v_mfma_f32_16x16x32_bf16 v[148:151], a[116:119], a[216:219], v[148:151]
    ds_read_b64_tr_b16 a[156:157], v229 offset:36864
    v_add_f32 v194, v194, v188
    v_mfma_f32_16x16x32_bf16 v[156:159], a[112:115], a[212:215], v[156:159]
    ds_read_b64_tr_b16 a[158:159], v229 offset:38912
    v_cvt_pk_bf16_f32 v162, v188, v189
    v_mfma_f32_16x16x32_bf16 v[156:159], a[116:119], a[220:223], v[156:159]
    ds_read_b64_tr_b16 a[112:113], v230 offset:36864
    s_waitcnt lgkmcnt(13)
    v_mfma_f32_16x16x32_bf16 v[148:151], a[120:123], a[224:227], v[148:151]
    ds_read_b64_tr_b16 a[114:115], v230 offset:38912
    v_add_f32 v194, v194, v189
    v_mfma_f32_16x16x32_bf16 v[148:151], a[124:127], a[232:235], v[148:151]
    ds_read_b64_tr_b16 a[116:117], v231 offset:36864
    v_add_f32 v194, v194, v190
    v_mfma_f32_16x16x32_bf16 v[156:159], a[120:123], a[228:231], v[156:159]
    ds_read_b64_tr_b16 a[118:119], v231 offset:38912
    v_cvt_pk_bf16_f32 v163, v190, v191
    v_mfma_f32_16x16x32_bf16 v[156:159], a[124:127], a[236:239], v[156:159]
    ds_read_b64_tr_b16 a[120:121], v228 offset:40960
    v_add_f32 v194, v194, v191
    v_mfma_f32_16x16x32_bf16 v[148:151], a[128:131], a[240:243], v[148:151]
    ds_read_b64_tr_b16 a[122:123], v228 offset:43008
    global_load_lds_dwordx4 v234, s[70:71] offset:2048
    v_mfma_f32_16x16x32_bf16 v[148:151], a[132:135], a[248:251], v[148:151]
    ds_read_b64_tr_b16 a[124:125], v229 offset:40960
    v_mfma_f32_16x16x32_bf16 v[156:159], a[128:131], a[244:247], v[156:159]
    ds_read_b64_tr_b16 a[126:127], v229 offset:43008
    v_mfma_f32_16x16x32_bf16 v[156:159], a[132:135], a[252:255], v[156:159]
    ds_read_b64_tr_b16 a[128:129], v230 offset:40960
    v_exp_f32 v184, v136
    s_waitcnt lgkmcnt(13)
    v_mfma_f32_16x16x32_bf16 v[0:3], a[136:139], v[168:171], v[0:3]
    ds_read_b64_tr_b16 a[130:131], v230 offset:43008
    v_mfma_f32_16x16x32_bf16 v[8:11], a[136:139], v[172:175], v[8:11]
    ds_read_b64_tr_b16 a[132:133], v231 offset:40960
    v_exp_f32 v185, v137
    v_mfma_f32_16x16x32_bf16 v[4:7], a[140:143], v[168:171], v[4:7]
    ds_read_b64_tr_b16 a[134:135], v231 offset:43008
    v_mfma_f32_16x16x32_bf16 v[12:15], a[140:143], v[172:175], v[12:15]
    ds_read_b64_tr_b16 a[136:137], v228 offset:45056
    v_exp_f32 v186, v138
    v_mfma_f32_16x16x32_bf16 v[16:19], a[144:147], v[168:171], v[16:19]
    ds_read_b64_tr_b16 a[138:139], v228 offset:47104
    global_load_lds_dwordx4 v235, s[70:71] offset:3072
    v_exp_f32 v187, v139
    v_mfma_f32_16x16x32_bf16 v[24:27], a[144:147], v[172:175], v[24:27]
    ds_read_b64_tr_b16 a[140:141], v229 offset:45056
    v_add_f32 v195, v184, v185
    v_mfma_f32_16x16x32_bf16 v[20:23], a[148:151], v[168:171], v[20:23]
    ds_read_b64_tr_b16 a[142:143], v229 offset:47104
    s_add_u32 m0, s42, 49152
    v_mfma_f32_16x16x32_bf16 v[28:31], a[148:151], v[172:175], v[28:31]
    ds_read_b64_tr_b16 a[144:145], v230 offset:45056
    v_cvt_pk_bf16_f32 v164, v184, v185
    s_waitcnt lgkmcnt(13)
    v_mfma_f32_16x16x32_bf16 v[32:35], a[152:155], v[168:171], v[32:35]
    ds_read_b64_tr_b16 a[146:147], v230 offset:47104
    v_add_f32 v195, v195, v186
    v_mfma_f32_16x16x32_bf16 v[40:43], a[152:155], v[172:175], v[40:43]
    ds_read_b64_tr_b16 a[148:149], v231 offset:45056
    s_add_u32 s70, s68, 229376
    v_mfma_f32_16x16x32_bf16 v[36:39], a[156:159], v[168:171], v[36:39]
    ds_read_b64_tr_b16 a[150:151], v231 offset:47104
    v_cvt_pk_bf16_f32 v165, v186, v187
    v_mfma_f32_16x16x32_bf16 v[44:47], a[156:159], v[172:175], v[44:47]
    ds_read_b128 a[152:155], v220 offset:49152
    global_load_lds_dwordx4 v232, s[70:71] offset:0
    v_mfma_f32_16x16x32_bf16 v[48:51], a[112:115], v[168:171], v[48:51]
    ds_read_b128 a[156:159], v221 offset:49152
    v_add_f32 v195, v195, v187
    v_mfma_f32_16x16x32_bf16 v[56:59], a[112:115], v[172:175], v[56:59]
    v_exp_f32 v188, v140
    v_mfma_f32_16x16x32_bf16 v[52:55], a[116:119], v[168:171], v[52:55]
    v_exp_f32 v189, v141
    v_mfma_f32_16x16x32_bf16 v[60:63], a[116:119], v[172:175], v[60:63]
    ds_read_b128 a[112:115], v222 offset:49152
    s_waitcnt lgkmcnt(11)
    v_mfma_f32_16x16x32_bf16 v[64:67], a[120:123], v[168:171], v[64:67]
    ds_read_b128 a[116:119], v223 offset:49152
    v_mfma_f32_16x16x32_bf16 v[72:75], a[120:123], v[172:175], v[72:75]
    v_exp_f32 v190, v142
    v_mfma_f32_16x16x32_bf16 v[68:71], a[124:127], v[168:171], v[68:71]
    v_exp_f32 v191, v143
    v_mfma_f32_16x16x32_bf16 v[76:79], a[124:127], v[172:175], v[76:79]
    ds_read_b128 a[120:123], v220 offset:49408
    global_load_lds_dwordx4 v233, s[70:71] offset:1024
    v_mfma_f32_16x16x32_bf16 v[80:83], a[128:131], v[168:171], v[80:83]
    ds_read_b128 a[124:127], v221 offset:49408
    v_add_f32 v195, v195, v188
    v_mfma_f32_16x16x32_bf16 v[88:91], a[128:131], v[172:175], v[88:91]
    v_cvt_pk_bf16_f32 v166, v188, v189
    v_add_f32 v195, v195, v189
    v_mfma_f32_16x16x32_bf16 v[84:87], a[132:135], v[168:171], v[84:87]
    v_add_f32 v195, v195, v190
    v_cvt_pk_bf16_f32 v167, v190, v191
    v_mfma_f32_16x16x32_bf16 v[92:95], a[132:135], v[172:175], v[92:95]
    ds_read_b128 a[128:131], v222 offset:49408
    s_waitcnt lgkmcnt(7)
    v_mfma_f32_16x16x32_bf16 v[96:99], a[136:139], v[168:171], v[96:99]
    ds_read_b128 a[132:135], v223 offset:49408
    v_add_f32 v195, v195, v191
    v_mfma_f32_16x16x32_bf16 v[104:107], a[136:139], v[172:175], v[104:107]
    v_mfma_f32_16x16x32_bf16 v[100:103], a[140:143], v[168:171], v[100:103]
    v_mfma_f32_16x16x32_bf16 v[108:111], a[140:143], v[172:175], v[108:111]
    ds_read_b128 a[136:139], v220 offset:57344
    global_load_lds_dwordx4 v234, s[70:71] offset:2048
    v_mfma_f32_16x16x32_bf16 v[112:115], a[144:147], v[168:171], v[112:115]
    ds_read_b128 a[140:143], v221 offset:57344
    v_mfma_f32_16x16x32_bf16 v[120:123], a[144:147], v[172:175], v[120:123]
    v_mfma_f32_16x16x32_bf16 v[116:119], a[148:151], v[168:171], v[116:119]
    v_mfma_f32_16x16x32_bf16 v[124:127], a[148:151], v[172:175], v[124:127]
    ds_read_b128 a[144:147], v222 offset:57344
    v_max_f32 v196, v194, v195
    v_cmp_lt_f32 vcc, s101, v196
    s_nop 3
    s_cbranch_vccnz L_slow_12
L_back_12:
    v_add_f32 v192, v192, v194
    v_add_f32 v193, v193, v195
    s_waitcnt lgkmcnt(7)
    v_mfma_f32_16x16x32_bf16 v[128:131], a[152:155], a[192:195], v[176:179]
    ds_read_b128 a[148:151], v223 offset:57344
    v_mfma_f32_16x16x32_bf16 v[128:131], a[156:159], a[200:203], v[128:131]
    v_exp_f32 v184, v144
    v_mfma_f32_16x16x32_bf16 v[136:139], a[152:155], a[196:199], v[180:183]
    v_exp_f32 v185, v145
    v_mfma_f32_16x16x32_bf16 v[136:139], a[156:159], a[204:207], v[136:139]
    ds_read_b128 a[152:155], v220 offset:57600
    global_load_lds_dwordx4 v235, s[70:71] offset:3072
    v_mfma_f32_16x16x32_bf16 v[128:131], a[112:115], a[208:211], v[128:131]
    ds_read_b128 a[156:159], v221 offset:57600
    v_mfma_f32_16x16x32_bf16 v[128:131], a[116:119], a[216:219], v[128:131]
    v_exp_f32 v186, v146
    v_mfma_f32_16x16x32_bf16 v[136:139], a[112:115], a[212:215], v[136:139]
    v_exp_f32 v187, v147
    v_mfma_f32_16x16x32_bf16 v[136:139], a[116:119], a[220:223], v[136:139]
    ds_read_b128 a[112:115], v222 offset:57600
    s_waitcnt lgkmcnt(7)
    v_mfma_f32_16x16x32_bf16 v[128:131], a[120:123], a[224:227], v[128:131]
    ds_read_b128 a[116:119], v223 offset:57600
    v_add_f32 v194, v184, v185
    v_mfma_f32_16x16x32_bf16 v[128:131], a[124:127], a[232:235], v[128:131]
    v_cvt_pk_bf16_f32 v168, v184, v185
    v_add_f32 v194, v194, v186
    v_mfma_f32_16x16x32_bf16 v[136:139], a[120:123], a[228:231], v[136:139]
    v_cvt_pk_bf16_f32 v169, v186, v187
    v_add_f32 v194, v194, v187
    v_mfma_f32_16x16x32_bf16 v[136:139], a[124:127], a[236:239], v[136:139]
    s_waitcnt vmcnt(8)
    s_barrier
    ds_read_b64_tr_b16 a[120:121], v224 offset:0
    s_add_u32 m0, s42, 65536
    s_add_u32 s70, s68, 245760
    v_mfma_f32_16x16x32_bf16 v[128:131], a[128:131], a[240:243], v[128:131]
    ds_read_b64_tr_b16 a[122:123], v224 offset:2048
    global_load_lds_dwordx4 v232, s[70:71] offset:0
    v_mfma_f32_16x16x32_bf16 v[128:131], a[132:135], a[248:251], v[128:131]
    ds_read_b64_tr_b16 a[124:125], v225 offset:0
    v_mfma_f32_16x16x32_bf16 v[136:139], a[128:131], a[244:247], v[136:139]
    ds_read_b64_tr_b16 a[126:127], v225 offset:2048
    v_mfma_f32_16x16x32_bf16 v[136:139], a[132:135], a[252:255], v[136:139]
    ds_read_b64_tr_b16 a[128:129], v226 offset:0
    s_waitcnt lgkmcnt(9)
    v_mfma_f32_16x16x32_bf16 v[132:135], a[136:139], a[192:195], v[176:179]
    ds_read_b64_tr_b16 a[130:131], v226 offset:2048
    v_exp_f32 v188, v148
    v_mfma_f32_16x16x32_bf16 v[132:135], a[140:143], a[200:203], v[132:135]
    ds_read_b64_tr_b16 a[132:133], v227 offset:0
    v_exp_f32 v189, v149
    v_mfma_f32_16x16x32_bf16 v[140:143], a[136:139], a[196:199], v[180:183]
    ds_read_b64_tr_b16 a[134:135], v227 offset:2048
    v_mfma_f32_16x16x32_bf16 v[140:143], a[140:143], a[204:207], v[140:143]
    ds_read_b64_tr_b16 a[136:137], v224 offset:4096
    v_exp_f32 v190, v150
    v_mfma_f32_16x16x32_bf16 v[132:135], a[144:147], a[208:211], v[132:135]
    ds_read_b64_tr_b16 a[138:139], v224 offset:6144
    global_load_lds_dwordx4 v233, s[70:71] offset:1024
    v_exp_f32 v191, v151
    v_mfma_f32_16x16x32_bf16 v[132:135], a[148:151], a[216:219], v[132:135]
    ds_read_b64_tr_b16 a[140:141], v225 offset:4096
    v_add_f32 v194, v194, v188
    v_mfma_f32_16x16x32_bf16 v[140:143], a[144:147], a[212:215], v[140:143]
    ds_read_b64_tr_b16 a[142:143], v225 offset:6144
    v_cvt_pk_bf16_f32 v170, v188, v189
    v_mfma_f32_16x16x32_bf16 v[140:143], a[148:151], a[220:223], v[140:143]
    ds_read_b64_tr_b16 a[144:145], v226 offset:4096
    s_waitcnt lgkmcnt(13)
    v_mfma_f32_16x16x32_bf16 v[132:135], a[152:155], a[224:227], v[132:135]
    ds_read_b64_tr_b16 a[146:147], v226 offset:6144
    v_add_f32 v194, v194, v189
    v_mfma_f32_16x16x32_bf16 v[132:135], a[156:159], a[232:235], v[132:135]
    ds_read_b64_tr_b16 a[148:149], v227 offset:4096
    v_add_f32 v194, v194, v190
    v_mfma_f32_16x16x32_bf16 v[140:143], a[152:155], a[228:231], v[140:143]
    ds_read_b64_tr_b16 a[150:151], v227 offset:6144
    v_cvt_pk_bf16_f32 v171, v190, v191
    v_mfma_f32_16x16x32_bf16 v[140:143], a[156:159], a[236:239], v[140:143]
    ds_read_b64_tr_b16 a[152:153], v224 offset:8192
    v_add_f32 v194, v194, v191
    v_mfma_f32_16x16x32_bf16 v[132:135], a[112:115], a[240:243], v[132:135]
    ds_read_b64_tr_b16 a[154:155], v224 offset:10240
    global_load_lds_dwordx4 v234, s[70:71] offset:2048
    v_mfma_f32_16x16x32_bf16 v[132:135], a[116:119], a[248:251], v[132:135]
    ds_read_b64_tr_b16 a[156:157], v225 offset:8192
    v_mfma_f32_16x16x32_bf16 v[140:143], a[112:115], a[244:247], v[140:143]
    ds_read_b64_tr_b16 a[158:159], v225 offset:10240
    v_mfma_f32_16x16x32_bf16 v[140:143], a[116:119], a[252:255], v[140:143]
    ds_read_b64_tr_b16 a[112:113], v226 offset:8192
    v_exp_f32 v184, v152
    s_waitcnt lgkmcnt(13)
    v_mfma_f32_16x16x32_bf16 v[0:3], a[120:123], v[160:163], v[0:3]
    ds_read_b64_tr_b16 a[114:115], v226 offset:10240
    v_mfma_f32_16x16x32_bf16 v[8:11], a[120:123], v[164:167], v[8:11]
    ds_read_b64_tr_b16 a[116:117], v227 offset:8192
    v_exp_f32 v185, v153
    v_mfma_f32_16x16x32_bf16 v[4:7], a[124:127], v[160:163], v[4:7]
    ds_read_b64_tr_b16 a[118:119], v227 offset:10240
    v_mfma_f32_16x16x32_bf16 v[12:15], a[124:127], v[164:167], v[12:15]
    ds_read_b64_tr_b16 a[120:121], v224 offset:12288
    v_exp_f32 v186, v154
    v_mfma_f32_16x16x32_bf16 v[16:19], a[128:131], v[160:163], v[16:19]
    ds_read_b64_tr_b16 a[122:123], v224 offset:14336
    global_load_lds_dwordx4 v235, s[70:71] offset:3072
    v_exp_f32 v187, v155
    v_mfma_f32_16x16x32_bf16 v[24:27], a[128:131], v[164:167], v[24:27]
    ds_read_b64_tr_b16 a[124:125], v225 offset:12288
    s_and_b32 s100, s28, 0x0fffffff
    v_add_u32 v237, s100, v244
    s_mov_b32 s100, 896
    v_mad_u32_u24 v236, v243, s100, v237
    v_mfma_f32_16x16x32_bf16 v[20:23], a[132:135], v[160:163], v[20:23]
    ds_read_b64_tr_b16 a[126:127], v225 offset:14336
    v_add_u32 v237, 6144, v236
    v_add_f32 v195, v184, v185
    v_mfma_f32_16x16x32_bf16 v[28:31], a[132:135], v[164:167], v[28:31]
    ds_read_b64_tr_b16 a[128:129], v226 offset:12288
    v_add_u32 v238, 12288, v236
    v_cvt_pk_bf16_f32 v172, v184, v185
    s_waitcnt lgkmcnt(13)
    v_mfma_f32_16x16x32_bf16 v[32:35], a[136:139], v[160:163], v[32:35]
    ds_read_b64_tr_b16 a[130:131], v226 offset:14336
    v_add_u32 v239, 18432, v236
    s_mov_b32 s73, s29
    v_mfma_f32_16x16x32_bf16 v[40:43], a[136:139], v[164:167], v[40:43]
    ds_read_b64_tr_b16 a[132:133], v227 offset:12288
    s_and_b32 s69, s28, 0xf0000000
    s_add_u32 s69, s69, s58
    v_add_f32 v195, v195, v186
    v_mfma_f32_16x16x32_bf16 v[36:39], a[140:143], v[160:163], v[36:39]
    ds_read_b64_tr_b16 a[134:135], v227 offset:14336
    s_add_u32 m0, s42, 81920
    v_mfma_f32_16x16x32_bf16 v[44:47], a[140:143], v[164:167], v[44:47]
    ds_read_b128 a[136:139], v216 offset:16384
    s_add_u32 s72, s69, 0
    global_load_lds_dwordx4 v236, s[72:73] offset:0
    v_cvt_pk_bf16_f32 v173, v186, v187
    v_mfma_f32_16x16x32_bf16 v[48:51], a[144:147], v[160:163], v[48:51]
    ds_read_b128 a[140:143], v217 offset:16384
    v_add_f32 v195, v195, v187
    v_mfma_f32_16x16x32_bf16 v[56:59], a[144:147], v[164:167], v[56:59]
    v_exp_f32 v188, v156
    v_mfma_f32_16x16x32_bf16 v[52:55], a[148:151], v[160:163], v[52:55]
    v_exp_f32 v189, v157
    v_mfma_f32_16x16x32_bf16 v[60:63], a[148:151], v[164:167], v[60:63]
    ds_read_b128 a[144:147], v218 offset:16384
    s_waitcnt lgkmcnt(11)
    v_mfma_f32_16x16x32_bf16 v[64:67], a[152:155], v[160:163], v[64:67]
    ds_read_b128 a[148:151], v219 offset:16384
    v_mfma_f32_16x16x32_bf16 v[72:75], a[152:155], v[164:167], v[72:75]
    v_exp_f32 v190, v158
    v_mfma_f32_16x16x32_bf16 v[68:71], a[156:159], v[160:163], v[68:71]
    v_exp_f32 v191, v159
    v_mfma_f32_16x16x32_bf16 v[76:79], a[156:159], v[164:167], v[76:79]
    ds_read_b128 a[152:155], v216 offset:16640
    global_load_lds_dwordx4 v237, s[72:73] offset:1024
    v_mfma_f32_16x16x32_bf16 v[80:83], a[112:115], v[160:163], v[80:83]
    ds_read_b128 a[156:159], v217 offset:16640
    v_add_f32 v195, v195, v188
    v_mfma_f32_16x16x32_bf16 v[88:91], a[112:115], v[164:167], v[88:91]
    v_cvt_pk_bf16_f32 v174, v188, v189
    v_add_f32 v195, v195, v189
    v_mfma_f32_16x16x32_bf16 v[84:87], a[116:119], v[160:163], v[84:87]
    v_add_f32 v195, v195, v190
    v_cvt_pk_bf16_f32 v175, v190, v191
    v_mfma_f32_16x16x32_bf16 v[92:95], a[116:119], v[164:167], v[92:95]
    ds_read_b128 a[112:115], v218 offset:16640
    s_waitcnt lgkmcnt(7)
    v_mfma_f32_16x16x32_bf16 v[96:99], a[120:123], v[160:163], v[96:99]
    ds_read_b128 a[116:119], v219 offset:16640
    v_add_f32 v195, v195, v191
    v_mfma_f32_16x16x32_bf16 v[104:107], a[120:123], v[164:167], v[104:107]
    v_mfma_f32_16x16x32_bf16 v[100:103], a[124:127], v[160:163], v[100:103]
    v_mfma_f32_16x16x32_bf16 v[108:111], a[124:127], v[164:167], v[108:111]
    ds_read_b128 a[120:123], v216 offset:24576
    global_load_lds_dwordx4 v238, s[72:73] offset:2048
    v_mfma_f32_16x16x32_bf16 v[112:115], a[128:131], v[160:163], v[112:115]
    ds_read_b128 a[124:127], v217 offset:24576
    v_mfma_f32_16x16x32_bf16 v[120:123], a[128:131], v[164:167], v[120:123]
    v_mfma_f32_16x16x32_bf16 v[116:119], a[132:135], v[160:163], v[116:119]
    v_mfma_f32_16x16x32_bf16 v[124:127], a[132:135], v[164:167], v[124:127]
    ds_read_b128 a[128:131], v218 offset:24576
    v_max_f32 v196, v194, v195
    v_cmp_lt_f32 vcc, s101, v196
    s_nop 3
    s_cbranch_vccnz L_slow_13
L_back_13:
    v_add_f32 v192, v192, v194
    v_add_f32 v193, v193, v195
    s_waitcnt lgkmcnt(7)
    v_mfma_f32_16x16x32_bf16 v[144:147], a[136:139], a[192:195], v[176:179]
    ds_read_b128 a[132:135], v219 offset:24576
    v_mfma_f32_16x16x32_bf16 v[144:147], a[140:143], a[200:203], v[144:147]
    v_exp_f32 v184, v128
    v_mfma_f32_16x16x32_bf16 v[152:155], a[136:139], a[196:199], v[180:183]
    v_exp_f32 v185, v129
    v_mfma_f32_16x16x32_bf16 v[152:155], a[140:143], a[204:207], v[152:155]
    ds_read_b128 a[136:139], v216 offset:24832
    global_load_lds_dwordx4 v239, s[72:73] offset:3072
    v_mfma_f32_16x16x32_bf16 v[144:147], a[144:147], a[208:211], v[144:147]
    ds_read_b128 a[140:143], v217 offset:24832
    v_mfma_f32_16x16x32_bf16 v[144:147], a[148:151], a[216:219], v[144:147]
    v_exp_f32 v186, v130
    v_mfma_f32_16x16x32_bf16 v[152:155], a[144:147], a[212:215], v[152:155]
    v_exp_f32 v187, v131
    v_mfma_f32_16x16x32_bf16 v[152:155], a[148:151], a[220:223], v[152:155]
    ds_read_b128 a[144:147], v218 offset:24832
    s_waitcnt lgkmcnt(7)
    v_mfma_f32_16x16x32_bf16 v[144:147], a[152:155], a[224:227], v[144:147]
    ds_read_b128 a[148:151], v219 offset:24832
    v_add_f32 v194, v184, v185
    v_mfma_f32_16x16x32_bf16 v[144:147], a[156:159], a[232:235], v[144:147]
    v_cvt_pk_bf16_f32 v160, v184, v185
    v_add_f32 v194, v194, v186
    v_mfma_f32_16x16x32_bf16 v[152:155], a[152:155], a[228:231], v[152:155]
    v_cvt_pk_bf16_f32 v161, v186, v187
    v_add_f32 v194, v194, v187
    v_mfma_f32_16x16x32_bf16 v[152:155], a[156:159], a[236:239], v[152:155]
    s_waitcnt vmcnt(8)
    s_barrier
    ds_read_b64_tr_b16 a[152:153], v224 offset:32768
    s_add_u32 m0, s42, 98304
    s_add_u32 s72, s69, 57344
    v_mfma_f32_16x16x32_bf16 v[144:147], a[112:115], a[240:243], v[144:147]
    ds_read_b64_tr_b16 a[154:155], v224 offset:34816
    global_load_lds_dwordx4 v236, s[72:73] offset:0
    v_mfma_f32_16x16x32_bf16 v[144:147], a[116:119], a[248:251], v[144:147]
    ds_read_b64_tr_b16 a[156:157], v225 offset:32768
    v_mfma_f32_16x16x32_bf16 v[152:155], a[112:115], a[244:247], v[152:155]
    ds_read_b64_tr_b16 a[158:159], v225 offset:34816
    v_mfma_f32_16x16x32_bf16 v[152:155], a[116:119], a[252:255], v[152:155]
    ds_read_b64_tr_b16 a[112:113], v226 offset:32768
    s_waitcnt lgkmcnt(9)
    v_mfma_f32_16x16x32_bf16 v[148:151], a[120:123], a[192:195], v[176:179]
    ds_read_b64_tr_b16 a[114:115], v226 offset:34816
    v_exp_f32 v188, v132
    v_mfma_f32_16x16x32_bf16 v[148:151], a[124:127], a[200:203], v[148:151]
    ds_read_b64_tr_b16 a[116:117], v227 offset:32768
    v_exp_f32 v189, v133
    v_mfma_f32_16x16x32_bf16 v[156:159], a[120:123], a[196:199], v[180:183]
    ds_read_b64_tr_b16 a[118:119], v227 offset:34816
    v_mfma_f32_16x16x32_bf16 v[156:159], a[124:127], a[204:207], v[156:159]
    ds_read_b64_tr_b16 a[120:121], v224 offset:36864
    v_exp_f32 v190, v134
    v_mfma_f32_16x16x32_bf16 v[148:151], a[128:131], a[208:211], v[148:151]
    ds_read_b64_tr_b16 a[122:123], v224 offset:38912
    global_load_lds_dwordx4 v237, s[72:73] offset:1024
    v_exp_f32 v191, v135
    v_mfma_f32_16x16x32_bf16 v[148:151], a[132:135], a[216:219], v[148:151]
    ds_read_b64_tr_b16 a[124:125], v225 offset:36864
    v_add_f32 v194, v194, v188
    v_mfma_f32_16x16x32_bf16 v[156:159], a[128:131], a[212:215], v[156:159]
    ds_read_b64_tr_b16 a[126:127], v225 offset:38912
    v_cvt_pk_bf16_f32 v162, v188, v189
    v_mfma_f32_16x16x32_bf16 v[156:159], a[132:135], a[220:223], v[156:159]
    ds_read_b64_tr_b16 a[128:129], v226 offset:36864
    s_waitcnt lgkmcnt(13)
    v_mfma_f32_16x16x32_bf16 v[148:151], a[136:139], a[224:227], v[148:151]
    ds_read_b64_tr_b16 a[130:131], v226 offset:38912
    v_add_f32 v194, v194, v189
    v_mfma_f32_16x16x32_bf16 v[148:151], a[140:143], a[232:235], v[148:151]
    ds_read_b64_tr_b16 a[132:133], v227 offset:36864
    v_add_f32 v194, v194, v190
    v_mfma_f32_16x16x32_bf16 v[156:159], a[136:139], a[228:231], v[156:159]
    ds_read_b64_tr_b16 a[134:135], v227 offset:38912
    v_cvt_pk_bf16_f32 v163, v190, v191
    v_mfma_f32_16x16x32_bf16 v[156:159], a[140:143], a[236:239], v[156:159]
    ds_read_b64_tr_b16 a[136:137], v224 offset:40960
    v_add_f32 v194, v194, v191
    v_mfma_f32_16x16x32_bf16 v[148:151], a[144:147], a[240:243], v[148:151]
    ds_read_b64_tr_b16 a[138:139], v224 offset:43008
    global_load_lds_dwordx4 v238, s[72:73] offset:2048
    v_mfma_f32_16x16x32_bf16 v[148:151], a[148:151], a[248:251], v[148:151]
    ds_read_b64_tr_b16 a[140:141], v225 offset:40960
    v_mfma_f32_16x16x32_bf16 v[156:159], a[144:147], a[244:247], v[156:159]
    ds_read_b64_tr_b16 a[142:143], v225 offset:43008
    v_mfma_f32_16x16x32_bf16 v[156:159], a[148:151], a[252:255], v[156:159]
    ds_read_b64_tr_b16 a[144:145], v226 offset:40960
    v_exp_f32 v184, v136
    s_waitcnt lgkmcnt(13)
    v_mfma_f32_16x16x32_bf16 v[0:3], a[152:155], v[168:171], v[0:3]
    ds_read_b64_tr_b16 a[146:147], v226 offset:43008
    v_mfma_f32_16x16x32_bf16 v[8:11], a[152:155], v[172:175], v[8:11]
    ds_read_b64_tr_b16 a[148:149], v227 offset:40960
    v_exp_f32 v185, v137
    v_mfma_f32_16x16x32_bf16 v[4:7], a[156:159], v[168:171], v[4:7]
    ds_read_b64_tr_b16 a[150:151], v227 offset:43008
    v_mfma_f32_16x16x32_bf16 v[12:15], a[156:159], v[172:175], v[12:15]
    ds_read_b64_tr_b16 a[152:153], v224 offset:45056
    v_exp_f32 v186, v138
    v_mfma_f32_16x16x32_bf16 v[16:19], a[112:115], v[168:171], v[16:19]
    ds_read_b64_tr_b16 a[154:155], v224 offset:47104
    global_load_lds_dwordx4 v239, s[72:73] offset:3072
    v_exp_f32 v187, v139
    v_mfma_f32_16x16x32_bf16 v[24:27], a[112:115], v[172:175], v[24:27]
    ds_read_b64_tr_b16 a[156:157], v225 offset:45056
    v_add_f32 v195, v184, v185
    v_mfma_f32_16x16x32_bf16 v[20:23], a[116:119], v[168:171], v[20:23]
    ds_read_b64_tr_b16 a[158:159], v225 offset:47104
    s_add_u32 m0, s42, 114688
    v_mfma_f32_16x16x32_bf16 v[28:31], a[116:119], v[172:175], v[28:31]
    ds_read_b64_tr_b16 a[112:113], v226 offset:45056
    v_cvt_pk_bf16_f32 v164, v184, v185
    s_waitcnt lgkmcnt(13)
    v_mfma_f32_16x16x32_bf16 v[32:35], a[120:123], v[168:171], v[32:35]
    ds_read_b64_tr_b16 a[114:115], v226 offset:47104
    v_add_f32 v195, v195, v186
    v_mfma_f32_16x16x32_bf16 v[40:43], a[120:123], v[172:175], v[40:43]
    ds_read_b64_tr_b16 a[116:117], v227 offset:45056
    s_add_u32 s72, s69, 114688
    v_mfma_f32_16x16x32_bf16 v[36:39], a[124:127], v[168:171], v[36:39]
    ds_read_b64_tr_b16 a[118:119], v227 offset:47104
    v_cvt_pk_bf16_f32 v165, v186, v187
    v_mfma_f32_16x16x32_bf16 v[44:47], a[124:127], v[172:175], v[44:47]
    ds_read_b64_tr_b16 a[120:121], v224 offset:49152
    global_load_lds_dwordx4 v236, s[72:73] offset:0
    v_mfma_f32_16x16x32_bf16 v[48:51], a[128:131], v[168:171], v[48:51]
    ds_read_b64_tr_b16 a[122:123], v224 offset:51200
    v_add_f32 v195, v195, v187
    v_mfma_f32_16x16x32_bf16 v[56:59], a[128:131], v[172:175], v[56:59]
    ds_read_b64_tr_b16 a[124:125], v225 offset:49152
    v_mfma_f32_16x16x32_bf16 v[52:55], a[132:135], v[168:171], v[52:55]
    ds_read_b64_tr_b16 a[126:127], v225 offset:51200
    v_exp_f32 v188, v140
    v_mfma_f32_16x16x32_bf16 v[60:63], a[132:135], v[172:175], v[60:63]
    ds_read_b64_tr_b16 a[128:129], v226 offset:49152
    v_exp_f32 v189, v141
    s_waitcnt lgkmcnt(13)
    v_mfma_f32_16x16x32_bf16 v[64:67], a[136:139], v[168:171], v[64:67]
    ds_read_b64_tr_b16 a[130:131], v226 offset:51200
    v_mfma_f32_16x16x32_bf16 v[72:75], a[136:139], v[172:175], v[72:75]
    ds_read_b64_tr_b16 a[132:133], v227 offset:49152
    v_exp_f32 v190, v142
    v_mfma_f32_16x16x32_bf16 v[68:71], a[140:143], v[168:171], v[68:71]
    ds_read_b64_tr_b16 a[134:135], v227 offset:51200
    v_exp_f32 v191, v143
    v_mfma_f32_16x16x32_bf16 v[76:79], a[140:143], v[172:175], v[76:79]
    ds_read_b64_tr_b16 a[136:137], v224 offset:53248
    global_load_lds_dwordx4 v237, s[72:73] offset:1024
    v_mfma_f32_16x16x32_bf16 v[80:83], a[144:147], v[168:171], v[80:83]
    ds_read_b64_tr_b16 a[138:139], v224 offset:55296
    v_add_f32 v195, v195, v188
    v_mfma_f32_16x16x32_bf16 v[88:91], a[144:147], v[172:175], v[88:91]
    ds_read_b64_tr_b16 a[140:141], v225 offset:53248
    v_cvt_pk_bf16_f32 v166, v188, v189
    v_mfma_f32_16x16x32_bf16 v[84:87], a[148:151], v[168:171], v[84:87]
    ds_read_b64_tr_b16 a[142:143], v225 offset:55296
    v_add_f32 v195, v195, v189
    v_mfma_f32_16x16x32_bf16 v[92:95], a[148:151], v[172:175], v[92:95]
    ds_read_b64_tr_b16 a[144:145], v226 offset:53248
    s_waitcnt lgkmcnt(13)
    v_mfma_f32_16x16x32_bf16 v[96:99], a[152:155], v[168:171], v[96:99]
    ds_read_b64_tr_b16 a[146:147], v226 offset:55296
    v_add_f32 v195, v195, v190
    v_mfma_f32_16x16x32_bf16 v[104:107], a[152:155], v[172:175], v[104:107]
    ds_read_b64_tr_b16 a[148:149], v227 offset:53248
    v_cvt_pk_bf16_f32 v167, v190, v191
    v_mfma_f32_16x16x32_bf16 v[100:103], a[156:159], v[168:171], v[100:103]
    ds_read_b64_tr_b16 a[150:151], v227 offset:55296
    v_add_f32 v195, v195, v191
    v_mfma_f32_16x16x32_bf16 v[108:111], a[156:159], v[172:175], v[108:111]
    ds_read_b64_tr_b16 a[152:153], v224 offset:57344
    global_load_lds_dwordx4 v238, s[72:73] offset:2048
    v_mfma_f32_16x16x32_bf16 v[112:115], a[112:115], v[168:171], v[112:115]
    ds_read_b64_tr_b16 a[154:155], v224 offset:59392
    v_mfma_f32_16x16x32_bf16 v[120:123], a[112:115], v[172:175], v[120:123]
    ds_read_b64_tr_b16 a[156:157], v225 offset:57344
    v_mfma_f32_16x16x32_bf16 v[116:119], a[116:119], v[168:171], v[116:119]
    ds_read_b64_tr_b16 a[158:159], v225 offset:59392
    v_mfma_f32_16x16x32_bf16 v[124:127], a[116:119], v[172:175], v[124:127]
    ds_read_b64_tr_b16 a[112:113], v226 offset:57344
    v_max_f32 v196, v194, v195
    v_cmp_lt_f32 vcc, s101, v196
    s_nop 3
    s_cbranch_vccnz L_slow_14
L_back_14:
    v_add_f32 v192, v192, v194
    v_add_f32 v193, v193, v195
    s_waitcnt lgkmcnt(13)
    v_mfma_f32_16x16x32_bf16 v[0:3], a[120:123], v[160:163], v[0:3]
    ds_read_b64_tr_b16 a[114:115], v226 offset:59392
    v_mfma_f32_16x16x32_bf16 v[8:11], a[120:123], v[164:167], v[8:11]
    ds_read_b64_tr_b16 a[116:117], v227 offset:57344
    v_exp_f32 v184, v144
    v_mfma_f32_16x16x32_bf16 v[4:7], a[124:127], v[160:163], v[4:7]
    ds_read_b64_tr_b16 a[118:119], v227 offset:59392
    v_exp_f32 v185, v145
    v_mfma_f32_16x16x32_bf16 v[12:15], a[124:127], v[164:167], v[12:15]
    ds_read_b64_tr_b16 a[120:121], v224 offset:61440
    global_load_lds_dwordx4 v239, s[72:73] offset:3072
    v_exp_f32 v186, v146
    v_mfma_f32_16x16x32_bf16 v[16:19], a[128:131], v[160:163], v[16:19]
    ds_read_b64_tr_b16 a[122:123], v224 offset:63488
    v_exp_f32 v187, v147
    v_add_f32 v194, v184, v185
    v_mfma_f32_16x16x32_bf16 v[24:27], a[128:131], v[164:167], v[24:27]
    ds_read_b64_tr_b16 a[124:125], v225 offset:61440
    v_cvt_pk_bf16_f32 v168, v184, v185
    v_mfma_f32_16x16x32_bf16 v[20:23], a[132:135], v[160:163], v[20:23]
    ds_read_b64_tr_b16 a[126:127], v225 offset:63488
    v_add_f32 v194, v194, v186
    v_mfma_f32_16x16x32_bf16 v[28:31], a[132:135], v[164:167], v[28:31]
    ds_read_b64_tr_b16 a[128:129], v226 offset:61440
    v_cvt_pk_bf16_f32 v169, v186, v187
    v_add_f32 v194, v194, v187
    s_waitcnt lgkmcnt(13)
    v_mfma_f32_16x16x32_bf16 v[32:35], a[136:139], v[160:163], v[32:35]
    ds_read_b64_tr_b16 a[130:131], v226 offset:63488
    v_exp_f32 v188, v148
    v_mfma_f32_16x16x32_bf16 v[40:43], a[136:139], v[164:167], v[40:43]
    ds_read_b64_tr_b16 a[132:133], v227 offset:61440
    v_exp_f32 v189, v149
    v_mfma_f32_16x16x32_bf16 v[36:39], a[140:143], v[160:163], v[36:39]
    ds_read_b64_tr_b16 a[134:135], v227 offset:63488
    v_exp_f32 v190, v150
    v_exp_f32 v191, v151
    v_mfma_f32_16x16x32_bf16 v[44:47], a[140:143], v[164:167], v[44:47]
    s_waitcnt vmcnt(12)
    s_barrier
    ds_read_b64_tr_b16 a[136:137], v228 offset:0
    s_add_u32 m0, s42, 0
    s_add_u32 s72, s69, 172032
    v_add_f32 v194, v194, v188
    v_mfma_f32_16x16x32_bf16 v[48:51], a[144:147], v[160:163], v[48:51]
    ds_read_b64_tr_b16 a[138:139], v228 offset:2048
    global_load_lds_dwordx4 v236, s[72:73] offset:0
    v_cvt_pk_bf16_f32 v170, v188, v189
    v_mfma_f32_16x16x32_bf16 v[56:59], a[144:147], v[164:167], v[56:59]
    ds_read_b64_tr_b16 a[140:141], v229 offset:0
    v_add_f32 v194, v194, v189
    v_add_f32 v194, v194, v190
    v_mfma_f32_16x16x32_bf16 v[52:55], a[148:151], v[160:163], v[52:55]
    ds_read_b64_tr_b16 a[142:143], v229 offset:2048
    v_cvt_pk_bf16_f32 v171, v190, v191
    v_mfma_f32_16x16x32_bf16 v[60:63], a[148:151], v[164:167], v[60:63]
    ds_read_b64_tr_b16 a[144:145], v230 offset:0
    v_add_f32 v194, v194, v191
    v_exp_f32 v184, v152
    s_waitcnt lgkmcnt(13)
    v_mfma_f32_16x16x32_bf16 v[64:67], a[152:155], v[160:163], v[64:67]
    ds_read_b64_tr_b16 a[146:147], v230 offset:2048
    global_load_lds_dwordx4 v237, s[72:73] offset:1024
    v_exp_f32 v185, v153
    v_mfma_f32_16x16x32_bf16 v[72:75], a[152:155], v[164:167], v[72:75]
    ds_read_b64_tr_b16 a[148:149], v231 offset:0
    v_exp_f32 v186, v154
    v_mfma_f32_16x16x32_bf16 v[68:71], a[156:159], v[160:163], v[68:71]
    ds_read_b64_tr_b16 a[150:151], v231 offset:2048
    v_exp_f32 v187, v155
    v_add_f32 v195, v184, v185
    v_mfma_f32_16x16x32_bf16 v[76:79], a[156:159], v[164:167], v[76:79]
    ds_read_b64_tr_b16 a[152:153], v228 offset:4096
    v_cvt_pk_bf16_f32 v172, v184, v185
    v_mfma_f32_16x16x32_bf16 v[80:83], a[112:115], v[160:163], v[80:83]
    ds_read_b64_tr_b16 a[154:155], v228 offset:6144
    global_load_lds_dwordx4 v238, s[72:73] offset:2048
    v_add_f32 v195, v195, v186
    v_mfma_f32_16x16x32_bf16 v[88:91], a[112:115], v[164:167], v[88:91]
    ds_read_b64_tr_b16 a[156:157], v229 offset:4096
    v_cvt_pk_bf16_f32 v173, v186, v187
    v_add_f32 v195, v195, v187
    v_mfma_f32_16x16x32_bf16 v[84:87], a[116:119], v[160:163], v[84:87]
    ds_read_b64_tr_b16 a[158:159], v229 offset:6144
    v_exp_f32 v188, v156
    v_mfma_f32_16x16x32_bf16 v[92:95], a[116:119], v[164:167], v[92:95]
    ds_read_b64_tr_b16 a[112:113], v230 offset:4096
    v_exp_f32 v189, v157
    s_waitcnt lgkmcnt(13)
    v_mfma_f32_16x16x32_bf16 v[96:99], a[120:123], v[160:163], v[96:99]
    ds_read_b64_tr_b16 a[114:115], v230 offset:6144
    global_load_lds_dwordx4 v239, s[72:73] offset:3072
    v_exp_f32 v190, v158
    v_exp_f32 v191, v159
    v_mfma_f32_16x16x32_bf16 v[104:107], a[120:123], v[164:167], v[104:107]
    ds_read_b64_tr_b16 a[116:117], v231 offset:4096
    s_and_b32 s69, s28, 0xf0000000
    s_add_u32 s69, s69, s61
    v_add_f32 v195, v195, v188
    v_mfma_f32_16x16x32_bf16 v[100:103], a[124:127], v[160:163], v[100:103]
    ds_read_b64_tr_b16 a[118:119], v231 offset:6144
    s_add_u32 m0, s42, 16384
    v_cvt_pk_bf16_f32 v174, v188, v189
    v_mfma_f32_16x16x32_bf16 v[108:111], a[124:127], v[164:167], v[108:111]
    ds_read_b64_tr_b16 a[120:121], v228 offset:8192
    s_add_u32 s72, s69, 0
    global_load_lds_dwordx4 v236, s[72:73] offset:0
    v_add_f32 v195, v195, v189
    v_add_f32 v195, v195, v190
    v_mfma_f32_16x16x32_bf16 v[112:115], a[128:131], v[160:163], v[112:115]
    ds_read_b64_tr_b16 a[122:123], v228 offset:10240
    v_cvt_pk_bf16_f32 v175, v190, v191
    v_mfma_f32_16x16x32_bf16 v[120:123], a[128:131], v[164:167], v[120:123]
    ds_read_b64_tr_b16 a[124:125], v229 offset:8192
    v_add_f32 v195, v195, v191
    v_mfma_f32_16x16x32_bf16 v[116:119], a[132:135], v[160:163], v[116:119]
    ds_read_b64_tr_b16 a[126:127], v229 offset:10240
    v_mfma_f32_16x16x32_bf16 v[124:127], a[132:135], v[164:167], v[124:127]
    ds_read_b64_tr_b16 a[128:129], v230 offset:8192
    global_load_lds_dwordx4 v237, s[72:73] offset:1024
    v_max_f32 v196, v194, v195
    v_cmp_lt_f32 vcc, s101, v196
    s_nop 3
    s_cbranch_vccnz L_slow_15
L_back_15:
    v_add_f32 v192, v192, v194
    v_add_f32 v193, v193, v195
    s_waitcnt lgkmcnt(13)
    v_mfma_f32_16x16x32_bf16 v[0:3], a[136:139], v[168:171], v[0:3]
    ds_read_b64_tr_b16 a[130:131], v230 offset:10240
    v_mov_b32 v184, v192
    v_mfma_f32_16x16x32_bf16 v[8:11], a[136:139], v[172:175], v[8:11]
    ds_read_b64_tr_b16 a[132:133], v231 offset:8192
    v_mov_b32 v185, v193
    s_nop 0
    v_mfma_f32_16x16x32_bf16 v[4:7], a[140:143], v[168:171], v[4:7]
    ds_read_b64_tr_b16 a[134:135], v231 offset:10240
    s_nop 0
    v_permlane16_swap_b32 v192, v184
    v_mfma_f32_16x16x32_bf16 v[12:15], a[140:143], v[172:175], v[12:15]
    ds_read_b64_tr_b16 a[136:137], v228 offset:12288
    global_load_lds_dwordx4 v238, s[72:73] offset:2048
    v_permlane16_swap_b32 v193, v185
    s_nop 0
    v_mfma_f32_16x16x32_bf16 v[16:19], a[144:147], v[168:171], v[16:19]
    ds_read_b64_tr_b16 a[138:139], v228 offset:14336
    s_nop 0
    v_add_f32 v192, v192, v184
    v_mfma_f32_16x16x32_bf16 v[24:27], a[144:147], v[172:175], v[24:27]
    ds_read_b64_tr_b16 a[140:141], v229 offset:12288
    v_add_f32 v193, v193, v185
    v_mov_b32 v184, v192
    v_mov_b32 v185, v193
    v_mfma_f32_16x16x32_bf16 v[20:23], a[148:151], v[168:171], v[20:23]
    ds_read_b64_tr_b16 a[142:143], v229 offset:14336
    s_nop 0
    s_nop 0
    v_mfma_f32_16x16x32_bf16 v[28:31], a[148:151], v[172:175], v[28:31]
    ds_read_b64_tr_b16 a[144:145], v230 offset:12288
    global_load_lds_dwordx4 v239, s[72:73] offset:3072
    v_permlane32_swap_b32 v192, v184
    v_permlane32_swap_b32 v193, v185
    s_waitcnt lgkmcnt(13)
    v_mfma_f32_16x16x32_bf16 v[32:35], a[152:155], v[168:171], v[32:35]
    ds_read_b64_tr_b16 a[146:147], v230 offset:14336
    s_nop 0
    s_nop 0
    v_mfma_f32_16x16x32_bf16 v[40:43], a[152:155], v[172:175], v[40:43]
    ds_read_b64_tr_b16 a[148:149], v231 offset:12288
    v_add_f32 v192, v192, v184
    v_add_f32 v193, v193, v185
    v_mfma_f32_16x16x32_bf16 v[36:39], a[156:159], v[168:171], v[36:39]
    ds_read_b64_tr_b16 a[150:151], v231 offset:14336
    v_rcp_f32 v234, v192
    v_rcp_f32 v235, v193
    v_mfma_f32_16x16x32_bf16 v[44:47], a[156:159], v[172:175], v[44:47]
    s_waitcnt vmcnt(12)
    s_barrier
    ds_read_b64_tr_b16 a[152:153], v204 offset:16384
    s_add_u32 m0, s42, 32768
    s_add_u32 s72, s69, 57344
    v_mfma_f32_16x16x32_bf16 v[48:51], a[112:115], v[168:171], v[48:51]
    ds_read_b64_tr_b16 a[154:155], v204 offset:18432
    global_load_lds_dwordx4 v236, s[72:73] offset:0
    v_mul_f32 v184, v0, v234
    v_mfma_f32_16x16x32_bf16 v[56:59], a[112:115], v[172:175], v[56:59]
    ds_read_b64_tr_b16 a[156:157], v204 offset:20480
    v_mul_f32 v185, v1, v234
    v_mul_f32 v186, v2, v234
    v_mul_f32 v187, v3, v234
    v_mul_f32 v188, v4, v234
    v_mfma_f32_16x16x32_bf16 v[52:55], a[116:119], v[168:171], v[52:55]
    ds_read_b64_tr_b16 a[158:159], v204 offset:22528
    v_mul_f32 v189, v5, v234
    v_mul_f32 v190, v6, v234
    v_mul_f32 v191, v7, v234
    v_cvt_pk_bf16_f32 v0, v184, v185
    v_mfma_f32_16x16x32_bf16 v[60:63], a[116:119], v[172:175], v[60:63]
    ds_read_b64_tr_b16 a[112:113], v205 offset:16384
    v_cvt_pk_bf16_f32 v1, v186, v187
    v_cvt_pk_bf16_f32 v2, v188, v189
    v_cvt_pk_bf16_f32 v3, v190, v191
    ds_write_b128 v245, v[0:3] offset:0
    s_waitcnt lgkmcnt(14)
    v_mfma_f32_16x16x32_bf16 v[64:67], a[120:123], v[168:171], v[64:67]
    ds_read_b64_tr_b16 a[114:115], v205 offset:18432
    global_load_lds_dwordx4 v237, s[72:73] offset:1024
    v_mul_f32 v184, v8, v235
    v_mul_f32 v185, v9, v235
    v_mul_f32 v186, v10, v235
    v_mul_f32 v187, v11, v235
    v_mfma_f32_16x16x32_bf16 v[72:75], a[120:123], v[172:175], v[72:75]
    ds_read_b64_tr_b16 a[116:117], v205 offset:20480
    v_mul_f32 v188, v12, v235
    v_mul_f32 v189, v13, v235
    v_mul_f32 v190, v14, v235
    v_mul_f32 v191, v15, v235
    v_mfma_f32_16x16x32_bf16 v[68:71], a[124:127], v[168:171], v[68:71]
    ds_read_b64_tr_b16 a[118:119], v205 offset:22528
    v_cvt_pk_bf16_f32 v8, v184, v185
    v_cvt_pk_bf16_f32 v9, v186, v187
    v_cvt_pk_bf16_f32 v10, v188, v189
    v_cvt_pk_bf16_f32 v11, v190, v191
    ds_write_b128 v245, v[8:11] offset:1024
    v_mfma_f32_16x16x32_bf16 v[76:79], a[124:127], v[172:175], v[76:79]
    ds_read_b64_tr_b16 a[120:121], v206 offset:16384
    v_mul_f32 v184, v16, v234
    v_mul_f32 v185, v17, v234
    v_mul_f32 v186, v18, v234
    v_mul_f32 v187, v19, v234
    v_mfma_f32_16x16x32_bf16 v[80:83], a[128:131], v[168:171], v[80:83]
    ds_read_b64_tr_b16 a[122:123], v206 offset:18432
    global_load_lds_dwordx4 v238, s[72:73] offset:2048
    v_mul_f32 v188, v20, v234
    v_mul_f32 v189, v21, v234
    v_mul_f32 v190, v22, v234
    v_mul_f32 v191, v23, v234
    v_mfma_f32_16x16x32_bf16 v[88:91], a[128:131], v[172:175], v[88:91]
    ds_read_b64_tr_b16 a[124:125], v206 offset:20480
    v_cvt_pk_bf16_f32 v16, v184, v185
    v_cvt_pk_bf16_f32 v17, v186, v187
    v_cvt_pk_bf16_f32 v18, v188, v189
    v_cvt_pk_bf16_f32 v19, v190, v191
    v_mfma_f32_16x16x32_bf16 v[84:87], a[132:135], v[168:171], v[84:87]
    ds_read_b64_tr_b16 a[126:127], v206 offset:22528
    ds_write_b128 v245, v[16:19] offset:2048
    v_mul_f32 v184, v24, v235
    v_mul_f32 v185, v25, v235
    v_mul_f32 v186, v26, v235
    v_mfma_f32_16x16x32_bf16 v[92:95], a[132:135], v[172:175], v[92:95]
    ds_read_b64_tr_b16 a[128:129], v207 offset:16384
    v_mul_f32 v187, v27, v235
    v_mul_f32 v188, v28, v235
    v_mul_f32 v189, v29, v235
    v_mul_f32 v190, v30, v235
    s_waitcnt lgkmcnt(15)
    v_mfma_f32_16x16x32_bf16 v[96:99], a[136:139], v[168:171], v[96:99]
    ds_read_b64_tr_b16 a[130:131], v207 offset:18432
    global_load_lds_dwordx4 v239, s[72:73] offset:3072
    v_mul_f32 v191, v31, v235
    v_cvt_pk_bf16_f32 v24, v184, v185
    v_cvt_pk_bf16_f32 v25, v186, v187
    v_cvt_pk_bf16_f32 v26, v188, v189
    v_cvt_pk_bf16_f32 v27, v190, v191
    v_mfma_f32_16x16x32_bf16 v[104:107], a[136:139], v[172:175], v[104:107]
    ds_read_b64_tr_b16 a[132:133], v207 offset:20480
    s_add_u32 m0, s42, 49152
    ds_write_b128 v245, v[24:27] offset:3072
    v_mul_f32 v184, v32, v234
    v_mul_f32 v185, v33, v234
    v_mul_f32 v186, v34, v234
    v_mfma_f32_16x16x32_bf16 v[100:103], a[140:143], v[168:171], v[100:103]
    ds_read_b64_tr_b16 a[134:135], v207 offset:22528
    s_add_u32 s72, s69, 114688
    v_mul_f32 v187, v35, v234
    v_mul_f32 v188, v36, v234
    v_mul_f32 v189, v37, v234
    v_mul_f32 v190, v38, v234
    v_mfma_f32_16x16x32_bf16 v[108:111], a[140:143], v[172:175], v[108:111]
    ds_read_b64_tr_b16 a[136:137], v204 offset:32768
    global_load_lds_dwordx4 v236, s[72:73] offset:0
    v_mul_f32 v191, v39, v234
    v_cvt_pk_bf16_f32 v32, v184, v185
    v_cvt_pk_bf16_f32 v33, v186, v187
    v_cvt_pk_bf16_f32 v34, v188, v189
    v_mfma_f32_16x16x32_bf16 v[112:115], a[144:147], v[168:171], v[112:115]
    ds_read_b64_tr_b16 a[138:139], v204 offset:34816
    v_cvt_pk_bf16_f32 v35, v190, v191
    ds_write_b128 v245, v[32:35] offset:4096
    v_mul_f32 v184, v40, v235
    v_mul_f32 v185, v41, v235
    v_mfma_f32_16x16x32_bf16 v[120:123], a[144:147], v[172:175], v[120:123]
    ds_read_b64_tr_b16 a[140:141], v204 offset:36864
    v_mul_f32 v186, v42, v235
    v_mul_f32 v187, v43, v235
    v_mul_f32 v188, v44, v235
    v_mul_f32 v189, v45, v235
    v_mfma_f32_16x16x32_bf16 v[116:119], a[148:151], v[168:171], v[116:119]
    ds_read_b64_tr_b16 a[142:143], v204 offset:38912
    v_mul_f32 v190, v46, v235
    v_mul_f32 v191, v47, v235
    v_cvt_pk_bf16_f32 v40, v184, v185
    v_cvt_pk_bf16_f32 v41, v186, v187
    v_cvt_pk_bf16_f32 v42, v188, v189
    v_mfma_f32_16x16x32_bf16 v[124:127], a[148:151], v[172:175], v[124:127]
    ds_read_b64_tr_b16 a[144:145], v205 offset:32768
    global_load_lds_dwordx4 v237, s[72:73] offset:1024
    v_cvt_pk_bf16_f32 v43, v190, v191
    ds_write_b128 v245, v[40:43] offset:5120
    v_mul_f32 v184, v48, v234
    v_mul_f32 v185, v49, v234
    s_waitcnt lgkmcnt(15)
    v_mfma_f32_16x16x32_bf16 v[128:131], a[152:155], v[0:3], 0
    ds_read_b64_tr_b16 a[146:147], v205 offset:34816
    v_mul_f32 v186, v50, v234
    v_mul_f32 v187, v51, v234
    v_mul_f32 v188, v52, v234
    v_mul_f32 v189, v53, v234
    v_mfma_f32_16x16x32_bf16 v[128:131], a[156:159], v[16:19], v[128:131]
    ds_read_b64_tr_b16 a[148:149], v205 offset:36864
    v_mul_f32 v190, v54, v234
    v_mul_f32 v191, v55, v234
    v_cvt_pk_bf16_f32 v48, v184, v185
    v_cvt_pk_bf16_f32 v49, v186, v187
    v_mfma_f32_16x16x32_bf16 v[132:135], a[152:155], v[8:11], 0
    ds_read_b64_tr_b16 a[150:151], v205 offset:38912
    v_cvt_pk_bf16_f32 v50, v188, v189
    v_cvt_pk_bf16_f32 v51, v190, v191
    ds_write_b128 v245, v[48:51] offset:6144
    v_mul_f32 v184, v56, v235
    v_mfma_f32_16x16x32_bf16 v[132:135], a[156:159], v[24:27], v[132:135]
    ds_read_b64_tr_b16 a[152:153], v206 offset:32768
    global_load_lds_dwordx4 v238, s[72:73] offset:2048
    v_mul_f32 v185, v57, v235
    v_mul_f32 v186, v58, v235
    v_mul_f32 v187, v59, v235
    v_mul_f32 v188, v60, v235
    v_mfma_f32_16x16x32_bf16 v[136:139], a[112:115], v[0:3], 0
    ds_read_b64_tr_b16 a[154:155], v206 offset:34816
    v_mul_f32 v189, v61, v235
    v_mul_f32 v190, v62, v235
    v_mul_f32 v191, v63, v235
    v_cvt_pk_bf16_f32 v56, v184, v185
    v_cvt_pk_bf16_f32 v57, v186, v187
    v_mfma_f32_16x16x32_bf16 v[136:139], a[116:119], v[16:19], v[136:139]
    ds_read_b64_tr_b16 a[156:157], v206 offset:36864
    v_cvt_pk_bf16_f32 v58, v188, v189
    v_cvt_pk_bf16_f32 v59, v190, v191
    ds_write_b128 v245, v[56:59] offset:7168
    v_mul_f32 v184, v64, v234
    v_mfma_f32_16x16x32_bf16 v[140:143], a[112:115], v[8:11], 0
    ds_read_b64_tr_b16 a[158:159], v206 offset:38912
    v_mul_f32 v185, v65, v234
    v_mul_f32 v186, v66, v234
    v_mul_f32 v187, v67, v234
    v_mul_f32 v188, v68, v234
    v_mfma_f32_16x16x32_bf16 v[140:143], a[116:119], v[24:27], v[140:143]
    ds_read_b64_tr_b16 a[112:113], v207 offset:32768
    global_load_lds_dwordx4 v239, s[72:73] offset:3072
    v_mul_f32 v189, v69, v234
    v_mul_f32 v190, v70, v234
    v_mul_f32 v191, v71, v234
    v_cvt_pk_bf16_f32 v64, v184, v185
    s_waitcnt lgkmcnt(15)
    v_mfma_f32_16x16x32_bf16 v[144:147], a[120:123], v[0:3], 0
    ds_read_b64_tr_b16 a[114:115], v207 offset:34816
    v_cvt_pk_bf16_f32 v65, v186, v187
    v_cvt_pk_bf16_f32 v66, v188, v189
    v_cvt_pk_bf16_f32 v67, v190, v191
    v_mul_f32 v184, v72, v235
    v_mfma_f32_16x16x32_bf16 v[144:147], a[124:127], v[16:19], v[144:147]
    ds_read_b64_tr_b16 a[116:117], v207 offset:36864
    v_mul_f32 v185, v73, v235
    v_mul_f32 v186, v74, v235
    v_mul_f32 v187, v75, v235
    v_mul_f32 v188, v76, v235
    v_mfma_f32_16x16x32_bf16 v[148:151], a[120:123], v[8:11], 0
    ds_read_b64_tr_b16 a[118:119], v207 offset:38912
    v_mul_f32 v189, v77, v235
    v_mul_f32 v190, v78, v235
    v_mul_f32 v191, v79, v235
    v_cvt_pk_bf16_f32 v72, v184, v185
    v_cvt_pk_bf16_f32 v73, v186, v187
    v_mfma_f32_16x16x32_bf16 v[148:151], a[124:127], v[24:27], v[148:151]
    s_waitcnt lgkmcnt(5)
    s_waitcnt vmcnt(12)
    s_barrier
    ds_read_b64_tr_b16 a[120:121], v204 offset:49152
    ds_read_b128 a[192:195], v246 offset:0
    s_add_u32 m0, s42, 65536
    s_add_u32 s72, s69, 172032
    v_cvt_pk_bf16_f32 v74, v188, v189
    v_cvt_pk_bf16_f32 v75, v190, v191
    v_mul_f32 v184, v80, v234
    v_mul_f32 v185, v81, v234
    v_mfma_f32_16x16x32_bf16 v[152:155], a[128:131], v[0:3], 0
    ds_read_b64_tr_b16 a[122:123], v204 offset:51200
    ds_read_b128 a[196:199], v246 offset:1024
    global_load_lds_dwordx4 v236, s[72:73] offset:0
    v_mul_f32 v186, v82, v234
    v_mul_f32 v187, v83, v234
    v_mul_f32 v188, v84, v234
    v_mul_f32 v189, v85, v234
    v_mfma_f32_16x16x32_bf16 v[152:155], a[132:135], v[16:19], v[152:155]
    ds_read_b64_tr_b16 a[124:125], v204 offset:53248
    ds_read_b128 a[200:203], v246 offset:2048
    v_mul_f32 v190, v86, v234
    v_mul_f32 v191, v87, v234
    v_cvt_pk_bf16_f32 v80, v184, v185
    v_cvt_pk_bf16_f32 v81, v186, v187
    v_mfma_f32_16x16x32_bf16 v[156:159], a[128:131], v[8:11], 0
    ds_read_b64_tr_b16 a[126:127], v204 offset:55296
    ds_read_b128 a[204:207], v246 offset:3072
    v_cvt_pk_bf16_f32 v82, v188, v189
    v_cvt_pk_bf16_f32 v83, v190, v191
    v_mul_f32 v184, v88, v235
    v_mul_f32 v185, v89, v235
    v_mfma_f32_16x16x32_bf16 v[156:159], a[132:135], v[24:27], v[156:159]
    ds_read_b64_tr_b16 a[128:129], v205 offset:49152
    v_mul_f32 v186, v90, v235
    v_mul_f32 v187, v91, v235
    v_mul_f32 v188, v92, v235
    v_mul_f32 v189, v93, v235
    v_mfma_f32_16x16x32_bf16 v[128:131], a[136:139], v[32:35], v[128:131]
    ds_read_b64_tr_b16 a[130:131], v205 offset:51200
    ds_read_b128 a[208:211], v246 offset:4096
    v_mul_f32 v190, v94, v235
    v_mul_f32 v191, v95, v235
    v_cvt_pk_bf16_f32 v88, v184, v185
    v_cvt_pk_bf16_f32 v89, v186, v187
    v_cvt_pk_bf16_f32 v90, v188, v189
    v_mfma_f32_16x16x32_bf16 v[128:131], a[140:143], v[48:51], v[128:131]
    ds_read_b64_tr_b16 a[132:133], v205 offset:53248
    ds_read_b128 a[212:215], v246 offset:5120
    v_cvt_pk_bf16_f32 v91, v190, v191
    v_mul_f32 v184, v96, v234
    v_mul_f32 v185, v97, v234
    v_mul_f32 v186, v98, v234
    v_mfma_f32_16x16x32_bf16 v[132:135], a[136:139], v[40:43], v[132:135]
    ds_read_b64_tr_b16 a[134:135], v205 offset:55296
    ds_read_b128 a[216:219], v246 offset:6144
    v_mul_f32 v187, v99, v234
    v_mul_f32 v188, v100, v234
    v_mul_f32 v189, v101, v234
    v_mul_f32 v190, v102, v234
    v_mfma_f32_16x16x32_bf16 v[132:135], a[140:143], v[56:59], v[132:135]
    ds_read_b64_tr_b16 a[136:137], v206 offset:49152
    ds_read_b128 a[220:223], v246 offset:7168
    v_mul_f32 v191, v103, v234
    v_cvt_pk_bf16_f32 v96, v184, v185
    v_cvt_pk_bf16_f32 v97, v186, v187
    v_cvt_pk_bf16_f32 v98, v188, v189
    v_mfma_f32_16x16x32_bf16 v[136:139], a[144:147], v[32:35], v[136:139]
    ds_read_b64_tr_b16 a[138:139], v206 offset:51200
    global_load_lds_dwordx4 v237, s[72:73] offset:1024
    v_cvt_pk_bf16_f32 v99, v190, v191
    v_mul_f32 v184, v104, v235
    v_mul_f32 v185, v105, v235
    v_mul_f32 v186, v106, v235
    v_mfma_f32_16x16x32_bf16 v[136:139], a[148:151], v[48:51], v[136:139]
    ds_read_b64_tr_b16 a[140:141], v206 offset:53248
    v_mul_f32 v187, v107, v235
    v_mul_f32 v188, v108, v235
    v_mul_f32 v189, v109, v235
    v_mul_f32 v190, v110, v235
    v_mfma_f32_16x16x32_bf16 v[140:143], a[144:147], v[40:43], v[140:143]
    ds_read_b64_tr_b16 a[142:143], v206 offset:55296
    v_mul_f32 v191, v111, v235
    v_cvt_pk_bf16_f32 v104, v184, v185
    v_cvt_pk_bf16_f32 v105, v186, v187
    v_cvt_pk_bf16_f32 v106, v188, v189
    v_cvt_pk_bf16_f32 v107, v190, v191
    v_mfma_f32_16x16x32_bf16 v[140:143], a[148:151], v[56:59], v[140:143]
    ds_read_b64_tr_b16 a[144:145], v207 offset:49152
    v_mul_f32 v184, v112, v234
    v_mul_f32 v185, v113, v234
    v_mul_f32 v186, v114, v234
    v_mul_f32 v187, v115, v234
    s_waitcnt lgkmcnt(15)
    v_mfma_f32_16x16x32_bf16 v[144:147], a[152:155], v[32:35], v[144:147]
    ds_read_b64_tr_b16 a[146:147], v207 offset:51200
    v_mul_f32 v188, v116, v234
    v_mul_f32 v189, v117, v234
    v_mul_f32 v190, v118, v234
    v_mul_f32 v191, v119, v234
    v_mfma_f32_16x16x32_bf16 v[144:147], a[156:159], v[48:51], v[144:147]
    ds_read_b64_tr_b16 a[148:149], v207 offset:53248
    v_cvt_pk_bf16_f32 v112, v184, v185
    v_cvt_pk_bf16_f32 v113, v186, v187
    v_cvt_pk_bf16_f32 v114, v188, v189
    v_cvt_pk_bf16_f32 v115, v190, v191
    v_mfma_f32_16x16x32_bf16 v[148:151], a[152:155], v[40:43], v[148:151]
    ds_read_b64_tr_b16 a[150:151], v207 offset:55296
    v_mul_f32 v184, v120, v235
    v_mul_f32 v185, v121, v235
    v_mul_f32 v186, v122, v235
    v_mul_f32 v187, v123, v235
    v_mfma_f32_16x16x32_bf16 v[148:151], a[156:159], v[56:59], v[148:151]
    ds_read_b64_tr_b16 a[152:153], v200 offset:0
    global_load_lds_dwordx4 v238, s[72:73] offset:2048
    v_mul_f32 v188, v124, v235
    v_mul_f32 v189, v125, v235
    v_mul_f32 v190, v126, v235
    v_mul_f32 v191, v127, v235
    v_mfma_f32_16x16x32_bf16 v[152:155], a[112:115], v[32:35], v[152:155]
    ds_read_b64_tr_b16 a[154:155], v200 offset:2048
    v_cvt_pk_bf16_f32 v120, v184, v185
    v_cvt_pk_bf16_f32 v121, v186, v187
    v_cvt_pk_bf16_f32 v122, v188, v189
    v_cvt_pk_bf16_f32 v123, v190, v191
    v_mfma_f32_16x16x32_bf16 v[152:155], a[116:119], v[48:51], v[152:155]
    ds_read_b64_tr_b16 a[156:157], v200 offset:4096
    v_mfma_f32_16x16x32_bf16 v[156:159], a[112:115], v[40:43], v[156:159]
    ds_read_b64_tr_b16 a[158:159], v200 offset:6144
    v_mfma_f32_16x16x32_bf16 v[156:159], a[116:119], v[56:59], v[156:159]
    ds_read_b64_tr_b16 a[112:113], v201 offset:0
    s_waitcnt lgkmcnt(15)
    v_mfma_f32_16x16x32_bf16 v[128:131], a[120:123], v[64:67], v[128:131]
    ds_read_b64_tr_b16 a[114:115], v201 offset:2048
    v_mfma_f32_16x16x32_bf16 v[128:131], a[124:127], v[80:83], v[128:131]
    ds_read_b64_tr_b16 a[116:117], v201 offset:4096
    v_mfma_f32_16x16x32_bf16 v[132:135], a[120:123], v[72:75], v[132:135]
    ds_read_b64_tr_b16 a[118:119], v201 offset:6144
    v_mfma_f32_16x16x32_bf16 v[132:135], a[124:127], v[88:91], v[132:135]
    ds_read_b64_tr_b16 a[120:121], v202 offset:0
    global_load_lds_dwordx4 v239, s[72:73] offset:3072
    v_mfma_f32_16x16x32_bf16 v[136:139], a[128:131], v[64:67], v[136:139]
    ds_read_b64_tr_b16 a[122:123], v202 offset:2048
    v_mfma_f32_16x16x32_bf16 v[136:139], a[132:135], v[80:83], v[136:139]
    ds_read_b64_tr_b16 a[124:125], v202 offset:4096
    v_mfma_f32_16x16x32_bf16 v[140:143], a[128:131], v[72:75], v[140:143]
    ds_read_b64_tr_b16 a[126:127], v202 offset:6144
    v_mfma_f32_16x16x32_bf16 v[140:143], a[132:135], v[88:91], v[140:143]
    ds_read_b64_tr_b16 a[128:129], v203 offset:0
    s_waitcnt lgkmcnt(13)
    v_mfma_f32_16x16x32_bf16 v[144:147], a[136:139], v[64:67], v[144:147]
    ds_read_b64_tr_b16 a[130:131], v203 offset:2048
    s_load_dwordx2 s[16:17], s[0:1], 0
    s_load_dwordx2 s[20:21], s[0:1], 72
    v_mfma_f32_16x16x32_bf16 v[144:147], a[140:143], v[80:83], v[144:147]
    ds_read_b64_tr_b16 a[132:133], v203 offset:4096
    v_mfma_f32_16x16x32_bf16 v[148:151], a[136:139], v[72:75], v[148:151]
    ds_read_b64_tr_b16 a[134:135], v203 offset:6144
    v_mfma_f32_16x16x32_bf16 v[148:151], a[140:143], v[88:91], v[148:151]
    s_waitcnt vmcnt(8)
    s_barrier
    ds_read_b64_tr_b16 a[136:137], v200 offset:16384
    ds_write_b128 v245, v[64:67] offset:0
    s_and_b32 s69, s28, 0xf0000000
    s_add_u32 s69, s69, s59
    s_add_u32 m0, s42, 81920
    s_add_u32 s72, s69, 0
    v_mfma_f32_16x16x32_bf16 v[152:155], a[144:147], v[64:67], v[152:155]
    ds_read_b64_tr_b16 a[138:139], v200 offset:18432
    ds_write_b128 v245, v[72:75] offset:1024
    global_load_lds_dwordx4 v236, s[72:73] offset:0
    v_mfma_f32_16x16x32_bf16 v[152:155], a[148:151], v[80:83], v[152:155]
    ds_read_b64_tr_b16 a[140:141], v200 offset:20480
    ds_write_b128 v245, v[80:83] offset:2048
    v_mfma_f32_16x16x32_bf16 v[156:159], a[144:147], v[72:75], v[156:159]
    ds_read_b64_tr_b16 a[142:143], v200 offset:22528
    ds_write_b128 v245, v[88:91] offset:3072
    v_mfma_f32_16x16x32_bf16 v[156:159], a[148:151], v[88:91], v[156:159]
    ds_read_b64_tr_b16 a[144:145], v201 offset:16384
    s_waitcnt lgkmcnt(15)
    v_mfma_f32_16x16x32_bf16 v[128:131], a[152:155], v[96:99], v[128:131]
    ds_read_b64_tr_b16 a[146:147], v201 offset:18432
    ds_write_b128 v245, v[96:99] offset:4096
    global_load_lds_dwordx4 v237, s[72:73] offset:1024
    v_mfma_f32_16x16x32_bf16 v[128:131], a[156:159], v[112:115], v[128:131]
    ds_read_b64_tr_b16 a[148:149], v201 offset:20480
    ds_write_b128 v245, v[104:107] offset:5120
    v_mfma_f32_16x16x32_bf16 v[132:135], a[152:155], v[104:107], v[132:135]
    ds_read_b64_tr_b16 a[150:151], v201 offset:22528
    ds_write_b128 v245, v[112:115] offset:6144
    v_mfma_f32_16x16x32_bf16 v[132:135], a[156:159], v[120:123], v[132:135]
    ds_read_b64_tr_b16 a[152:153], v202 offset:16384
    ds_write_b128 v245, v[120:123] offset:7168
    v_mfma_f32_16x16x32_bf16 v[136:139], a[112:115], v[96:99], v[136:139]
    ds_read_b64_tr_b16 a[154:155], v202 offset:18432
    global_load_lds_dwordx4 v238, s[72:73] offset:2048
    v_mfma_f32_16x16x32_bf16 v[136:139], a[116:119], v[112:115], v[136:139]
    ds_read_b64_tr_b16 a[156:157], v202 offset:20480
    v_mfma_f32_16x16x32_bf16 v[140:143], a[112:115], v[104:107], v[140:143]
    ds_read_b64_tr_b16 a[158:159], v202 offset:22528
    v_mfma_f32_16x16x32_bf16 v[140:143], a[116:119], v[120:123], v[140:143]
    ds_read_b64_tr_b16 a[112:113], v203 offset:16384
    s_waitcnt lgkmcnt(15)
    v_mfma_f32_16x16x32_bf16 v[144:147], a[120:123], v[96:99], v[144:147]
    ds_read_b64_tr_b16 a[114:115], v203 offset:18432
    global_load_lds_dwordx4 v239, s[72:73] offset:3072
    v_mfma_f32_16x16x32_bf16 v[144:147], a[124:127], v[112:115], v[144:147]
    ds_read_b64_tr_b16 a[116:117], v203 offset:20480
    s_add_u32 m0, s42, 98304
    v_mfma_f32_16x16x32_bf16 v[148:151], a[120:123], v[104:107], v[148:151]
    ds_read_b64_tr_b16 a[118:119], v203 offset:22528
    s_add_u32 s72, s69, 57344
    v_mfma_f32_16x16x32_bf16 v[148:151], a[124:127], v[120:123], v[148:151]
    ds_read_b64_tr_b16 a[120:121], v200 offset:32768
    global_load_lds_dwordx4 v236, s[72:73] offset:0
    v_mfma_f32_16x16x32_bf16 v[152:155], a[128:131], v[96:99], v[152:155]
    ds_read_b64_tr_b16 a[122:123], v200 offset:34816
    v_mfma_f32_16x16x32_bf16 v[152:155], a[132:135], v[112:115], v[152:155]
    ds_read_b64_tr_b16 a[124:125], v200 offset:36864
    v_mfma_f32_16x16x32_bf16 v[156:159], a[128:131], v[104:107], v[156:159]
    ds_read_b64_tr_b16 a[126:127], v200 offset:38912
    v_mfma_f32_16x16x32_bf16 v[156:159], a[132:135], v[120:123], v[156:159]
    ds_read_b64_tr_b16 a[128:129], v201 offset:32768
    global_load_lds_dwordx4 v237, s[72:73] offset:1024
    s_waitcnt lgkmcnt(15)
    v_mfma_f32_16x16x32_bf16 v[128:131], a[136:139], a[192:195], v[128:131]
    ds_read_b64_tr_b16 a[130:131], v201 offset:34816
    v_mfma_f32_16x16x32_bf16 v[128:131], a[140:143], a[200:203], v[128:131]
    ds_read_b64_tr_b16 a[132:133], v201 offset:36864
    v_mfma_f32_16x16x32_bf16 v[132:135], a[136:139], a[196:199], v[132:135]
    ds_read_b64_tr_b16 a[134:135], v201 offset:38912
    v_mfma_f32_16x16x32_bf16 v[132:135], a[140:143], a[204:207], v[132:135]
    ds_read_b64_tr_b16 a[136:137], v202 offset:32768
    global_load_lds_dwordx4 v238, s[72:73] offset:2048
    v_mfma_f32_16x16x32_bf16 v[136:139], a[144:147], a[192:195], v[136:139]
    ds_read_b64_tr_b16 a[138:139], v202 offset:34816
    v_mfma_f32_16x16x32_bf16 v[136:139], a[148:151], a[200:203], v[136:139]
    ds_read_b64_tr_b16 a[140:141], v202 offset:36864
    v_mfma_f32_16x16x32_bf16 v[140:143], a[144:147], a[196:199], v[140:143]
    ds_read_b64_tr_b16 a[142:143], v202 offset:38912
    v_mfma_f32_16x16x32_bf16 v[140:143], a[148:151], a[204:207], v[140:143]
    ds_read_b64_tr_b16 a[144:145], v203 offset:32768
    global_load_lds_dwordx4 v239, s[72:73] offset:3072
    s_waitcnt lgkmcnt(13)
    v_mfma_f32_16x16x32_bf16 v[144:147], a[152:155], a[192:195], v[144:147]
    ds_read_b64_tr_b16 a[146:147], v203 offset:34816
    v_mfma_f32_16x16x32_bf16 v[144:147], a[156:159], a[200:203], v[144:147]
    ds_read_b64_tr_b16 a[148:149], v203 offset:36864
    v_mfma_f32_16x16x32_bf16 v[148:151], a[152:155], a[196:199], v[148:151]
    ds_read_b64_tr_b16 a[150:151], v203 offset:38912
    v_mfma_f32_16x16x32_bf16 v[148:151], a[156:159], a[204:207], v[148:151]
    s_waitcnt vmcnt(8)
    s_barrier
    ds_read_b64_tr_b16 a[152:153], v200 offset:49152
    ds_read_b128 a[224:227], v246 offset:0
    s_add_u32 m0, s42, 114688
    s_add_u32 s72, s69, 114688
    v_mfma_f32_16x16x32_bf16 v[152:155], a[112:115], a[192:195], v[152:155]
    ds_read_b64_tr_b16 a[154:155], v200 offset:51200
    ds_read_b128 a[228:231], v246 offset:1024
    global_load_lds_dwordx4 v236, s[72:73] offset:0
    v_mfma_f32_16x16x32_bf16 v[152:155], a[116:119], a[200:203], v[152:155]
    ds_read_b64_tr_b16 a[156:157], v200 offset:53248
    ds_read_b128 a[232:235], v246 offset:2048
    v_mfma_f32_16x16x32_bf16 v[156:159], a[112:115], a[196:199], v[156:159]
    ds_read_b64_tr_b16 a[158:159], v200 offset:55296
    ds_read_b128 a[236:239], v246 offset:3072
    v_mfma_f32_16x16x32_bf16 v[156:159], a[116:119], a[204:207], v[156:159]
    ds_read_b64_tr_b16 a[112:113], v201 offset:49152
    s_waitcnt lgkmcnt(15)
    v_mfma_f32_16x16x32_bf16 v[128:131], a[120:123], a[208:211], v[128:131]
    ds_read_b64_tr_b16 a[114:115], v201 offset:51200
    ds_read_b128 a[240:243], v246 offset:4096
    global_load_lds_dwordx4 v237, s[72:73] offset:1024
    v_mfma_f32_16x16x32_bf16 v[128:131], a[124:127], a[216:219], v[128:131]
    ds_read_b64_tr_b16 a[116:117], v201 offset:53248
    ds_read_b128 a[244:247], v246 offset:5120
    v_mfma_f32_16x16x32_bf16 v[132:135], a[120:123], a[212:215], v[132:135]
    ds_read_b64_tr_b16 a[118:119], v201 offset:55296
    ds_read_b128 a[248:251], v246 offset:6144
    v_mfma_f32_16x16x32_bf16 v[132:135], a[124:127], a[220:223], v[132:135]
    ds_read_b64_tr_b16 a[120:121], v202 offset:49152
    ds_read_b128 a[252:255], v246 offset:7168
    v_mfma_f32_16x16x32_bf16 v[136:139], a[128:131], a[208:211], v[136:139]
    ds_read_b64_tr_b16 a[122:123], v202 offset:51200
    global_load_lds_dwordx4 v238, s[72:73] offset:2048
    s_waitcnt lgkmcnt(0)
    s_mov_b32 s18, 1835008
    s_mov_b32 s19, 0x00020000
    s_mov_b32 s22, 1835008
    s_mov_b32 s23, 0x00020000
    s_mul_i32 s50, s36, 7
    s_add_u32 s50, s50, s38
    s_add_u32 s51, s50, 4
    s_cmp_eq_u32 s38, 3
    s_cselect_b32 s51, s50, s51
    s_mul_i32 s52, s37, 458752
    s_lshl_b32 s98, s50, 10
    s_add_u32 s52, s52, s98
    s_cmp_ge_u32 s50, 28
    s_cselect_b32 s98, 1, 0
    s_mul_i32 s99, s98, 28
    s_sub_u32 s99, s50, s99
    s_lshl_b32 s54, s37, 6
    s_lshl_b32 s98, s98, 5
    s_add_u32 s54, s54, s98
    s_and_b32 s98, s99, 1
    s_lshl_b32 s98, s98, 4
    s_add_u32 s54, s54, s98
    s_mul_i32 s54, s54, 896
    s_lshr_b32 s99, s99, 1
    s_lshl_b32 s99, s99, 6
    s_add_u32 s54, s54, s99
    s_mul_i32 s53, s37, 458752
    s_lshl_b32 s98, s51, 10
    s_add_u32 s53, s53, s98
    s_cmp_ge_u32 s51, 28
    s_cselect_b32 s98, 1, 0
    s_mul_i32 s99, s98, 28
    s_sub_u32 s99, s51, s99
    s_lshl_b32 s55, s37, 6
    s_lshl_b32 s98, s98, 5
    s_add_u32 s55, s55, s98
    s_and_b32 s98, s99, 1
    s_lshl_b32 s98, s98, 4
    s_add_u32 s55, s55, s98
    s_mul_i32 s55, s55, 896
    s_lshr_b32 s99, s99, 1
    s_lshl_b32 s99, s99, 6
    s_add_u32 s55, s55, s99
    s_mov_b32 s56, 0x00003f80
    s_mov_b32 s57, 0x3f800000
    v_mfma_f32_16x16x32_bf16 v[136:139], a[132:135], a[216:219], v[136:139]
    ds_read_b64_tr_b16 a[124:125], v202 offset:53248
    v_mfma_f32_16x16x32_bf16 v[140:143], a[128:131], a[212:215], v[140:143]
    ds_read_b64_tr_b16 a[126:127], v202 offset:55296
    v_mfma_f32_16x16x32_bf16 v[140:143], a[132:135], a[220:223], v[140:143]
    ds_read_b64_tr_b16 a[128:129], v203 offset:49152
    v_mfma_f32_16x16x32_bf16 v[144:147], a[136:139], a[208:211], v[144:147]
    ds_read_b64_tr_b16 a[130:131], v203 offset:51200
    global_load_lds_dwordx4 v239, s[72:73] offset:3072
    v_mfma_f32_16x16x32_bf16 v[144:147], a[140:143], a[216:219], v[144:147]
    ds_read_b64_tr_b16 a[132:133], v203 offset:53248
    s_add_u32 m0, s42, 0
    v_mfma_f32_16x16x32_bf16 v[148:151], a[136:139], a[212:215], v[148:151]
    ds_read_b64_tr_b16 a[134:135], v203 offset:55296
    s_add_u32 s72, s69, 172032
    v_mfma_f32_16x16x32_bf16 v[148:151], a[140:143], a[220:223], v[148:151]
    ds_read_b64_tr_b16 a[136:137], v204 offset:0
    global_load_lds_dwordx4 v236, s[72:73] offset:0
    v_mfma_f32_16x16x32_bf16 v[152:155], a[144:147], a[208:211], v[152:155]
    ds_read_b64_tr_b16 a[138:139], v204 offset:2048
    v_mfma_f32_16x16x32_bf16 v[152:155], a[148:151], a[216:219], v[152:155]
    ds_read_b64_tr_b16 a[140:141], v204 offset:4096
    v_mfma_f32_16x16x32_bf16 v[156:159], a[144:147], a[212:215], v[156:159]
    ds_read_b64_tr_b16 a[142:143], v204 offset:6144
    v_mfma_f32_16x16x32_bf16 v[156:159], a[148:151], a[220:223], v[156:159]
    ds_read_b64_tr_b16 a[144:145], v205 offset:0
    global_load_lds_dwordx4 v237, s[72:73] offset:1024
    v_mfma_f32_16x16x32_bf16 v[128:131], a[152:155], a[224:227], v[128:131]
    ds_read_b64_tr_b16 a[146:147], v205 offset:2048
    v_mfma_f32_16x16x32_bf16 v[128:131], a[156:159], a[232:235], v[128:131]
    ds_read_b64_tr_b16 a[148:149], v205 offset:4096
    v_mfma_f32_16x16x32_bf16 v[132:135], a[152:155], a[228:231], v[132:135]
    ds_read_b64_tr_b16 a[150:151], v205 offset:6144
    v_mfma_f32_16x16x32_bf16 v[132:135], a[156:159], a[236:239], v[132:135]
    ds_read_b64_tr_b16 a[152:153], v206 offset:0
    global_load_lds_dwordx4 v238, s[72:73] offset:2048
    v_mfma_f32_16x16x32_bf16 v[136:139], a[112:115], a[224:227], v[136:139]
    ds_read_b64_tr_b16 a[154:155], v206 offset:2048
    v_mfma_f32_16x16x32_bf16 v[136:139], a[116:119], a[232:235], v[136:139]
    ds_read_b64_tr_b16 a[156:157], v206 offset:4096
    v_mfma_f32_16x16x32_bf16 v[140:143], a[112:115], a[228:231], v[140:143]
    ds_read_b64_tr_b16 a[158:159], v206 offset:6144
    v_mfma_f32_16x16x32_bf16 v[140:143], a[116:119], a[236:239], v[140:143]
    ds_read_b64_tr_b16 a[112:113], v207 offset:0
    global_load_lds_dwordx4 v239, s[72:73] offset:3072
    s_waitcnt lgkmcnt(13)
    v_mfma_f32_16x16x32_bf16 v[144:147], a[120:123], a[224:227], v[144:147]
    ds_read_b64_tr_b16 a[114:115], v207 offset:2048
    v_mfma_f32_16x16x32_bf16 v[144:147], a[124:127], a[232:235], v[144:147]
    ds_read_b64_tr_b16 a[116:117], v207 offset:4096
    v_mfma_f32_16x16x32_bf16 v[148:151], a[120:123], a[228:231], v[148:151]
    ds_read_b64_tr_b16 a[118:119], v207 offset:6144
    v_mfma_f32_16x16x32_bf16 v[148:151], a[124:127], a[236:239], v[148:151]
    s_waitcnt vmcnt(8)
    s_barrier
    ds_read_b64_tr_b16 a[120:121], v204 offset:16384
    s_lshl_b32 s100, s37, 3
    v_mov_b32 v254, 0
    buffer_load_dwordx2 v[242:243], v254, s[12:15], s100 offen offset:0 sc1
    s_and_b32 s69, s28, 0xf0000000
    s_add_u32 s69, s69, s62
    s_add_u32 m0, s42, 16384
    s_add_u32 s72, s69, 0
    v_mfma_f32_16x16x32_bf16 v[152:155], a[128:131], a[224:227], v[152:155]
    ds_read_b64_tr_b16 a[122:123], v204 offset:18432
    global_load_lds_dwordx4 v236, s[72:73] offset:0
    v_mfma_f32_16x16x32_bf16 v[152:155], a[132:135], a[232:235], v[152:155]
    ds_read_b64_tr_b16 a[124:125], v204 offset:20480
    v_mfma_f32_16x16x32_bf16 v[156:159], a[128:131], a[228:231], v[156:159]
    ds_read_b64_tr_b16 a[126:127], v204 offset:22528
    v_mfma_f32_16x16x32_bf16 v[156:159], a[132:135], a[236:239], v[156:159]
    ds_read_b64_tr_b16 a[128:129], v205 offset:16384
    s_waitcnt lgkmcnt(13)
    v_mfma_f32_16x16x32_bf16 v[128:131], a[136:139], a[240:243], v[128:131]
    ds_read_b64_tr_b16 a[130:131], v205 offset:18432
    global_load_lds_dwordx4 v237, s[72:73] offset:1024
    v_mfma_f32_16x16x32_bf16 v[128:131], a[140:143], a[248:251], v[128:131]
    ds_read_b64_tr_b16 a[132:133], v205 offset:20480
    v_mfma_f32_16x16x32_bf16 v[132:135], a[136:139], a[244:247], v[132:135]
    ds_read_b64_tr_b16 a[134:135], v205 offset:22528
    v_mfma_f32_16x16x32_bf16 v[132:135], a[140:143], a[252:255], v[132:135]
    ds_read_b64_tr_b16 a[136:137], v206 offset:16384
    v_mfma_f32_16x16x32_bf16 v[136:139], a[144:147], a[240:243], v[136:139]
    ds_read_b64_tr_b16 a[138:139], v206 offset:18432
    global_load_lds_dwordx4 v238, s[72:73] offset:2048
    v_mfma_f32_16x16x32_bf16 v[136:139], a[148:151], a[248:251], v[136:139]
    ds_read_b64_tr_b16 a[140:141], v206 offset:20480
    v_mfma_f32_16x16x32_bf16 v[140:143], a[144:147], a[244:247], v[140:143]
    ds_read_b64_tr_b16 a[142:143], v206 offset:22528
    v_mfma_f32_16x16x32_bf16 v[140:143], a[148:151], a[252:255], v[140:143]
    ds_read_b64_tr_b16 a[144:145], v207 offset:16384
    s_waitcnt lgkmcnt(13)
    v_mfma_f32_16x16x32_bf16 v[144:147], a[152:155], a[240:243], v[144:147]
    ds_read_b64_tr_b16 a[146:147], v207 offset:18432
    global_load_lds_dwordx4 v239, s[72:73] offset:3072
    v_mfma_f32_16x16x32_bf16 v[144:147], a[156:159], a[248:251], v[144:147]
    ds_read_b64_tr_b16 a[148:149], v207 offset:20480
    s_add_u32 m0, s42, 32768
    v_mfma_f32_16x16x32_bf16 v[148:151], a[152:155], a[244:247], v[148:151]
    ds_read_b64_tr_b16 a[150:151], v207 offset:22528
    s_add_u32 s72, s69, 57344
    v_mfma_f32_16x16x32_bf16 v[148:151], a[156:159], a[252:255], v[148:151]
    ds_read_b64_tr_b16 a[152:153], v204 offset:32768
    global_load_lds_dwordx4 v236, s[72:73] offset:0
    v_mfma_f32_16x16x32_bf16 v[152:155], a[112:115], a[240:243], v[152:155]
    ds_read_b64_tr_b16 a[154:155], v204 offset:34816
    v_mfma_f32_16x16x32_bf16 v[152:155], a[116:119], a[248:251], v[152:155]
    ds_read_b64_tr_b16 a[156:157], v204 offset:36864
    v_mfma_f32_16x16x32_bf16 v[156:159], a[112:115], a[244:247], v[156:159]
    ds_read_b64_tr_b16 a[158:159], v204 offset:38912
    v_mfma_f32_16x16x32_bf16 v[156:159], a[116:119], a[252:255], v[156:159]
    ds_read_b64_tr_b16 a[112:113], v205 offset:32768
    global_load_lds_dwordx4 v237, s[72:73] offset:1024
    s_waitcnt lgkmcnt(13)
    v_mfma_f32_16x16x32_bf16 v[160:163], a[120:123], v[0:3], 0
    ds_read_b64_tr_b16 a[114:115], v205 offset:34816
    v_mfma_f32_16x16x32_bf16 v[160:163], a[124:127], v[16:19], v[160:163]
    ds_read_b64_tr_b16 a[116:117], v205 offset:36864
    v_mfma_f32_16x16x32_bf16 v[164:167], a[120:123], v[8:11], 0
    ds_read_b64_tr_b16 a[118:119], v205 offset:38912
    v_mfma_f32_16x16x32_bf16 v[164:167], a[124:127], v[24:27], v[164:167]
    ds_read_b64_tr_b16 a[120:121], v206 offset:32768
    global_load_lds_dwordx4 v238, s[72:73] offset:2048
    v_mfma_f32_16x16x32_bf16 v[168:171], a[128:131], v[0:3], 0
    ds_read_b64_tr_b16 a[122:123], v206 offset:34816
    v_mfma_f32_16x16x32_bf16 v[168:171], a[132:135], v[16:19], v[168:171]
    ds_read_b64_tr_b16 a[124:125], v206 offset:36864
    v_mfma_f32_16x16x32_bf16 v[172:175], a[128:131], v[8:11], 0
    ds_read_b64_tr_b16 a[126:127], v206 offset:38912
    s_add_u32 s99, s89, s90
    v_mfma_f32_16x16x32_bf16 v[172:175], a[132:135], v[24:27], v[172:175]
    ds_read_b64_tr_b16 a[128:129], v207 offset:32768
    global_load_lds_dwordx4 v239, s[72:73] offset:3072
    s_waitcnt lgkmcnt(13)
    v_mfma_f32_16x16x32_bf16 v[176:179], a[136:139], v[0:3], 0
    ds_read_b64_tr_b16 a[130:131], v207 offset:34816
    s_lshl_b32 s98, s39, 13
    v_mfma_f32_16x16x32_bf16 v[176:179], a[140:143], v[16:19], v[176:179]
    ds_read_b64_tr_b16 a[132:133], v207 offset:36864
    v_cvt_pk_bf16_f32 v192, v128, v129
    v_mfma_f32_16x16x32_bf16 v[180:183], a[136:139], v[8:11], 0
    ds_read_b64_tr_b16 a[134:135], v207 offset:38912
    v_mfma_f32_16x16x32_bf16 v[180:183], a[140:143], v[24:27], v[180:183]
    s_waitcnt vmcnt(9)
    s_barrier
    ds_read_b64_tr_b16 a[136:137], v204 offset:49152
    s_add_u32 m0, s42, 49152
    s_add_u32 s72, s69, 114688
    s_xor_b32 s100, s98, 8192
    v_mfma_f32_16x16x32_bf16 v[184:187], a[144:147], v[0:3], 0
    ds_read_b64_tr_b16 a[138:139], v204 offset:51200
    global_load_lds_dwordx4 v236, s[72:73] offset:0
    v_cvt_pk_bf16_f32 v193, v130, v131
    v_mfma_f32_16x16x32_bf16 v[184:187], a[148:151], v[16:19], v[184:187]
    ds_read_b64_tr_b16 a[140:141], v204 offset:53248
    v_add_u32 v212, s100, v208
    v_mfma_f32_16x16x32_bf16 v[188:191], a[144:147], v[8:11], 0
    ds_read_b64_tr_b16 a[142:143], v204 offset:55296
    v_cvt_pk_bf16_f32 v194, v136, v137
    v_mfma_f32_16x16x32_bf16 v[188:191], a[148:151], v[24:27], v[188:191]
    ds_read_b64_tr_b16 a[144:145], v205 offset:49152
    v_add_u32 v213, s100, v209
    s_waitcnt lgkmcnt(13)
    v_mfma_f32_16x16x32_bf16 v[160:163], a[152:155], v[32:35], v[160:163]
    ds_read_b64_tr_b16 a[146:147], v205 offset:51200
    global_load_lds_dwordx4 v237, s[72:73] offset:1024
    v_mfma_f32_16x16x32_bf16 v[160:163], a[156:159], v[48:51], v[160:163]
    ds_read_b64_tr_b16 a[148:149], v205 offset:53248
    v_cvt_pk_bf16_f32 v195, v138, v139
    v_add_u32 v214, s100, v210
    v_mfma_f32_16x16x32_bf16 v[164:167], a[152:155], v[40:43], v[164:167]
    ds_read_b64_tr_b16 a[150:151], v205 offset:55296
    buffer_store_dwordx4 v[192:195], v240, s[32:35], s99 offen offset:0 sc1
    v_mfma_f32_16x16x32_bf16 v[164:167], a[156:159], v[56:59], v[164:167]
    ds_read_b64_tr_b16 a[152:153], v206 offset:49152
    v_add_u32 v215, s100, v211
    v_mfma_f32_16x16x32_bf16 v[168:171], a[112:115], v[32:35], v[168:171]
    ds_read_b64_tr_b16 a[154:155], v206 offset:51200
    global_load_lds_dwordx4 v238, s[72:73] offset:2048
    v_mfma_f32_16x16x32_bf16 v[168:171], a[116:119], v[48:51], v[168:171]
    ds_read_b64_tr_b16 a[156:157], v206 offset:53248
    v_mfma_f32_16x16x32_bf16 v[172:175], a[112:115], v[40:43], v[172:175]
    ds_read_b64_tr_b16 a[158:159], v206 offset:55296
    v_add_u32 v208, s98, v208
    v_cvt_pk_bf16_f32 v196, v132, v133
    v_mfma_f32_16x16x32_bf16 v[172:175], a[116:119], v[56:59], v[172:175]
    ds_read_b64_tr_b16 a[112:113], v207 offset:49152
    s_waitcnt lgkmcnt(13)
    v_mfma_f32_16x16x32_bf16 v[176:179], a[120:123], v[32:35], v[176:179]
    ds_read_b64_tr_b16 a[114:115], v207 offset:51200
    global_load_lds_dwordx4 v239, s[72:73] offset:3072
    v_add_u32 v209, s98, v209
    v_cvt_pk_bf16_f32 v197, v134, v135
    v_mfma_f32_16x16x32_bf16 v[176:179], a[124:127], v[48:51], v[176:179]
    ds_read_b64_tr_b16 a[116:117], v207 offset:53248
    s_add_u32 m0, s42, 65536
    v_mfma_f32_16x16x32_bf16 v[180:183], a[120:123], v[40:43], v[180:183]
    ds_read_b64_tr_b16 a[118:119], v207 offset:55296
    s_add_u32 s72, s69, 172032
    v_add_u32 v210, s98, v210
    v_mfma_f32_16x16x32_bf16 v[180:183], a[124:127], v[56:59], v[180:183]
    ds_read_b64_tr_b16 a[120:121], v200 offset:0
    global_load_lds_dwordx4 v236, s[72:73] offset:0
    v_cvt_pk_bf16_f32 v198, v140, v141
    v_mfma_f32_16x16x32_bf16 v[184:187], a[128:131], v[32:35], v[184:187]
    ds_read_b64_tr_b16 a[122:123], v200 offset:2048
    v_add_u32 v211, s98, v211
    v_mfma_f32_16x16x32_bf16 v[184:187], a[132:135], v[48:51], v[184:187]
    ds_read_b64_tr_b16 a[124:125], v200 offset:4096
    v_cvt_pk_bf16_f32 v199, v142, v143
    v_mfma_f32_16x16x32_bf16 v[188:191], a[128:131], v[40:43], v[188:191]
    ds_read_b64_tr_b16 a[126:127], v200 offset:6144
    buffer_store_dwordx4 v[196:199], v240, s[32:35], s99 offen offset:1024 sc1
    v_mfma_f32_16x16x32_bf16 v[188:191], a[132:135], v[56:59], v[188:191]
    ds_read_b64_tr_b16 a[128:129], v201 offset:0
    global_load_lds_dwordx4 v237, s[72:73] offset:1024
    s_waitcnt lgkmcnt(13)
    v_mfma_f32_16x16x32_bf16 v[160:163], a[136:139], v[64:67], v[160:163]
    ds_read_b64_tr_b16 a[130:131], v201 offset:2048
    v_cvt_pk_bf16_f32 v192, v144, v145
    v_mfma_f32_16x16x32_bf16 v[160:163], a[140:143], v[80:83], v[160:163]
    ds_read_b64_tr_b16 a[132:133], v201 offset:4096
    v_cvt_pk_bf16_f32 v193, v146, v147
    v_mfma_f32_16x16x32_bf16 v[164:167], a[136:139], v[72:75], v[164:167]
    ds_read_b64_tr_b16 a[134:135], v201 offset:6144
    v_cvt_pk_bf16_f32 v194, v152, v153
    v_mfma_f32_16x16x32_bf16 v[164:167], a[140:143], v[88:91], v[164:167]
    ds_read_b64_tr_b16 a[136:137], v202 offset:0
    global_load_lds_dwordx4 v238, s[72:73] offset:2048
    v_mfma_f32_16x16x32_bf16 v[168:171], a[144:147], v[64:67], v[168:171]
    ds_read_b64_tr_b16 a[138:139], v202 offset:2048
    v_cvt_pk_bf16_f32 v195, v154, v155
    v_mfma_f32_16x16x32_bf16 v[168:171], a[148:151], v[80:83], v[168:171]
    ds_read_b64_tr_b16 a[140:141], v202 offset:4096
    buffer_store_dwordx4 v[192:195], v240, s[32:35], s99 offen offset:2048 sc1
    v_mfma_f32_16x16x32_bf16 v[172:175], a[144:147], v[72:75], v[172:175]
    ds_read_b64_tr_b16 a[142:143], v202 offset:6144
    v_cvt_pk_bf16_f32 v196, v148, v149
    v_mfma_f32_16x16x32_bf16 v[172:175], a[148:151], v[88:91], v[172:175]
    ds_read_b64_tr_b16 a[144:145], v203 offset:0
    global_load_lds_dwordx4 v239, s[72:73] offset:3072
    s_waitcnt lgkmcnt(13)
    v_mfma_f32_16x16x32_bf16 v[176:179], a[152:155], v[64:67], v[176:179]
    ds_read_b64_tr_b16 a[146:147], v203 offset:2048
    v_cvt_pk_bf16_f32 v197, v150, v151
    v_mfma_f32_16x16x32_bf16 v[176:179], a[156:159], v[80:83], v[176:179]
    ds_read_b64_tr_b16 a[148:149], v203 offset:4096
    v_cvt_pk_bf16_f32 v198, v156, v157
    v_mfma_f32_16x16x32_bf16 v[180:183], a[152:155], v[72:75], v[180:183]
    ds_read_b64_tr_b16 a[150:151], v203 offset:6144
    v_cvt_pk_bf16_f32 v199, v158, v159
    v_mfma_f32_16x16x32_bf16 v[180:183], a[156:159], v[88:91], v[180:183]
    s_waitcnt vmcnt(11)
    s_barrier
    ds_read_b64_tr_b16 a[152:153], v200 offset:16384
    s_and_b32 s69, s28, 0xf0000000
    s_add_u32 s69, s69, s60
    s_add_u32 m0, s42, 81920
    s_add_u32 s72, s69, 0
    v_mfma_f32_16x16x32_bf16 v[184:187], a[112:115], v[64:67], v[184:187]
    ds_read_b64_tr_b16 a[154:155], v200 offset:18432
    global_load_lds_dwordx4 v236, s[72:73] offset:0
    v_mfma_f32_16x16x32_bf16 v[184:187], a[116:119], v[80:83], v[184:187]
    ds_read_b64_tr_b16 a[156:157], v200 offset:20480
    buffer_store_dwordx4 v[196:199], v240, s[32:35], s99 offen offset:3072 sc1
    v_mfma_f32_16x16x32_bf16 v[188:191], a[112:115], v[72:75], v[188:191]
    ds_read_b64_tr_b16 a[158:159], v200 offset:22528
    v_mfma_f32_16x16x32_bf16 v[188:191], a[116:119], v[88:91], v[188:191]
    ds_read_b64_tr_b16 a[112:113], v201 offset:16384
    s_waitcnt lgkmcnt(13)
    v_mfma_f32_16x16x32_bf16 v[160:163], a[120:123], v[96:99], v[160:163]
    ds_read_b64_tr_b16 a[114:115], v201 offset:18432
    global_load_lds_dwordx4 v237, s[72:73] offset:1024
    v_mfma_f32_16x16x32_bf16 v[160:163], a[124:127], v[112:115], v[160:163]
    ds_read_b64_tr_b16 a[116:117], v201 offset:20480
    v_mfma_f32_16x16x32_bf16 v[164:167], a[120:123], v[104:107], v[164:167]
    ds_read_b64_tr_b16 a[118:119], v201 offset:22528
    v_mfma_f32_16x16x32_bf16 v[164:167], a[124:127], v[120:123], v[164:167]
    ds_read_b64_tr_b16 a[120:121], v202 offset:16384
    v_mfma_f32_16x16x32_bf16 v[168:171], a[128:131], v[96:99], v[168:171]
    ds_read_b64_tr_b16 a[122:123], v202 offset:18432
    global_load_lds_dwordx4 v238, s[72:73] offset:2048
    v_mfma_f32_16x16x32_bf16 v[168:171], a[132:135], v[112:115], v[168:171]
    ds_read_b64_tr_b16 a[124:125], v202 offset:20480
    v_mfma_f32_16x16x32_bf16 v[172:175], a[128:131], v[104:107], v[172:175]
    ds_read_b64_tr_b16 a[126:127], v202 offset:22528
    v_mfma_f32_16x16x32_bf16 v[172:175], a[132:135], v[120:123], v[172:175]
    ds_read_b64_tr_b16 a[128:129], v203 offset:16384
    s_waitcnt lgkmcnt(13)
    v_mfma_f32_16x16x32_bf16 v[176:179], a[136:139], v[96:99], v[176:179]
    ds_read_b64_tr_b16 a[130:131], v203 offset:18432
    global_load_lds_dwordx4 v239, s[72:73] offset:3072
    v_mfma_f32_16x16x32_bf16 v[176:179], a[140:143], v[112:115], v[176:179]
    ds_read_b64_tr_b16 a[132:133], v203 offset:20480
    s_add_u32 m0, s42, 98304
    v_mfma_f32_16x16x32_bf16 v[180:183], a[136:139], v[104:107], v[180:183]
    ds_read_b64_tr_b16 a[134:135], v203 offset:22528
    s_add_u32 s72, s69, 57344
    v_mfma_f32_16x16x32_bf16 v[180:183], a[140:143], v[120:123], v[180:183]
    ds_read_b64_tr_b16 a[136:137], v200 offset:32768
    global_load_lds_dwordx4 v236, s[72:73] offset:0
    v_mfma_f32_16x16x32_bf16 v[184:187], a[144:147], v[96:99], v[184:187]
    ds_read_b64_tr_b16 a[138:139], v200 offset:34816
    v_mfma_f32_16x16x32_bf16 v[184:187], a[148:151], v[112:115], v[184:187]
    ds_read_b64_tr_b16 a[140:141], v200 offset:36864
    v_mfma_f32_16x16x32_bf16 v[188:191], a[144:147], v[104:107], v[188:191]
    ds_read_b64_tr_b16 a[142:143], v200 offset:38912
    v_mfma_f32_16x16x32_bf16 v[188:191], a[148:151], v[120:123], v[188:191]
    ds_read_b64_tr_b16 a[144:145], v201 offset:32768
    global_load_lds_dwordx4 v237, s[72:73] offset:1024
    s_waitcnt lgkmcnt(13)
    v_mfma_f32_16x16x32_bf16 v[160:163], a[152:155], a[192:195], v[160:163]
    ds_read_b64_tr_b16 a[146:147], v201 offset:34816
    v_mfma_f32_16x16x32_bf16 v[160:163], a[156:159], a[200:203], v[160:163]
    ds_read_b64_tr_b16 a[148:149], v201 offset:36864
    v_mfma_f32_16x16x32_bf16 v[164:167], a[152:155], a[196:199], v[164:167]
    ds_read_b64_tr_b16 a[150:151], v201 offset:38912
    v_mfma_f32_16x16x32_bf16 v[164:167], a[156:159], a[204:207], v[164:167]
    ds_read_b64_tr_b16 a[152:153], v202 offset:32768
    global_load_lds_dwordx4 v238, s[72:73] offset:2048
    v_mfma_f32_16x16x32_bf16 v[168:171], a[112:115], a[192:195], v[168:171]
    ds_read_b64_tr_b16 a[154:155], v202 offset:34816
    v_mfma_f32_16x16x32_bf16 v[168:171], a[116:119], a[200:203], v[168:171]
    ds_read_b64_tr_b16 a[156:157], v202 offset:36864
    v_mfma_f32_16x16x32_bf16 v[172:175], a[112:115], a[196:199], v[172:175]
    ds_read_b64_tr_b16 a[158:159], v202 offset:38912
    v_mfma_f32_16x16x32_bf16 v[172:175], a[116:119], a[204:207], v[172:175]
    ds_read_b64_tr_b16 a[112:113], v203 offset:32768
    global_load_lds_dwordx4 v239, s[72:73] offset:3072
    s_waitcnt lgkmcnt(13)
    v_mfma_f32_16x16x32_bf16 v[176:179], a[120:123], a[192:195], v[176:179]
    ds_read_b64_tr_b16 a[114:115], v203 offset:34816
    v_mfma_f32_16x16x32_bf16 v[176:179], a[124:127], a[200:203], v[176:179]
    ds_read_b64_tr_b16 a[116:117], v203 offset:36864
    v_mfma_f32_16x16x32_bf16 v[180:183], a[120:123], a[196:199], v[180:183]
    ds_read_b64_tr_b16 a[118:119], v203 offset:38912
    v_mfma_f32_16x16x32_bf16 v[180:183], a[124:127], a[204:207], v[180:183]
    s_waitcnt vmcnt(9)
    s_barrier
    ds_read_b64_tr_b16 a[120:121], v200 offset:49152
    v_lshrrev_b32 v252, 1, v242
    v_lshrrev_b32 v253, 1, v243
    v_or_b32 v252, v252, v242
    s_add_u32 m0, s42, 114688
    s_add_u32 s72, s69, 114688
    v_mfma_f32_16x16x32_bf16 v[184:187], a[128:131], a[192:195], v[184:187]
    ds_read_b64_tr_b16 a[122:123], v200 offset:51200
    v_or_b32 v253, v253, v243
    v_and_b32 v252, v252, v253
    v_and_b32 v252, 0x01010101, v252
    global_load_lds_dwordx4 v236, s[72:73] offset:0
    v_mfma_f32_16x16x32_bf16 v[184:187], a[132:135], a[200:203], v[184:187]
    ds_read_b64_tr_b16 a[124:125], v200 offset:53248
    v_cmp_eq_u32 vcc, 0x01010101, v252
    s_nop 3
    s_cbranch_vccz L_gspin
L_gback:
    v_mfma_f32_16x16x32_bf16 v[188:191], a[128:131], a[196:199], v[188:191]
    ds_read_b64_tr_b16 a[126:127], v200 offset:55296
    v_mfma_f32_16x16x32_bf16 v[188:191], a[132:135], a[204:207], v[188:191]
    ds_read_b64_tr_b16 a[128:129], v201 offset:49152
    s_waitcnt lgkmcnt(13)
    v_mfma_f32_16x16x32_bf16 v[160:163], a[136:139], a[208:211], v[160:163]
    ds_read_b64_tr_b16 a[130:131], v201 offset:51200
    global_load_lds_dwordx4 v237, s[72:73] offset:1024
    v_mfma_f32_16x16x32_bf16 v[160:163], a[140:143], a[216:219], v[160:163]
    ds_read_b64_tr_b16 a[132:133], v201 offset:53248
    v_mfma_f32_16x16x32_bf16 v[164:167], a[136:139], a[212:215], v[164:167]
    ds_read_b64_tr_b16 a[134:135], v201 offset:55296
    v_mfma_f32_16x16x32_bf16 v[164:167], a[140:143], a[220:223], v[164:167]
    ds_read_b64_tr_b16 a[136:137], v202 offset:49152
    v_mfma_f32_16x16x32_bf16 v[168:171], a[144:147], a[208:211], v[168:171]
    ds_read_b64_tr_b16 a[138:139], v202 offset:51200
    global_load_lds_dwordx4 v238, s[72:73] offset:2048
    v_mfma_f32_16x16x32_bf16 v[168:171], a[148:151], a[216:219], v[168:171]
    ds_read_b64_tr_b16 a[140:141], v202 offset:53248
    v_mfma_f32_16x16x32_bf16 v[172:175], a[144:147], a[212:215], v[172:175]
    ds_read_b64_tr_b16 a[142:143], v202 offset:55296
    v_mfma_f32_16x16x32_bf16 v[172:175], a[148:151], a[220:223], v[172:175]
    ds_read_b64_tr_b16 a[144:145], v203 offset:49152
    s_waitcnt lgkmcnt(13)
    v_mfma_f32_16x16x32_bf16 v[176:179], a[152:155], a[208:211], v[176:179]
    ds_read_b64_tr_b16 a[146:147], v203 offset:51200
    global_load_lds_dwordx4 v239, s[72:73] offset:3072
    v_mfma_f32_16x16x32_bf16 v[176:179], a[156:159], a[216:219], v[176:179]
    ds_read_b64_tr_b16 a[148:149], v203 offset:53248
    s_add_u32 m0, s42, 0
    v_mfma_f32_16x16x32_bf16 v[180:183], a[152:155], a[212:215], v[180:183]
    ds_read_b64_tr_b16 a[150:151], v203 offset:55296
    s_add_u32 s72, s69, 172032
    v_mfma_f32_16x16x32_bf16 v[180:183], a[156:159], a[220:223], v[180:183]
    ds_read_b64_tr_b16 a[152:153], v204 offset:0
    global_load_lds_dwordx4 v236, s[72:73] offset:0
    v_mfma_f32_16x16x32_bf16 v[184:187], a[112:115], a[208:211], v[184:187]
    ds_read_b64_tr_b16 a[154:155], v204 offset:2048
    v_mfma_f32_16x16x32_bf16 v[184:187], a[116:119], a[216:219], v[184:187]
    ds_read_b64_tr_b16 a[156:157], v204 offset:4096
    v_mfma_f32_16x16x32_bf16 v[188:191], a[112:115], a[212:215], v[188:191]
    ds_read_b64_tr_b16 a[158:159], v204 offset:6144
    v_mfma_f32_16x16x32_bf16 v[188:191], a[116:119], a[220:223], v[188:191]
    ds_read_b64_tr_b16 a[112:113], v205 offset:0
    global_load_lds_dwordx4 v237, s[72:73] offset:1024
    s_waitcnt lgkmcnt(13)
    v_mfma_f32_16x16x32_bf16 v[160:163], a[120:123], a[224:227], v[160:163]
    ds_read_b64_tr_b16 a[114:115], v205 offset:2048
    v_mfma_f32_16x16x32_bf16 v[160:163], a[124:127], a[232:235], v[160:163]
    ds_read_b64_tr_b16 a[116:117], v205 offset:4096
    v_mfma_f32_16x16x32_bf16 v[164:167], a[120:123], a[228:231], v[164:167]
    ds_read_b64_tr_b16 a[118:119], v205 offset:6144
    v_mfma_f32_16x16x32_bf16 v[164:167], a[124:127], a[236:239], v[164:167]
    ds_read_b64_tr_b16 a[120:121], v206 offset:0
    global_load_lds_dwordx4 v238, s[72:73] offset:2048
    v_mfma_f32_16x16x32_bf16 v[168:171], a[128:131], a[224:227], v[168:171]
    ds_read_b64_tr_b16 a[122:123], v206 offset:2048
    v_mfma_f32_16x16x32_bf16 v[168:171], a[132:135], a[232:235], v[168:171]
    ds_read_b64_tr_b16 a[124:125], v206 offset:4096
    v_mfma_f32_16x16x32_bf16 v[172:175], a[128:131], a[228:231], v[172:175]
    ds_read_b64_tr_b16 a[126:127], v206 offset:6144
    v_mfma_f32_16x16x32_bf16 v[172:175], a[132:135], a[236:239], v[172:175]
    ds_read_b64_tr_b16 a[128:129], v207 offset:0
    global_load_lds_dwordx4 v239, s[72:73] offset:3072
    s_waitcnt lgkmcnt(13)
    v_mfma_f32_16x16x32_bf16 v[176:179], a[136:139], a[224:227], v[176:179]
    ds_read_b64_tr_b16 a[130:131], v207 offset:2048
    v_mfma_f32_16x16x32_bf16 v[176:179], a[140:143], a[232:235], v[176:179]
    ds_read_b64_tr_b16 a[132:133], v207 offset:4096
    v_mfma_f32_16x16x32_bf16 v[180:183], a[136:139], a[228:231], v[180:183]
    ds_read_b64_tr_b16 a[134:135], v207 offset:6144
    v_mfma_f32_16x16x32_bf16 v[180:183], a[140:143], a[236:239], v[180:183]
    s_waitcnt vmcnt(8)
    s_barrier
    ds_read_b64_tr_b16 a[136:137], v204 offset:16384
    s_and_b32 s69, s28, 0xf0000000
    s_add_u32 s69, s69, s63
    s_add_u32 m0, s42, 16384
    s_add_u32 s72, s69, 0
    v_mfma_f32_16x16x32_bf16 v[184:187], a[144:147], a[224:227], v[184:187]
    ds_read_b64_tr_b16 a[138:139], v204 offset:18432
    global_load_lds_dwordx4 v236, s[72:73] offset:0
    v_mfma_f32_16x16x32_bf16 v[184:187], a[148:151], a[232:235], v[184:187]
    ds_read_b64_tr_b16 a[140:141], v204 offset:20480
    v_mfma_f32_16x16x32_bf16 v[188:191], a[144:147], a[228:231], v[188:191]
    ds_read_b64_tr_b16 a[142:143], v204 offset:22528
    v_mfma_f32_16x16x32_bf16 v[188:191], a[148:151], a[236:239], v[188:191]
    ds_read_b64_tr_b16 a[144:145], v205 offset:16384
    s_waitcnt lgkmcnt(13)
    v_mfma_f32_16x16x32_bf16 v[160:163], a[152:155], a[240:243], v[160:163]
    ds_read_b64_tr_b16 a[146:147], v205 offset:18432
    global_load_lds_dwordx4 v237, s[72:73] offset:1024
    v_mfma_f32_16x16x32_bf16 v[160:163], a[156:159], a[248:251], v[160:163]
    ds_read_b64_tr_b16 a[148:149], v205 offset:20480
    v_mfma_f32_16x16x32_bf16 v[164:167], a[152:155], a[244:247], v[164:167]
    ds_read_b64_tr_b16 a[150:151], v205 offset:22528
    v_mfma_f32_16x16x32_bf16 v[164:167], a[156:159], a[252:255], v[164:167]
    ds_read_b64_tr_b16 a[152:153], v206 offset:16384
    v_mfma_f32_16x16x32_bf16 v[168:171], a[112:115], a[240:243], v[168:171]
    ds_read_b64_tr_b16 a[154:155], v206 offset:18432
    global_load_lds_dwordx4 v238, s[72:73] offset:2048
    v_mfma_f32_16x16x32_bf16 v[168:171], a[116:119], a[248:251], v[168:171]
    ds_read_b64_tr_b16 a[156:157], v206 offset:20480
    v_mfma_f32_16x16x32_bf16 v[172:175], a[112:115], a[244:247], v[172:175]
    ds_read_b64_tr_b16 a[158:159], v206 offset:22528
    v_mfma_f32_16x16x32_bf16 v[172:175], a[116:119], a[252:255], v[172:175]
    ds_read_b64_tr_b16 a[112:113], v207 offset:16384
    s_waitcnt lgkmcnt(13)
    v_mfma_f32_16x16x32_bf16 v[176:179], a[120:123], a[240:243], v[176:179]
    ds_read_b64_tr_b16 a[114:115], v207 offset:18432
    global_load_lds_dwordx4 v239, s[72:73] offset:3072
    v_mfma_f32_16x16x32_bf16 v[176:179], a[124:127], a[248:251], v[176:179]
    ds_read_b64_tr_b16 a[116:117], v207 offset:20480
    s_add_u32 m0, s42, 32768
    v_mfma_f32_16x16x32_bf16 v[180:183], a[120:123], a[244:247], v[180:183]
    ds_read_b64_tr_b16 a[118:119], v207 offset:22528
    s_add_u32 s72, s69, 57344
    v_mfma_f32_16x16x32_bf16 v[180:183], a[124:127], a[252:255], v[180:183]
    ds_read_b64_tr_b16 a[120:121], v204 offset:32768
    global_load_lds_dwordx4 v236, s[72:73] offset:0
    v_mfma_f32_16x16x32_bf16 v[184:187], a[128:131], a[240:243], v[184:187]
    ds_read_b64_tr_b16 a[122:123], v204 offset:34816
    v_mfma_f32_16x16x32_bf16 v[184:187], a[132:135], a[248:251], v[184:187]
    ds_read_b64_tr_b16 a[124:125], v204 offset:36864
    v_mfma_f32_16x16x32_bf16 v[188:191], a[128:131], a[244:247], v[188:191]
    ds_read_b64_tr_b16 a[126:127], v204 offset:38912
    v_mfma_f32_16x16x32_bf16 v[188:191], a[132:135], a[252:255], v[188:191]
    ds_read_b64_tr_b16 a[128:129], v205 offset:32768
    global_load_lds_dwordx4 v237, s[72:73] offset:1024
    s_waitcnt lgkmcnt(13)
    v_mfma_f32_16x16x32_bf16 v[128:131], a[136:139], v[0:3], 0
    ds_read_b64_tr_b16 a[130:131], v205 offset:34816
    v_mfma_f32_16x16x32_bf16 v[128:131], a[140:143], v[16:19], v[128:131]
    ds_read_b64_tr_b16 a[132:133], v205 offset:36864
    v_mfma_f32_16x16x32_bf16 v[132:135], a[136:139], v[8:11], 0
    ds_read_b64_tr_b16 a[134:135], v205 offset:38912
    v_mfma_f32_16x16x32_bf16 v[132:135], a[140:143], v[24:27], v[132:135]
    ds_read_b64_tr_b16 a[136:137], v206 offset:32768
    global_load_lds_dwordx4 v238, s[72:73] offset:2048
    v_mfma_f32_16x16x32_bf16 v[136:139], a[144:147], v[0:3], 0
    ds_read_b64_tr_b16 a[138:139], v206 offset:34816
    v_mfma_f32_16x16x32_bf16 v[136:139], a[148:151], v[16:19], v[136:139]
    ds_read_b64_tr_b16 a[140:141], v206 offset:36864
    v_mfma_f32_16x16x32_bf16 v[140:143], a[144:147], v[8:11], 0
    ds_read_b64_tr_b16 a[142:143], v206 offset:38912
    s_add_u32 s99, s89, s91
    v_mfma_f32_16x16x32_bf16 v[140:143], a[148:151], v[24:27], v[140:143]
    ds_read_b64_tr_b16 a[144:145], v207 offset:32768
    global_load_lds_dwordx4 v239, s[72:73] offset:3072
    s_waitcnt lgkmcnt(13)
    v_mfma_f32_16x16x32_bf16 v[144:147], a[152:155], v[0:3], 0
    ds_read_b64_tr_b16 a[146:147], v207 offset:34816
    v_cvt_pk_bf16_f32 v192, v160, v161
    v_mfma_f32_16x16x32_bf16 v[144:147], a[156:159], v[16:19], v[144:147]
    ds_read_b64_tr_b16 a[148:149], v207 offset:36864
    v_cvt_pk_bf16_f32 v193, v162, v163
    v_mfma_f32_16x16x32_bf16 v[148:151], a[152:155], v[8:11], 0
    ds_read_b64_tr_b16 a[150:151], v207 offset:38912
    v_cvt_pk_bf16_f32 v194, v168, v169
    v_mfma_f32_16x16x32_bf16 v[148:151], a[156:159], v[24:27], v[148:151]
    s_waitcnt vmcnt(8)
    s_barrier
    ds_read_b64_tr_b16 a[152:153], v204 offset:49152
    s_add_u32 m0, s42, 49152
    s_add_u32 s72, s69, 114688
    v_mfma_f32_16x16x32_bf16 v[152:155], a[112:115], v[0:3], 0
    ds_read_b64_tr_b16 a[154:155], v204 offset:51200
    global_load_lds_dwordx4 v236, s[72:73] offset:0
    v_mfma_f32_16x16x32_bf16 v[152:155], a[116:119], v[16:19], v[152:155]
    ds_read_b64_tr_b16 a[156:157], v204 offset:53248
    v_cvt_pk_bf16_f32 v195, v170, v171
    v_mfma_f32_16x16x32_bf16 v[156:159], a[112:115], v[8:11], 0
    ds_read_b64_tr_b16 a[158:159], v204 offset:55296
    buffer_store_dwordx4 v[192:195], v240, s[32:35], s99 offen offset:0 sc1
    v_mfma_f32_16x16x32_bf16 v[156:159], a[116:119], v[24:27], v[156:159]
    ds_read_b64_tr_b16 a[112:113], v205 offset:49152
    s_waitcnt lgkmcnt(13)
    v_mfma_f32_16x16x32_bf16 v[128:131], a[120:123], v[32:35], v[128:131]
    ds_read_b64_tr_b16 a[114:115], v205 offset:51200
    global_load_lds_dwordx4 v237, s[72:73] offset:1024
    v_mfma_f32_16x16x32_bf16 v[128:131], a[124:127], v[48:51], v[128:131]
    ds_read_b64_tr_b16 a[116:117], v205 offset:53248
    v_cvt_pk_bf16_f32 v196, v164, v165
    v_mfma_f32_16x16x32_bf16 v[132:135], a[120:123], v[40:43], v[132:135]
    ds_read_b64_tr_b16 a[118:119], v205 offset:55296
    v_cvt_pk_bf16_f32 v197, v166, v167
    v_mfma_f32_16x16x32_bf16 v[132:135], a[124:127], v[56:59], v[132:135]
    ds_read_b64_tr_b16 a[120:121], v206 offset:49152
    v_cvt_pk_bf16_f32 v198, v172, v173
    v_mfma_f32_16x16x32_bf16 v[136:139], a[128:131], v[32:35], v[136:139]
    ds_read_b64_tr_b16 a[122:123], v206 offset:51200
    global_load_lds_dwordx4 v238, s[72:73] offset:2048
    v_mfma_f32_16x16x32_bf16 v[136:139], a[132:135], v[48:51], v[136:139]
    ds_read_b64_tr_b16 a[124:125], v206 offset:53248
    v_cvt_pk_bf16_f32 v199, v174, v175
    v_mfma_f32_16x16x32_bf16 v[140:143], a[128:131], v[40:43], v[140:143]
    ds_read_b64_tr_b16 a[126:127], v206 offset:55296
    buffer_store_dwordx4 v[196:199], v240, s[32:35], s99 offen offset:1024 sc1
    v_mfma_f32_16x16x32_bf16 v[140:143], a[132:135], v[56:59], v[140:143]
    ds_read_b64_tr_b16 a[128:129], v207 offset:49152
    s_waitcnt lgkmcnt(13)
    v_mfma_f32_16x16x32_bf16 v[144:147], a[136:139], v[32:35], v[144:147]
    ds_read_b64_tr_b16 a[130:131], v207 offset:51200
    global_load_lds_dwordx4 v239, s[72:73] offset:3072
    v_mfma_f32_16x16x32_bf16 v[144:147], a[140:143], v[48:51], v[144:147]
    ds_read_b64_tr_b16 a[132:133], v207 offset:53248
    s_add_u32 m0, s42, 65536
    v_mfma_f32_16x16x32_bf16 v[148:151], a[136:139], v[40:43], v[148:151]
    ds_read_b64_tr_b16 a[134:135], v207 offset:55296
    s_add_u32 s72, s69, 172032
    v_mfma_f32_16x16x32_bf16 v[148:151], a[140:143], v[56:59], v[148:151]
    ds_read_b64_tr_b16 a[136:137], v200 offset:0
    global_load_lds_dwordx4 v236, s[72:73] offset:0
    v_mfma_f32_16x16x32_bf16 v[152:155], a[144:147], v[32:35], v[152:155]
    ds_read_b64_tr_b16 a[138:139], v200 offset:2048
    v_cvt_pk_bf16_f32 v192, v176, v177
    v_mfma_f32_16x16x32_bf16 v[152:155], a[148:151], v[48:51], v[152:155]
    ds_read_b64_tr_b16 a[140:141], v200 offset:4096
    v_cvt_pk_bf16_f32 v193, v178, v179
    v_mfma_f32_16x16x32_bf16 v[156:159], a[144:147], v[40:43], v[156:159]
    ds_read_b64_tr_b16 a[142:143], v200 offset:6144
    v_cvt_pk_bf16_f32 v194, v184, v185
    v_mfma_f32_16x16x32_bf16 v[156:159], a[148:151], v[56:59], v[156:159]
    ds_read_b64_tr_b16 a[144:145], v201 offset:0
    global_load_lds_dwordx4 v237, s[72:73] offset:1024
    s_waitcnt lgkmcnt(13)
    v_mfma_f32_16x16x32_bf16 v[128:131], a[152:155], v[64:67], v[128:131]
    ds_read_b64_tr_b16 a[146:147], v201 offset:2048
    v_cvt_pk_bf16_f32 v195, v186, v187
    v_mfma_f32_16x16x32_bf16 v[128:131], a[156:159], v[80:83], v[128:131]
    ds_read_b64_tr_b16 a[148:149], v201 offset:4096
    buffer_store_dwordx4 v[192:195], v240, s[32:35], s99 offen offset:2048 sc1
    v_mfma_f32_16x16x32_bf16 v[132:135], a[152:155], v[72:75], v[132:135]
    ds_read_b64_tr_b16 a[150:151], v201 offset:6144
    v_cvt_pk_bf16_f32 v196, v180, v181
    v_mfma_f32_16x16x32_bf16 v[132:135], a[156:159], v[88:91], v[132:135]
    ds_read_b64_tr_b16 a[152:153], v202 offset:0
    global_load_lds_dwordx4 v238, s[72:73] offset:2048
    v_mfma_f32_16x16x32_bf16 v[136:139], a[112:115], v[64:67], v[136:139]
    ds_read_b64_tr_b16 a[154:155], v202 offset:2048
    v_cvt_pk_bf16_f32 v197, v182, v183
    v_mfma_f32_16x16x32_bf16 v[136:139], a[116:119], v[80:83], v[136:139]
    ds_read_b64_tr_b16 a[156:157], v202 offset:4096
    v_cvt_pk_bf16_f32 v198, v188, v189
    v_mfma_f32_16x16x32_bf16 v[140:143], a[112:115], v[72:75], v[140:143]
    ds_read_b64_tr_b16 a[158:159], v202 offset:6144
    v_cvt_pk_bf16_f32 v199, v190, v191
    v_mfma_f32_16x16x32_bf16 v[140:143], a[116:119], v[88:91], v[140:143]
    ds_read_b64_tr_b16 a[112:113], v203 offset:0
    global_load_lds_dwordx4 v239, s[72:73] offset:3072
    s_waitcnt lgkmcnt(13)
    v_mfma_f32_16x16x32_bf16 v[144:147], a[120:123], v[64:67], v[144:147]
    ds_read_b64_tr_b16 a[114:115], v203 offset:2048
    buffer_store_dwordx4 v[196:199], v240, s[32:35], s99 offen offset:3072 sc1
    v_mfma_f32_16x16x32_bf16 v[144:147], a[124:127], v[80:83], v[144:147]
    ds_read_b64_tr_b16 a[116:117], v203 offset:4096
    v_mfma_f32_16x16x32_bf16 v[148:151], a[120:123], v[72:75], v[148:151]
    ds_read_b64_tr_b16 a[118:119], v203 offset:6144
    v_mfma_f32_16x16x32_bf16 v[148:151], a[124:127], v[88:91], v[148:151]
    s_waitcnt vmcnt(12)
    s_barrier
    ds_read_b64_tr_b16 a[120:121], v200 offset:16384
    s_and_b32 s69, s28, 0xf0000000
    s_add_u32 s69, s69, s88
    s_add_u32 m0, s42, 81920
    s_add_u32 s72, s69, 0
    v_mfma_f32_16x16x32_bf16 v[152:155], a[128:131], v[64:67], v[152:155]
    ds_read_b64_tr_b16 a[122:123], v200 offset:18432
    global_load_lds_dwordx4 v236, s[72:73] offset:0
    v_mfma_f32_16x16x32_bf16 v[152:155], a[132:135], v[80:83], v[152:155]
    ds_read_b64_tr_b16 a[124:125], v200 offset:20480
    v_mfma_f32_16x16x32_bf16 v[156:159], a[128:131], v[72:75], v[156:159]
    ds_read_b64_tr_b16 a[126:127], v200 offset:22528
    v_mfma_f32_16x16x32_bf16 v[156:159], a[132:135], v[88:91], v[156:159]
    ds_read_b64_tr_b16 a[128:129], v201 offset:16384
    s_waitcnt lgkmcnt(13)
    v_mfma_f32_16x16x32_bf16 v[128:131], a[136:139], v[96:99], v[128:131]
    ds_read_b64_tr_b16 a[130:131], v201 offset:18432
    global_load_lds_dwordx4 v237, s[72:73] offset:1024
    v_mfma_f32_16x16x32_bf16 v[128:131], a[140:143], v[112:115], v[128:131]
    ds_read_b64_tr_b16 a[132:133], v201 offset:20480
    v_mfma_f32_16x16x32_bf16 v[132:135], a[136:139], v[104:107], v[132:135]
    ds_read_b64_tr_b16 a[134:135], v201 offset:22528
    v_mfma_f32_16x16x32_bf16 v[132:135], a[140:143], v[120:123], v[132:135]
    ds_read_b64_tr_b16 a[136:137], v202 offset:16384
    v_mfma_f32_16x16x32_bf16 v[136:139], a[144:147], v[96:99], v[136:139]
    ds_read_b64_tr_b16 a[138:139], v202 offset:18432
    global_load_lds_dwordx4 v238, s[72:73] offset:2048
    v_mfma_f32_16x16x32_bf16 v[136:139], a[148:151], v[112:115], v[136:139]
    ds_read_b64_tr_b16 a[140:141], v202 offset:20480
    v_mfma_f32_16x16x32_bf16 v[140:143], a[144:147], v[104:107], v[140:143]
    ds_read_b64_tr_b16 a[142:143], v202 offset:22528
    v_mfma_f32_16x16x32_bf16 v[140:143], a[148:151], v[120:123], v[140:143]
    ds_read_b64_tr_b16 a[144:145], v203 offset:16384
    s_waitcnt lgkmcnt(13)
    v_mfma_f32_16x16x32_bf16 v[144:147], a[152:155], v[96:99], v[144:147]
    ds_read_b64_tr_b16 a[146:147], v203 offset:18432
    global_load_lds_dwordx4 v239, s[72:73] offset:3072
    v_mfma_f32_16x16x32_bf16 v[144:147], a[156:159], v[112:115], v[144:147]
    ds_read_b64_tr_b16 a[148:149], v203 offset:20480
    s_add_u32 m0, s42, 98304
    v_mfma_f32_16x16x32_bf16 v[148:151], a[152:155], v[104:107], v[148:151]
    ds_read_b64_tr_b16 a[150:151], v203 offset:22528
    s_add_u32 s72, s69, 57344
    v_mfma_f32_16x16x32_bf16 v[148:151], a[156:159], v[120:123], v[148:151]
    ds_read_b64_tr_b16 a[152:153], v200 offset:32768
    global_load_lds_dwordx4 v236, s[72:73] offset:0
    v_mfma_f32_16x16x32_bf16 v[152:155], a[112:115], v[96:99], v[152:155]
    ds_read_b64_tr_b16 a[154:155], v200 offset:34816
    v_mfma_f32_16x16x32_bf16 v[152:155], a[116:119], v[112:115], v[152:155]
    ds_read_b64_tr_b16 a[156:157], v200 offset:36864
    v_mfma_f32_16x16x32_bf16 v[156:159], a[112:115], v[104:107], v[156:159]
    ds_read_b64_tr_b16 a[158:159], v200 offset:38912
    v_mfma_f32_16x16x32_bf16 v[156:159], a[116:119], v[120:123], v[156:159]
    ds_read_b64_tr_b16 a[112:113], v201 offset:32768
    global_load_lds_dwordx4 v237, s[72:73] offset:1024
    s_waitcnt lgkmcnt(13)
    v_mfma_f32_16x16x32_bf16 v[128:131], a[120:123], a[192:195], v[128:131]
    ds_read_b64_tr_b16 a[114:115], v201 offset:34816
    v_mfma_f32_16x16x32_bf16 v[128:131], a[124:127], a[200:203], v[128:131]
    ds_read_b64_tr_b16 a[116:117], v201 offset:36864
    v_mfma_f32_16x16x32_bf16 v[132:135], a[120:123], a[196:199], v[132:135]
    ds_read_b64_tr_b16 a[118:119], v201 offset:38912
    v_mfma_f32_16x16x32_bf16 v[132:135], a[124:127], a[204:207], v[132:135]
    ds_read_b64_tr_b16 a[120:121], v202 offset:32768
    global_load_lds_dwordx4 v238, s[72:73] offset:2048
    v_mfma_f32_16x16x32_bf16 v[136:139], a[128:131], a[192:195], v[136:139]
    ds_read_b64_tr_b16 a[122:123], v202 offset:34816
    v_mfma_f32_16x16x32_bf16 v[136:139], a[132:135], a[200:203], v[136:139]
    ds_read_b64_tr_b16 a[124:125], v202 offset:36864
    v_mfma_f32_16x16x32_bf16 v[140:143], a[128:131], a[196:199], v[140:143]
    ds_read_b64_tr_b16 a[126:127], v202 offset:38912
    v_mfma_f32_16x16x32_bf16 v[140:143], a[132:135], a[204:207], v[140:143]
    ds_read_b64_tr_b16 a[128:129], v203 offset:32768
    global_load_lds_dwordx4 v239, s[72:73] offset:3072
    s_waitcnt lgkmcnt(13)
    v_mfma_f32_16x16x32_bf16 v[144:147], a[136:139], a[192:195], v[144:147]
    ds_read_b64_tr_b16 a[130:131], v203 offset:34816
    v_mfma_f32_16x16x32_bf16 v[144:147], a[140:143], a[200:203], v[144:147]
    ds_read_b64_tr_b16 a[132:133], v203 offset:36864
    v_mfma_f32_16x16x32_bf16 v[148:151], a[136:139], a[196:199], v[148:151]
    ds_read_b64_tr_b16 a[134:135], v203 offset:38912
    v_mfma_f32_16x16x32_bf16 v[148:151], a[140:143], a[204:207], v[148:151]
    s_waitcnt vmcnt(9)
    s_barrier
    ds_read_b64_tr_b16 a[136:137], v200 offset:49152
    s_add_u32 m0, s42, 114688
    s_add_u32 s72, s69, 114688
    v_mfma_f32_16x16x32_bf16 v[152:155], a[144:147], a[192:195], v[152:155]
    ds_read_b64_tr_b16 a[138:139], v200 offset:51200
    global_load_lds_dwordx4 v236, s[72:73] offset:0
    v_mfma_f32_16x16x32_bf16 v[152:155], a[148:151], a[200:203], v[152:155]
    ds_read_b64_tr_b16 a[140:141], v200 offset:53248
    v_mfma_f32_16x16x32_bf16 v[156:159], a[144:147], a[196:199], v[156:159]
    ds_read_b64_tr_b16 a[142:143], v200 offset:55296
    v_mfma_f32_16x16x32_bf16 v[156:159], a[148:151], a[204:207], v[156:159]
    ds_read_b64_tr_b16 a[144:145], v201 offset:49152
    s_waitcnt lgkmcnt(13)
    v_mfma_f32_16x16x32_bf16 v[128:131], a[152:155], a[208:211], v[128:131]
    ds_read_b64_tr_b16 a[146:147], v201 offset:51200
    global_load_lds_dwordx4 v237, s[72:73] offset:1024
    v_mfma_f32_16x16x32_bf16 v[128:131], a[156:159], a[216:219], v[128:131]
    ds_read_b64_tr_b16 a[148:149], v201 offset:53248
    v_mfma_f32_16x16x32_bf16 v[132:135], a[152:155], a[212:215], v[132:135]
    ds_read_b64_tr_b16 a[150:151], v201 offset:55296
    v_mfma_f32_16x16x32_bf16 v[132:135], a[156:159], a[220:223], v[132:135]
    ds_read_b64_tr_b16 a[152:153], v202 offset:49152
    v_mfma_f32_16x16x32_bf16 v[136:139], a[112:115], a[208:211], v[136:139]
    ds_read_b64_tr_b16 a[154:155], v202 offset:51200
    global_load_lds_dwordx4 v238, s[72:73] offset:2048
    v_mfma_f32_16x16x32_bf16 v[136:139], a[116:119], a[216:219], v[136:139]
    ds_read_b64_tr_b16 a[156:157], v202 offset:53248
    v_mfma_f32_16x16x32_bf16 v[140:143], a[112:115], a[212:215], v[140:143]
    ds_read_b64_tr_b16 a[158:159], v202 offset:55296
    v_mfma_f32_16x16x32_bf16 v[140:143], a[116:119], a[220:223], v[140:143]
    ds_read_b64_tr_b16 a[112:113], v203 offset:49152
    s_waitcnt lgkmcnt(13)
    v_mfma_f32_16x16x32_bf16 v[144:147], a[120:123], a[208:211], v[144:147]
    ds_read_b64_tr_b16 a[114:115], v203 offset:51200
    global_load_lds_dwordx4 v239, s[72:73] offset:3072
    v_mfma_f32_16x16x32_bf16 v[144:147], a[124:127], a[216:219], v[144:147]
    ds_read_b64_tr_b16 a[116:117], v203 offset:53248
    s_add_u32 m0, s42, 0
    v_mfma_f32_16x16x32_bf16 v[148:151], a[120:123], a[212:215], v[148:151]
    ds_read_b64_tr_b16 a[118:119], v203 offset:55296
    s_add_u32 s72, s69, 172032
    v_mfma_f32_16x16x32_bf16 v[148:151], a[124:127], a[220:223], v[148:151]
    ds_read_b64_tr_b16 a[120:121], v204 offset:0
    global_load_lds_dwordx4 v236, s[72:73] offset:0
    v_mfma_f32_16x16x32_bf16 v[152:155], a[128:131], a[208:211], v[152:155]
    ds_read_b64_tr_b16 a[122:123], v204 offset:2048
    v_mfma_f32_16x16x32_bf16 v[152:155], a[132:135], a[216:219], v[152:155]
    ds_read_b64_tr_b16 a[124:125], v204 offset:4096
    v_mfma_f32_16x16x32_bf16 v[156:159], a[128:131], a[212:215], v[156:159]
    ds_read_b64_tr_b16 a[126:127], v204 offset:6144
    v_mfma_f32_16x16x32_bf16 v[156:159], a[132:135], a[220:223], v[156:159]
    ds_read_b64_tr_b16 a[128:129], v205 offset:0
    global_load_lds_dwordx4 v237, s[72:73] offset:1024
    s_waitcnt lgkmcnt(13)
    v_mfma_f32_16x16x32_bf16 v[128:131], a[136:139], a[224:227], v[128:131]
    ds_read_b64_tr_b16 a[130:131], v205 offset:2048
    v_mfma_f32_16x16x32_bf16 v[128:131], a[140:143], a[232:235], v[128:131]
    ds_read_b64_tr_b16 a[132:133], v205 offset:4096
    v_mfma_f32_16x16x32_bf16 v[132:135], a[136:139], a[228:231], v[132:135]
    ds_read_b64_tr_b16 a[134:135], v205 offset:6144
    v_mfma_f32_16x16x32_bf16 v[132:135], a[140:143], a[236:239], v[132:135]
    ds_read_b64_tr_b16 a[136:137], v206 offset:0
    global_load_lds_dwordx4 v238, s[72:73] offset:2048
    v_mfma_f32_16x16x32_bf16 v[136:139], a[144:147], a[224:227], v[136:139]
    ds_read_b64_tr_b16 a[138:139], v206 offset:2048
    v_mfma_f32_16x16x32_bf16 v[136:139], a[148:151], a[232:235], v[136:139]
    ds_read_b64_tr_b16 a[140:141], v206 offset:4096
    v_mfma_f32_16x16x32_bf16 v[140:143], a[144:147], a[228:231], v[140:143]
    ds_read_b64_tr_b16 a[142:143], v206 offset:6144
    v_mfma_f32_16x16x32_bf16 v[140:143], a[148:151], a[236:239], v[140:143]
    ds_read_b64_tr_b16 a[144:145], v207 offset:0
    global_load_lds_dwordx4 v239, s[72:73] offset:3072
    s_waitcnt lgkmcnt(13)
    v_mfma_f32_16x16x32_bf16 v[144:147], a[152:155], a[224:227], v[144:147]
    ds_read_b64_tr_b16 a[146:147], v207 offset:2048
    v_mfma_f32_16x16x32_bf16 v[144:147], a[156:159], a[232:235], v[144:147]
    ds_read_b64_tr_b16 a[148:149], v207 offset:4096
    v_mfma_f32_16x16x32_bf16 v[148:151], a[152:155], a[228:231], v[148:151]
    ds_read_b64_tr_b16 a[150:151], v207 offset:6144
    v_mfma_f32_16x16x32_bf16 v[148:151], a[156:159], a[236:239], v[148:151]
    s_waitcnt vmcnt(8)
    s_barrier
    ds_read_b64_tr_b16 a[152:153], v210 offset:16384
    v_mfma_f32_16x16x32_bf16 v[152:155], a[112:115], a[224:227], v[152:155]
    ds_read_b64_tr_b16 a[154:155], v210 offset:18432
    v_mfma_f32_16x16x32_bf16 v[152:155], a[116:119], a[232:235], v[152:155]
    ds_read_b64_tr_b16 a[156:157], v210 offset:20480
    v_mfma_f32_16x16x32_bf16 v[156:159], a[112:115], a[228:231], v[156:159]
    ds_read_b64_tr_b16 a[158:159], v210 offset:22528
    v_mfma_f32_16x16x32_bf16 v[156:159], a[116:119], a[236:239], v[156:159]
    ds_read_b64_tr_b16 a[112:113], v211 offset:16384
    s_waitcnt lgkmcnt(13)
    v_mfma_f32_16x16x32_bf16 v[128:131], a[120:123], a[240:243], v[128:131]
    ds_read_b64_tr_b16 a[114:115], v211 offset:18432
    v_mfma_f32_16x16x32_bf16 v[128:131], a[124:127], a[248:251], v[128:131]
    ds_read_b64_tr_b16 a[116:117], v211 offset:20480
    v_mfma_f32_16x16x32_bf16 v[132:135], a[120:123], a[244:247], v[132:135]
    ds_read_b64_tr_b16 a[118:119], v211 offset:22528
    v_mfma_f32_16x16x32_bf16 v[132:135], a[124:127], a[252:255], v[132:135]
    ds_read_b64_tr_b16 a[120:121], v214 offset:16384
    v_mfma_f32_16x16x32_bf16 v[136:139], a[128:131], a[240:243], v[136:139]
    ds_read_b64_tr_b16 a[122:123], v214 offset:18432
    v_mfma_f32_16x16x32_bf16 v[136:139], a[132:135], a[248:251], v[136:139]
    ds_read_b64_tr_b16 a[124:125], v214 offset:20480
    v_mfma_f32_16x16x32_bf16 v[140:143], a[128:131], a[244:247], v[140:143]
    ds_read_b64_tr_b16 a[126:127], v214 offset:22528
    v_mfma_f32_16x16x32_bf16 v[140:143], a[132:135], a[252:255], v[140:143]
    ds_read_b64_tr_b16 a[128:129], v215 offset:16384
    s_waitcnt lgkmcnt(13)
    v_mfma_f32_16x16x32_bf16 v[144:147], a[136:139], a[240:243], v[144:147]
    ds_read_b64_tr_b16 a[130:131], v215 offset:18432
    v_mfma_f32_16x16x32_bf16 v[144:147], a[140:143], a[248:251], v[144:147]
    ds_read_b64_tr_b16 a[132:133], v215 offset:20480
    v_mfma_f32_16x16x32_bf16 v[148:151], a[136:139], a[244:247], v[148:151]
    ds_read_b64_tr_b16 a[134:135], v215 offset:22528
    v_mfma_f32_16x16x32_bf16 v[148:151], a[140:143], a[252:255], v[148:151]
    ds_read_b64_tr_b16 a[136:137], v210 offset:32768
    v_mfma_f32_16x16x32_bf16 v[152:155], a[144:147], a[240:243], v[152:155]
    ds_read_b64_tr_b16 a[138:139], v210 offset:34816
    v_mfma_f32_16x16x32_bf16 v[152:155], a[148:151], a[248:251], v[152:155]
    ds_read_b64_tr_b16 a[140:141], v210 offset:36864
    v_mfma_f32_16x16x32_bf16 v[156:159], a[144:147], a[244:247], v[156:159]
    ds_read_b64_tr_b16 a[142:143], v210 offset:38912
    v_mfma_f32_16x16x32_bf16 v[156:159], a[148:151], a[252:255], v[156:159]
    ds_read_b64_tr_b16 a[144:145], v211 offset:32768
    s_waitcnt lgkmcnt(13)
    v_mfma_f32_16x16x32_bf16 v[160:163], a[152:155], v[0:3], 0
    ds_read_b64_tr_b16 a[146:147], v211 offset:34816
    v_mfma_f32_16x16x32_bf16 v[160:163], a[156:159], v[16:19], v[160:163]
    ds_read_b64_tr_b16 a[148:149], v211 offset:36864
    v_mfma_f32_16x16x32_bf16 v[164:167], a[152:155], v[8:11], 0
    ds_read_b64_tr_b16 a[150:151], v211 offset:38912
    v_mfma_f32_16x16x32_bf16 v[164:167], a[156:159], v[24:27], v[164:167]
    ds_read_b64_tr_b16 a[152:153], v214 offset:32768
    v_mfma_f32_16x16x32_bf16 v[168:171], a[112:115], v[0:3], 0
    ds_read_b64_tr_b16 a[154:155], v214 offset:34816
    v_mfma_f32_16x16x32_bf16 v[168:171], a[116:119], v[16:19], v[168:171]
    ds_read_b64_tr_b16 a[156:157], v214 offset:36864
    v_mfma_f32_16x16x32_bf16 v[172:175], a[112:115], v[8:11], 0
    ds_read_b64_tr_b16 a[158:159], v214 offset:38912
    s_add_u32 s99, s89, s92
    v_mfma_f32_16x16x32_bf16 v[172:175], a[116:119], v[24:27], v[172:175]
    ds_read_b64_tr_b16 a[112:113], v215 offset:32768
    s_waitcnt lgkmcnt(13)
    v_mfma_f32_16x16x32_bf16 v[160:163], a[120:123], a[192:195], v[160:163]
    ds_read_b64_tr_b16 a[114:115], v215 offset:34816
    v_cvt_pk_bf16_f32 v192, v128, v129
    v_mfma_f32_16x16x32_bf16 v[160:163], a[124:127], a[200:203], v[160:163]
    ds_read_b64_tr_b16 a[116:117], v215 offset:36864
    v_cvt_pk_bf16_f32 v193, v130, v131
    v_mfma_f32_16x16x32_bf16 v[164:167], a[120:123], a[196:199], v[164:167]
    ds_read_b64_tr_b16 a[118:119], v215 offset:38912
    v_cvt_pk_bf16_f32 v194, v136, v137
    v_mfma_f32_16x16x32_bf16 v[164:167], a[124:127], a[204:207], v[164:167]
    s_waitcnt vmcnt(0)
    s_barrier
    ds_read_b64_tr_b16 a[120:121], v210 offset:49152
    v_mfma_f32_16x16x32_bf16 v[168:171], a[128:131], a[192:195], v[168:171]
    ds_read_b64_tr_b16 a[122:123], v210 offset:51200
    v_cvt_pk_bf16_f32 v195, v138, v139
    v_mfma_f32_16x16x32_bf16 v[168:171], a[132:135], a[200:203], v[168:171]
    ds_read_b64_tr_b16 a[124:125], v210 offset:53248
    buffer_store_dwordx4 v[192:195], v240, s[32:35], s99 offen offset:0 sc1
    v_mfma_f32_16x16x32_bf16 v[172:175], a[128:131], a[196:199], v[172:175]
    ds_read_b64_tr_b16 a[126:127], v210 offset:55296
    v_cvt_pk_bf16_f32 v196, v132, v133
    v_mfma_f32_16x16x32_bf16 v[172:175], a[132:135], a[204:207], v[172:175]
    ds_read_b64_tr_b16 a[128:129], v211 offset:49152
    s_waitcnt lgkmcnt(13)
    v_mfma_f32_16x16x32_bf16 v[160:163], a[136:139], v[32:35], v[160:163]
    ds_read_b64_tr_b16 a[130:131], v211 offset:51200
    v_cvt_pk_bf16_f32 v197, v134, v135
    v_mfma_f32_16x16x32_bf16 v[160:163], a[140:143], v[48:51], v[160:163]
    ds_read_b64_tr_b16 a[132:133], v211 offset:53248
    v_cvt_pk_bf16_f32 v198, v140, v141
    v_mfma_f32_16x16x32_bf16 v[164:167], a[136:139], v[40:43], v[164:167]
    ds_read_b64_tr_b16 a[134:135], v211 offset:55296
    v_cvt_pk_bf16_f32 v199, v142, v143
    v_mfma_f32_16x16x32_bf16 v[164:167], a[140:143], v[56:59], v[164:167]
    ds_read_b64_tr_b16 a[136:137], v214 offset:49152
    buffer_store_dwordx4 v[196:199], v240, s[32:35], s99 offen offset:1024 sc1
    v_mfma_f32_16x16x32_bf16 v[168:171], a[144:147], v[32:35], v[168:171]
    ds_read_b64_tr_b16 a[138:139], v214 offset:51200
    v_cvt_pk_bf16_f32 v192, v144, v145
    v_mfma_f32_16x16x32_bf16 v[168:171], a[148:151], v[48:51], v[168:171]
    ds_read_b64_tr_b16 a[140:141], v214 offset:53248
    v_cvt_pk_bf16_f32 v193, v146, v147
    v_mfma_f32_16x16x32_bf16 v[172:175], a[144:147], v[40:43], v[172:175]
    ds_read_b64_tr_b16 a[142:143], v214 offset:55296
    v_cvt_pk_bf16_f32 v194, v152, v153
    v_mfma_f32_16x16x32_bf16 v[172:175], a[148:151], v[56:59], v[172:175]
    ds_read_b64_tr_b16 a[144:145], v215 offset:49152
    s_waitcnt lgkmcnt(13)
    v_mfma_f32_16x16x32_bf16 v[160:163], a[152:155], a[208:211], v[160:163]
    ds_read_b64_tr_b16 a[146:147], v215 offset:51200
    v_cvt_pk_bf16_f32 v195, v154, v155
    v_mfma_f32_16x16x32_bf16 v[160:163], a[156:159], a[216:219], v[160:163]
    ds_read_b64_tr_b16 a[148:149], v215 offset:53248
    buffer_store_dwordx4 v[192:195], v240, s[32:35], s99 offen offset:2048 sc1
    v_mfma_f32_16x16x32_bf16 v[164:167], a[152:155], a[212:215], v[164:167]
    ds_read_b64_tr_b16 a[150:151], v215 offset:55296
    v_cvt_pk_bf16_f32 v196, v148, v149
    v_mfma_f32_16x16x32_bf16 v[164:167], a[156:159], a[220:223], v[164:167]
    ds_read_b64_tr_b16 a[152:153], v208 offset:0
    v_cvt_pk_bf16_f32 v197, v150, v151
    v_mfma_f32_16x16x32_bf16 v[168:171], a[112:115], a[208:211], v[168:171]
    ds_read_b64_tr_b16 a[154:155], v208 offset:2048
    v_cvt_pk_bf16_f32 v198, v156, v157
    v_mfma_f32_16x16x32_bf16 v[168:171], a[116:119], a[216:219], v[168:171]
    ds_read_b64_tr_b16 a[156:157], v208 offset:4096
    v_cvt_pk_bf16_f32 v199, v158, v159
    v_mfma_f32_16x16x32_bf16 v[172:175], a[112:115], a[212:215], v[172:175]
    ds_read_b64_tr_b16 a[158:159], v208 offset:6144
    buffer_store_dwordx4 v[196:199], v240, s[32:35], s99 offen offset:3072 sc1
    v_mfma_f32_16x16x32_bf16 v[172:175], a[116:119], a[220:223], v[172:175]
    ds_read_b64_tr_b16 a[112:113], v209 offset:0
    s_waitcnt lgkmcnt(13)
    v_mfma_f32_16x16x32_bf16 v[160:163], a[120:123], v[64:67], v[160:163]
    ds_read_b64_tr_b16 a[114:115], v209 offset:2048
    v_mfma_f32_16x16x32_bf16 v[160:163], a[124:127], v[80:83], v[160:163]
    ds_read_b64_tr_b16 a[116:117], v209 offset:4096
    v_mfma_f32_16x16x32_bf16 v[164:167], a[120:123], v[72:75], v[164:167]
    ds_read_b64_tr_b16 a[118:119], v209 offset:6144
    v_mfma_f32_16x16x32_bf16 v[164:167], a[124:127], v[88:91], v[164:167]
    ds_read_b64_tr_b16 a[120:121], v212 offset:0
    v_mfma_f32_16x16x32_bf16 v[168:171], a[128:131], v[64:67], v[168:171]
    ds_read_b64_tr_b16 a[122:123], v212 offset:2048
    v_mfma_f32_16x16x32_bf16 v[168:171], a[132:135], v[80:83], v[168:171]
    ds_read_b64_tr_b16 a[124:125], v212 offset:4096
    v_mfma_f32_16x16x32_bf16 v[172:175], a[128:131], v[72:75], v[172:175]
    ds_read_b64_tr_b16 a[126:127], v212 offset:6144
    v_mfma_f32_16x16x32_bf16 v[172:175], a[132:135], v[88:91], v[172:175]
    ds_read_b64_tr_b16 a[128:129], v213 offset:0
    s_waitcnt lgkmcnt(13)
    v_mfma_f32_16x16x32_bf16 v[160:163], a[136:139], a[224:227], v[160:163]
    ds_read_b64_tr_b16 a[130:131], v213 offset:2048
    v_mfma_f32_16x16x32_bf16 v[160:163], a[140:143], a[232:235], v[160:163]
    ds_read_b64_tr_b16 a[132:133], v213 offset:4096
    v_mfma_f32_16x16x32_bf16 v[164:167], a[136:139], a[228:231], v[164:167]
    ds_read_b64_tr_b16 a[134:135], v213 offset:6144
    v_mfma_f32_16x16x32_bf16 v[164:167], a[140:143], a[236:239], v[164:167]
    v_mfma_f32_16x16x32_bf16 v[168:171], a[144:147], a[224:227], v[168:171]
    v_mfma_f32_16x16x32_bf16 v[168:171], a[148:151], a[232:235], v[168:171]
    v_mfma_f32_16x16x32_bf16 v[172:175], a[144:147], a[228:231], v[172:175]
    v_mfma_f32_16x16x32_bf16 v[172:175], a[148:151], a[236:239], v[172:175]
    s_waitcnt lgkmcnt(8)
    v_mfma_f32_16x16x32_bf16 v[160:163], a[152:155], v[96:99], v[160:163]
    v_mfma_f32_16x16x32_bf16 v[160:163], a[156:159], v[112:115], v[160:163]
    v_mfma_f32_16x16x32_bf16 v[164:167], a[152:155], v[104:107], v[164:167]
    v_mfma_f32_16x16x32_bf16 v[164:167], a[156:159], v[120:123], v[164:167]
    v_mfma_f32_16x16x32_bf16 v[168:171], a[112:115], v[96:99], v[168:171]
    v_mfma_f32_16x16x32_bf16 v[168:171], a[116:119], v[112:115], v[168:171]
    v_mfma_f32_16x16x32_bf16 v[172:175], a[112:115], v[104:107], v[172:175]
    v_mfma_f32_16x16x32_bf16 v[172:175], a[116:119], v[120:123], v[172:175]
    s_waitcnt lgkmcnt(0)
    v_mfma_f32_16x16x32_bf16 v[160:163], a[120:123], a[240:243], v[160:163]
    v_mfma_f32_16x16x32_bf16 v[160:163], a[124:127], a[248:251], v[160:163]
    v_mfma_f32_16x16x32_bf16 v[164:167], a[120:123], a[244:247], v[164:167]
    v_mfma_f32_16x16x32_bf16 v[164:167], a[124:127], a[252:255], v[164:167]
    v_mfma_f32_16x16x32_bf16 v[168:171], a[128:131], a[240:243], v[168:171]
    v_mfma_f32_16x16x32_bf16 v[168:171], a[132:135], a[248:251], v[168:171]
    v_mfma_f32_16x16x32_bf16 v[172:175], a[128:131], a[244:247], v[172:175]
    v_mfma_f32_16x16x32_bf16 v[172:175], a[132:135], a[252:255], v[172:175]
    s_add_u32 s99, s89, s93
    s_nop 0
    v_cvt_pk_bf16_f32 v192, v160, v161
    v_cvt_pk_bf16_f32 v193, v162, v163
    s_nop 1
    v_cvt_pk_bf16_f32 v194, v168, v169
    v_cvt_pk_bf16_f32 v195, v170, v171
    buffer_store_dwordx4 v[192:195], v240, s[32:35], s99 offen offset:0 sc1
    v_cvt_pk_bf16_f32 v196, v164, v165
    v_cvt_pk_bf16_f32 v197, v166, v167
    v_cvt_pk_bf16_f32 v198, v172, v173
    v_cvt_pk_bf16_f32 v199, v174, v175
    buffer_store_dwordx4 v[196:199], v240, s[32:35], s99 offen offset:1024 sc1
    s_waitcnt vmcnt(0)
    s_barrier
    v_cmp_gt_u32 vcc, 256, v241
    s_nop 1
    v_cndmask_b32 v252, v241, 0, vcc
    s_lshl_b32 s98, s2, 7
    s_add_u32 s98, s98, 29360128
    v_mov_b32 v253, 2
    buffer_store_dword v253, v252, s[32:35], s98 offen offset:0 sc1
    s_cmp_eq_u32 s38, 3
    s_cbranch_scc1 L_w3
    s_add_u32 s48, s52, 14680064
    buffer_load_dwordx4 v[4:7], v240, s[32:35], s48 offen offset:0 sc1
    s_add_u32 s49, s52, 14737408
    buffer_load_dwordx4 v[12:15], v240, s[32:35], s49 offen offset:0 sc1
    s_add_u32 s48, s52, 14794752
    buffer_load_dwordx4 v[20:23], v240, s[32:35], s48 offen offset:0 sc1
    s_add_u32 s49, s52, 14852096
    buffer_load_dwordx4 v[28:31], v240, s[32:35], s49 offen offset:0 sc1
    s_add_u32 s48, s52, 14909440
    buffer_load_dwordx4 v[36:39], v240, s[32:35], s48 offen offset:0 sc1
    s_add_u32 s49, s52, 14966784
    buffer_load_dwordx4 v[44:47], v240, s[32:35], s49 offen offset:0 sc1
    s_add_u32 s48, s52, 15024128
    buffer_load_dwordx4 v[52:55], v240, s[32:35], s48 offen offset:0 sc1
    s_add_u32 s49, s52, 15081472
    buffer_load_dwordx4 v[60:63], v240, s[32:35], s49 offen offset:0 sc1
    s_add_u32 s48, s53, 14680064
    buffer_load_dwordx4 v[68:71], v240, s[32:35], s48 offen offset:0 sc1
    s_add_u32 s49, s53, 14737408
    buffer_load_dwordx4 v[76:79], v240, s[32:35], s49 offen offset:0 sc1
    s_add_u32 s48, s53, 14794752
    buffer_load_dwordx4 v[84:87], v240, s[32:35], s48 offen offset:0 sc1
    s_add_u32 s49, s53, 14852096
    buffer_load_dwordx4 v[92:95], v240, s[32:35], s49 offen offset:0 sc1
    s_add_u32 s48, s53, 14909440
    buffer_load_dwordx4 v[100:103], v240, s[32:35], s48 offen offset:0 sc1
    s_add_u32 s49, s53, 14966784
    buffer_load_dwordx4 v[108:111], v240, s[32:35], s49 offen offset:0 sc1
    s_add_u32 s48, s53, 15024128
    buffer_load_dwordx4 v[116:119], v240, s[32:35], s48 offen offset:0 sc1
    s_add_u32 s49, s53, 15081472
    buffer_load_dwordx4 v[124:127], v240, s[32:35], s49 offen offset:0 sc1
    s_branch L_poll_done
L_w3:
    s_mov_b32 s99, 200000
    s_lshl_b32 s100, s37, 10
    s_add_u32 s100, s100, 29360128
    v_lshlrev_b32 v254, 7, v249
    v_mov_b32 v253, 0x7ffffff0
    v_cmp_gt_u32 vcc, 8, v249
    s_nop 1
    v_cndmask_b32 v254, v253, v254, vcc
L_poll:
    buffer_load_dword v242, v254, s[32:35], s100 offen sc1
    s_waitcnt vmcnt(0)
    v_cmp_eq_u32 vcc, 2, v242
    s_nop 4
    s_and_b32 s3, vcc_lo, 0xff
    s_cmp_eq_u32 s3, 0xff
    s_cbranch_scc1 L_poll_done
    s_sleep 1
    s_sub_u32 s99, s99, 1
    s_cmp_lg_u32 s99, 0
    s_cbranch_scc1 L_poll
L_poll_done:
    s_barrier
    s_cmp_eq_u32 s38, 3
    s_cbranch_scc0 L_w3g
    s_add_u32 s48, s52, 14680064
    buffer_load_dwordx4 v[4:7], v240, s[32:35], s48 offen offset:0 sc1
    s_add_u32 s49, s52, 14737408
    buffer_load_dwordx4 v[12:15], v240, s[32:35], s49 offen offset:0 sc1
    s_add_u32 s48, s52, 14794752
    buffer_load_dwordx4 v[20:23], v240, s[32:35], s48 offen offset:0 sc1
    s_add_u32 s49, s52, 14852096
    buffer_load_dwordx4 v[28:31], v240, s[32:35], s49 offen offset:0 sc1
    s_add_u32 s48, s52, 14909440
    buffer_load_dwordx4 v[36:39], v240, s[32:35], s48 offen offset:0 sc1
    s_add_u32 s49, s52, 14966784
    buffer_load_dwordx4 v[44:47], v240, s[32:35], s49 offen offset:0 sc1
    s_add_u32 s48, s52, 15024128
    buffer_load_dwordx4 v[52:55], v240, s[32:35], s48 offen offset:0 sc1
    s_add_u32 s49, s52, 15081472
    buffer_load_dwordx4 v[60:63], v240, s[32:35], s49 offen offset:0 sc1
L_w3g:
    s_add_u32 s48, s52, 0
    buffer_load_dwordx4 v[128:131], v240, s[32:35], s48 offen offset:0 sc1
    s_add_u32 s49, s52, 57344
    buffer_load_dwordx4 v[132:135], v240, s[32:35], s49 offen offset:0 sc1
    s_add_u32 s48, s52, 114688
    buffer_load_dwordx4 v[136:139], v240, s[32:35], s48 offen offset:0 sc1
    s_add_u32 s49, s52, 172032
    buffer_load_dwordx4 v[140:143], v240, s[32:35], s49 offen offset:0 sc1
    s_add_u32 s48, s52, 229376
    buffer_load_dwordx4 v[144:147], v240, s[32:35], s48 offen offset:0 sc1
    s_add_u32 s49, s52, 286720
    buffer_load_dwordx4 v[148:151], v240, s[32:35], s49 offen offset:0 sc1
    s_add_u32 s48, s52, 344064
    buffer_load_dwordx4 v[152:155], v240, s[32:35], s48 offen offset:0 sc1
    s_add_u32 s49, s52, 401408
    buffer_load_dwordx4 v[156:159], v240, s[32:35], s49 offen offset:0 sc1
    s_add_u32 s48, s53, 0
    buffer_load_dwordx4 v[160:163], v240, s[32:35], s48 offen offset:0 sc1
    s_add_u32 s49, s53, 57344
    buffer_load_dwordx4 v[164:167], v240, s[32:35], s49 offen offset:0 sc1
    s_add_u32 s48, s53, 114688
    buffer_load_dwordx4 v[168:171], v240, s[32:35], s48 offen offset:0 sc1
    s_add_u32 s49, s53, 172032
    buffer_load_dwordx4 v[172:175], v240, s[32:35], s49 offen offset:0 sc1
    s_add_u32 s48, s53, 229376
    buffer_load_dwordx4 v[176:179], v240, s[32:35], s48 offen offset:0 sc1
    s_add_u32 s49, s53, 286720
    buffer_load_dwordx4 v[180:183], v240, s[32:35], s49 offen offset:0 sc1
    s_add_u32 s48, s53, 344064
    buffer_load_dwordx4 v[184:187], v240, s[32:35], s48 offen offset:0 sc1
    s_add_u32 s49, s53, 401408
    buffer_load_dwordx4 v[188:191], v240, s[32:35], s49 offen offset:0 sc1
    s_mov_b32 s98, 896
    v_lshlrev_b32 v232, 4, v251
    v_mad_u32_u24 v232, v250, s98, v232
    buffer_load_dwordx4 v[192:195], v232, s[16:19], s54 offen offset:0
    buffer_load_dwordx4 v[196:199], v232, s[16:19], s55 offen offset:0
    s_waitcnt vmcnt(18)
    v_dot2_f32_bf16 v200, v4, s56, 0
    v_dot2_f32_bf16 v201, v4, s57, 0
    v_dot2_f32_bf16 v202, v5, s56, 0
    v_dot2_f32_bf16 v203, v5, s57, 0
    v_dot2_f32_bf16 v204, v6, s56, 0
    v_dot2_f32_bf16 v205, v6, s57, 0
    v_dot2_f32_bf16 v206, v7, s56, 0
    v_dot2_f32_bf16 v207, v7, s57, 0
    v_dot2_f32_bf16 v200, v12, s56, v200
    v_dot2_f32_bf16 v201, v12, s57, v201
    v_dot2_f32_bf16 v202, v13, s56, v202
    v_dot2_f32_bf16 v203, v13, s57, v203
    v_dot2_f32_bf16 v204, v14, s56, v204
    v_dot2_f32_bf16 v205, v14, s57, v205
    v_dot2_f32_bf16 v206, v15, s56, v206
    v_dot2_f32_bf16 v207, v15, s57, v207
    v_dot2_f32_bf16 v200, v20, s56, v200
    v_dot2_f32_bf16 v201, v20, s57, v201
    v_dot2_f32_bf16 v202, v21, s56, v202
    v_dot2_f32_bf16 v203, v21, s57, v203
    v_dot2_f32_bf16 v204, v22, s56, v204
    v_dot2_f32_bf16 v205, v22, s57, v205
    v_dot2_f32_bf16 v206, v23, s56, v206
    v_dot2_f32_bf16 v207, v23, s57, v207
    v_dot2_f32_bf16 v200, v28, s56, v200
    v_dot2_f32_bf16 v201, v28, s57, v201
    v_dot2_f32_bf16 v202, v29, s56, v202
    v_dot2_f32_bf16 v203, v29, s57, v203
    v_dot2_f32_bf16 v204, v30, s56, v204
    v_dot2_f32_bf16 v205, v30, s57, v205
    v_dot2_f32_bf16 v206, v31, s56, v206
    v_dot2_f32_bf16 v207, v31, s57, v207
    v_dot2_f32_bf16 v200, v36, s56, v200
    v_dot2_f32_bf16 v201, v36, s57, v201
    v_dot2_f32_bf16 v202, v37, s56, v202
    v_dot2_f32_bf16 v203, v37, s57, v203
    v_dot2_f32_bf16 v204, v38, s56, v204
    v_dot2_f32_bf16 v205, v38, s57, v205
    v_dot2_f32_bf16 v206, v39, s56, v206
    v_dot2_f32_bf16 v207, v39, s57, v207
    v_dot2_f32_bf16 v200, v44, s56, v200
    v_dot2_f32_bf16 v201, v44, s57, v201
    v_dot2_f32_bf16 v202, v45, s56, v202
    v_dot2_f32_bf16 v203, v45, s57, v203
    v_dot2_f32_bf16 v204, v46, s56, v204
    v_dot2_f32_bf16 v205, v46, s57, v205
    v_dot2_f32_bf16 v206, v47, s56, v206
    v_dot2_f32_bf16 v207, v47, s57, v207
    v_dot2_f32_bf16 v200, v52, s56, v200
    v_dot2_f32_bf16 v201, v52, s57, v201
    v_dot2_f32_bf16 v202, v53, s56, v202
    v_dot2_f32_bf16 v203, v53, s57, v203
    v_dot2_f32_bf16 v204, v54, s56, v204
    v_dot2_f32_bf16 v205, v54, s57, v205
    v_dot2_f32_bf16 v206, v55, s56, v206
    v_dot2_f32_bf16 v207, v55, s57, v207
    v_dot2_f32_bf16 v200, v60, s56, v200
    v_dot2_f32_bf16 v201, v60, s57, v201
    v_dot2_f32_bf16 v202, v61, s56, v202
    v_dot2_f32_bf16 v203, v61, s57, v203
    v_dot2_f32_bf16 v204, v62, s56, v204
    v_dot2_f32_bf16 v205, v62, s57, v205
    v_dot2_f32_bf16 v206, v63, s56, v206
    v_dot2_f32_bf16 v207, v63, s57, v207
    v_dot2_f32_bf16 v208, v68, s56, 0
    v_dot2_f32_bf16 v209, v68, s57, 0
    v_dot2_f32_bf16 v210, v69, s56, 0
    v_dot2_f32_bf16 v211, v69, s57, 0
    v_dot2_f32_bf16 v212, v70, s56, 0
    v_dot2_f32_bf16 v213, v70, s57, 0
    v_dot2_f32_bf16 v214, v71, s56, 0
    v_dot2_f32_bf16 v215, v71, s57, 0
    v_dot2_f32_bf16 v208, v76, s56, v208
    v_dot2_f32_bf16 v209, v76, s57, v209
    v_dot2_f32_bf16 v210, v77, s56, v210
    v_dot2_f32_bf16 v211, v77, s57, v211
    v_dot2_f32_bf16 v212, v78, s56, v212
    v_dot2_f32_bf16 v213, v78, s57, v213
    v_dot2_f32_bf16 v214, v79, s56, v214
    v_dot2_f32_bf16 v215, v79, s57, v215
    v_dot2_f32_bf16 v208, v84, s56, v208
    v_dot2_f32_bf16 v209, v84, s57, v209
    v_dot2_f32_bf16 v210, v85, s56, v210
    v_dot2_f32_bf16 v211, v85, s57, v211
    v_dot2_f32_bf16 v212, v86, s56, v212
    v_dot2_f32_bf16 v213, v86, s57, v213
    v_dot2_f32_bf16 v214, v87, s56, v214
    v_dot2_f32_bf16 v215, v87, s57, v215
    v_dot2_f32_bf16 v208, v92, s56, v208
    v_dot2_f32_bf16 v209, v92, s57, v209
    v_dot2_f32_bf16 v210, v93, s56, v210
    v_dot2_f32_bf16 v211, v93, s57, v211
    v_dot2_f32_bf16 v212, v94, s56, v212
    v_dot2_f32_bf16 v213, v94, s57, v213
    v_dot2_f32_bf16 v214, v95, s56, v214
    v_dot2_f32_bf16 v215, v95, s57, v215
    v_dot2_f32_bf16 v208, v100, s56, v208
    v_dot2_f32_bf16 v209, v100, s57, v209
    v_dot2_f32_bf16 v210, v101, s56, v210
    v_dot2_f32_bf16 v211, v101, s57, v211
    v_dot2_f32_bf16 v212, v102, s56, v212
    v_dot2_f32_bf16 v213, v102, s57, v213
    v_dot2_f32_bf16 v214, v103, s56, v214
    v_dot2_f32_bf16 v215, v103, s57, v215
    v_dot2_f32_bf16 v208, v108, s56, v208
    v_dot2_f32_bf16 v209, v108, s57, v209
    v_dot2_f32_bf16 v210, v109, s56, v210
    v_dot2_f32_bf16 v211, v109, s57, v211
    v_dot2_f32_bf16 v212, v110, s56, v212
    v_dot2_f32_bf16 v213, v110, s57, v213
    v_dot2_f32_bf16 v214, v111, s56, v214
    v_dot2_f32_bf16 v215, v111, s57, v215
    v_dot2_f32_bf16 v208, v116, s56, v208
    v_dot2_f32_bf16 v209, v116, s57, v209
    v_dot2_f32_bf16 v210, v117, s56, v210
    v_dot2_f32_bf16 v211, v117, s57, v211
    v_dot2_f32_bf16 v212, v118, s56, v212
    v_dot2_f32_bf16 v213, v118, s57, v213
    v_dot2_f32_bf16 v214, v119, s56, v214
    v_dot2_f32_bf16 v215, v119, s57, v215
    v_dot2_f32_bf16 v208, v124, s56, v208
    v_dot2_f32_bf16 v209, v124, s57, v209
    v_dot2_f32_bf16 v210, v125, s56, v210
    v_dot2_f32_bf16 v211, v125, s57, v211
    v_dot2_f32_bf16 v212, v126, s56, v212
    v_dot2_f32_bf16 v213, v126, s57, v213
    v_dot2_f32_bf16 v214, v127, s56, v214
    v_dot2_f32_bf16 v215, v127, s57, v215
    v_mul_f32 v200, 0x42f5fdf0, v200
    v_mul_f32 v201, 0x42f5fdf0, v201
    v_mul_f32 v202, 0x42f5fdf0, v202
    v_mul_f32 v203, 0x42f5fdf0, v203
    v_mul_f32 v204, 0x42f5fdf0, v204
    v_mul_f32 v205, 0x42f5fdf0, v205
    v_mul_f32 v206, 0x42f5fdf0, v206
    v_mul_f32 v207, 0x42f5fdf0, v207
    v_mul_f32 v216, 0xbfb8aa3b, v200
    v_mul_f32 v217, 0xbfb8aa3b, v201
    v_mul_f32 v218, 0xbfb8aa3b, v202
    v_mul_f32 v219, 0xbfb8aa3b, v203
    v_mul_f32 v220, 0xbfb8aa3b, v204
    v_mul_f32 v221, 0xbfb8aa3b, v205
    v_mul_f32 v222, 0xbfb8aa3b, v206
    v_mul_f32 v223, 0xbfb8aa3b, v207
    v_exp_f32 v216, v216
    v_exp_f32 v217, v217
    v_exp_f32 v218, v218
    v_exp_f32 v219, v219
    v_exp_f32 v220, v220
    v_exp_f32 v221, v221
    v_exp_f32 v222, v222
    v_exp_f32 v223, v223
    v_add_f32 v216, 1.0, v216
    v_add_f32 v217, 1.0, v217
    v_add_f32 v218, 1.0, v218
    v_add_f32 v219, 1.0, v219
    v_add_f32 v220, 1.0, v220
    v_add_f32 v221, 1.0, v221
    v_add_f32 v222, 1.0, v222
    v_add_f32 v223, 1.0, v223
    v_rcp_f32 v216, v216
    v_rcp_f32 v217, v217
    v_rcp_f32 v218, v218
    v_rcp_f32 v219, v219
    v_rcp_f32 v220, v220
    v_rcp_f32 v221, v221
    v_rcp_f32 v222, v222
    v_rcp_f32 v223, v223
    v_mul_f32 v200, v200, v216
    v_mul_f32 v201, v201, v217
    v_mul_f32 v202, v202, v218
    v_mul_f32 v203, v203, v219
    v_mul_f32 v204, v204, v220
    v_mul_f32 v205, v205, v221
    v_mul_f32 v206, v206, v222
    v_mul_f32 v207, v207, v223
    v_mul_f32 v208, 0x42f5fdf0, v208
    v_mul_f32 v209, 0x42f5fdf0, v209
    v_mul_f32 v210, 0x42f5fdf0, v210
    v_mul_f32 v211, 0x42f5fdf0, v211
    v_mul_f32 v212, 0x42f5fdf0, v212
    v_mul_f32 v213, 0x42f5fdf0, v213
    v_mul_f32 v214, 0x42f5fdf0, v214
    v_mul_f32 v215, 0x42f5fdf0, v215
    v_mul_f32 v224, 0xbfb8aa3b, v208
    v_mul_f32 v225, 0xbfb8aa3b, v209
    v_mul_f32 v226, 0xbfb8aa3b, v210
    v_mul_f32 v227, 0xbfb8aa3b, v211
    v_mul_f32 v228, 0xbfb8aa3b, v212
    v_mul_f32 v229, 0xbfb8aa3b, v213
    v_mul_f32 v230, 0xbfb8aa3b, v214
    v_mul_f32 v231, 0xbfb8aa3b, v215
    v_exp_f32 v224, v224
    v_exp_f32 v225, v225
    v_exp_f32 v226, v226
    v_exp_f32 v227, v227
    v_exp_f32 v228, v228
    v_exp_f32 v229, v229
    v_exp_f32 v230, v230
    v_exp_f32 v231, v231
    v_add_f32 v224, 1.0, v224
    v_add_f32 v225, 1.0, v225
    v_add_f32 v226, 1.0, v226
    v_add_f32 v227, 1.0, v227
    v_add_f32 v228, 1.0, v228
    v_add_f32 v229, 1.0, v229
    v_add_f32 v230, 1.0, v230
    v_add_f32 v231, 1.0, v231
    v_rcp_f32 v224, v224
    v_rcp_f32 v225, v225
    v_rcp_f32 v226, v226
    v_rcp_f32 v227, v227
    v_rcp_f32 v228, v228
    v_rcp_f32 v229, v229
    v_rcp_f32 v230, v230
    v_rcp_f32 v231, v231
    v_mul_f32 v208, v208, v224
    v_mul_f32 v209, v209, v225
    v_mul_f32 v210, v210, v226
    v_mul_f32 v211, v211, v227
    v_mul_f32 v212, v212, v228
    v_mul_f32 v213, v213, v229
    v_mul_f32 v214, v214, v230
    v_mul_f32 v215, v215, v231
    s_mov_b32 s100, 0xffff0000
    s_cmp_eq_u32 s38, 3
    s_cselect_b32 s55, 0x70000000, s55
    s_waitcnt vmcnt(17)
    v_dot2_f32_bf16 v0, v128, s56, 0
    v_dot2_f32_bf16 v1, v128, s57, 0
    v_dot2_f32_bf16 v2, v129, s56, 0
    v_dot2_f32_bf16 v3, v129, s57, 0
    v_dot2_f32_bf16 v4, v130, s56, 0
    v_dot2_f32_bf16 v5, v130, s57, 0
    v_dot2_f32_bf16 v6, v131, s56, 0
    v_dot2_f32_bf16 v7, v131, s57, 0
    s_waitcnt vmcnt(16)
    v_dot2_f32_bf16 v0, v132, s56, v0
    v_dot2_f32_bf16 v1, v132, s57, v1
    v_dot2_f32_bf16 v2, v133, s56, v2
    v_dot2_f32_bf16 v3, v133, s57, v3
    v_dot2_f32_bf16 v4, v134, s56, v4
    v_dot2_f32_bf16 v5, v134, s57, v5
    v_dot2_f32_bf16 v6, v135, s56, v6
    v_dot2_f32_bf16 v7, v135, s57, v7
    s_waitcnt vmcnt(15)
    v_dot2_f32_bf16 v0, v136, s56, v0
    v_dot2_f32_bf16 v1, v136, s57, v1
    v_dot2_f32_bf16 v2, v137, s56, v2
    v_dot2_f32_bf16 v3, v137, s57, v3
    v_dot2_f32_bf16 v4, v138, s56, v4
    v_dot2_f32_bf16 v5, v138, s57, v5
    v_dot2_f32_bf16 v6, v139, s56, v6
    v_dot2_f32_bf16 v7, v139, s57, v7
    s_waitcnt vmcnt(14)
    v_dot2_f32_bf16 v0, v140, s56, v0
    v_dot2_f32_bf16 v1, v140, s57, v1
    v_dot2_f32_bf16 v2, v141, s56, v2
    v_dot2_f32_bf16 v3, v141, s57, v3
    v_dot2_f32_bf16 v4, v142, s56, v4
    v_dot2_f32_bf16 v5, v142, s57, v5
    v_dot2_f32_bf16 v6, v143, s56, v6
    v_dot2_f32_bf16 v7, v143, s57, v7
    s_waitcnt vmcnt(13)
    v_dot2_f32_bf16 v0, v144, s56, v0
    v_dot2_f32_bf16 v1, v144, s57, v1
    v_dot2_f32_bf16 v2, v145, s56, v2
    v_dot2_f32_bf16 v3, v145, s57, v3
    v_dot2_f32_bf16 v4, v146, s56, v4
    v_dot2_f32_bf16 v5, v146, s57, v5
    v_dot2_f32_bf16 v6, v147, s56, v6
    v_dot2_f32_bf16 v7, v147, s57, v7
    s_waitcnt vmcnt(12)
    v_dot2_f32_bf16 v0, v148, s56, v0
    v_dot2_f32_bf16 v1, v148, s57, v1
    v_dot2_f32_bf16 v2, v149, s56, v2
    v_dot2_f32_bf16 v3, v149, s57, v3
    v_dot2_f32_bf16 v4, v150, s56, v4
    v_dot2_f32_bf16 v5, v150, s57, v5
    v_dot2_f32_bf16 v6, v151, s56, v6
    v_dot2_f32_bf16 v7, v151, s57, v7
    s_waitcnt vmcnt(11)
    v_dot2_f32_bf16 v0, v152, s56, v0
    v_dot2_f32_bf16 v1, v152, s57, v1
    v_dot2_f32_bf16 v2, v153, s56, v2
    v_dot2_f32_bf16 v3, v153, s57, v3
    v_dot2_f32_bf16 v4, v154, s56, v4
    v_dot2_f32_bf16 v5, v154, s57, v5
    v_dot2_f32_bf16 v6, v155, s56, v6
    v_dot2_f32_bf16 v7, v155, s57, v7
    s_waitcnt vmcnt(10)
    v_dot2_f32_bf16 v0, v156, s56, v0
    v_dot2_f32_bf16 v1, v156, s57, v1
    v_dot2_f32_bf16 v2, v157, s56, v2
    v_dot2_f32_bf16 v3, v157, s57, v3
    v_dot2_f32_bf16 v4, v158, s56, v4
    v_dot2_f32_bf16 v5, v158, s57, v5
    v_dot2_f32_bf16 v6, v159, s56, v6
    v_dot2_f32_bf16 v7, v159, s57, v7
    v_mul_f32 v0, v0, v200
    v_mul_f32 v1, v1, v201
    v_mul_f32 v2, v2, v202
    v_mul_f32 v3, v3, v203
    v_mul_f32 v4, v4, v204
    v_mul_f32 v5, v5, v205
    v_mul_f32 v6, v6, v206
    v_mul_f32 v7, v7, v207
    v_cvt_pk_bf16_f32 v16, v0, v1
    v_cvt_pk_bf16_f32 v17, v2, v3
    v_cvt_pk_bf16_f32 v18, v4, v5
    v_cvt_pk_bf16_f32 v19, v6, v7
    s_nop 0
    v_permlane32_swap_b32 v16, v18
    v_permlane32_swap_b32 v17, v19
    s_nop 0
    v_permlane16_swap_b32 v16, v18
    v_permlane16_swap_b32 v17, v19
    v_lshlrev_b32 v24, 16, v16
    v_and_b32 v25, s100, v16
    s_waitcnt vmcnt(1)
    v_lshlrev_b32 v32, 16, v192
    v_and_b32 v33, s100, v192
    v_lshlrev_b32 v26, 16, v17
    v_and_b32 v27, s100, v17
    v_lshlrev_b32 v34, 16, v193
    v_and_b32 v35, s100, v193
    v_lshlrev_b32 v28, 16, v18
    v_and_b32 v29, s100, v18
    v_lshlrev_b32 v36, 16, v194
    v_and_b32 v37, s100, v194
    v_lshlrev_b32 v30, 16, v19
    v_and_b32 v31, s100, v19
    v_lshlrev_b32 v38, 16, v195
    v_and_b32 v39, s100, v195
    v_add_f32 v24, v24, v32
    v_add_f32 v25, v25, v33
    v_add_f32 v26, v26, v34
    v_add_f32 v27, v27, v35
    v_add_f32 v28, v28, v36
    v_add_f32 v29, v29, v37
    v_add_f32 v30, v30, v38
    v_add_f32 v31, v31, v39
    v_cvt_pk_bf16_f32 v16, v24, v25
    v_cvt_pk_bf16_f32 v17, v26, v27
    v_cvt_pk_bf16_f32 v18, v28, v29
    v_cvt_pk_bf16_f32 v19, v30, v31
    buffer_store_dwordx4 v[16:19], v232, s[20:23], s54 offen offset:0
    v_dot2_f32_bf16 v8, v160, s56, 0
    v_dot2_f32_bf16 v9, v160, s57, 0
    v_dot2_f32_bf16 v10, v161, s56, 0
    v_dot2_f32_bf16 v11, v161, s57, 0
    v_dot2_f32_bf16 v12, v162, s56, 0
    v_dot2_f32_bf16 v13, v162, s57, 0
    v_dot2_f32_bf16 v14, v163, s56, 0
    v_dot2_f32_bf16 v15, v163, s57, 0
    v_dot2_f32_bf16 v8, v164, s56, v8
    v_dot2_f32_bf16 v9, v164, s57, v9
    v_dot2_f32_bf16 v10, v165, s56, v10
    v_dot2_f32_bf16 v11, v165, s57, v11
    v_dot2_f32_bf16 v12, v166, s56, v12
    v_dot2_f32_bf16 v13, v166, s57, v13
    v_dot2_f32_bf16 v14, v167, s56, v14
    v_dot2_f32_bf16 v15, v167, s57, v15
    v_dot2_f32_bf16 v8, v168, s56, v8
    v_dot2_f32_bf16 v9, v168, s57, v9
    v_dot2_f32_bf16 v10, v169, s56, v10
    v_dot2_f32_bf16 v11, v169, s57, v11
    v_dot2_f32_bf16 v12, v170, s56, v12
    v_dot2_f32_bf16 v13, v170, s57, v13
    v_dot2_f32_bf16 v14, v171, s56, v14
    v_dot2_f32_bf16 v15, v171, s57, v15
    v_dot2_f32_bf16 v8, v172, s56, v8
    v_dot2_f32_bf16 v9, v172, s57, v9
    v_dot2_f32_bf16 v10, v173, s56, v10
    v_dot2_f32_bf16 v11, v173, s57, v11
    v_dot2_f32_bf16 v12, v174, s56, v12
    v_dot2_f32_bf16 v13, v174, s57, v13
    v_dot2_f32_bf16 v14, v175, s56, v14
    v_dot2_f32_bf16 v15, v175, s57, v15
    v_dot2_f32_bf16 v8, v176, s56, v8
    v_dot2_f32_bf16 v9, v176, s57, v9
    v_dot2_f32_bf16 v10, v177, s56, v10
    v_dot2_f32_bf16 v11, v177, s57, v11
    v_dot2_f32_bf16 v12, v178, s56, v12
    v_dot2_f32_bf16 v13, v178, s57, v13
    v_dot2_f32_bf16 v14, v179, s56, v14
    v_dot2_f32_bf16 v15, v179, s57, v15
    v_dot2_f32_bf16 v8, v180, s56, v8
    v_dot2_f32_bf16 v9, v180, s57, v9
    v_dot2_f32_bf16 v10, v181, s56, v10
    v_dot2_f32_bf16 v11, v181, s57, v11
    v_dot2_f32_bf16 v12, v182, s56, v12
    v_dot2_f32_bf16 v13, v182, s57, v13
    v_dot2_f32_bf16 v14, v183, s56, v14
    v_dot2_f32_bf16 v15, v183, s57, v15
    v_dot2_f32_bf16 v8, v184, s56, v8
    v_dot2_f32_bf16 v9, v184, s57, v9
    v_dot2_f32_bf16 v10, v185, s56, v10
    v_dot2_f32_bf16 v11, v185, s57, v11
    v_dot2_f32_bf16 v12, v186, s56, v12
    v_dot2_f32_bf16 v13, v186, s57, v13
    v_dot2_f32_bf16 v14, v187, s56, v14
    v_dot2_f32_bf16 v15, v187, s57, v15
    v_dot2_f32_bf16 v8, v188, s56, v8
    v_dot2_f32_bf16 v9, v188, s57, v9
    v_dot2_f32_bf16 v10, v189, s56, v10
    v_dot2_f32_bf16 v11, v189, s57, v11
    v_dot2_f32_bf16 v12, v190, s56, v12
    v_dot2_f32_bf16 v13, v190, s57, v13
    v_dot2_f32_bf16 v14, v191, s56, v14
    v_dot2_f32_bf16 v15, v191, s57, v15
    v_mul_f32 v8, v8, v208
    v_mul_f32 v9, v9, v209
    v_mul_f32 v10, v10, v210
    v_mul_f32 v11, v11, v211
    v_mul_f32 v12, v12, v212
    v_mul_f32 v13, v13, v213
    v_mul_f32 v14, v14, v214
    v_mul_f32 v15, v15, v215
    v_cvt_pk_bf16_f32 v20, v8, v9
    v_cvt_pk_bf16_f32 v21, v10, v11
    v_cvt_pk_bf16_f32 v22, v12, v13
    v_cvt_pk_bf16_f32 v23, v14, v15
    s_nop 0
    v_permlane32_swap_b32 v20, v22
    v_permlane32_swap_b32 v21, v23
    s_nop 0
    v_permlane16_swap_b32 v20, v22
    v_permlane16_swap_b32 v21, v23
    v_lshlrev_b32 v40, 16, v20
    v_and_b32 v41, s100, v20
    s_waitcnt vmcnt(1)
    v_lshlrev_b32 v48, 16, v196
    v_and_b32 v49, s100, v196
    v_lshlrev_b32 v42, 16, v21
    v_and_b32 v43, s100, v21
    v_lshlrev_b32 v50, 16, v197
    v_and_b32 v51, s100, v197
    v_lshlrev_b32 v44, 16, v22
    v_and_b32 v45, s100, v22
    v_lshlrev_b32 v52, 16, v198
    v_and_b32 v53, s100, v198
    v_lshlrev_b32 v46, 16, v23
    v_and_b32 v47, s100, v23
    v_lshlrev_b32 v54, 16, v199
    v_and_b32 v55, s100, v199
    v_add_f32 v40, v40, v48
    v_add_f32 v41, v41, v49
    v_add_f32 v42, v42, v50
    v_add_f32 v43, v43, v51
    v_add_f32 v44, v44, v52
    v_add_f32 v45, v45, v53
    v_add_f32 v46, v46, v54
    v_add_f32 v47, v47, v55
    v_cvt_pk_bf16_f32 v20, v40, v41
    v_cvt_pk_bf16_f32 v21, v42, v43
    v_cvt_pk_bf16_f32 v22, v44, v45
    v_cvt_pk_bf16_f32 v23, v46, v47
    buffer_store_dwordx4 v[20:23], v232, s[20:23], s55 offen offset:0
    s_waitcnt vmcnt(0)
L_main_end:
    s_endpgm
L_slow_1:
    s_call_b64 s[64:65], L_slowsub_1
    s_branch L_back_1
L_slow_2:
    s_call_b64 s[64:65], L_slowsub_0
    s_branch L_back_2
L_slow_3:
    s_call_b64 s[64:65], L_slowsub_1
    s_branch L_back_3
L_slow_4:
    s_call_b64 s[64:65], L_slowsub_0
    s_branch L_back_4
L_slow_5:
    s_call_b64 s[64:65], L_slowsub_1
    s_branch L_back_5
L_slow_6:
    s_call_b64 s[64:65], L_slowsub_0
    s_branch L_back_6
L_slow_7:
    s_call_b64 s[64:65], L_slowsub_1
    s_branch L_back_7
L_slow_8:
    s_call_b64 s[64:65], L_slowsub_0
    s_branch L_back_8
L_slow_9:
    s_call_b64 s[64:65], L_slowsub_1
    s_branch L_back_9
L_slow_10:
    s_call_b64 s[64:65], L_slowsub_0
    s_branch L_back_10
L_slow_11:
    s_call_b64 s[64:65], L_slowsub_1
    s_branch L_back_11
L_slow_12:
    s_call_b64 s[64:65], L_slowsub_0
    s_branch L_back_12
L_slow_13:
    s_call_b64 s[64:65], L_slowsub_1
    s_branch L_back_13
L_slow_14:
    s_call_b64 s[64:65], L_slowsub_0
    s_branch L_back_14
L_slow_15:
    s_call_b64 s[64:65], L_slowsub_1
    s_branch L_back_15
L_slowsub_0:
    s_nop 15
    v_max3_f32 v184, v128, v129, v130
    v_max3_f32 v184, v184, v131, v132
    v_max3_f32 v184, v184, v133, v134
    v_max_f32 v184, v184, v135
    v_mov_b32 v186, v184
    s_nop 0
    s_nop 0
    v_permlane16_swap_b32 v184, v186
    s_nop 0
    v_max_f32 v184, v184, v186
    v_mov_b32 v186, v184
    s_nop 0
    s_nop 0
    v_permlane32_swap_b32 v184, v186
    s_nop 0
    v_max_f32 v184, v184, v186
    v_max_f32 v184, 0, v184
    v_max3_f32 v185, v136, v137, v138
    v_max3_f32 v185, v185, v139, v140
    v_max3_f32 v185, v185, v141, v142
    v_max_f32 v185, v185, v143
    v_mov_b32 v186, v185
    s_nop 0
    s_nop 0
    v_permlane16_swap_b32 v185, v186
    s_nop 0
    v_max_f32 v185, v185, v186
    v_mov_b32 v186, v185
    s_nop 0
    s_nop 0
    v_permlane32_swap_b32 v185, v186
    s_nop 0
    v_max_f32 v185, v185, v186
    v_max_f32 v185, 0, v185
    v_sub_f32 v186, 0, v184
    v_exp_f32 v186, v186
    v_sub_f32 v176, v176, v184
    v_sub_f32 v177, v177, v184
    v_sub_f32 v178, v178, v184
    v_sub_f32 v179, v179, v184
    v_sub_f32 v128, v128, v184
    v_sub_f32 v129, v129, v184
    v_sub_f32 v130, v130, v184
    v_sub_f32 v131, v131, v184
    v_sub_f32 v132, v132, v184
    v_sub_f32 v133, v133, v184
    v_sub_f32 v134, v134, v184
    v_sub_f32 v135, v135, v184
    v_sub_f32 v144, v144, v184
    v_sub_f32 v145, v145, v184
    v_sub_f32 v146, v146, v184
    v_sub_f32 v147, v147, v184
    v_sub_f32 v148, v148, v184
    v_sub_f32 v149, v149, v184
    v_sub_f32 v150, v150, v184
    v_sub_f32 v151, v151, v184
    v_mul_f32 v192, v192, v186
    v_mul_f32 v0, v0, v186
    v_mul_f32 v1, v1, v186
    v_mul_f32 v2, v2, v186
    v_mul_f32 v3, v3, v186
    v_mul_f32 v4, v4, v186
    v_mul_f32 v5, v5, v186
    v_mul_f32 v6, v6, v186
    v_mul_f32 v7, v7, v186
    v_mul_f32 v16, v16, v186
    v_mul_f32 v17, v17, v186
    v_mul_f32 v18, v18, v186
    v_mul_f32 v19, v19, v186
    v_mul_f32 v20, v20, v186
    v_mul_f32 v21, v21, v186
    v_mul_f32 v22, v22, v186
    v_mul_f32 v23, v23, v186
    v_mul_f32 v32, v32, v186
    v_mul_f32 v33, v33, v186
    v_mul_f32 v34, v34, v186
    v_mul_f32 v35, v35, v186
    v_mul_f32 v36, v36, v186
    v_mul_f32 v37, v37, v186
    v_mul_f32 v38, v38, v186
    v_mul_f32 v39, v39, v186
    v_mul_f32 v48, v48, v186
    v_mul_f32 v49, v49, v186
    v_mul_f32 v50, v50, v186
    v_mul_f32 v51, v51, v186
    v_mul_f32 v52, v52, v186
    v_mul_f32 v53, v53, v186
    v_mul_f32 v54, v54, v186
    v_mul_f32 v55, v55, v186
    v_mul_f32 v64, v64, v186
    v_mul_f32 v65, v65, v186
    v_mul_f32 v66, v66, v186
    v_mul_f32 v67, v67, v186
    v_mul_f32 v68, v68, v186
    v_mul_f32 v69, v69, v186
    v_mul_f32 v70, v70, v186
    v_mul_f32 v71, v71, v186
    v_mul_f32 v80, v80, v186
    v_mul_f32 v81, v81, v186
    v_mul_f32 v82, v82, v186
    v_mul_f32 v83, v83, v186
    v_mul_f32 v84, v84, v186
    v_mul_f32 v85, v85, v186
    v_mul_f32 v86, v86, v186
    v_mul_f32 v87, v87, v186
    v_mul_f32 v96, v96, v186
    v_mul_f32 v97, v97, v186
    v_mul_f32 v98, v98, v186
    v_mul_f32 v99, v99, v186
    v_mul_f32 v100, v100, v186
    v_mul_f32 v101, v101, v186
    v_mul_f32 v102, v102, v186
    v_mul_f32 v103, v103, v186
    v_mul_f32 v112, v112, v186
    v_mul_f32 v113, v113, v186
    v_mul_f32 v114, v114, v186
    v_mul_f32 v115, v115, v186
    v_mul_f32 v116, v116, v186
    v_mul_f32 v117, v117, v186
    v_mul_f32 v118, v118, v186
    v_mul_f32 v119, v119, v186
    v_sub_f32 v187, 0, v185
    v_exp_f32 v187, v187
    v_sub_f32 v180, v180, v185
    v_sub_f32 v181, v181, v185
    v_sub_f32 v182, v182, v185
    v_sub_f32 v183, v183, v185
    v_sub_f32 v136, v136, v185
    v_sub_f32 v137, v137, v185
    v_sub_f32 v138, v138, v185
    v_sub_f32 v139, v139, v185
    v_sub_f32 v140, v140, v185
    v_sub_f32 v141, v141, v185
    v_sub_f32 v142, v142, v185
    v_sub_f32 v143, v143, v185
    v_sub_f32 v152, v152, v185
    v_sub_f32 v153, v153, v185
    v_sub_f32 v154, v154, v185
    v_sub_f32 v155, v155, v185
    v_sub_f32 v156, v156, v185
    v_sub_f32 v157, v157, v185
    v_sub_f32 v158, v158, v185
    v_sub_f32 v159, v159, v185
    v_mul_f32 v193, v193, v187
    v_mul_f32 v8, v8, v187
    v_mul_f32 v9, v9, v187
    v_mul_f32 v10, v10, v187
    v_mul_f32 v11, v11, v187
    v_mul_f32 v12, v12, v187
    v_mul_f32 v13, v13, v187
    v_mul_f32 v14, v14, v187
    v_mul_f32 v15, v15, v187
    v_mul_f32 v24, v24, v187
    v_mul_f32 v25, v25, v187
    v_mul_f32 v26, v26, v187
    v_mul_f32 v27, v27, v187
    v_mul_f32 v28, v28, v187
    v_mul_f32 v29, v29, v187
    v_mul_f32 v30, v30, v187
    v_mul_f32 v31, v31, v187
    v_mul_f32 v40, v40, v187
    v_mul_f32 v41, v41, v187
    v_mul_f32 v42, v42, v187
    v_mul_f32 v43, v43, v187
    v_mul_f32 v44, v44, v187
    v_mul_f32 v45, v45, v187
    v_mul_f32 v46, v46, v187
    v_mul_f32 v47, v47, v187
    v_mul_f32 v56, v56, v187
    v_mul_f32 v57, v57, v187
    v_mul_f32 v58, v58, v187
    v_mul_f32 v59, v59, v187
    v_mul_f32 v60, v60, v187
    v_mul_f32 v61, v61, v187
    v_mul_f32 v62, v62, v187
    v_mul_f32 v63, v63, v187
    v_mul_f32 v72, v72, v187
    v_mul_f32 v73, v73, v187
    v_mul_f32 v74, v74, v187
    v_mul_f32 v75, v75, v187
    v_mul_f32 v76, v76, v187
    v_mul_f32 v77, v77, v187
    v_mul_f32 v78, v78, v187
    v_mul_f32 v79, v79, v187
    v_mul_f32 v88, v88, v187
    v_mul_f32 v89, v89, v187
    v_mul_f32 v90, v90, v187
    v_mul_f32 v91, v91, v187
    v_mul_f32 v92, v92, v187
    v_mul_f32 v93, v93, v187
    v_mul_f32 v94, v94, v187
    v_mul_f32 v95, v95, v187
    v_mul_f32 v104, v104, v187
    v_mul_f32 v105, v105, v187
    v_mul_f32 v106, v106, v187
    v_mul_f32 v107, v107, v187
    v_mul_f32 v108, v108, v187
    v_mul_f32 v109, v109, v187
    v_mul_f32 v110, v110, v187
    v_mul_f32 v111, v111, v187
    v_mul_f32 v120, v120, v187
    v_mul_f32 v121, v121, v187
    v_mul_f32 v122, v122, v187
    v_mul_f32 v123, v123, v187
    v_mul_f32 v124, v124, v187
    v_mul_f32 v125, v125, v187
    v_mul_f32 v126, v126, v187
    v_mul_f32 v127, v127, v187
    v_exp_f32 v184, v128
    v_exp_f32 v185, v129
    v_exp_f32 v186, v130
    v_exp_f32 v187, v131
    v_add_f32 v194, v184, v185
    v_cvt_pk_bf16_f32 v160, v184, v185
    v_add_f32 v194, v194, v186
    v_cvt_pk_bf16_f32 v161, v186, v187
    v_add_f32 v194, v194, v187
    v_exp_f32 v188, v132
    v_exp_f32 v189, v133
    v_exp_f32 v190, v134
    v_exp_f32 v191, v135
    v_add_f32 v194, v194, v188
    v_cvt_pk_bf16_f32 v162, v188, v189
    v_add_f32 v194, v194, v189
    v_add_f32 v194, v194, v190
    v_cvt_pk_bf16_f32 v163, v190, v191
    v_add_f32 v194, v194, v191
    v_exp_f32 v184, v136
    v_exp_f32 v185, v137
    v_exp_f32 v186, v138
    v_exp_f32 v187, v139
    v_add_f32 v195, v184, v185
    v_cvt_pk_bf16_f32 v164, v184, v185
    v_add_f32 v195, v195, v186
    v_cvt_pk_bf16_f32 v165, v186, v187
    v_add_f32 v195, v195, v187
    v_exp_f32 v188, v140
    v_exp_f32 v189, v141
    v_exp_f32 v190, v142
    v_exp_f32 v191, v143
    v_add_f32 v195, v195, v188
    v_cvt_pk_bf16_f32 v166, v188, v189
    v_add_f32 v195, v195, v189
    v_add_f32 v195, v195, v190
    v_cvt_pk_bf16_f32 v167, v190, v191
    v_add_f32 v195, v195, v191
    s_nop 3
    s_setpc_b64 s[64:65]
L_slowsub_1:
    s_nop 15
    v_max3_f32 v184, v144, v145, v146
    v_max3_f32 v184, v184, v147, v148
    v_max3_f32 v184, v184, v149, v150
    v_max_f32 v184, v184, v151
    v_mov_b32 v186, v184
    s_nop 0
    s_nop 0
    v_permlane16_swap_b32 v184, v186
    s_nop 0
    v_max_f32 v184, v184, v186
    v_mov_b32 v186, v184
    s_nop 0
    s_nop 0
    v_permlane32_swap_b32 v184, v186
    s_nop 0
    v_max_f32 v184, v184, v186
    v_max_f32 v184, 0, v184
    v_max3_f32 v185, v152, v153, v154
    v_max3_f32 v185, v185, v155, v156
    v_max3_f32 v185, v185, v157, v158
    v_max_f32 v185, v185, v159
    v_mov_b32 v186, v185
    s_nop 0
    s_nop 0
    v_permlane16_swap_b32 v185, v186
    s_nop 0
    v_max_f32 v185, v185, v186
    v_mov_b32 v186, v185
    s_nop 0
    s_nop 0
    v_permlane32_swap_b32 v185, v186
    s_nop 0
    v_max_f32 v185, v185, v186
    v_max_f32 v185, 0, v185
    v_sub_f32 v186, 0, v184
    v_exp_f32 v186, v186
    v_sub_f32 v176, v176, v184
    v_sub_f32 v177, v177, v184
    v_sub_f32 v178, v178, v184
    v_sub_f32 v179, v179, v184
    v_sub_f32 v144, v144, v184
    v_sub_f32 v145, v145, v184
    v_sub_f32 v146, v146, v184
    v_sub_f32 v147, v147, v184
    v_sub_f32 v148, v148, v184
    v_sub_f32 v149, v149, v184
    v_sub_f32 v150, v150, v184
    v_sub_f32 v151, v151, v184
    v_sub_f32 v128, v128, v184
    v_sub_f32 v129, v129, v184
    v_sub_f32 v130, v130, v184
    v_sub_f32 v131, v131, v184
    v_sub_f32 v132, v132, v184
    v_sub_f32 v133, v133, v184
    v_sub_f32 v134, v134, v184
    v_sub_f32 v135, v135, v184
    v_mul_f32 v192, v192, v186
    v_mul_f32 v0, v0, v186
    v_mul_f32 v1, v1, v186
    v_mul_f32 v2, v2, v186
    v_mul_f32 v3, v3, v186
    v_mul_f32 v4, v4, v186
    v_mul_f32 v5, v5, v186
    v_mul_f32 v6, v6, v186
    v_mul_f32 v7, v7, v186
    v_mul_f32 v16, v16, v186
    v_mul_f32 v17, v17, v186
    v_mul_f32 v18, v18, v186
    v_mul_f32 v19, v19, v186
    v_mul_f32 v20, v20, v186
    v_mul_f32 v21, v21, v186
    v_mul_f32 v22, v22, v186
    v_mul_f32 v23, v23, v186
    v_mul_f32 v32, v32, v186
    v_mul_f32 v33, v33, v186
    v_mul_f32 v34, v34, v186
    v_mul_f32 v35, v35, v186
    v_mul_f32 v36, v36, v186
    v_mul_f32 v37, v37, v186
    v_mul_f32 v38, v38, v186
    v_mul_f32 v39, v39, v186
    v_mul_f32 v48, v48, v186
    v_mul_f32 v49, v49, v186
    v_mul_f32 v50, v50, v186
    v_mul_f32 v51, v51, v186
    v_mul_f32 v52, v52, v186
    v_mul_f32 v53, v53, v186
    v_mul_f32 v54, v54, v186
    v_mul_f32 v55, v55, v186
    v_mul_f32 v64, v64, v186
    v_mul_f32 v65, v65, v186
    v_mul_f32 v66, v66, v186
    v_mul_f32 v67, v67, v186
    v_mul_f32 v68, v68, v186
    v_mul_f32 v69, v69, v186
    v_mul_f32 v70, v70, v186
    v_mul_f32 v71, v71, v186
    v_mul_f32 v80, v80, v186
    v_mul_f32 v81, v81, v186
    v_mul_f32 v82, v82, v186
    v_mul_f32 v83, v83, v186
    v_mul_f32 v84, v84, v186
    v_mul_f32 v85, v85, v186
    v_mul_f32 v86, v86, v186
    v_mul_f32 v87, v87, v186
    v_mul_f32 v96, v96, v186
    v_mul_f32 v97, v97, v186
    v_mul_f32 v98, v98, v186
    v_mul_f32 v99, v99, v186
    v_mul_f32 v100, v100, v186
    v_mul_f32 v101, v101, v186
    v_mul_f32 v102, v102, v186
    v_mul_f32 v103, v103, v186
    v_mul_f32 v112, v112, v186
    v_mul_f32 v113, v113, v186
    v_mul_f32 v114, v114, v186
    v_mul_f32 v115, v115, v186
    v_mul_f32 v116, v116, v186
    v_mul_f32 v117, v117, v186
    v_mul_f32 v118, v118, v186
    v_mul_f32 v119, v119, v186
    v_sub_f32 v187, 0, v185
    v_exp_f32 v187, v187
    v_sub_f32 v180, v180, v185
    v_sub_f32 v181, v181, v185
    v_sub_f32 v182, v182, v185
    v_sub_f32 v183, v183, v185
    v_sub_f32 v152, v152, v185
    v_sub_f32 v153, v153, v185
    v_sub_f32 v154, v154, v185
    v_sub_f32 v155, v155, v185
    v_sub_f32 v156, v156, v185
    v_sub_f32 v157, v157, v185
    v_sub_f32 v158, v158, v185
    v_sub_f32 v159, v159, v185
    v_sub_f32 v136, v136, v185
    v_sub_f32 v137, v137, v185
    v_sub_f32 v138, v138, v185
    v_sub_f32 v139, v139, v185
    v_sub_f32 v140, v140, v185
    v_sub_f32 v141, v141, v185
    v_sub_f32 v142, v142, v185
    v_sub_f32 v143, v143, v185
    v_mul_f32 v193, v193, v187
    v_mul_f32 v8, v8, v187
    v_mul_f32 v9, v9, v187
    v_mul_f32 v10, v10, v187
    v_mul_f32 v11, v11, v187
    v_mul_f32 v12, v12, v187
    v_mul_f32 v13, v13, v187
    v_mul_f32 v14, v14, v187
    v_mul_f32 v15, v15, v187
    v_mul_f32 v24, v24, v187
    v_mul_f32 v25, v25, v187
    v_mul_f32 v26, v26, v187
    v_mul_f32 v27, v27, v187
    v_mul_f32 v28, v28, v187
    v_mul_f32 v29, v29, v187
    v_mul_f32 v30, v30, v187
    v_mul_f32 v31, v31, v187
    v_mul_f32 v40, v40, v187
    v_mul_f32 v41, v41, v187
    v_mul_f32 v42, v42, v187
    v_mul_f32 v43, v43, v187
    v_mul_f32 v44, v44, v187
    v_mul_f32 v45, v45, v187
    v_mul_f32 v46, v46, v187
    v_mul_f32 v47, v47, v187
    v_mul_f32 v56, v56, v187
    v_mul_f32 v57, v57, v187
    v_mul_f32 v58, v58, v187
    v_mul_f32 v59, v59, v187
    v_mul_f32 v60, v60, v187
    v_mul_f32 v61, v61, v187
    v_mul_f32 v62, v62, v187
    v_mul_f32 v63, v63, v187
    v_mul_f32 v72, v72, v187
    v_mul_f32 v73, v73, v187
    v_mul_f32 v74, v74, v187
    v_mul_f32 v75, v75, v187
    v_mul_f32 v76, v76, v187
    v_mul_f32 v77, v77, v187
    v_mul_f32 v78, v78, v187
    v_mul_f32 v79, v79, v187
    v_mul_f32 v88, v88, v187
    v_mul_f32 v89, v89, v187
    v_mul_f32 v90, v90, v187
    v_mul_f32 v91, v91, v187
    v_mul_f32 v92, v92, v187
    v_mul_f32 v93, v93, v187
    v_mul_f32 v94, v94, v187
    v_mul_f32 v95, v95, v187
    v_mul_f32 v104, v104, v187
    v_mul_f32 v105, v105, v187
    v_mul_f32 v106, v106, v187
    v_mul_f32 v107, v107, v187
    v_mul_f32 v108, v108, v187
    v_mul_f32 v109, v109, v187
    v_mul_f32 v110, v110, v187
    v_mul_f32 v111, v111, v187
    v_mul_f32 v120, v120, v187
    v_mul_f32 v121, v121, v187
    v_mul_f32 v122, v122, v187
    v_mul_f32 v123, v123, v187
    v_mul_f32 v124, v124, v187
    v_mul_f32 v125, v125, v187
    v_mul_f32 v126, v126, v187
    v_mul_f32 v127, v127, v187
    v_exp_f32 v184, v144
    v_exp_f32 v185, v145
    v_exp_f32 v186, v146
    v_exp_f32 v187, v147
    v_add_f32 v194, v184, v185
    v_cvt_pk_bf16_f32 v168, v184, v185
    v_add_f32 v194, v194, v186
    v_cvt_pk_bf16_f32 v169, v186, v187
    v_add_f32 v194, v194, v187
    v_exp_f32 v188, v148
    v_exp_f32 v189, v149
    v_exp_f32 v190, v150
    v_exp_f32 v191, v151
    v_add_f32 v194, v194, v188
    v_cvt_pk_bf16_f32 v170, v188, v189
    v_add_f32 v194, v194, v189
    v_add_f32 v194, v194, v190
    v_cvt_pk_bf16_f32 v171, v190, v191
    v_add_f32 v194, v194, v191
    v_exp_f32 v184, v152
    v_exp_f32 v185, v153
    v_exp_f32 v186, v154
    v_exp_f32 v187, v155
    v_add_f32 v195, v184, v185
    v_cvt_pk_bf16_f32 v172, v184, v185
    v_add_f32 v195, v195, v186
    v_cvt_pk_bf16_f32 v173, v186, v187
    v_add_f32 v195, v195, v187
    v_exp_f32 v188, v156
    v_exp_f32 v189, v157
    v_exp_f32 v190, v158
    v_exp_f32 v191, v159
    v_add_f32 v195, v195, v188
    v_cvt_pk_bf16_f32 v174, v188, v189
    v_add_f32 v195, v195, v189
    v_add_f32 v195, v195, v190
    v_cvt_pk_bf16_f32 v175, v190, v191
    v_add_f32 v195, v195, v191
    s_nop 3
    s_setpc_b64 s[64:65]
L_gspin:
    s_mov_b32 s99, 200000
L_gspin_loop:
    s_lshl_b32 s100, s37, 3
    v_mov_b32 v254, 0
    buffer_load_dwordx2 v[242:243], v254, s[12:15], s100 offen sc1
    s_waitcnt vmcnt(0)
    v_lshrrev_b32 v252, 1, v242
    v_lshrrev_b32 v253, 1, v243
    v_or_b32 v252, v252, v242
    v_or_b32 v253, v253, v243
    v_and_b32 v252, v252, v253
    v_and_b32 v252, 0x01010101, v252
    v_cmp_eq_u32 vcc, 0x01010101, v252
    s_nop 4
    s_cbranch_vccnz L_gback
    s_sub_u32 s99, s99, 1
    s_cmp_lg_u32 s99, 0
    s_cbranch_scc1 L_gspin_loop
    s_branch L_gback
L_main_code_end:
L_all_code_end:
.section .rodata,"a"
.p2align 6
.amdhsa_kernel recurrent_scan__sliding_block_cached__glu_gated_geglu__prompt_kernel
  .amdhsa_next_free_vgpr 512
  .amdhsa_next_free_sgpr 102
  .amdhsa_accum_offset 256
  .amdhsa_group_segment_fixed_size 0
  .amdhsa_kernarg_size 96
  .amdhsa_user_sgpr_count 2
  .amdhsa_user_sgpr_kernarg_segment_ptr 1
  .amdhsa_system_sgpr_workgroup_id_x 1
  .amdhsa_float_denorm_mode_32 3
.end_amdhsa_kernel
```
